```python
import torch

def _softmax(x, axis=-1):
    return torch.softmax(x, dim=axis)

def _gelu(x):
    return torch.nn.functional.gelu(x, approximate='tanh')

def _silu(x):
    return torch.nn.functional.silu(x)

def _sigmoid(x):
    return torch.sigmoid(x)

def _layernorm(x, axis=-1, eps=1e-05):
    m = x.mean(dim=axis, keepdim=True)
    v = x.var(dim=axis, keepdim=True, unbiased=False)
    return (x - m) / torch.sqrt(v + eps)

def _scatter_add(tgt, idx, src, axis=0):
    return tgt.clone().index_add_(axis, idx, src)

def _segment_sum(src, seg, n):
    out = torch.zeros((n,) + src.shape[1:], dtype=src.dtype)
    return out.index_add_(0, seg, src)

def _pad(x, pw):
    flat = tuple((v for pair in reversed(pw) for v in pair))
    return torch.nn.functional.pad(x, flat)
kernel_name = 'interleave_layers__memory_aug_recurrent_mem_tr__mha_block__prompt'

def setup_inputs():

    _w = lambda a: (lambda t: t.to(torch.bfloat16) if t.is_floating_point() else t)(torch.as_tensor(a))

    def _A_setup():
        B, S, Dm = (1, 2048, 576)
        H, Dh = (32, 128)
        M, seg = (8, 32)
        seg = min(seg, S)
        S = S // seg * seg
        return {'x': _w((lambda *s: torch.randn(*s, dtype=torch.bfloat16) * 0.05)(B, S, Dm)), 'mem0': _w((lambda *s: torch.randn(*s, dtype=torch.bfloat16) * 0.2)(B, M, Dm)), 'Wq': _w((lambda *s: torch.randn(*s, dtype=torch.bfloat16) * 1.6)(Dm, H, Dh) * Dm ** (-0.5)), 'Wk': _w((lambda *s: torch.randn(*s, dtype=torch.bfloat16) * 1.6)(Dm, H, Dh) * Dm ** (-0.5)), 'Wv': _w((lambda *s: torch.randn(*s, dtype=torch.bfloat16) * 0.2)(Dm, H, Dh) * Dm ** (-0.5)), 'Wo': _w((lambda *s: torch.randn(*s, dtype=torch.bfloat16) * 0.2)(H, Dh, Dm) * (H * Dh) ** (-0.5)), 'seg_len': seg}
    _A_in = _A_setup()

    def _B_setup():
        B, S, D, H = (1, 2048, 576, 32)
        return {'x': _w((lambda *s: torch.randn(*s, dtype=torch.bfloat16) * 0.05)(B, S, D)), 'wqkv': _w((lambda *s: torch.randn(*s, dtype=torch.bfloat16) * 0.05)(D, 3 * D)), 'wo': _w((lambda *s: torch.randn(*s, dtype=torch.bfloat16) * 0.05)(D, D))}
    _B_in = _B_setup()
    return {'A_x': _A_in['x'], 'A_mem0': _A_in['mem0'], 'A_Wq': _A_in['Wq'], 'A_Wk': _A_in['Wk'], 'A_Wv': _A_in['Wv'], 'A_Wo': _A_in['Wo'], 'A_seg_len': _A_in['seg_len'], 'B_x': _B_in['x'], 'B_wqkv': _B_in['wqkv'], 'B_wo': _B_in['wo']}

def reference(A_x, A_mem0, A_Wq, A_Wk, A_Wv, A_Wo, A_seg_len, B_x, B_wqkv, B_wo):

    def _A_ref(x, mem0, Wq, Wk, Wv, Wo, seg_len):
        B, S, Dm = x.shape
        H, Dh = (Wq.shape[1], Wq.shape[2])
        M = mem0.shape[1]
        scale = Dh ** (-0.5)
        n_seg = S // seg_len
        L = M + seg_len
        idx = torch.arange(L)
        mask = (idx[:, None] < M) | (idx[:, None] >= idx[None, :])
        mem = mem0
        outs = []
        for s in range(n_seg):
            xs = x[:, s * seg_len:(s + 1) * seg_len, :].clone()
            h = torch.concatenate([mem, xs], axis=1)
            q = torch.einsum('btd,dhe->bhte', h, Wq)
            k = torch.einsum('btd,dhe->bhte', h, Wk)
            v = torch.einsum('btd,dhe->bhte', h, Wv)
            scores = torch.einsum('bhqe,bhke->bhqk', q, k) * scale
            scores = torch.where(mask[None, None], scores, -1000000000.0)
            p = _softmax(scores, axis=-1)
            o = torch.einsum('bhqk,bhke->bhqe', p, v)
            o = torch.einsum('bhte,hed->btd', o, Wo)
            mem = o[:, :M, :].clone()
            outs.append(o[:, M:, :])
        return torch.concatenate(outs, axis=1)

    def _B_ref(x, wqkv, wo):
        B, S, D = x.shape
        H = 32
        Dh = D // H
        qkv = (lambda x, *d: x.permute(*d))((x @ wqkv).reshape(B, S, 3, H, Dh), 2, 0, 3, 1, 4)
        q, k, v = (qkv[0], qkv[1], qkv[2])
        scores = torch.einsum('bhqd,bhkd->bhqk', q, k) * Dh ** (-0.5)
        p = _softmax(scores, axis=-1)
        o = torch.einsum('bhqk,bhkd->bhqd', p, v)
        return (lambda x, *d: x.permute(*d))(o, 0, 2, 1, 3).reshape(B, S, D) @ wo
    x = A_x
    x = x + _A_ref(_layernorm(x, axis=-1), A_mem0, A_Wq, A_Wk, A_Wv, A_Wo, A_seg_len)
    x = x + _B_ref(_layernorm(x, axis=-1), B_wqkv, B_wo)
    x = x + _A_ref(_layernorm(x, axis=-1), A_mem0, A_Wq, A_Wk, A_Wv, A_Wo, A_seg_len)
    x = x + _B_ref(_layernorm(x, axis=-1), B_wqkv, B_wo)
    return x
```

```asm
; @launch kernel=main_kernel grid=(256,1,1) block=(256,1,1) lds=163840
; @launch kernel=fin_kernel grid=(256,1,1) block=(512,1,1) lds=163840
.amdgcn_target "amdgcn-amd-amdhsa--gfx950"
.text
.globl main_kernel
.type main_kernel,@function
.globl fin_kernel
.type fin_kernel,@function
.p2align 8
main_kernel:
    s_mov_b32 s96, 0
    s_cmp_ge_u32 s2, 256
    s_cbranch_scc1 L_exit
    s_load_dwordx4 s[64:67], s[0:1], 0
    s_load_dwordx8 s[68:75], s[0:1], 16
    s_load_dwordx4 s[76:79], s[0:1], 88
    s_load_dwordx4 s[80:83], s[0:1], 64
    s_getreg_b32 s3, hwreg(HW_REG_XCC_ID, 0, 3)
    v_lshrrev_b32 v8, 6, v0
    s_mov_b32 s95, 400000
    v_readfirstlane_b32 s32, v8
    s_waitcnt lgkmcnt(0)
    s_sub_u32 s3, s3, 3
    s_and_b32 s3, s3, 7
    s_mov_b32 s4, s76
    s_mov_b32 s5, s77
    s_mov_b32 s6, 256
    s_mov_b32 s7, 0x00020000
    s_mov_b32 s8, s78
    s_mov_b32 s9, s79
    s_mov_b32 s10, 268435456
    s_mov_b32 s11, 0x00020000
    s_mov_b32 s12, s68
    s_mov_b32 s13, s69
    s_mov_b32 s14, 4718592
    s_mov_b32 s15, 0x00020000
    s_mov_b32 s16, s70
    s_mov_b32 s17, s71
    s_mov_b32 s18, 4718592
    s_mov_b32 s19, 0x00020000
    s_mov_b32 s20, s72
    s_mov_b32 s21, s73
    s_mov_b32 s22, 4718592
    s_mov_b32 s23, 0x00020000
    s_mov_b32 s24, s74
    s_mov_b32 s25, s75
    s_mov_b32 s26, 4718592
    s_mov_b32 s27, 0x00020000
    s_mov_b32 s28, s64
    s_mov_b32 s29, s65
    s_mov_b32 s30, 2359296
    s_mov_b32 s31, 0x00020000
    s_lshr_b32 s85, s2, 3
    s_lshl_b32 s97, s3, 5
    s_add_u32 s97, s97, s85
    s_lshl_b32 s84, s3, 2
    s_add_u32 s84, s84, 128
    s_lshl_b32 s93, 1, s85
    v_mov_b32 v79, s93
    v_mov_b32 v78, v0
    s_cmp_lg_u32 s32, 0
    s_cbranch_scc1 A_c1
    s_mov_b64 exec, 1
    buffer_atomic_or v79, off, s[4:7], s84 sc0
    s_mov_b64 exec, -1
A_c1:
    s_cmp_lt_u32 s3, 5
    s_cbranch_scc1 A_disp
    s_mul_i32 s85, s85, 3
    s_add_u32 s85, s85, s3
    s_sub_u32 s85, s85, 5
    s_lshl_b32 s85, s85, 15
    v_lshlrev_b32 v3, 7, v0
    v_add_u32 v3, s85, v3
    s_mov_b32 s86, 0
    buffer_load_dword v72, v3, s[24:27], s86 offen
    s_mov_b32 s86, 3145728
    buffer_load_dword v72, v3, s[24:27], s86 offen
    s_mov_b32 s86, 0
    buffer_load_dword v72, v3, s[20:23], s86 offen
    s_mov_b32 s86, 3145728
    buffer_load_dword v72, v3, s[20:23], s86 offen
    s_mov_b32 s86, 0
    buffer_load_dword v72, v3, s[12:15], s86 offen
    s_mov_b32 s86, 3145728
    buffer_load_dword v72, v3, s[12:15], s86 offen
    s_mov_b32 s86, 0
    buffer_load_dword v72, v3, s[16:19], s86 offen
    s_mov_b32 s86, 3145728
    buffer_load_dword v72, v3, s[16:19], s86 offen
    s_branch A_disp
A_over:
    s_cmp_lg_u32 s32, 0
    s_cbranch_scc1 A_c3
    s_and_b32 s86, s97, 0xe0
    s_lshr_b32 s84, s86, 3
    s_add_u32 s84, s84, 128
A_o3:
    v_readfirstlane_b32 s85, v79
    s_ff0_i32_b32 s87, s85
    s_cmp_eq_u32 s85, -1
    s_cbranch_scc1 A_o4
    s_lshl_b32 s85, 1, s87
    v_mov_b32 v79, s85
    s_mov_b64 exec, 1
    buffer_atomic_or v79, off, s[4:7], s84 sc0
    s_mov_b64 exec, -1
    s_waitcnt vmcnt(0)
    v_readfirstlane_b32 s94, v79
    s_and_b32 s94, s94, s85
    s_cbranch_scc1 A_o3
    s_branch A_o5
A_o4:
    v_mov_b32 v2, 1
    s_mov_b32 s84, 160
    s_mov_b64 exec, 1
    buffer_atomic_add v2, off, s[4:7], s84 sc0
    s_mov_b64 exec, -1
    s_waitcnt vmcnt(0)
    v_readfirstlane_b32 s85, v2
A_o1:
    buffer_load_dwordx4 v[4:7], off, s[4:7], 0 offset:128 sc1
    buffer_load_dwordx4 v[8:11], off, s[4:7], 0 offset:144 sc1
    buffer_load_dword v12, off, s[4:7], 0 offset:160 sc1
    s_sub_u32 s95, s95, 1
    s_cmp_eq_u32 s95, 0
    s_cbranch_scc1 L_end
    s_waitcnt vmcnt(0)
    v_bcnt_u32_b32 v12, v4, v12
    v_bcnt_u32_b32 v12, v5, v12
    v_bcnt_u32_b32 v12, v6, v12
    v_bcnt_u32_b32 v12, v7, v12
    v_bcnt_u32_b32 v12, v8, v12
    v_bcnt_u32_b32 v12, v9, v12
    v_bcnt_u32_b32 v12, v10, v12
    v_bcnt_u32_b32 v12, v11, v12
    v_cmp_gt_u32 vcc, 0x100, v12
    s_cbranch_vccnz A_o1
    v_readfirstlane_b32 s84, v4
    s_mov_b32 s86, 0
    s_bcnt0_i32_b32 s87, s84
    s_cmp_lt_u32 s85, s87
    s_cbranch_scc1 A_o2
    s_sub_u32 s85, s85, s87
    v_readfirstlane_b32 s84, v5
    s_mov_b32 s86, 32
    s_bcnt0_i32_b32 s87, s84
    s_cmp_lt_u32 s85, s87
    s_cbranch_scc1 A_o2
    s_sub_u32 s85, s85, s87
    v_readfirstlane_b32 s84, v6
    s_mov_b32 s86, 64
    s_bcnt0_i32_b32 s87, s84
    s_cmp_lt_u32 s85, s87
    s_cbranch_scc1 A_o2
    s_sub_u32 s85, s85, s87
    v_readfirstlane_b32 s84, v7
    s_mov_b32 s86, 96
    s_bcnt0_i32_b32 s87, s84
    s_cmp_lt_u32 s85, s87
    s_cbranch_scc1 A_o2
    s_sub_u32 s85, s85, s87
    v_readfirstlane_b32 s84, v8
    s_mov_b32 s86, 128
    s_bcnt0_i32_b32 s87, s84
    s_cmp_lt_u32 s85, s87
    s_cbranch_scc1 A_o2
    s_sub_u32 s85, s85, s87
    v_readfirstlane_b32 s84, v9
    s_mov_b32 s86, 160
    s_bcnt0_i32_b32 s87, s84
    s_cmp_lt_u32 s85, s87
    s_cbranch_scc1 A_o2
    s_sub_u32 s85, s85, s87
    v_readfirstlane_b32 s84, v10
    s_mov_b32 s86, 192
    s_bcnt0_i32_b32 s87, s84
    s_cmp_lt_u32 s85, s87
    s_cbranch_scc1 A_o2
    s_sub_u32 s85, s85, s87
    v_readfirstlane_b32 s84, v11
    s_mov_b32 s86, 224
    s_bcnt0_i32_b32 s87, s84
    s_cmp_lt_u32 s85, s87
    s_cbranch_scc1 A_o2
    s_sub_u32 s85, s85, s87
    s_branch L_end
A_o2:
    s_ff0_i32_b32 s87, s84
    s_bitset1_b32 s84, s87
    s_sub_u32 s85, s85, 1
    s_cbranch_scc0 A_o2
A_o5:
    s_add_u32 s86, s86, s87
    v_mov_b32 v2, s86
    v_mov_b32 v1, 0
    ds_write_b32 v1, v2
    s_waitcnt lgkmcnt(0)
A_c3:
    s_barrier
    v_mov_b32 v1, 0
    ds_read_b32 v2, v1
    s_waitcnt lgkmcnt(0)
    v_readfirstlane_b32 s97, v2
    s_barrier
    s_mov_b32 s93, 0
    v_mov_b32 v0, v78
    s_load_dwordx4 s[64:67], s[0:1], 0
    s_load_dwordx8 s[68:75], s[0:1], 16
    s_load_dwordx4 s[76:79], s[0:1], 88
    s_load_dwordx4 s[80:83], s[0:1], 64
    s_waitcnt lgkmcnt(0)
    s_mov_b32 s4, s76
    s_mov_b32 s5, s77
    s_mov_b32 s6, 256
    s_mov_b32 s7, 0x00020000
    s_mov_b32 s8, s78
    s_mov_b32 s9, s79
    s_mov_b32 s10, 268435456
    s_mov_b32 s11, 0x00020000
    s_mov_b32 s12, s68
    s_mov_b32 s13, s69
    s_mov_b32 s14, 4718592
    s_mov_b32 s15, 0x00020000
    s_mov_b32 s16, s70
    s_mov_b32 s17, s71
    s_mov_b32 s18, 4718592
    s_mov_b32 s19, 0x00020000
    s_mov_b32 s20, s72
    s_mov_b32 s21, s73
    s_mov_b32 s22, 4718592
    s_mov_b32 s23, 0x00020000
    s_mov_b32 s24, s74
    s_mov_b32 s25, s75
    s_mov_b32 s26, 4718592
    s_mov_b32 s27, 0x00020000
    s_mov_b32 s28, s64
    s_mov_b32 s29, s65
    s_mov_b32 s30, 2359296
    s_mov_b32 s31, 0x00020000
A_disp:
    s_cmp_lt_u32 s97, 32
    s_cbranch_scc1 R_team
    s_lshr_b32 s84, s97, 5
    s_and_b32 s85, s97, 31
    s_cmp_lt_u32 s97, 160
    s_cbranch_scc0 A_r2
    s_sub_u32 s84, s84, 1
    s_mul_i32 s86, s85, 43
    s_lshr_b32 s86, s86, 7
    s_lshl_b32 s33, s84, 3
    s_add_u32 s33, s33, s86
    s_mul_i32 s86, s86, 3
    s_sub_u32 s34, s85, s86
    s_cmp_lt_u32 s85, 24
    s_cbranch_scc1 R_q
    s_waitcnt vmcnt(0) lgkmcnt(0)
    s_barrier
    v_mov_b32 v77, 163836
    s_cmp_lg_u32 s32, 0
    s_cbranch_scc1 X_cm
    s_mov_b64 exec, 1
    ds_write_b32 v77, v79
    s_mov_b64 exec, -1
    s_waitcnt lgkmcnt(0)
X_cm:
    s_barrier
    ds_read_b32 v77, v77
    s_waitcnt lgkmcnt(0)
    v_readfirstlane_b32 s94, v77
    s_barrier
    s_and_b32 s94, s94, s93
    s_cbranch_scc1 A_over
    s_add_u32 s33, s84, 28
    s_cmp_eq_u32 s85, 31
    s_cbranch_scc1 R_a
    s_lshr_b32 s34, s84, 1
    s_and_b32 s84, s84, 1
    s_mul_i32 s84, s84, 7
    s_add_u32 s84, s84, s85
    s_sub_u32 s35, s84, 24
    s_branch R_b
A_r2:
    s_waitcnt vmcnt(0) lgkmcnt(0)
    s_barrier
    v_mov_b32 v77, 163836
    s_cmp_lg_u32 s32, 0
    s_cbranch_scc1 Y_cm
    s_mov_b64 exec, 1
    ds_write_b32 v77, v79
    s_mov_b64 exec, -1
    s_waitcnt lgkmcnt(0)
Y_cm:
    s_barrier
    ds_read_b32 v77, v77
    s_waitcnt lgkmcnt(0)
    v_readfirstlane_b32 s94, v77
    s_barrier
    s_and_b32 s94, s94, s93
    s_cbranch_scc1 A_over
    s_sub_u32 s34, s84, 5
    s_mov_b32 s35, s85
    s_mul_i32 s47, s34, 18
    s_add_u32 s47, s47, s85
    s_cmp_eq_u32 s34, 2
    s_cbranch_scc1 A_r3
    s_mul_i32 s33, s34, 14
    s_add_u32 s33, s33, s85
    s_sub_u32 s33, s33, 18
    s_cmp_ge_u32 s85, 18
    s_cbranch_scc1 R_a
A_r3:
    s_cmp_ge_u32 s47, 64
    s_cbranch_scc1 LN_done
    v_and_b32 v60, 63, v0
    v_lshlrev_b32 v1, 4, v60
    s_mov_b32 s41, 1152
    s_mov_b32 s42, 16
    s_lshl_b32 s43, s42, 3
    s_mul_i32 s44, s32, 9216
    v_and_b32 v61, 7, v60
    v_lshl_add_u32 v61, s32, 3, v61
    v_lshrrev_b32 v62, 3, v60
    v_mul_lo_u32 v2, v61, s41
    v_lshlrev_b32 v61, 4, v61
    v_lshl_add_u32 v61, v62, 9, v61
    v_add_u32 v3, 0, v61
    v_mul_lo_u32 v62, v62, s42
    v_add_u32 v2, v2, v62
    s_mul_i32 s41, s47, 36864
    s_add_u32 m0, s44, 0
    s_nop 0
    buffer_load_dwordx4 v2, s[28:31], s41 offen sc1 lds
    s_add_u32 m0, s44, 1024
    s_add_u32 s41, s41, s43
    buffer_load_dwordx4 v2, s[28:31], s41 offen sc1 lds
    s_add_u32 m0, s44, 2048
    s_add_u32 s41, s41, s43
    buffer_load_dwordx4 v2, s[28:31], s41 offen sc1 lds
    s_add_u32 m0, s44, 3072
    s_add_u32 s41, s41, s43
    buffer_load_dwordx4 v2, s[28:31], s41 offen sc1 lds
    s_add_u32 m0, s44, 4096
    s_add_u32 s41, s41, s43
    buffer_load_dwordx4 v2, s[28:31], s41 offen sc1 lds
    s_add_u32 m0, s44, 5120
    s_add_u32 s41, s41, s43
    buffer_load_dwordx4 v2, s[28:31], s41 offen sc1 lds
    s_add_u32 m0, s44, 6144
    s_add_u32 s41, s41, s43
    buffer_load_dwordx4 v2, s[28:31], s41 offen sc1 lds
    s_add_u32 m0, s44, 7168
    s_add_u32 s41, s41, s43
    buffer_load_dwordx4 v2, s[28:31], s41 offen sc1 lds
    s_add_u32 m0, s44, 8192
    s_add_u32 s41, s41, s43
    buffer_load_dwordx4 v2, s[28:31], s41 offen sc1 lds
    s_mul_i32 s45, s47, 36864
    s_add_u32 s45, s45, 4194304
    s_mov_b32 s46, 0x3f803f80
    s_waitcnt vmcnt(0)
    v_add_u32 v6, s44, v1
    ds_read_b128 v[8:11], v6 offset:0
    ds_read_b128 v[12:15], v6 offset:1024
    ds_read_b128 v[16:19], v6 offset:2048
    ds_read_b128 v[20:23], v6 offset:3072
    ds_read_b128 v[24:27], v6 offset:4096
    ds_read_b128 v[28:31], v6 offset:5120
    ds_read_b128 v[32:35], v6 offset:6144
    ds_read_b128 v[36:39], v6 offset:7168
    ds_read_b128 v[40:43], v6 offset:8192
    v_mov_b32 v6, 0
    v_mov_b32 v44, 0
    s_waitcnt lgkmcnt(8)
    v_dot2_f32_bf16 v6, v8, s46, v6
    v_dot2_f32_bf16 v44, v8, v8, v44
    v_dot2_f32_bf16 v6, v9, s46, v6
    v_dot2_f32_bf16 v44, v9, v9, v44
    v_dot2_f32_bf16 v6, v10, s46, v6
    v_dot2_f32_bf16 v44, v10, v10, v44
    v_dot2_f32_bf16 v6, v11, s46, v6
    v_dot2_f32_bf16 v44, v11, v11, v44
    s_waitcnt lgkmcnt(7)
    v_dot2_f32_bf16 v6, v12, s46, v6
    v_dot2_f32_bf16 v44, v12, v12, v44
    v_dot2_f32_bf16 v6, v13, s46, v6
    v_dot2_f32_bf16 v44, v13, v13, v44
    v_dot2_f32_bf16 v6, v14, s46, v6
    v_dot2_f32_bf16 v44, v14, v14, v44
    v_dot2_f32_bf16 v6, v15, s46, v6
    v_dot2_f32_bf16 v44, v15, v15, v44
    s_waitcnt lgkmcnt(6)
    v_dot2_f32_bf16 v6, v16, s46, v6
    v_dot2_f32_bf16 v44, v16, v16, v44
    v_dot2_f32_bf16 v6, v17, s46, v6
    v_dot2_f32_bf16 v44, v17, v17, v44
    v_dot2_f32_bf16 v6, v18, s46, v6
    v_dot2_f32_bf16 v44, v18, v18, v44
    v_dot2_f32_bf16 v6, v19, s46, v6
    v_dot2_f32_bf16 v44, v19, v19, v44
    s_waitcnt lgkmcnt(5)
    v_dot2_f32_bf16 v6, v20, s46, v6
    v_dot2_f32_bf16 v44, v20, v20, v44
    v_dot2_f32_bf16 v6, v21, s46, v6
    v_dot2_f32_bf16 v44, v21, v21, v44
    v_dot2_f32_bf16 v6, v22, s46, v6
    v_dot2_f32_bf16 v44, v22, v22, v44
    v_dot2_f32_bf16 v6, v23, s46, v6
    v_dot2_f32_bf16 v44, v23, v23, v44
    s_waitcnt lgkmcnt(4)
    v_dot2_f32_bf16 v6, v24, s46, v6
    v_dot2_f32_bf16 v44, v24, v24, v44
    v_dot2_f32_bf16 v6, v25, s46, v6
    v_dot2_f32_bf16 v44, v25, v25, v44
    v_dot2_f32_bf16 v6, v26, s46, v6
    v_dot2_f32_bf16 v44, v26, v26, v44
    v_dot2_f32_bf16 v6, v27, s46, v6
    v_dot2_f32_bf16 v44, v27, v27, v44
    s_waitcnt lgkmcnt(3)
    v_dot2_f32_bf16 v6, v28, s46, v6
    v_dot2_f32_bf16 v44, v28, v28, v44
    v_dot2_f32_bf16 v6, v29, s46, v6
    v_dot2_f32_bf16 v44, v29, v29, v44
    v_dot2_f32_bf16 v6, v30, s46, v6
    v_dot2_f32_bf16 v44, v30, v30, v44
    v_dot2_f32_bf16 v6, v31, s46, v6
    v_dot2_f32_bf16 v44, v31, v31, v44
    s_waitcnt lgkmcnt(2)
    v_dot2_f32_bf16 v6, v32, s46, v6
    v_dot2_f32_bf16 v44, v32, v32, v44
    v_dot2_f32_bf16 v6, v33, s46, v6
    v_dot2_f32_bf16 v44, v33, v33, v44
    v_dot2_f32_bf16 v6, v34, s46, v6
    v_dot2_f32_bf16 v44, v34, v34, v44
    v_dot2_f32_bf16 v6, v35, s46, v6
    v_dot2_f32_bf16 v44, v35, v35, v44
    s_waitcnt lgkmcnt(1)
    v_dot2_f32_bf16 v6, v36, s46, v6
    v_dot2_f32_bf16 v44, v36, v36, v44
    v_dot2_f32_bf16 v6, v37, s46, v6
    v_dot2_f32_bf16 v44, v37, v37, v44
    v_dot2_f32_bf16 v6, v38, s46, v6
    v_dot2_f32_bf16 v44, v38, v38, v44
    v_dot2_f32_bf16 v6, v39, s46, v6
    v_dot2_f32_bf16 v44, v39, v39, v44
    s_waitcnt lgkmcnt(0)
    v_dot2_f32_bf16 v6, v40, s46, v6
    v_dot2_f32_bf16 v44, v40, v40, v44
    v_dot2_f32_bf16 v6, v41, s46, v6
    v_dot2_f32_bf16 v44, v41, v41, v44
    v_dot2_f32_bf16 v6, v42, s46, v6
    v_dot2_f32_bf16 v44, v42, v42, v44
    v_dot2_f32_bf16 v6, v43, s46, v6
    v_dot2_f32_bf16 v44, v43, v43, v44
    s_nop 2
    v_add_f32_dpp v6, v6, v6 row_ror:8 row_mask:0xf bank_mask:0xf
    v_add_f32_dpp v44, v44, v44 row_ror:8 row_mask:0xf bank_mask:0xf
    v_mov_b32 v45, v6
    v_mov_b32 v7, v44
    s_nop 0
    v_permlane16_swap_b32 v6, v45
    v_permlane16_swap_b32 v44, v7
    v_add_f32 v6, v6, v45
    v_add_f32 v44, v44, v7
    v_mov_b32 v45, v6
    v_mov_b32 v7, v44
    s_nop 0
    v_permlane32_swap_b32 v6, v45
    v_permlane32_swap_b32 v44, v7
    v_add_f32 v6, v6, v45
    v_add_f32 v44, v44, v7
    v_mul_f32 v6, 0x3ae38e39, v6
    v_mul_f32 v44, 0x3ae38e39, v44
    v_fma_f32 v44, -v6, v6, v44
    v_max_f32 v44, 0, v44
    v_add_f32 v44, 0x3727c5ac, v44
    v_rsq_f32 v44, v44
    s_nop 0
    v_mul_f32 v45, v6, v44
    v_lshlrev_b32 v6, 16, v8
    v_and_b32 v7, 0xffff0000, v8
    v_pk_fma_f32 v[6:7], v[6:7], v[44:45], v[44:45] op_sel:[0,0,1] op_sel_hi:[1,0,1] neg_lo:[0,0,1] neg_hi:[0,0,1]
    s_nop 0
    v_cvt_pk_bf16_f32 v8, v6, v7
    v_lshlrev_b32 v6, 16, v9
    v_and_b32 v7, 0xffff0000, v9
    v_pk_fma_f32 v[6:7], v[6:7], v[44:45], v[44:45] op_sel:[0,0,1] op_sel_hi:[1,0,1] neg_lo:[0,0,1] neg_hi:[0,0,1]
    s_nop 0
    v_cvt_pk_bf16_f32 v9, v6, v7
    v_lshlrev_b32 v6, 16, v10
    v_and_b32 v7, 0xffff0000, v10
    v_pk_fma_f32 v[6:7], v[6:7], v[44:45], v[44:45] op_sel:[0,0,1] op_sel_hi:[1,0,1] neg_lo:[0,0,1] neg_hi:[0,0,1]
    s_nop 0
    v_cvt_pk_bf16_f32 v10, v6, v7
    v_lshlrev_b32 v6, 16, v11
    v_and_b32 v7, 0xffff0000, v11
    v_pk_fma_f32 v[6:7], v[6:7], v[44:45], v[44:45] op_sel:[0,0,1] op_sel_hi:[1,0,1] neg_lo:[0,0,1] neg_hi:[0,0,1]
    s_nop 0
    v_cvt_pk_bf16_f32 v11, v6, v7
    s_add_u32 s41, s45, 0
    buffer_store_dwordx4 v[8:11], v3, s[8:11], s41 offen sc1
    v_lshlrev_b32 v6, 16, v12
    v_and_b32 v7, 0xffff0000, v12
    v_pk_fma_f32 v[6:7], v[6:7], v[44:45], v[44:45] op_sel:[0,0,1] op_sel_hi:[1,0,1] neg_lo:[0,0,1] neg_hi:[0,0,1]
    s_nop 0
    v_cvt_pk_bf16_f32 v12, v6, v7
    v_lshlrev_b32 v6, 16, v13
    v_and_b32 v7, 0xffff0000, v13
    v_pk_fma_f32 v[6:7], v[6:7], v[44:45], v[44:45] op_sel:[0,0,1] op_sel_hi:[1,0,1] neg_lo:[0,0,1] neg_hi:[0,0,1]
    s_nop 0
    v_cvt_pk_bf16_f32 v13, v6, v7
    v_lshlrev_b32 v6, 16, v14
    v_and_b32 v7, 0xffff0000, v14
    v_pk_fma_f32 v[6:7], v[6:7], v[44:45], v[44:45] op_sel:[0,0,1] op_sel_hi:[1,0,1] neg_lo:[0,0,1] neg_hi:[0,0,1]
    s_nop 0
    v_cvt_pk_bf16_f32 v14, v6, v7
    v_lshlrev_b32 v6, 16, v15
    v_and_b32 v7, 0xffff0000, v15
    v_pk_fma_f32 v[6:7], v[6:7], v[44:45], v[44:45] op_sel:[0,0,1] op_sel_hi:[1,0,1] neg_lo:[0,0,1] neg_hi:[0,0,1]
    s_nop 0
    v_cvt_pk_bf16_f32 v15, v6, v7
    s_add_u32 s41, s45, 4096
    buffer_store_dwordx4 v[12:15], v3, s[8:11], s41 offen sc1
    v_lshlrev_b32 v6, 16, v16
    v_and_b32 v7, 0xffff0000, v16
    v_pk_fma_f32 v[6:7], v[6:7], v[44:45], v[44:45] op_sel:[0,0,1] op_sel_hi:[1,0,1] neg_lo:[0,0,1] neg_hi:[0,0,1]
    s_nop 0
    v_cvt_pk_bf16_f32 v16, v6, v7
    v_lshlrev_b32 v6, 16, v17
    v_and_b32 v7, 0xffff0000, v17
    v_pk_fma_f32 v[6:7], v[6:7], v[44:45], v[44:45] op_sel:[0,0,1] op_sel_hi:[1,0,1] neg_lo:[0,0,1] neg_hi:[0,0,1]
    s_nop 0
    v_cvt_pk_bf16_f32 v17, v6, v7
    v_lshlrev_b32 v6, 16, v18
    v_and_b32 v7, 0xffff0000, v18
    v_pk_fma_f32 v[6:7], v[6:7], v[44:45], v[44:45] op_sel:[0,0,1] op_sel_hi:[1,0,1] neg_lo:[0,0,1] neg_hi:[0,0,1]
    s_nop 0
    v_cvt_pk_bf16_f32 v18, v6, v7
    v_lshlrev_b32 v6, 16, v19
    v_and_b32 v7, 0xffff0000, v19
    v_pk_fma_f32 v[6:7], v[6:7], v[44:45], v[44:45] op_sel:[0,0,1] op_sel_hi:[1,0,1] neg_lo:[0,0,1] neg_hi:[0,0,1]
    s_nop 0
    v_cvt_pk_bf16_f32 v19, v6, v7
    s_add_u32 s41, s45, 8192
    buffer_store_dwordx4 v[16:19], v3, s[8:11], s41 offen sc1
    v_lshlrev_b32 v6, 16, v20
    v_and_b32 v7, 0xffff0000, v20
    v_pk_fma_f32 v[6:7], v[6:7], v[44:45], v[44:45] op_sel:[0,0,1] op_sel_hi:[1,0,1] neg_lo:[0,0,1] neg_hi:[0,0,1]
    s_nop 0
    v_cvt_pk_bf16_f32 v20, v6, v7
    v_lshlrev_b32 v6, 16, v21
    v_and_b32 v7, 0xffff0000, v21
    v_pk_fma_f32 v[6:7], v[6:7], v[44:45], v[44:45] op_sel:[0,0,1] op_sel_hi:[1,0,1] neg_lo:[0,0,1] neg_hi:[0,0,1]
    s_nop 0
    v_cvt_pk_bf16_f32 v21, v6, v7
    v_lshlrev_b32 v6, 16, v22
    v_and_b32 v7, 0xffff0000, v22
    v_pk_fma_f32 v[6:7], v[6:7], v[44:45], v[44:45] op_sel:[0,0,1] op_sel_hi:[1,0,1] neg_lo:[0,0,1] neg_hi:[0,0,1]
    s_nop 0
    v_cvt_pk_bf16_f32 v22, v6, v7
    v_lshlrev_b32 v6, 16, v23
    v_and_b32 v7, 0xffff0000, v23
    v_pk_fma_f32 v[6:7], v[6:7], v[44:45], v[44:45] op_sel:[0,0,1] op_sel_hi:[1,0,1] neg_lo:[0,0,1] neg_hi:[0,0,1]
    s_nop 0
    v_cvt_pk_bf16_f32 v23, v6, v7
    s_add_u32 s41, s45, 12288
    buffer_store_dwordx4 v[20:23], v3, s[8:11], s41 offen sc1
    v_lshlrev_b32 v6, 16, v24
    v_and_b32 v7, 0xffff0000, v24
    v_pk_fma_f32 v[6:7], v[6:7], v[44:45], v[44:45] op_sel:[0,0,1] op_sel_hi:[1,0,1] neg_lo:[0,0,1] neg_hi:[0,0,1]
    s_nop 0
    v_cvt_pk_bf16_f32 v24, v6, v7
    v_lshlrev_b32 v6, 16, v25
    v_and_b32 v7, 0xffff0000, v25
    v_pk_fma_f32 v[6:7], v[6:7], v[44:45], v[44:45] op_sel:[0,0,1] op_sel_hi:[1,0,1] neg_lo:[0,0,1] neg_hi:[0,0,1]
    s_nop 0
    v_cvt_pk_bf16_f32 v25, v6, v7
    v_lshlrev_b32 v6, 16, v26
    v_and_b32 v7, 0xffff0000, v26
    v_pk_fma_f32 v[6:7], v[6:7], v[44:45], v[44:45] op_sel:[0,0,1] op_sel_hi:[1,0,1] neg_lo:[0,0,1] neg_hi:[0,0,1]
    s_nop 0
    v_cvt_pk_bf16_f32 v26, v6, v7
    v_lshlrev_b32 v6, 16, v27
    v_and_b32 v7, 0xffff0000, v27
    v_pk_fma_f32 v[6:7], v[6:7], v[44:45], v[44:45] op_sel:[0,0,1] op_sel_hi:[1,0,1] neg_lo:[0,0,1] neg_hi:[0,0,1]
    s_nop 0
    v_cvt_pk_bf16_f32 v27, v6, v7
    s_add_u32 s41, s45, 16384
    buffer_store_dwordx4 v[24:27], v3, s[8:11], s41 offen sc1
    v_lshlrev_b32 v6, 16, v28
    v_and_b32 v7, 0xffff0000, v28
    v_pk_fma_f32 v[6:7], v[6:7], v[44:45], v[44:45] op_sel:[0,0,1] op_sel_hi:[1,0,1] neg_lo:[0,0,1] neg_hi:[0,0,1]
    s_nop 0
    v_cvt_pk_bf16_f32 v28, v6, v7
    v_lshlrev_b32 v6, 16, v29
    v_and_b32 v7, 0xffff0000, v29
    v_pk_fma_f32 v[6:7], v[6:7], v[44:45], v[44:45] op_sel:[0,0,1] op_sel_hi:[1,0,1] neg_lo:[0,0,1] neg_hi:[0,0,1]
    s_nop 0
    v_cvt_pk_bf16_f32 v29, v6, v7
    v_lshlrev_b32 v6, 16, v30
    v_and_b32 v7, 0xffff0000, v30
    v_pk_fma_f32 v[6:7], v[6:7], v[44:45], v[44:45] op_sel:[0,0,1] op_sel_hi:[1,0,1] neg_lo:[0,0,1] neg_hi:[0,0,1]
    s_nop 0
    v_cvt_pk_bf16_f32 v30, v6, v7
    v_lshlrev_b32 v6, 16, v31
    v_and_b32 v7, 0xffff0000, v31
    v_pk_fma_f32 v[6:7], v[6:7], v[44:45], v[44:45] op_sel:[0,0,1] op_sel_hi:[1,0,1] neg_lo:[0,0,1] neg_hi:[0,0,1]
    s_nop 0
    v_cvt_pk_bf16_f32 v31, v6, v7
    s_add_u32 s41, s45, 20480
    buffer_store_dwordx4 v[28:31], v3, s[8:11], s41 offen sc1
    v_lshlrev_b32 v6, 16, v32
    v_and_b32 v7, 0xffff0000, v32
    v_pk_fma_f32 v[6:7], v[6:7], v[44:45], v[44:45] op_sel:[0,0,1] op_sel_hi:[1,0,1] neg_lo:[0,0,1] neg_hi:[0,0,1]
    s_nop 0
    v_cvt_pk_bf16_f32 v32, v6, v7
    v_lshlrev_b32 v6, 16, v33
    v_and_b32 v7, 0xffff0000, v33
    v_pk_fma_f32 v[6:7], v[6:7], v[44:45], v[44:45] op_sel:[0,0,1] op_sel_hi:[1,0,1] neg_lo:[0,0,1] neg_hi:[0,0,1]
    s_nop 0
    v_cvt_pk_bf16_f32 v33, v6, v7
    v_lshlrev_b32 v6, 16, v34
    v_and_b32 v7, 0xffff0000, v34
    v_pk_fma_f32 v[6:7], v[6:7], v[44:45], v[44:45] op_sel:[0,0,1] op_sel_hi:[1,0,1] neg_lo:[0,0,1] neg_hi:[0,0,1]
    s_nop 0
    v_cvt_pk_bf16_f32 v34, v6, v7
    v_lshlrev_b32 v6, 16, v35
    v_and_b32 v7, 0xffff0000, v35
    v_pk_fma_f32 v[6:7], v[6:7], v[44:45], v[44:45] op_sel:[0,0,1] op_sel_hi:[1,0,1] neg_lo:[0,0,1] neg_hi:[0,0,1]
    s_nop 0
    v_cvt_pk_bf16_f32 v35, v6, v7
    s_add_u32 s41, s45, 24576
    buffer_store_dwordx4 v[32:35], v3, s[8:11], s41 offen sc1
    v_lshlrev_b32 v6, 16, v36
    v_and_b32 v7, 0xffff0000, v36
    v_pk_fma_f32 v[6:7], v[6:7], v[44:45], v[44:45] op_sel:[0,0,1] op_sel_hi:[1,0,1] neg_lo:[0,0,1] neg_hi:[0,0,1]
    s_nop 0
    v_cvt_pk_bf16_f32 v36, v6, v7
    v_lshlrev_b32 v6, 16, v37
    v_and_b32 v7, 0xffff0000, v37
    v_pk_fma_f32 v[6:7], v[6:7], v[44:45], v[44:45] op_sel:[0,0,1] op_sel_hi:[1,0,1] neg_lo:[0,0,1] neg_hi:[0,0,1]
    s_nop 0
    v_cvt_pk_bf16_f32 v37, v6, v7
    v_lshlrev_b32 v6, 16, v38
    v_and_b32 v7, 0xffff0000, v38
    v_pk_fma_f32 v[6:7], v[6:7], v[44:45], v[44:45] op_sel:[0,0,1] op_sel_hi:[1,0,1] neg_lo:[0,0,1] neg_hi:[0,0,1]
    s_nop 0
    v_cvt_pk_bf16_f32 v38, v6, v7
    v_lshlrev_b32 v6, 16, v39
    v_and_b32 v7, 0xffff0000, v39
    v_pk_fma_f32 v[6:7], v[6:7], v[44:45], v[44:45] op_sel:[0,0,1] op_sel_hi:[1,0,1] neg_lo:[0,0,1] neg_hi:[0,0,1]
    s_nop 0
    v_cvt_pk_bf16_f32 v39, v6, v7
    s_add_u32 s41, s45, 28672
    buffer_store_dwordx4 v[36:39], v3, s[8:11], s41 offen sc1
    v_lshlrev_b32 v6, 16, v40
    v_and_b32 v7, 0xffff0000, v40
    v_pk_fma_f32 v[6:7], v[6:7], v[44:45], v[44:45] op_sel:[0,0,1] op_sel_hi:[1,0,1] neg_lo:[0,0,1] neg_hi:[0,0,1]
    s_nop 0
    v_cvt_pk_bf16_f32 v40, v6, v7
    v_lshlrev_b32 v6, 16, v41
    v_and_b32 v7, 0xffff0000, v41
    v_pk_fma_f32 v[6:7], v[6:7], v[44:45], v[44:45] op_sel:[0,0,1] op_sel_hi:[1,0,1] neg_lo:[0,0,1] neg_hi:[0,0,1]
    s_nop 0
    v_cvt_pk_bf16_f32 v41, v6, v7
    v_lshlrev_b32 v6, 16, v42
    v_and_b32 v7, 0xffff0000, v42
    v_pk_fma_f32 v[6:7], v[6:7], v[44:45], v[44:45] op_sel:[0,0,1] op_sel_hi:[1,0,1] neg_lo:[0,0,1] neg_hi:[0,0,1]
    s_nop 0
    v_cvt_pk_bf16_f32 v42, v6, v7
    v_lshlrev_b32 v6, 16, v43
    v_and_b32 v7, 0xffff0000, v43
    v_pk_fma_f32 v[6:7], v[6:7], v[44:45], v[44:45] op_sel:[0,0,1] op_sel_hi:[1,0,1] neg_lo:[0,0,1] neg_hi:[0,0,1]
    s_nop 0
    v_cvt_pk_bf16_f32 v43, v6, v7
    s_add_u32 s41, s45, 32768
    buffer_store_dwordx4 v[40:43], v3, s[8:11], s41 offen sc1
    s_waitcnt vmcnt(0)
    s_cmp_lg_u32 s32, 0
    s_cbranch_scc1 LN_iw_ok
    s_mov_b32 s94, 36
LN_iw:
    buffer_load_dword v79, off, s[4:7], s94 sc1
    s_sub_u32 s95, s95, 1
    s_cmp_eq_u32 s95, 0
    s_cbranch_scc1 L_end
    s_waitcnt vmcnt(0)
    v_cmp_gt_u32 vcc, 32, v79
    s_cbranch_vccz LN_iw_ok
    s_sleep 1
    s_branch LN_iw
LN_iw_ok:
    s_barrier
    s_cmp_lg_u32 s32, 0
    s_cbranch_scc1 LN_done
    v_mov_b32 v4, 1
    s_lshl_b32 s41, s47, 2
    s_add_u32 s41, s41, 3194880
    s_mov_b64 exec, 1
    buffer_store_dword v4, off, s[8:11], s41 sc1
    s_mov_b64 exec, -1
LN_done:
    s_cmp_eq_u32 s34, 2
    s_cbranch_scc1 A_r4
    s_cmp_lt_u32 s35, 12
    s_cbranch_scc1 R_o
    s_mul_i32 s84, s34, 6
    s_add_u32 s35, s35, s84
    s_sub_u32 s35, s35, 12
    s_mov_b32 s34, 2
    s_branch R_o
A_r4:
    s_sub_u32 s34, s85, 22
    s_cmp_ge_u32 s85, 25
    s_cbranch_scc1 R_l
    s_mul_i32 s34, s85, 52
    s_lshr_b32 s34, s34, 8
    s_mul_i32 s35, s34, 5
    s_sub_u32 s35, s85, s35
    s_branch R_p
R_b:
    s_mov_b32 s12, s80
    s_mov_b32 s13, s81
    s_mov_b32 s14, 1990656
    s_mov_b32 s15, 0x00020000
    v_and_b32 v60, 63, v0
    s_lshl_b32 s39, s35, 2
    s_add_u32 s39, s39, s32
    s_mul_i32 s38, s39, 3641
    s_lshr_b32 s38, s38, 16
    s_mul_i32 s41, s38, 18
    s_sub_u32 s39, s39, s41
    s_cmp_ge_u32 s39, 16
    s_cselect_b32 s52, 1, 0
    s_cmp_ge_u32 s38, 2
    s_cselect_b32 s52, s38, s52
    s_mul_i32 s41, s39, 72
    s_mov_b32 s42, 8
    s_mov_b32 s43, 8
    s_cmp_eq_u32 s52, 0
    s_cbranch_scc1 B_k0
    s_lshl_b32 s41, s39, 6
    s_mov_b32 s43, 0
    s_cmp_eq_u32 s52, 1
    s_cbranch_scc0 B_k0
    s_sub_u32 s41, s39, 16
    s_mul_i32 s41, s41, 576
    s_add_u32 s41, s41, 32
    s_mov_b32 s42, 72
B_k0:
    s_min_u32 s44, s38, 2
    s_mul_i32 s44, s44, 1152
    s_add_u32 s41, s41, s44
    v_and_b32 v61, 7, v60
    v_mul_lo_u32 v64, v61, s42
    v_lshrrev_b32 v61, 2, v61
    v_mul_lo_u32 v61, v61, s43
    v_add3_u32 v64, v64, v61, s41
    v_lshrrev_b32 v61, 3, v60
    v_mul_u32_u24 v61, 3456, v61
    v_add_u32 v64, v64, v61
    s_mul_i32 s43, s32, 36864
    v_lshlrev_b32 v63, 3, v60
    v_add_u32 v63, s43, v63
    v_bfe_u32 v61, v60, 2, 2
    v_lshrrev_b32 v62, 5, v60
    v_lshl_add_u32 v61, v62, 3, v61
    v_lshlrev_b32 v61, 6, v61
    v_bfe_u32 v62, v60, 4, 1
    v_lshl_add_u32 v61, v62, 5, v61
    v_and_b32 v62, 3, v60
    v_lshlrev_b32 v62, 3, v62
    v_add3_u32 v65, v61, v62, s43
    s_mov_b32 s44, 0
    buffer_load_dwordx2 v[100:101], v64, s[12:15], s44 offen
    s_mov_b32 s44, 27648
    buffer_load_dwordx2 v[102:103], v64, s[12:15], s44 offen
    s_mov_b32 s44, 55296
    buffer_load_dwordx2 v[104:105], v64, s[12:15], s44 offen
    s_mov_b32 s44, 82944
    buffer_load_dwordx2 v[106:107], v64, s[12:15], s44 offen
    s_mov_b32 s44, 110592
    buffer_load_dwordx2 v[108:109], v64, s[12:15], s44 offen
    s_mov_b32 s44, 138240
    buffer_load_dwordx2 v[110:111], v64, s[12:15], s44 offen
    s_mov_b32 s44, 165888
    buffer_load_dwordx2 v[112:113], v64, s[12:15], s44 offen
    s_mov_b32 s44, 193536
    buffer_load_dwordx2 v[114:115], v64, s[12:15], s44 offen
    s_mov_b32 s44, 221184
    buffer_load_dwordx2 v[116:117], v64, s[12:15], s44 offen
    s_mov_b32 s44, 248832
    buffer_load_dwordx2 v[118:119], v64, s[12:15], s44 offen
    s_mov_b32 s44, 276480
    buffer_load_dwordx2 v[120:121], v64, s[12:15], s44 offen
    s_mov_b32 s44, 304128
    buffer_load_dwordx2 v[122:123], v64, s[12:15], s44 offen
    s_mov_b32 s44, 331776
    buffer_load_dwordx2 v[124:125], v64, s[12:15], s44 offen
    s_mov_b32 s44, 359424
    buffer_load_dwordx2 v[126:127], v64, s[12:15], s44 offen
    s_mov_b32 s44, 387072
    buffer_load_dwordx2 v[128:129], v64, s[12:15], s44 offen
    s_mov_b32 s44, 414720
    buffer_load_dwordx2 v[130:131], v64, s[12:15], s44 offen
    s_mov_b32 s44, 442368
    buffer_load_dwordx2 v[132:133], v64, s[12:15], s44 offen
    s_mov_b32 s44, 470016
    buffer_load_dwordx2 v[134:135], v64, s[12:15], s44 offen
    s_mov_b32 s44, 497664
    buffer_load_dwordx2 v[136:137], v64, s[12:15], s44 offen
    s_mov_b32 s44, 525312
    buffer_load_dwordx2 v[138:139], v64, s[12:15], s44 offen
    s_mov_b32 s44, 552960
    buffer_load_dwordx2 v[140:141], v64, s[12:15], s44 offen
    s_mov_b32 s44, 580608
    buffer_load_dwordx2 v[142:143], v64, s[12:15], s44 offen
    s_mov_b32 s44, 608256
    buffer_load_dwordx2 v[144:145], v64, s[12:15], s44 offen
    s_mov_b32 s44, 635904
    buffer_load_dwordx2 v[146:147], v64, s[12:15], s44 offen
    s_mov_b32 s44, 663552
    buffer_load_dwordx2 v[148:149], v64, s[12:15], s44 offen
    s_mov_b32 s44, 691200
    buffer_load_dwordx2 v[150:151], v64, s[12:15], s44 offen
    s_mov_b32 s44, 718848
    buffer_load_dwordx2 v[152:153], v64, s[12:15], s44 offen
    s_mov_b32 s44, 746496
    buffer_load_dwordx2 v[154:155], v64, s[12:15], s44 offen
    s_mov_b32 s44, 774144
    buffer_load_dwordx2 v[156:157], v64, s[12:15], s44 offen
    s_mov_b32 s44, 801792
    buffer_load_dwordx2 v[158:159], v64, s[12:15], s44 offen
    s_mov_b32 s44, 829440
    buffer_load_dwordx2 v[160:161], v64, s[12:15], s44 offen
    s_mov_b32 s44, 857088
    buffer_load_dwordx2 v[162:163], v64, s[12:15], s44 offen
    s_mov_b32 s44, 884736
    buffer_load_dwordx2 v[164:165], v64, s[12:15], s44 offen
    s_mov_b32 s44, 912384
    buffer_load_dwordx2 v[166:167], v64, s[12:15], s44 offen
    s_mov_b32 s44, 940032
    buffer_load_dwordx2 v[168:169], v64, s[12:15], s44 offen
    s_mov_b32 s44, 967680
    buffer_load_dwordx2 v[170:171], v64, s[12:15], s44 offen
    s_waitcnt vmcnt(20)
    s_mov_b32 s44, 995328
    buffer_load_dwordx2 v[172:173], v64, s[12:15], s44 offen
    s_mov_b32 s44, 1022976
    buffer_load_dwordx2 v[174:175], v64, s[12:15], s44 offen
    s_mov_b32 s44, 1050624
    buffer_load_dwordx2 v[176:177], v64, s[12:15], s44 offen
    s_mov_b32 s44, 1078272
    buffer_load_dwordx2 v[178:179], v64, s[12:15], s44 offen
    s_mov_b32 s44, 1105920
    buffer_load_dwordx2 v[180:181], v64, s[12:15], s44 offen
    s_mov_b32 s44, 1133568
    buffer_load_dwordx2 v[182:183], v64, s[12:15], s44 offen
    s_mov_b32 s44, 1161216
    buffer_load_dwordx2 v[184:185], v64, s[12:15], s44 offen
    s_mov_b32 s44, 1188864
    buffer_load_dwordx2 v[186:187], v64, s[12:15], s44 offen
    s_mov_b32 s44, 1216512
    buffer_load_dwordx2 v[188:189], v64, s[12:15], s44 offen
    s_mov_b32 s44, 1244160
    buffer_load_dwordx2 v[190:191], v64, s[12:15], s44 offen
    s_mov_b32 s44, 1271808
    buffer_load_dwordx2 v[192:193], v64, s[12:15], s44 offen
    s_mov_b32 s44, 1299456
    buffer_load_dwordx2 v[194:195], v64, s[12:15], s44 offen
    s_mov_b32 s44, 1327104
    buffer_load_dwordx2 v[196:197], v64, s[12:15], s44 offen
    s_mov_b32 s44, 1354752
    buffer_load_dwordx2 v[198:199], v64, s[12:15], s44 offen
    s_mov_b32 s44, 1382400
    buffer_load_dwordx2 v[200:201], v64, s[12:15], s44 offen
    s_mov_b32 s44, 1410048
    buffer_load_dwordx2 v[202:203], v64, s[12:15], s44 offen
    s_mov_b32 s44, 1437696
    buffer_load_dwordx2 v[204:205], v64, s[12:15], s44 offen
    s_mov_b32 s44, 1465344
    buffer_load_dwordx2 v[206:207], v64, s[12:15], s44 offen
    s_mov_b32 s44, 1492992
    buffer_load_dwordx2 v[208:209], v64, s[12:15], s44 offen
    s_mov_b32 s44, 1520640
    buffer_load_dwordx2 v[210:211], v64, s[12:15], s44 offen
    s_mov_b32 s44, 1548288
    buffer_load_dwordx2 v[212:213], v64, s[12:15], s44 offen
    s_mov_b32 s44, 1575936
    buffer_load_dwordx2 v[214:215], v64, s[12:15], s44 offen
    s_mov_b32 s44, 1603584
    buffer_load_dwordx2 v[216:217], v64, s[12:15], s44 offen
    s_mov_b32 s44, 1631232
    buffer_load_dwordx2 v[218:219], v64, s[12:15], s44 offen
    s_mov_b32 s44, 1658880
    buffer_load_dwordx2 v[220:221], v64, s[12:15], s44 offen
    s_mov_b32 s44, 1686528
    buffer_load_dwordx2 v[222:223], v64, s[12:15], s44 offen
    s_mov_b32 s44, 1714176
    buffer_load_dwordx2 v[224:225], v64, s[12:15], s44 offen
    s_mov_b32 s44, 1741824
    buffer_load_dwordx2 v[226:227], v64, s[12:15], s44 offen
    s_mov_b32 s44, 1769472
    buffer_load_dwordx2 v[228:229], v64, s[12:15], s44 offen
    s_mov_b32 s44, 1797120
    buffer_load_dwordx2 v[230:231], v64, s[12:15], s44 offen
    s_mov_b32 s44, 1824768
    buffer_load_dwordx2 v[232:233], v64, s[12:15], s44 offen
    s_mov_b32 s44, 1852416
    buffer_load_dwordx2 v[234:235], v64, s[12:15], s44 offen
    s_mov_b32 s44, 1880064
    buffer_load_dwordx2 v[236:237], v64, s[12:15], s44 offen
    s_mov_b32 s44, 1907712
    buffer_load_dwordx2 v[238:239], v64, s[12:15], s44 offen
    s_mov_b32 s44, 1935360
    buffer_load_dwordx2 v[240:241], v64, s[12:15], s44 offen
    s_mov_b32 s44, 1963008
    buffer_load_dwordx2 v[242:243], v64, s[12:15], s44 offen
    ds_write_b64 v63, v[100:101] offset:0
    ds_write_b64 v63, v[102:103] offset:512
    ds_write_b64 v63, v[104:105] offset:1024
    ds_write_b64 v63, v[106:107] offset:1536
    ds_write_b64 v63, v[108:109] offset:2048
    ds_write_b64 v63, v[110:111] offset:2560
    ds_write_b64 v63, v[112:113] offset:3072
    ds_write_b64 v63, v[114:115] offset:3584
    ds_write_b64 v63, v[116:117] offset:4096
    ds_write_b64 v63, v[118:119] offset:4608
    ds_write_b64 v63, v[120:121] offset:5120
    ds_write_b64 v63, v[122:123] offset:5632
    ds_write_b64 v63, v[124:125] offset:6144
    ds_write_b64 v63, v[126:127] offset:6656
    ds_write_b64 v63, v[128:129] offset:7168
    ds_write_b64 v63, v[130:131] offset:7680
    s_waitcnt vmcnt(55)
    ds_write_b64 v63, v[132:133] offset:8192
    s_waitcnt vmcnt(54)
    ds_write_b64 v63, v[134:135] offset:8704
    s_waitcnt vmcnt(53)
    ds_write_b64 v63, v[136:137] offset:9216
    s_waitcnt vmcnt(52)
    ds_write_b64 v63, v[138:139] offset:9728
    s_waitcnt vmcnt(51)
    ds_write_b64 v63, v[140:141] offset:10240
    s_waitcnt vmcnt(50)
    ds_write_b64 v63, v[142:143] offset:10752
    s_waitcnt vmcnt(49)
    ds_write_b64 v63, v[144:145] offset:11264
    s_waitcnt vmcnt(48)
    ds_write_b64 v63, v[146:147] offset:11776
    s_waitcnt vmcnt(47)
    ds_write_b64 v63, v[148:149] offset:12288
    s_waitcnt vmcnt(46)
    ds_write_b64 v63, v[150:151] offset:12800
    s_waitcnt vmcnt(45)
    ds_write_b64 v63, v[152:153] offset:13312
    s_waitcnt vmcnt(44)
    ds_write_b64 v63, v[154:155] offset:13824
    s_waitcnt vmcnt(43)
    ds_write_b64 v63, v[156:157] offset:14336
    s_waitcnt vmcnt(42)
    ds_write_b64 v63, v[158:159] offset:14848
    s_waitcnt vmcnt(41)
    ds_write_b64 v63, v[160:161] offset:15360
    s_waitcnt vmcnt(40)
    ds_write_b64 v63, v[162:163] offset:15872
    s_waitcnt vmcnt(39)
    ds_write_b64 v63, v[164:165] offset:16384
    s_waitcnt vmcnt(38)
    ds_write_b64 v63, v[166:167] offset:16896
    s_waitcnt vmcnt(37)
    ds_write_b64 v63, v[168:169] offset:17408
    s_waitcnt vmcnt(36)
    ds_write_b64 v63, v[170:171] offset:17920
    s_waitcnt vmcnt(35)
    ds_write_b64 v63, v[172:173] offset:18432
    s_waitcnt vmcnt(34)
    ds_write_b64 v63, v[174:175] offset:18944
    s_waitcnt vmcnt(33)
    ds_write_b64 v63, v[176:177] offset:19456
    s_waitcnt vmcnt(32)
    ds_write_b64 v63, v[178:179] offset:19968
    s_waitcnt vmcnt(31)
    ds_write_b64 v63, v[180:181] offset:20480
    s_waitcnt vmcnt(30)
    ds_write_b64 v63, v[182:183] offset:20992
    s_waitcnt vmcnt(29)
    ds_write_b64 v63, v[184:185] offset:21504
    s_waitcnt vmcnt(28)
    ds_write_b64 v63, v[186:187] offset:22016
    s_waitcnt vmcnt(27)
    ds_write_b64 v63, v[188:189] offset:22528
    s_waitcnt vmcnt(26)
    ds_write_b64 v63, v[190:191] offset:23040
    s_waitcnt vmcnt(25)
    ds_write_b64 v63, v[192:193] offset:23552
    s_waitcnt vmcnt(24)
    ds_write_b64 v63, v[194:195] offset:24064
    s_waitcnt vmcnt(23)
    ds_write_b64 v63, v[196:197] offset:24576
    s_waitcnt vmcnt(22)
    ds_write_b64 v63, v[198:199] offset:25088
    s_waitcnt vmcnt(21)
    ds_write_b64 v63, v[200:201] offset:25600
    s_waitcnt vmcnt(20)
    ds_write_b64 v63, v[202:203] offset:26112
    s_waitcnt vmcnt(19)
    ds_write_b64 v63, v[204:205] offset:26624
    s_waitcnt vmcnt(18)
    ds_write_b64 v63, v[206:207] offset:27136
    s_waitcnt vmcnt(17)
    ds_write_b64 v63, v[208:209] offset:27648
    s_waitcnt vmcnt(16)
    ds_write_b64 v63, v[210:211] offset:28160
    s_waitcnt vmcnt(15)
    ds_write_b64 v63, v[212:213] offset:28672
    s_waitcnt vmcnt(14)
    ds_write_b64 v63, v[214:215] offset:29184
    s_waitcnt vmcnt(13)
    ds_write_b64 v63, v[216:217] offset:29696
    s_waitcnt vmcnt(12)
    ds_write_b64 v63, v[218:219] offset:30208
    s_waitcnt vmcnt(11)
    ds_write_b64 v63, v[220:221] offset:30720
    s_waitcnt vmcnt(10)
    ds_write_b64 v63, v[222:223] offset:31232
    s_waitcnt vmcnt(9)
    ds_write_b64 v63, v[224:225] offset:31744
    s_waitcnt vmcnt(8)
    ds_write_b64 v63, v[226:227] offset:32256
    s_waitcnt vmcnt(7)
    ds_write_b64 v63, v[228:229] offset:32768
    s_waitcnt vmcnt(6)
    ds_write_b64 v63, v[230:231] offset:33280
    s_waitcnt vmcnt(5)
    ds_write_b64 v63, v[232:233] offset:33792
    s_waitcnt vmcnt(4)
    ds_write_b64 v63, v[234:235] offset:34304
    s_waitcnt vmcnt(3)
    ds_write_b64 v63, v[236:237] offset:34816
    s_waitcnt vmcnt(2)
    ds_write_b64 v63, v[238:239] offset:35328
    s_waitcnt vmcnt(1)
    ds_write_b64 v63, v[240:241] offset:35840
    s_waitcnt vmcnt(0)
    ds_write_b64 v63, v[242:243] offset:36352
    s_waitcnt lgkmcnt(0)
    ds_read_b64_tr_b16 a[0:1], v65 offset:0
    ds_read_b64_tr_b16 a[2:3], v65 offset:256
    ds_read_b64_tr_b16 a[4:5], v65 offset:1024
    ds_read_b64_tr_b16 a[6:7], v65 offset:1280
    ds_read_b64_tr_b16 a[8:9], v65 offset:2048
    ds_read_b64_tr_b16 a[10:11], v65 offset:2304
    ds_read_b64_tr_b16 a[12:13], v65 offset:3072
    ds_read_b64_tr_b16 a[14:15], v65 offset:3328
    ds_read_b64_tr_b16 a[16:17], v65 offset:4096
    ds_read_b64_tr_b16 a[18:19], v65 offset:4352
    ds_read_b64_tr_b16 a[20:21], v65 offset:5120
    ds_read_b64_tr_b16 a[22:23], v65 offset:5376
    ds_read_b64_tr_b16 a[24:25], v65 offset:6144
    ds_read_b64_tr_b16 a[26:27], v65 offset:6400
    ds_read_b64_tr_b16 a[28:29], v65 offset:7168
    ds_read_b64_tr_b16 a[30:31], v65 offset:7424
    ds_read_b64_tr_b16 a[32:33], v65 offset:8192
    ds_read_b64_tr_b16 a[34:35], v65 offset:8448
    ds_read_b64_tr_b16 a[36:37], v65 offset:9216
    ds_read_b64_tr_b16 a[38:39], v65 offset:9472
    ds_read_b64_tr_b16 a[40:41], v65 offset:10240
    ds_read_b64_tr_b16 a[42:43], v65 offset:10496
    ds_read_b64_tr_b16 a[44:45], v65 offset:11264
    ds_read_b64_tr_b16 a[46:47], v65 offset:11520
    ds_read_b64_tr_b16 a[48:49], v65 offset:12288
    ds_read_b64_tr_b16 a[50:51], v65 offset:12544
    ds_read_b64_tr_b16 a[52:53], v65 offset:13312
    ds_read_b64_tr_b16 a[54:55], v65 offset:13568
    ds_read_b64_tr_b16 a[56:57], v65 offset:14336
    ds_read_b64_tr_b16 a[58:59], v65 offset:14592
    ds_read_b64_tr_b16 a[60:61], v65 offset:15360
    ds_read_b64_tr_b16 a[62:63], v65 offset:15616
    ds_read_b64_tr_b16 a[64:65], v65 offset:16384
    ds_read_b64_tr_b16 a[66:67], v65 offset:16640
    ds_read_b64_tr_b16 a[68:69], v65 offset:17408
    ds_read_b64_tr_b16 a[70:71], v65 offset:17664
    ds_read_b64_tr_b16 a[72:73], v65 offset:18432
    ds_read_b64_tr_b16 a[74:75], v65 offset:18688
    ds_read_b64_tr_b16 a[76:77], v65 offset:19456
    ds_read_b64_tr_b16 a[78:79], v65 offset:19712
    ds_read_b64_tr_b16 a[80:81], v65 offset:20480
    ds_read_b64_tr_b16 a[82:83], v65 offset:20736
    ds_read_b64_tr_b16 a[84:85], v65 offset:21504
    ds_read_b64_tr_b16 a[86:87], v65 offset:21760
    ds_read_b64_tr_b16 a[88:89], v65 offset:22528
    ds_read_b64_tr_b16 a[90:91], v65 offset:22784
    ds_read_b64_tr_b16 a[92:93], v65 offset:23552
    ds_read_b64_tr_b16 a[94:95], v65 offset:23808
    ds_read_b64_tr_b16 a[96:97], v65 offset:24576
    ds_read_b64_tr_b16 a[98:99], v65 offset:24832
    ds_read_b64_tr_b16 a[100:101], v65 offset:25600
    ds_read_b64_tr_b16 a[102:103], v65 offset:25856
    ds_read_b64_tr_b16 a[104:105], v65 offset:26624
    ds_read_b64_tr_b16 a[106:107], v65 offset:26880
    ds_read_b64_tr_b16 a[108:109], v65 offset:27648
    ds_read_b64_tr_b16 a[110:111], v65 offset:27904
    ds_read_b64_tr_b16 a[112:113], v65 offset:28672
    ds_read_b64_tr_b16 a[114:115], v65 offset:28928
    ds_read_b64_tr_b16 a[116:117], v65 offset:29696
    ds_read_b64_tr_b16 a[118:119], v65 offset:29952
    ds_read_b64_tr_b16 a[120:121], v65 offset:30720
    ds_read_b64_tr_b16 a[122:123], v65 offset:30976
    ds_read_b64_tr_b16 a[124:125], v65 offset:31744
    ds_read_b64_tr_b16 a[126:127], v65 offset:32000
    ds_read_b64_tr_b16 a[128:129], v65 offset:32768
    ds_read_b64_tr_b16 a[130:131], v65 offset:33024
    ds_read_b64_tr_b16 a[132:133], v65 offset:33792
    ds_read_b64_tr_b16 a[134:135], v65 offset:34048
    ds_read_b64_tr_b16 a[136:137], v65 offset:34816
    ds_read_b64_tr_b16 a[138:139], v65 offset:35072
    ds_read_b64_tr_b16 a[140:141], v65 offset:35840
    ds_read_b64_tr_b16 a[142:143], v65 offset:36096
    s_mov_b32 s49, 0x3f803f80
    s_cmp_eq_u32 s38, 0
    s_cselect_b32 s48, 0x3eae1a93, 1.0
    s_mul_i32 s47, s32, 9216
    v_lshlrev_b32 v1, 3, v60
    s_lshl_b32 s41, s32, 9
    s_add_u32 s41, s41, 73728
    v_and_b32 v61, 31, v60
    v_lshl_add_u32 v2, v61, 2, s41
    v_lshrrev_b32 v61, 5, v60
    v_lshl_add_u32 v56, v61, 4, s41
    v_mov_b32 v32, s49
    v_mov_b32 v33, s49
    v_mov_b32 v34, s49
    v_mov_b32 v35, s49
    s_waitcnt lgkmcnt(0)
    s_cmp_ge_u32 s52, 2
    s_cbranch_scc1 B_cv
    v_mfma_f32_32x32x16_bf16 v[80:95], a[0:3], v[32:35], 0
    v_mfma_f32_32x32x16_bf16 v[80:95], a[4:7], v[32:35], v[80:95]
    v_mfma_f32_32x32x16_bf16 v[80:95], a[8:11], v[32:35], v[80:95]
    v_mfma_f32_32x32x16_bf16 v[80:95], a[12:15], v[32:35], v[80:95]
    v_mfma_f32_32x32x16_bf16 v[80:95], a[16:19], v[32:35], v[80:95]
    v_mfma_f32_32x32x16_bf16 v[80:95], a[20:23], v[32:35], v[80:95]
    v_mfma_f32_32x32x16_bf16 v[80:95], a[24:27], v[32:35], v[80:95]
    v_mfma_f32_32x32x16_bf16 v[80:95], a[28:31], v[32:35], v[80:95]
    v_mfma_f32_32x32x16_bf16 v[80:95], a[32:35], v[32:35], v[80:95]
    v_mfma_f32_32x32x16_bf16 v[80:95], a[36:39], v[32:35], v[80:95]
    v_mfma_f32_32x32x16_bf16 v[80:95], a[40:43], v[32:35], v[80:95]
    v_mfma_f32_32x32x16_bf16 v[80:95], a[44:47], v[32:35], v[80:95]
    v_mfma_f32_32x32x16_bf16 v[80:95], a[48:51], v[32:35], v[80:95]
    v_mfma_f32_32x32x16_bf16 v[80:95], a[52:55], v[32:35], v[80:95]
    v_mfma_f32_32x32x16_bf16 v[80:95], a[56:59], v[32:35], v[80:95]
    v_mfma_f32_32x32x16_bf16 v[80:95], a[60:63], v[32:35], v[80:95]
    v_mfma_f32_32x32x16_bf16 v[80:95], a[64:67], v[32:35], v[80:95]
    v_mfma_f32_32x32x16_bf16 v[80:95], a[68:71], v[32:35], v[80:95]
    v_mfma_f32_32x32x16_bf16 v[80:95], a[72:75], v[32:35], v[80:95]
    v_mfma_f32_32x32x16_bf16 v[80:95], a[76:79], v[32:35], v[80:95]
    v_mfma_f32_32x32x16_bf16 v[80:95], a[80:83], v[32:35], v[80:95]
    v_mfma_f32_32x32x16_bf16 v[80:95], a[84:87], v[32:35], v[80:95]
    v_mfma_f32_32x32x16_bf16 v[80:95], a[88:91], v[32:35], v[80:95]
    v_mfma_f32_32x32x16_bf16 v[80:95], a[92:95], v[32:35], v[80:95]
    v_mfma_f32_32x32x16_bf16 v[80:95], a[96:99], v[32:35], v[80:95]
    v_mfma_f32_32x32x16_bf16 v[80:95], a[100:103], v[32:35], v[80:95]
    v_mfma_f32_32x32x16_bf16 v[80:95], a[104:107], v[32:35], v[80:95]
    v_mfma_f32_32x32x16_bf16 v[80:95], a[108:111], v[32:35], v[80:95]
    v_mfma_f32_32x32x16_bf16 v[80:95], a[112:115], v[32:35], v[80:95]
    v_mfma_f32_32x32x16_bf16 v[80:95], a[116:119], v[32:35], v[80:95]
    v_mfma_f32_32x32x16_bf16 v[80:95], a[120:123], v[32:35], v[80:95]
    v_mfma_f32_32x32x16_bf16 v[80:95], a[124:127], v[32:35], v[80:95]
    v_mfma_f32_32x32x16_bf16 v[80:95], a[128:131], v[32:35], v[80:95]
    v_mfma_f32_32x32x16_bf16 v[80:95], a[132:135], v[32:35], v[80:95]
    v_mfma_f32_32x32x16_bf16 v[80:95], a[136:139], v[32:35], v[80:95]
    v_mfma_f32_32x32x16_bf16 v[80:95], a[140:143], v[32:35], v[80:95]
    s_branch B_cd
B_cv:
    v_mfma_f32_32x32x16_bf16 v[80:95], v[32:35], a[0:3], 0
    v_mfma_f32_32x32x16_bf16 v[80:95], v[32:35], a[4:7], v[80:95]
    v_mfma_f32_32x32x16_bf16 v[80:95], v[32:35], a[8:11], v[80:95]
    v_mfma_f32_32x32x16_bf16 v[80:95], v[32:35], a[12:15], v[80:95]
    v_mfma_f32_32x32x16_bf16 v[80:95], v[32:35], a[16:19], v[80:95]
    v_mfma_f32_32x32x16_bf16 v[80:95], v[32:35], a[20:23], v[80:95]
    v_mfma_f32_32x32x16_bf16 v[80:95], v[32:35], a[24:27], v[80:95]
    v_mfma_f32_32x32x16_bf16 v[80:95], v[32:35], a[28:31], v[80:95]
    v_mfma_f32_32x32x16_bf16 v[80:95], v[32:35], a[32:35], v[80:95]
    v_mfma_f32_32x32x16_bf16 v[80:95], v[32:35], a[36:39], v[80:95]
    v_mfma_f32_32x32x16_bf16 v[80:95], v[32:35], a[40:43], v[80:95]
    v_mfma_f32_32x32x16_bf16 v[80:95], v[32:35], a[44:47], v[80:95]
    v_mfma_f32_32x32x16_bf16 v[80:95], v[32:35], a[48:51], v[80:95]
    v_mfma_f32_32x32x16_bf16 v[80:95], v[32:35], a[52:55], v[80:95]
    v_mfma_f32_32x32x16_bf16 v[80:95], v[32:35], a[56:59], v[80:95]
    v_mfma_f32_32x32x16_bf16 v[80:95], v[32:35], a[60:63], v[80:95]
    v_mfma_f32_32x32x16_bf16 v[80:95], v[32:35], a[64:67], v[80:95]
    v_mfma_f32_32x32x16_bf16 v[80:95], v[32:35], a[68:71], v[80:95]
    v_mfma_f32_32x32x16_bf16 v[80:95], v[32:35], a[72:75], v[80:95]
    v_mfma_f32_32x32x16_bf16 v[80:95], v[32:35], a[76:79], v[80:95]
    v_mfma_f32_32x32x16_bf16 v[80:95], v[32:35], a[80:83], v[80:95]
    v_mfma_f32_32x32x16_bf16 v[80:95], v[32:35], a[84:87], v[80:95]
    v_mfma_f32_32x32x16_bf16 v[80:95], v[32:35], a[88:91], v[80:95]
    v_mfma_f32_32x32x16_bf16 v[80:95], v[32:35], a[92:95], v[80:95]
    v_mfma_f32_32x32x16_bf16 v[80:95], v[32:35], a[96:99], v[80:95]
    v_mfma_f32_32x32x16_bf16 v[80:95], v[32:35], a[100:103], v[80:95]
    v_mfma_f32_32x32x16_bf16 v[80:95], v[32:35], a[104:107], v[80:95]
    v_mfma_f32_32x32x16_bf16 v[80:95], v[32:35], a[108:111], v[80:95]
    v_mfma_f32_32x32x16_bf16 v[80:95], v[32:35], a[112:115], v[80:95]
    v_mfma_f32_32x32x16_bf16 v[80:95], v[32:35], a[116:119], v[80:95]
    v_mfma_f32_32x32x16_bf16 v[80:95], v[32:35], a[120:123], v[80:95]
    v_mfma_f32_32x32x16_bf16 v[80:95], v[32:35], a[124:127], v[80:95]
    v_mfma_f32_32x32x16_bf16 v[80:95], v[32:35], a[128:131], v[80:95]
    v_mfma_f32_32x32x16_bf16 v[80:95], v[32:35], a[132:135], v[80:95]
    v_mfma_f32_32x32x16_bf16 v[80:95], v[32:35], a[136:139], v[80:95]
    v_mfma_f32_32x32x16_bf16 v[80:95], v[32:35], a[140:143], v[80:95]
B_cd:
    v_and_b32 v61, 31, v60
    v_and_b32 v62, 19, v60
    v_bfe_u32 v63, v60, 2, 1
    v_lshl_add_u32 v62, v63, 3, v62
    v_bfe_u32 v63, v60, 3, 1
    v_lshl_add_u32 v62, v63, 2, v62
    s_cmp_eq_u32 s38, 1
    s_cselect_b64 vcc, -1, 0
    v_lshrrev_b32 v63, 5, v60
    v_cndmask_b32 v62, v61, v62, vcc
    s_cmp_eq_u32 s52, 0
    s_cbranch_scc0 B_a1
    v_lshlrev_b32 v3, 4, v62
    v_lshl_add_u32 v3, v63, 9, v3
    s_lshl_b32 s50, s39, 17
    s_lshl_b32 s41, s38, 21
    s_add_u32 s50, s50, s41
    s_add_u32 s50, s50, 83886080
    s_mov_b32 s51, 1024
    s_branch B_ad
B_a1:
    s_cmp_eq_u32 s52, 1
    s_cbranch_scc0 B_a2
    v_lshlrev_b32 v3, 2, v62
    v_lshl_add_u32 v3, v63, 14, v3
    s_sub_u32 s50, s39, 16
    s_lshl_b32 s50, s50, 17
    s_lshl_b32 s41, s38, 18
    s_add_u32 s50, s50, s41
    s_add_u32 s50, s50, 88080384
    s_mov_b32 s51, 128
    s_branch B_ad
B_a2:
    s_lshl_b32 s41, s39, 5
    v_add_u32 v62, s41, v61
    v_mul_u32_u24 v64, 3641, v62
    v_lshrrev_b32 v64, 16, v64
    v_mul_u32_u24 v65, 18, v64
    v_sub_u32 v62, v62, v65
    s_cmp_eq_u32 s52, 3
    s_cselect_b64 vcc, -1, 0
    s_nop 0
    v_cndmask_b32 v64, v64, v61, vcc
    v_mov_b32 v65, 18
    v_cndmask_b32 v62, v62, v65, vcc
    v_mul_u32_u24 v3, 77824, v64
    v_lshl_add_u32 v3, v62, 4, v3
    v_mul_u32_u24 v63, 304, v63
    v_add_u32 v3, v3, v63
    s_mov_b32 s50, 89128960
    s_mov_b32 s51, 1216
B_ad:
    v_lshlrev_b32 v0, 4, v60
    s_waitcnt lgkmcnt(0)
    s_cmp_lg_u32 s32, 0
    s_cbranch_scc1 B_iw_ok
    s_mov_b32 s94, 40
B_iw:
    buffer_load_dword v79, off, s[4:7], s94 sc1
    s_sub_u32 s95, s95, 1
    s_cmp_eq_u32 s95, 0
    s_cbranch_scc1 L_end
    s_waitcnt vmcnt(0)
    v_cmp_gt_u32 vcc, 32, v79
    s_cbranch_vccz B_iw_ok
    s_sleep 1
    s_branch B_iw
B_iw_ok:
    s_barrier
B_layer:
    s_mov_b32 s37, s34
    s_mov_b32 s53, -1
    v_mov_b32 v6, 0
    s_mov_b32 s56, 0
B_loop:
    s_cmp_eq_u32 s53, s37
    s_cbranch_scc0 B_get
    s_waitcnt vmcnt(0)
    v_mov_b64 v[100:101], v[120:121]
    v_mov_b64 v[102:103], v[122:123]
    v_mov_b64 v[104:105], v[124:125]
    v_mov_b64 v[106:107], v[126:127]
    v_mov_b64 v[108:109], v[128:129]
    v_mov_b64 v[110:111], v[130:131]
    s_branch B_have
B_get:
    s_lshl_b32 s41, s37, 7
    s_add_u32 s41, s41, 3182592
    v_cmp_gt_u32 vcc, 24, v6
    s_cbranch_vccz B_fl_ok
B_fl:
    buffer_load_dword v4, off, s[8:11], s41 sc1
    s_sub_u32 s95, s95, 1
    s_cmp_eq_u32 s95, 0
    s_cbranch_scc1 L_end
    s_waitcnt vmcnt(0)
    v_cmp_gt_u32 vcc, 24, v4
    s_cbranch_vccz B_fl_ok
    s_sleep 1
    s_branch B_fl
B_fl_ok:
    s_mul_i32 s41, s37, 36864
    s_add_u32 s41, s41, s47
    s_add_u32 s41, s41, 8388608
    s_add_u32 s42, s56, s47
    s_add_u32 m0, s42, 0
    s_add_u32 s44, s41, 0
    buffer_load_dwordx4 v0, s[8:11], s44 offen offset:0 sc1 lds
    buffer_load_dwordx4 v0, s[8:11], s44 offen offset:1024 sc1 lds
    buffer_load_dwordx4 v0, s[8:11], s44 offen offset:2048 sc1 lds
    buffer_load_dwordx4 v0, s[8:11], s44 offen offset:3072 sc1 lds
    s_add_u32 m0, s42, 4096
    s_add_u32 s44, s41, 4096
    buffer_load_dwordx4 v0, s[8:11], s44 offen offset:0 sc1 lds
    buffer_load_dwordx4 v0, s[8:11], s44 offen offset:1024 sc1 lds
    buffer_load_dwordx4 v0, s[8:11], s44 offen offset:2048 sc1 lds
    buffer_load_dwordx4 v0, s[8:11], s44 offen offset:3072 sc1 lds
    s_add_u32 m0, s42, 8192
    s_add_u32 s44, s41, 8192
    buffer_load_dwordx4 v0, s[8:11], s44 offen offset:0 sc1 lds
    s_mul_i32 s41, s37, 3072
    s_add_u32 s41, s41, 31457280
    buffer_load_dwordx2 v[100:101], v1, s[8:11], s41 offen offset:0 sc1
    buffer_load_dwordx2 v[102:103], v1, s[8:11], s41 offen offset:512 sc1
    buffer_load_dwordx2 v[104:105], v1, s[8:11], s41 offen offset:1024 sc1
    buffer_load_dwordx2 v[106:107], v1, s[8:11], s41 offen offset:1536 sc1
    buffer_load_dwordx2 v[108:109], v1, s[8:11], s41 offen offset:2048 sc1
    buffer_load_dwordx2 v[110:111], v1, s[8:11], s41 offen offset:2560 sc1
    s_waitcnt vmcnt(6)
B_have:
    s_add_u32 s54, s37, 2
    s_lshl_b32 s55, s54, 7
    s_add_u32 s55, s55, 3182592
    buffer_load_dword v6, off, s[8:11], s55 sc1
    v_add_u32 v5, s56, v0
    s_xor_b32 s56, s56, 36864
    s_barrier
    s_cmp_ge_u32 s52, 2
    s_cbranch_scc1 B_v
    ds_read_b128 v[32:35], v5 offset:0
    ds_read_b128 v[36:39], v5 offset:1024
    ds_read_b128 v[40:43], v5 offset:2048
    ds_read_b128 v[44:47], v5 offset:3072
    ds_read_b128 v[48:51], v5 offset:4096
    s_waitcnt lgkmcnt(4)
    v_mfma_f32_32x32x16_bf16 v[8:23], a[0:3], v[32:35], 0
    ds_read_b128 v[52:55], v5 offset:5120
    s_waitcnt lgkmcnt(4)
    v_mfma_f32_32x32x16_bf16 v[8:23], a[4:7], v[36:39], v[8:23]
    ds_read_b128 v[32:35], v5 offset:6144
    s_waitcnt lgkmcnt(4)
    v_mfma_f32_32x32x16_bf16 v[8:23], a[8:11], v[40:43], v[8:23]
    ds_read_b128 v[36:39], v5 offset:7168
    s_waitcnt lgkmcnt(4)
    v_mfma_f32_32x32x16_bf16 v[8:23], a[12:15], v[44:47], v[8:23]
    ds_read_b128 v[40:43], v5 offset:8192
    s_waitcnt lgkmcnt(4)
    v_mfma_f32_32x32x16_bf16 v[8:23], a[16:19], v[48:51], v[8:23]
    ds_read_b128 v[44:47], v5 offset:9216
    s_waitcnt lgkmcnt(4)
    v_mfma_f32_32x32x16_bf16 v[8:23], a[20:23], v[52:55], v[8:23]
    ds_read_b128 v[48:51], v5 offset:10240
    s_waitcnt lgkmcnt(4)
    v_mfma_f32_32x32x16_bf16 v[8:23], a[24:27], v[32:35], v[8:23]
    ds_read_b128 v[52:55], v5 offset:11264
    s_waitcnt lgkmcnt(4)
    v_mfma_f32_32x32x16_bf16 v[8:23], a[28:31], v[36:39], v[8:23]
    ds_read_b128 v[32:35], v5 offset:12288
    s_waitcnt lgkmcnt(4)
    v_mfma_f32_32x32x16_bf16 v[8:23], a[32:35], v[40:43], v[8:23]
    ds_read_b128 v[36:39], v5 offset:13312
    s_waitcnt vmcnt(1)
    v_add_f32 v100, v100, v102
    v_add_f32 v101, v101, v103
    v_add_f32 v100, v100, v104
    s_waitcnt lgkmcnt(4)
    v_mfma_f32_32x32x16_bf16 v[8:23], a[36:39], v[44:47], v[8:23]
    ds_read_b128 v[40:43], v5 offset:14336
    v_add_f32 v101, v101, v105
    v_add_f32 v100, v100, v106
    v_add_f32 v101, v101, v107
    s_waitcnt lgkmcnt(4)
    v_mfma_f32_32x32x16_bf16 v[8:23], a[40:43], v[48:51], v[8:23]
    ds_read_b128 v[44:47], v5 offset:15360
    v_add_f32 v100, v100, v108
    v_add_f32 v101, v101, v109
    v_add_f32 v100, v100, v110
    s_waitcnt lgkmcnt(4)
    v_mfma_f32_32x32x16_bf16 v[8:23], a[44:47], v[52:55], v[8:23]
    ds_read_b128 v[48:51], v5 offset:16384
    v_add_f32 v101, v101, v111
    v_mov_b32 v57, v100
    v_mov_b32 v58, v101
    s_waitcnt lgkmcnt(4)
    v_mfma_f32_32x32x16_bf16 v[8:23], a[48:51], v[32:35], v[8:23]
    ds_read_b128 v[52:55], v5 offset:17408
    s_nop 0
    v_permlane32_swap_b32 v100, v57
    v_permlane32_swap_b32 v101, v58
    s_waitcnt lgkmcnt(4)
    v_mfma_f32_32x32x16_bf16 v[8:23], a[52:55], v[36:39], v[8:23]
    ds_read_b128 v[32:35], v5 offset:18432
    v_add_f32 v100, v100, v57
    v_add_f32 v101, v101, v58
    v_mul_f32 v100, 0xbae38e39, v100
    s_waitcnt lgkmcnt(4)
    v_mfma_f32_32x32x16_bf16 v[8:23], a[56:59], v[40:43], v[8:23]
    ds_read_b128 v[36:39], v5 offset:19456
    v_mul_f32 v101, 0x3ae38e39, v101
    v_fma_f32 v101, -v100, v100, v101
    v_max_f32 v101, 0, v101
    s_waitcnt lgkmcnt(4)
    v_mfma_f32_32x32x16_bf16 v[8:23], a[60:63], v[44:47], v[8:23]
    ds_read_b128 v[40:43], v5 offset:20480
    v_add_f32 v101, 0x3727c5ac, v101
    v_rsq_f32 v101, v101
    s_nop 0
    s_waitcnt lgkmcnt(4)
    v_mfma_f32_32x32x16_bf16 v[8:23], a[64:67], v[48:51], v[8:23]
    ds_read_b128 v[44:47], v5 offset:21504
    v_mul_f32 v100, v100, v101
    v_mul_f32 v100, s48, v100
    v_mul_f32 v101, s48, v101
    s_waitcnt lgkmcnt(4)
    v_mfma_f32_32x32x16_bf16 v[8:23], a[68:71], v[52:55], v[8:23]
    ds_read_b128 v[48:51], v5 offset:22528
    v_mul_f32 v140, v100, v80
    v_mul_f32 v141, v100, v81
    v_mul_f32 v142, v100, v82
    s_waitcnt lgkmcnt(4)
    v_mfma_f32_32x32x16_bf16 v[8:23], a[72:75], v[32:35], v[8:23]
    ds_read_b128 v[52:55], v5 offset:23552
    v_mul_f32 v143, v100, v83
    v_mul_f32 v144, v100, v84
    v_mul_f32 v145, v100, v85
    s_waitcnt lgkmcnt(4)
    v_mfma_f32_32x32x16_bf16 v[8:23], a[76:79], v[36:39], v[8:23]
    ds_read_b128 v[32:35], v5 offset:24576
    v_mul_f32 v146, v100, v86
    v_mul_f32 v147, v100, v87
    v_mul_f32 v148, v100, v88
    s_waitcnt lgkmcnt(4)
    v_mfma_f32_32x32x16_bf16 v[8:23], a[80:83], v[40:43], v[8:23]
    ds_read_b128 v[36:39], v5 offset:25600
    v_mul_f32 v149, v100, v89
    v_mul_f32 v150, v100, v90
    v_mul_f32 v151, v100, v91
    s_waitcnt lgkmcnt(4)
    v_mfma_f32_32x32x16_bf16 v[8:23], a[84:87], v[44:47], v[8:23]
    ds_read_b128 v[40:43], v5 offset:26624
    v_mul_f32 v152, v100, v92
    v_mul_f32 v153, v100, v93
    v_mul_f32 v154, v100, v94
    s_waitcnt lgkmcnt(4)
    v_mfma_f32_32x32x16_bf16 v[8:23], a[88:91], v[48:51], v[8:23]
    ds_read_b128 v[44:47], v5 offset:27648
    v_mul_f32 v155, v100, v95
    s_waitcnt lgkmcnt(4)
    v_mfma_f32_32x32x16_bf16 v[8:23], a[92:95], v[52:55], v[8:23]
    ds_read_b128 v[48:51], v5 offset:28672
    s_waitcnt lgkmcnt(4)
    v_mfma_f32_32x32x16_bf16 v[8:23], a[96:99], v[32:35], v[8:23]
    ds_read_b128 v[52:55], v5 offset:29696
    s_waitcnt lgkmcnt(4)
    v_mfma_f32_32x32x16_bf16 v[8:23], a[100:103], v[36:39], v[8:23]
    ds_read_b128 v[32:35], v5 offset:30720
    s_waitcnt lgkmcnt(4)
    v_mfma_f32_32x32x16_bf16 v[8:23], a[104:107], v[40:43], v[8:23]
    ds_read_b128 v[36:39], v5 offset:31744
    s_waitcnt lgkmcnt(4)
    v_mfma_f32_32x32x16_bf16 v[8:23], a[108:111], v[44:47], v[8:23]
    ds_read_b128 v[40:43], v5 offset:32768
    s_waitcnt lgkmcnt(4)
    v_mfma_f32_32x32x16_bf16 v[8:23], a[112:115], v[48:51], v[8:23]
    ds_read_b128 v[44:47], v5 offset:33792
    s_waitcnt lgkmcnt(4)
    v_mfma_f32_32x32x16_bf16 v[8:23], a[116:119], v[52:55], v[8:23]
    ds_read_b128 v[48:51], v5 offset:34816
    s_waitcnt lgkmcnt(4)
    v_mfma_f32_32x32x16_bf16 v[8:23], a[120:123], v[32:35], v[8:23]
    ds_read_b128 v[52:55], v5 offset:35840
    s_waitcnt lgkmcnt(4)
    v_mfma_f32_32x32x16_bf16 v[8:23], a[124:127], v[36:39], v[8:23]
    s_waitcnt lgkmcnt(3)
    v_mfma_f32_32x32x16_bf16 v[8:23], a[128:131], v[40:43], v[8:23]
    s_waitcnt lgkmcnt(2)
    v_mfma_f32_32x32x16_bf16 v[8:23], a[132:135], v[44:47], v[8:23]
    s_waitcnt lgkmcnt(1)
    v_mfma_f32_32x32x16_bf16 v[8:23], a[136:139], v[48:51], v[8:23]
    s_waitcnt lgkmcnt(0)
    v_mfma_f32_32x32x16_bf16 v[8:23], a[140:143], v[52:55], v[8:23]
    s_waitcnt vmcnt(0)
    v_cmp_gt_u32 vcc, 24, v6
    s_mul_i32 s41, s37, s51
    s_add_u32 s41, s41, s50
    s_nop 7
    v_fma_f32 v8, v8, v101, v140
    v_fma_f32 v9, v9, v101, v141
    v_fma_f32 v10, v10, v101, v142
    v_fma_f32 v11, v11, v101, v143
    v_fma_f32 v12, v12, v101, v144
    v_fma_f32 v13, v13, v101, v145
    v_fma_f32 v14, v14, v101, v146
    v_fma_f32 v15, v15, v101, v147
    v_fma_f32 v16, v16, v101, v148
    v_fma_f32 v17, v17, v101, v149
    v_fma_f32 v18, v18, v101, v150
    v_fma_f32 v19, v19, v101, v151
    v_fma_f32 v20, v20, v101, v152
    v_fma_f32 v21, v21, v101, v153
    v_fma_f32 v22, v22, v101, v154
    v_fma_f32 v23, v23, v101, v155
    v_cvt_pk_bf16_f32 v24, v8, v9
    v_cvt_pk_bf16_f32 v25, v10, v11
    v_cvt_pk_bf16_f32 v26, v12, v13
    v_cvt_pk_bf16_f32 v27, v14, v15
    v_cvt_pk_bf16_f32 v28, v16, v17
    v_cvt_pk_bf16_f32 v29, v18, v19
    v_cvt_pk_bf16_f32 v30, v20, v21
    v_cvt_pk_bf16_f32 v31, v22, v23
    s_cmp_eq_u32 s52, 1
    s_cbranch_scc1 B_rem
    buffer_store_dwordx4 v[24:27], v3, s[8:11], s41 offen sc1
    s_add_u32 s41, s41, 65536
    buffer_store_dwordx4 v[28:31], v3, s[8:11], s41 offen sc1
    s_branch B_next
B_rem:
    s_add_u32 s42, s41, 0
    buffer_store_dword v24, v3, s[8:11], s42 offen sc1
    s_add_u32 s42, s41, 8192
    buffer_store_dword v25, v3, s[8:11], s42 offen sc1
    s_add_u32 s42, s41, 32768
    buffer_store_dword v26, v3, s[8:11], s42 offen sc1
    s_add_u32 s42, s41, 40960
    buffer_store_dword v27, v3, s[8:11], s42 offen sc1
    s_add_u32 s42, s41, 65536
    buffer_store_dword v28, v3, s[8:11], s42 offen sc1
    s_add_u32 s42, s41, 73728
    buffer_store_dword v29, v3, s[8:11], s42 offen sc1
    s_add_u32 s42, s41, 98304
    buffer_store_dword v30, v3, s[8:11], s42 offen sc1
    s_add_u32 s42, s41, 106496
    buffer_store_dword v31, v3, s[8:11], s42 offen sc1
    s_branch B_next
B_v:
    v_mov_b32 v24, s49
    v_mov_b32 v25, s49
    v_mov_b32 v26, s49
    v_mov_b32 v27, s49
    v_mov_b32 v28, s49
    v_mov_b32 v29, s49
    v_mov_b32 v30, s49
    v_mov_b32 v31, s49
    s_cmp_eq_u32 s52, 3
    s_cbranch_scc0 B_vg
    s_waitcnt vmcnt(0)
    v_cmp_gt_u32 vcc, 24, v6
    s_mul_i32 s41, s37, s51
    s_add_u32 s41, s41, s50
    s_branch B_vs
B_vg:
    ds_read_b128 v[32:35], v5 offset:0
    ds_read_b128 v[36:39], v5 offset:1024
    ds_read_b128 v[40:43], v5 offset:2048
    ds_read_b128 v[44:47], v5 offset:3072
    ds_read_b128 v[48:51], v5 offset:4096
    s_waitcnt lgkmcnt(4)
    v_mfma_f32_32x32x16_bf16 v[8:23], v[32:35], a[0:3], 0
    ds_read_b128 v[52:55], v5 offset:5120
    s_waitcnt lgkmcnt(4)
    v_mfma_f32_32x32x16_bf16 v[8:23], v[36:39], a[4:7], v[8:23]
    ds_read_b128 v[32:35], v5 offset:6144
    s_waitcnt lgkmcnt(4)
    v_mfma_f32_32x32x16_bf16 v[8:23], v[40:43], a[8:11], v[8:23]
    ds_read_b128 v[36:39], v5 offset:7168
    s_waitcnt lgkmcnt(4)
    v_mfma_f32_32x32x16_bf16 v[8:23], v[44:47], a[12:15], v[8:23]
    ds_read_b128 v[40:43], v5 offset:8192
    s_waitcnt lgkmcnt(4)
    v_mfma_f32_32x32x16_bf16 v[8:23], v[48:51], a[16:19], v[8:23]
    ds_read_b128 v[44:47], v5 offset:9216
    s_waitcnt lgkmcnt(4)
    v_mfma_f32_32x32x16_bf16 v[8:23], v[52:55], a[20:23], v[8:23]
    ds_read_b128 v[48:51], v5 offset:10240
    s_waitcnt lgkmcnt(4)
    v_mfma_f32_32x32x16_bf16 v[8:23], v[32:35], a[24:27], v[8:23]
    ds_read_b128 v[52:55], v5 offset:11264
    s_waitcnt lgkmcnt(4)
    v_mfma_f32_32x32x16_bf16 v[8:23], v[36:39], a[28:31], v[8:23]
    ds_read_b128 v[32:35], v5 offset:12288
    s_waitcnt lgkmcnt(4)
    v_mfma_f32_32x32x16_bf16 v[8:23], v[40:43], a[32:35], v[8:23]
    ds_read_b128 v[36:39], v5 offset:13312
    s_waitcnt vmcnt(1)
    v_add_f32 v100, v100, v102
    v_add_f32 v101, v101, v103
    v_add_f32 v100, v100, v104
    s_waitcnt lgkmcnt(4)
    v_mfma_f32_32x32x16_bf16 v[8:23], v[44:47], a[36:39], v[8:23]
    ds_read_b128 v[40:43], v5 offset:14336
    v_add_f32 v101, v101, v105
    v_add_f32 v100, v100, v106
    v_add_f32 v101, v101, v107
    s_waitcnt lgkmcnt(4)
    v_mfma_f32_32x32x16_bf16 v[8:23], v[48:51], a[40:43], v[8:23]
    ds_read_b128 v[44:47], v5 offset:15360
    v_add_f32 v100, v100, v108
    v_add_f32 v101, v101, v109
    v_add_f32 v100, v100, v110
    s_waitcnt lgkmcnt(4)
    v_mfma_f32_32x32x16_bf16 v[8:23], v[52:55], a[44:47], v[8:23]
    ds_read_b128 v[48:51], v5 offset:16384
    v_add_f32 v101, v101, v111
    v_mov_b32 v57, v100
    v_mov_b32 v58, v101
    s_waitcnt lgkmcnt(4)
    v_mfma_f32_32x32x16_bf16 v[8:23], v[32:35], a[48:51], v[8:23]
    ds_read_b128 v[52:55], v5 offset:17408
    s_nop 0
    v_permlane32_swap_b32 v100, v57
    v_permlane32_swap_b32 v101, v58
    s_waitcnt lgkmcnt(4)
    v_mfma_f32_32x32x16_bf16 v[8:23], v[36:39], a[52:55], v[8:23]
    ds_read_b128 v[32:35], v5 offset:18432
    v_add_f32 v100, v100, v57
    v_add_f32 v101, v101, v58
    v_mul_f32 v100, 0xbae38e39, v100
    s_waitcnt lgkmcnt(4)
    v_mfma_f32_32x32x16_bf16 v[8:23], v[40:43], a[56:59], v[8:23]
    ds_read_b128 v[36:39], v5 offset:19456
    v_mul_f32 v101, 0x3ae38e39, v101
    v_fma_f32 v101, -v100, v100, v101
    v_max_f32 v101, 0, v101
    s_waitcnt lgkmcnt(4)
    v_mfma_f32_32x32x16_bf16 v[8:23], v[44:47], a[60:63], v[8:23]
    ds_read_b128 v[40:43], v5 offset:20480
    v_add_f32 v101, 0x3727c5ac, v101
    v_rsq_f32 v101, v101
    s_nop 0
    s_waitcnt lgkmcnt(4)
    v_mfma_f32_32x32x16_bf16 v[8:23], v[48:51], a[64:67], v[8:23]
    ds_read_b128 v[44:47], v5 offset:21504
    v_mul_f32 v100, v100, v101
    ds_write2_b32 v2, v100, v101 offset0:0 offset1:32
    ds_read_b128 v[140:143], v56 offset:0
    s_waitcnt lgkmcnt(6)
    v_mfma_f32_32x32x16_bf16 v[8:23], v[52:55], a[68:71], v[8:23]
    ds_read_b128 v[48:51], v5 offset:22528
    ds_read_b128 v[144:147], v56 offset:32
    ds_read_b128 v[148:151], v56 offset:64
    ds_read_b128 v[152:155], v56 offset:96
    s_waitcnt lgkmcnt(9)
    v_mfma_f32_32x32x16_bf16 v[8:23], v[32:35], a[72:75], v[8:23]
    ds_read_b128 v[52:55], v5 offset:23552
    ds_read_b128 v[156:159], v56 offset:128
    ds_read_b128 v[160:163], v56 offset:160
    ds_read_b128 v[164:167], v56 offset:192
    s_waitcnt lgkmcnt(12)
    v_mfma_f32_32x32x16_bf16 v[8:23], v[36:39], a[76:79], v[8:23]
    ds_read_b128 v[32:35], v5 offset:24576
    ds_read_b128 v[168:171], v56 offset:224
    s_nop 0
    s_nop 0
    s_waitcnt lgkmcnt(13)
    v_mfma_f32_32x32x16_bf16 v[8:23], v[40:43], a[80:83], v[8:23]
    ds_read_b128 v[36:39], v5 offset:25600
    s_nop 0
    s_nop 0
    s_waitcnt lgkmcnt(11)
    v_mul_f32 v140, v140, v80
    v_mfma_f32_32x32x16_bf16 v[8:23], v[44:47], a[84:87], v[8:23]
    ds_read_b128 v[40:43], v5 offset:26624
    v_mul_f32 v141, v141, v80
    v_mul_f32 v142, v142, v80
    v_mul_f32 v143, v143, v80
    s_waitcnt lgkmcnt(11)
    v_mfma_f32_32x32x16_bf16 v[8:23], v[48:51], a[88:91], v[8:23]
    ds_read_b128 v[44:47], v5 offset:27648
    s_waitcnt lgkmcnt(11)
    v_mul_f32 v144, v144, v80
    v_mul_f32 v145, v145, v80
    v_mul_f32 v146, v146, v80
    s_waitcnt lgkmcnt(8)
    v_mfma_f32_32x32x16_bf16 v[8:23], v[52:55], a[92:95], v[8:23]
    ds_read_b128 v[48:51], v5 offset:28672
    v_mul_f32 v147, v147, v80
    v_mul_f32 v148, v148, v80
    v_mul_f32 v149, v149, v80
    s_waitcnt lgkmcnt(5)
    v_mfma_f32_32x32x16_bf16 v[8:23], v[32:35], a[96:99], v[8:23]
    ds_read_b128 v[52:55], v5 offset:29696
    v_mul_f32 v150, v150, v80
    v_mul_f32 v151, v151, v80
    v_mul_f32 v152, v152, v80
    s_waitcnt lgkmcnt(4)
    v_mfma_f32_32x32x16_bf16 v[8:23], v[36:39], a[100:103], v[8:23]
    ds_read_b128 v[32:35], v5 offset:30720
    v_mul_f32 v153, v153, v80
    v_mul_f32 v154, v154, v80
    v_mul_f32 v155, v155, v80
    s_waitcnt lgkmcnt(4)
    v_mfma_f32_32x32x16_bf16 v[8:23], v[40:43], a[104:107], v[8:23]
    ds_read_b128 v[36:39], v5 offset:31744
    s_waitcnt lgkmcnt(4)
    v_mfma_f32_32x32x16_bf16 v[8:23], v[44:47], a[108:111], v[8:23]
    ds_read_b128 v[40:43], v5 offset:32768
    s_waitcnt lgkmcnt(4)
    v_mfma_f32_32x32x16_bf16 v[8:23], v[48:51], a[112:115], v[8:23]
    ds_read_b128 v[44:47], v5 offset:33792
    s_waitcnt lgkmcnt(4)
    v_mfma_f32_32x32x16_bf16 v[8:23], v[52:55], a[116:119], v[8:23]
    ds_read_b128 v[48:51], v5 offset:34816
    s_waitcnt lgkmcnt(4)
    v_mfma_f32_32x32x16_bf16 v[8:23], v[32:35], a[120:123], v[8:23]
    ds_read_b128 v[52:55], v5 offset:35840
    s_waitcnt lgkmcnt(4)
    v_mfma_f32_32x32x16_bf16 v[8:23], v[36:39], a[124:127], v[8:23]
    s_waitcnt lgkmcnt(3)
    v_mfma_f32_32x32x16_bf16 v[8:23], v[40:43], a[128:131], v[8:23]
    s_waitcnt lgkmcnt(2)
    v_mfma_f32_32x32x16_bf16 v[8:23], v[44:47], a[132:135], v[8:23]
    s_waitcnt lgkmcnt(1)
    v_mfma_f32_32x32x16_bf16 v[8:23], v[48:51], a[136:139], v[8:23]
    s_waitcnt lgkmcnt(0)
    v_mfma_f32_32x32x16_bf16 v[8:23], v[52:55], a[140:143], v[8:23]
    s_waitcnt vmcnt(0)
    v_cmp_gt_u32 vcc, 24, v6
    s_mul_i32 s41, s37, s51
    s_add_u32 s41, s41, s50
    s_nop 7
    v_fma_f32 v8, v8, v156, v140
    v_fma_f32 v9, v9, v157, v141
    v_fma_f32 v10, v10, v158, v142
    v_fma_f32 v11, v11, v159, v143
    v_fma_f32 v12, v12, v160, v144
    v_fma_f32 v13, v13, v161, v145
    v_fma_f32 v14, v14, v162, v146
    v_fma_f32 v15, v15, v163, v147
    v_fma_f32 v16, v16, v164, v148
    v_fma_f32 v17, v17, v165, v149
    v_fma_f32 v18, v18, v166, v150
    v_fma_f32 v19, v19, v167, v151
    v_fma_f32 v20, v20, v168, v152
    v_fma_f32 v21, v21, v169, v153
    v_fma_f32 v22, v22, v170, v154
    v_fma_f32 v23, v23, v171, v155
    v_cvt_pk_bf16_f32 v24, v8, v9
    v_cvt_pk_bf16_f32 v25, v10, v11
    v_cvt_pk_bf16_f32 v26, v12, v13
    v_cvt_pk_bf16_f32 v27, v14, v15
    v_cvt_pk_bf16_f32 v28, v16, v17
    v_cvt_pk_bf16_f32 v29, v18, v19
    v_cvt_pk_bf16_f32 v30, v20, v21
    v_cvt_pk_bf16_f32 v31, v22, v23
B_vs:
    buffer_store_dwordx4 v[24:27], v3, s[8:11], s41 offen sc1
    buffer_store_dwordx4 v[28:31], v3, s[8:11], s41 offen offset:608 sc1
B_next:
    s_cbranch_vccnz B_n1
    s_mul_i32 s41, s54, 36864
    s_add_u32 s41, s41, s47
    s_add_u32 s41, s41, 8388608
    s_add_u32 s42, s56, s47
    s_add_u32 m0, s42, 0
    s_add_u32 s44, s41, 0
    buffer_load_dwordx4 v0, s[8:11], s44 offen offset:0 sc1 lds
    buffer_load_dwordx4 v0, s[8:11], s44 offen offset:1024 sc1 lds
    buffer_load_dwordx4 v0, s[8:11], s44 offen offset:2048 sc1 lds
    buffer_load_dwordx4 v0, s[8:11], s44 offen offset:3072 sc1 lds
    s_add_u32 m0, s42, 4096
    s_add_u32 s44, s41, 4096
    buffer_load_dwordx4 v0, s[8:11], s44 offen offset:0 sc1 lds
    buffer_load_dwordx4 v0, s[8:11], s44 offen offset:1024 sc1 lds
    buffer_load_dwordx4 v0, s[8:11], s44 offen offset:2048 sc1 lds
    buffer_load_dwordx4 v0, s[8:11], s44 offen offset:3072 sc1 lds
    s_add_u32 m0, s42, 8192
    s_add_u32 s44, s41, 8192
    buffer_load_dwordx4 v0, s[8:11], s44 offen offset:0 sc1 lds
    s_mul_i32 s41, s54, 3072
    s_add_u32 s41, s41, 31457280
    buffer_load_dwordx2 v[120:121], v1, s[8:11], s41 offen offset:0 sc1
    buffer_load_dwordx2 v[122:123], v1, s[8:11], s41 offen offset:512 sc1
    buffer_load_dwordx2 v[124:125], v1, s[8:11], s41 offen offset:1024 sc1
    buffer_load_dwordx2 v[126:127], v1, s[8:11], s41 offen offset:1536 sc1
    buffer_load_dwordx2 v[128:129], v1, s[8:11], s41 offen offset:2048 sc1
    buffer_load_dwordx2 v[130:131], v1, s[8:11], s41 offen offset:2560 sc1
    s_mov_b32 s53, s54
    s_waitcnt vmcnt(15)
    s_branch B_n2
B_n1:
    buffer_load_dword v6, off, s[8:11], s55 sc1
    s_waitcnt vmcnt(0)
B_n2:
    s_lshr_b32 s41, s37, 3
    s_lshl_b32 s41, s41, 7
    s_add_u32 s41, s41, 3198976
    v_mov_b32 v4, 1
    s_barrier
    s_cmp_lg_u32 s32, 1
    s_cbranch_scc1 B_ns
    s_mov_b64 exec, 1
    buffer_atomic_add v4, off, s[8:11], s41
    s_mov_b64 exec, -1
B_ns:
    s_add_u32 s37, s37, 2
    s_cmp_lt_u32 s37, 64
    s_cbranch_scc1 B_loop
    s_cmp_lg_u32 s96, 0
    s_cbranch_scc1 L_end
    s_mov_b32 s96, 1
    s_add_u32 s8, s8, 100663296
    s_addc_u32 s9, s9, 0
    s_mov_b32 s10, 167772160
    s_branch B_layer
R_o:
    v_and_b32 v60, 63, v0
    s_mul_i32 s41, s32, 1179648
    s_mul_i32 s42, s35, 96
    s_add_u32 s41, s41, s42
    v_lshrrev_b32 v61, 2, v60
    v_mul_u32_u24 v61, 1152, v61
    v_and_b32 v62, 3, v60
    v_lshlrev_b32 v63, 4, v62
    v_add3_u32 v64, v61, v63, s41
    v_lshrrev_b32 v61, 1, v60
    v_mul_u32_u24 v61, 1152, v61
    v_and_b32 v65, 16, v63
    v_add3_u32 v65, v61, v65, s41
    s_mul_i32 s43, s32, 36864
    s_add_u32 m0, s43, 0
    s_mov_b32 s44, 0
    buffer_load_dwordx4 v64, s[24:27], s44 offen lds
    s_add_u32 m0, s43, 1024
    s_mov_b32 s44, 18432
    buffer_load_dwordx4 v64, s[24:27], s44 offen lds
    s_add_u32 m0, s43, 2048
    s_mov_b32 s44, 36864
    buffer_load_dwordx4 v64, s[24:27], s44 offen lds
    s_add_u32 m0, s43, 3072
    s_mov_b32 s44, 55296
    buffer_load_dwordx4 v64, s[24:27], s44 offen lds
    s_add_u32 m0, s43, 4096
    s_mov_b32 s44, 64
    buffer_load_dwordx4 v65, s[24:27], s44 offen lds
    s_add_u32 m0, s43, 5120
    s_mov_b32 s44, 36928
    buffer_load_dwordx4 v65, s[24:27], s44 offen lds
    s_add_u32 m0, s43, 6144
    s_mov_b32 s44, 73728
    buffer_load_dwordx4 v64, s[24:27], s44 offen lds
    s_add_u32 m0, s43, 7168
    s_mov_b32 s44, 92160
    buffer_load_dwordx4 v64, s[24:27], s44 offen lds
    s_add_u32 m0, s43, 8192
    s_mov_b32 s44, 110592
    buffer_load_dwordx4 v64, s[24:27], s44 offen lds
    s_add_u32 m0, s43, 9216
    s_mov_b32 s44, 129024
    buffer_load_dwordx4 v64, s[24:27], s44 offen lds
    s_add_u32 m0, s43, 10240
    s_mov_b32 s44, 73792
    buffer_load_dwordx4 v65, s[24:27], s44 offen lds
    s_add_u32 m0, s43, 11264
    s_mov_b32 s44, 110656
    buffer_load_dwordx4 v65, s[24:27], s44 offen lds
    s_add_u32 m0, s43, 12288
    s_mov_b32 s44, 147456
    buffer_load_dwordx4 v64, s[24:27], s44 offen lds
    s_add_u32 m0, s43, 13312
    s_mov_b32 s44, 165888
    buffer_load_dwordx4 v64, s[24:27], s44 offen lds
    s_add_u32 m0, s43, 14336
    s_mov_b32 s44, 184320
    buffer_load_dwordx4 v64, s[24:27], s44 offen lds
    s_add_u32 m0, s43, 15360
    s_mov_b32 s44, 202752
    buffer_load_dwordx4 v64, s[24:27], s44 offen lds
    s_add_u32 m0, s43, 16384
    s_mov_b32 s44, 147520
    buffer_load_dwordx4 v65, s[24:27], s44 offen lds
    s_add_u32 m0, s43, 17408
    s_mov_b32 s44, 184384
    buffer_load_dwordx4 v65, s[24:27], s44 offen lds
    s_add_u32 m0, s43, 18432
    s_mov_b32 s44, 221184
    buffer_load_dwordx4 v64, s[24:27], s44 offen lds
    s_add_u32 m0, s43, 19456
    s_mov_b32 s44, 239616
    buffer_load_dwordx4 v64, s[24:27], s44 offen lds
    s_add_u32 m0, s43, 20480
    s_mov_b32 s44, 258048
    buffer_load_dwordx4 v64, s[24:27], s44 offen lds
    s_add_u32 m0, s43, 21504
    s_mov_b32 s44, 276480
    buffer_load_dwordx4 v64, s[24:27], s44 offen lds
    s_add_u32 m0, s43, 22528
    s_mov_b32 s44, 221248
    buffer_load_dwordx4 v65, s[24:27], s44 offen lds
    s_add_u32 m0, s43, 23552
    s_mov_b32 s44, 258112
    buffer_load_dwordx4 v65, s[24:27], s44 offen lds
    s_add_u32 m0, s43, 24576
    s_mov_b32 s44, 294912
    buffer_load_dwordx4 v64, s[24:27], s44 offen lds
    s_add_u32 m0, s43, 25600
    s_mov_b32 s44, 313344
    buffer_load_dwordx4 v64, s[24:27], s44 offen lds
    s_add_u32 m0, s43, 26624
    s_mov_b32 s44, 331776
    buffer_load_dwordx4 v64, s[24:27], s44 offen lds
    s_add_u32 m0, s43, 27648
    s_mov_b32 s44, 350208
    buffer_load_dwordx4 v64, s[24:27], s44 offen lds
    s_add_u32 m0, s43, 28672
    s_mov_b32 s44, 294976
    buffer_load_dwordx4 v65, s[24:27], s44 offen lds
    s_add_u32 m0, s43, 29696
    s_mov_b32 s44, 331840
    buffer_load_dwordx4 v65, s[24:27], s44 offen lds
    v_bfe_u32 v61, v60, 2, 3
    v_lshrrev_b32 v66, 5, v60
    v_lshl_add_u32 v61, v66, 4, v61
    v_lshlrev_b32 v61, 6, v61
    v_add_u32 v61, v61, v63
    v_add_u32 v66, s43, v61
    v_lshrrev_b32 v61, 1, v61
    v_add_u32 v67, s43, v61
    v_and_b32 v61, 15, v60
    v_lshrrev_b32 v62, 4, v60
    v_lshlrev_b32 v0, 4, v61
    s_mul_i32 s41, s35, 3072
    v_add_u32 v4, s41, v0
    v_lshl_add_u32 v0, v62, 9, v0
    v_add_u32 v3, s41, v0
    v_lshrrev_b32 v63, 5, v60
    v_lshl_add_u32 v4, v63, 9, v4
    v_add_u32 v4, 2048, v4
    v_and_b32 v63, 1, v62
    v_lshl_add_u32 v31, v63, 3, v4
    v_lshl_or_b32 v4, v63, 30, v4
    v_mul_u32_u24 v61, 1152, v61
    v_add_u32 v61, s42, v61
    v_lshl_add_u32 v1, v62, 4, v61
    v_lshl_add_u32 v2, v62, 3, v61
    v_add_u32 v2, 64, v2
    s_mov_b32 s38, 18432
    v_lshlrev_b32 v5, 4, v60
    s_lshl_b32 s41, s35, 8
    s_add_u32 s41, s41, 31457280
    v_lshlrev_b32 v61, 3, v60
    v_add_u32 v61, s41, v61
    v_cmp_gt_u32 vcc, 16, v60
    v_mov_b32 v62, 0x7ffff000
    s_nop 0
    v_cndmask_b32 v6, v62, v61, vcc
    s_mov_b32 s40, 0x3f803f80
    s_waitcnt vmcnt(24)
    ds_read_b64_tr_b16 a[0:1], v66 offset:0
    ds_read_b64_tr_b16 a[2:3], v66 offset:512
    ds_read_b64_tr_b16 a[4:5], v66 offset:8
    ds_read_b64_tr_b16 a[6:7], v66 offset:520
    ds_read_b64_tr_b16 v[128:129], v67 offset:4096
    ds_read_b64_tr_b16 v[130:131], v67 offset:4352
    ds_read_b64_tr_b16 a[8:9], v66 offset:2048
    ds_read_b64_tr_b16 a[10:11], v66 offset:2560
    ds_read_b64_tr_b16 a[12:13], v66 offset:2056
    ds_read_b64_tr_b16 a[14:15], v66 offset:2568
    ds_read_b64_tr_b16 v[132:133], v67 offset:5120
    ds_read_b64_tr_b16 v[134:135], v67 offset:5376
    s_add_u32 m0, s43, 30720
    s_mov_b32 s44, 368640
    buffer_load_dwordx4 v64, s[24:27], s44 offen lds
    s_add_u32 m0, s43, 31744
    s_mov_b32 s44, 387072
    buffer_load_dwordx4 v64, s[24:27], s44 offen lds
    s_add_u32 m0, s43, 32768
    s_mov_b32 s44, 405504
    buffer_load_dwordx4 v64, s[24:27], s44 offen lds
    s_add_u32 m0, s43, 33792
    s_mov_b32 s44, 423936
    buffer_load_dwordx4 v64, s[24:27], s44 offen lds
    s_add_u32 m0, s43, 34816
    s_mov_b32 s44, 368704
    buffer_load_dwordx4 v65, s[24:27], s44 offen lds
    s_add_u32 m0, s43, 35840
    s_mov_b32 s44, 405568
    buffer_load_dwordx4 v65, s[24:27], s44 offen lds
    s_waitcnt vmcnt(24)
    ds_read_b64_tr_b16 a[16:17], v66 offset:6144
    ds_read_b64_tr_b16 a[18:19], v66 offset:6656
    ds_read_b64_tr_b16 a[20:21], v66 offset:6152
    ds_read_b64_tr_b16 a[22:23], v66 offset:6664
    ds_read_b64_tr_b16 v[136:137], v67 offset:10240
    ds_read_b64_tr_b16 v[138:139], v67 offset:10496
    ds_read_b64_tr_b16 a[24:25], v66 offset:8192
    ds_read_b64_tr_b16 a[26:27], v66 offset:8704
    ds_read_b64_tr_b16 a[28:29], v66 offset:8200
    ds_read_b64_tr_b16 a[30:31], v66 offset:8712
    ds_read_b64_tr_b16 v[140:141], v67 offset:11264
    ds_read_b64_tr_b16 v[142:143], v67 offset:11520
    s_waitcnt lgkmcnt(12)
    s_add_u32 m0, s43, 0
    s_mov_b32 s44, 442368
    buffer_load_dwordx4 v64, s[24:27], s44 offen lds
    s_add_u32 m0, s43, 1024
    s_mov_b32 s44, 460800
    buffer_load_dwordx4 v64, s[24:27], s44 offen lds
    s_add_u32 m0, s43, 2048
    s_mov_b32 s44, 479232
    buffer_load_dwordx4 v64, s[24:27], s44 offen lds
    s_add_u32 m0, s43, 3072
    s_mov_b32 s44, 497664
    buffer_load_dwordx4 v64, s[24:27], s44 offen lds
    s_add_u32 m0, s43, 4096
    s_mov_b32 s44, 442432
    buffer_load_dwordx4 v65, s[24:27], s44 offen lds
    s_add_u32 m0, s43, 5120
    s_mov_b32 s44, 479296
    buffer_load_dwordx4 v65, s[24:27], s44 offen lds
    s_waitcnt vmcnt(24)
    ds_read_b64_tr_b16 a[32:33], v66 offset:12288
    ds_read_b64_tr_b16 a[34:35], v66 offset:12800
    ds_read_b64_tr_b16 a[36:37], v66 offset:12296
    ds_read_b64_tr_b16 a[38:39], v66 offset:12808
    ds_read_b64_tr_b16 v[144:145], v67 offset:16384
    ds_read_b64_tr_b16 v[146:147], v67 offset:16640
    ds_read_b64_tr_b16 a[40:41], v66 offset:14336
    ds_read_b64_tr_b16 a[42:43], v66 offset:14848
    ds_read_b64_tr_b16 a[44:45], v66 offset:14344
    ds_read_b64_tr_b16 a[46:47], v66 offset:14856
    ds_read_b64_tr_b16 v[148:149], v67 offset:17408
    ds_read_b64_tr_b16 v[150:151], v67 offset:17664
    s_waitcnt lgkmcnt(12)
    s_add_u32 m0, s43, 6144
    s_mov_b32 s44, 516096
    buffer_load_dwordx4 v64, s[24:27], s44 offen lds
    s_add_u32 m0, s43, 7168
    s_mov_b32 s44, 534528
    buffer_load_dwordx4 v64, s[24:27], s44 offen lds
    s_add_u32 m0, s43, 8192
    s_mov_b32 s44, 552960
    buffer_load_dwordx4 v64, s[24:27], s44 offen lds
    s_add_u32 m0, s43, 9216
    s_mov_b32 s44, 571392
    buffer_load_dwordx4 v64, s[24:27], s44 offen lds
    s_add_u32 m0, s43, 10240
    s_mov_b32 s44, 516160
    buffer_load_dwordx4 v65, s[24:27], s44 offen lds
    s_add_u32 m0, s43, 11264
    s_mov_b32 s44, 553024
    buffer_load_dwordx4 v65, s[24:27], s44 offen lds
    s_waitcnt vmcnt(24)
    ds_read_b64_tr_b16 a[48:49], v66 offset:18432
    ds_read_b64_tr_b16 a[50:51], v66 offset:18944
    ds_read_b64_tr_b16 a[52:53], v66 offset:18440
    ds_read_b64_tr_b16 a[54:55], v66 offset:18952
    ds_read_b64_tr_b16 v[152:153], v67 offset:22528
    ds_read_b64_tr_b16 v[154:155], v67 offset:22784
    ds_read_b64_tr_b16 a[56:57], v66 offset:20480
    ds_read_b64_tr_b16 a[58:59], v66 offset:20992
    ds_read_b64_tr_b16 a[60:61], v66 offset:20488
    ds_read_b64_tr_b16 a[62:63], v66 offset:21000
    ds_read_b64_tr_b16 v[156:157], v67 offset:23552
    ds_read_b64_tr_b16 v[158:159], v67 offset:23808
    s_waitcnt lgkmcnt(12)
    s_add_u32 m0, s43, 12288
    s_mov_b32 s44, 589824
    buffer_load_dwordx4 v64, s[24:27], s44 offen lds
    s_add_u32 m0, s43, 13312
    s_mov_b32 s44, 608256
    buffer_load_dwordx4 v64, s[24:27], s44 offen lds
    s_add_u32 m0, s43, 14336
    s_mov_b32 s44, 626688
    buffer_load_dwordx4 v64, s[24:27], s44 offen lds
    s_add_u32 m0, s43, 15360
    s_mov_b32 s44, 645120
    buffer_load_dwordx4 v64, s[24:27], s44 offen lds
    s_add_u32 m0, s43, 16384
    s_mov_b32 s44, 589888
    buffer_load_dwordx4 v65, s[24:27], s44 offen lds
    s_add_u32 m0, s43, 17408
    s_mov_b32 s44, 626752
    buffer_load_dwordx4 v65, s[24:27], s44 offen lds
    s_waitcnt vmcnt(24)
    ds_read_b64_tr_b16 a[64:65], v66 offset:24576
    ds_read_b64_tr_b16 a[66:67], v66 offset:25088
    ds_read_b64_tr_b16 a[68:69], v66 offset:24584
    ds_read_b64_tr_b16 a[70:71], v66 offset:25096
    ds_read_b64_tr_b16 v[160:161], v67 offset:28672
    ds_read_b64_tr_b16 v[162:163], v67 offset:28928
    ds_read_b64_tr_b16 a[72:73], v66 offset:26624
    ds_read_b64_tr_b16 a[74:75], v66 offset:27136
    ds_read_b64_tr_b16 a[76:77], v66 offset:26632
    ds_read_b64_tr_b16 a[78:79], v66 offset:27144
    ds_read_b64_tr_b16 v[164:165], v67 offset:29696
    ds_read_b64_tr_b16 v[166:167], v67 offset:29952
    s_waitcnt lgkmcnt(12)
    s_add_u32 m0, s43, 18432
    s_mov_b32 s44, 663552
    buffer_load_dwordx4 v64, s[24:27], s44 offen lds
    s_add_u32 m0, s43, 19456
    s_mov_b32 s44, 681984
    buffer_load_dwordx4 v64, s[24:27], s44 offen lds
    s_add_u32 m0, s43, 20480
    s_mov_b32 s44, 700416
    buffer_load_dwordx4 v64, s[24:27], s44 offen lds
    s_add_u32 m0, s43, 21504
    s_mov_b32 s44, 718848
    buffer_load_dwordx4 v64, s[24:27], s44 offen lds
    s_add_u32 m0, s43, 22528
    s_mov_b32 s44, 663616
    buffer_load_dwordx4 v65, s[24:27], s44 offen lds
    s_add_u32 m0, s43, 23552
    s_mov_b32 s44, 700480
    buffer_load_dwordx4 v65, s[24:27], s44 offen lds
    s_waitcnt vmcnt(24)
    ds_read_b64_tr_b16 a[80:81], v66 offset:30720
    ds_read_b64_tr_b16 a[82:83], v66 offset:31232
    ds_read_b64_tr_b16 a[84:85], v66 offset:30728
    ds_read_b64_tr_b16 a[86:87], v66 offset:31240
    ds_read_b64_tr_b16 v[168:169], v67 offset:34816
    ds_read_b64_tr_b16 v[170:171], v67 offset:35072
    ds_read_b64_tr_b16 a[88:89], v66 offset:32768
    ds_read_b64_tr_b16 a[90:91], v66 offset:33280
    ds_read_b64_tr_b16 a[92:93], v66 offset:32776
    ds_read_b64_tr_b16 a[94:95], v66 offset:33288
    ds_read_b64_tr_b16 v[172:173], v67 offset:35840
    ds_read_b64_tr_b16 v[174:175], v67 offset:36096
    s_waitcnt lgkmcnt(12)
    s_add_u32 m0, s43, 24576
    s_mov_b32 s44, 737280
    buffer_load_dwordx4 v64, s[24:27], s44 offen lds
    s_add_u32 m0, s43, 25600
    s_mov_b32 s44, 755712
    buffer_load_dwordx4 v64, s[24:27], s44 offen lds
    s_add_u32 m0, s43, 26624
    s_mov_b32 s44, 774144
    buffer_load_dwordx4 v64, s[24:27], s44 offen lds
    s_add_u32 m0, s43, 27648
    s_mov_b32 s44, 792576
    buffer_load_dwordx4 v64, s[24:27], s44 offen lds
    s_add_u32 m0, s43, 28672
    s_mov_b32 s44, 737344
    buffer_load_dwordx4 v65, s[24:27], s44 offen lds
    s_add_u32 m0, s43, 29696
    s_mov_b32 s44, 774208
    buffer_load_dwordx4 v65, s[24:27], s44 offen lds
    s_waitcnt vmcnt(24)
    ds_read_b64_tr_b16 a[96:97], v66 offset:0
    ds_read_b64_tr_b16 a[98:99], v66 offset:512
    ds_read_b64_tr_b16 a[100:101], v66 offset:8
    ds_read_b64_tr_b16 a[102:103], v66 offset:520
    ds_read_b64_tr_b16 v[176:177], v67 offset:4096
    ds_read_b64_tr_b16 v[178:179], v67 offset:4352
    ds_read_b64_tr_b16 a[104:105], v66 offset:2048
    ds_read_b64_tr_b16 a[106:107], v66 offset:2560
    ds_read_b64_tr_b16 a[108:109], v66 offset:2056
    ds_read_b64_tr_b16 a[110:111], v66 offset:2568
    ds_read_b64_tr_b16 v[180:181], v67 offset:5120
    ds_read_b64_tr_b16 v[182:183], v67 offset:5376
    s_waitcnt lgkmcnt(12)
    s_add_u32 m0, s43, 30720
    s_mov_b32 s44, 811008
    buffer_load_dwordx4 v64, s[24:27], s44 offen lds
    s_add_u32 m0, s43, 31744
    s_mov_b32 s44, 829440
    buffer_load_dwordx4 v64, s[24:27], s44 offen lds
    s_add_u32 m0, s43, 32768
    s_mov_b32 s44, 847872
    buffer_load_dwordx4 v64, s[24:27], s44 offen lds
    s_add_u32 m0, s43, 33792
    s_mov_b32 s44, 866304
    buffer_load_dwordx4 v64, s[24:27], s44 offen lds
    s_add_u32 m0, s43, 34816
    s_mov_b32 s44, 811072
    buffer_load_dwordx4 v65, s[24:27], s44 offen lds
    s_add_u32 m0, s43, 35840
    s_mov_b32 s44, 847936
    buffer_load_dwordx4 v65, s[24:27], s44 offen lds
    s_waitcnt vmcnt(24)
    ds_read_b64_tr_b16 a[112:113], v66 offset:6144
    ds_read_b64_tr_b16 a[114:115], v66 offset:6656
    ds_read_b64_tr_b16 a[116:117], v66 offset:6152
    ds_read_b64_tr_b16 a[118:119], v66 offset:6664
    ds_read_b64_tr_b16 v[184:185], v67 offset:10240
    ds_read_b64_tr_b16 v[186:187], v67 offset:10496
    ds_read_b64_tr_b16 a[120:121], v66 offset:8192
    ds_read_b64_tr_b16 a[122:123], v66 offset:8704
    ds_read_b64_tr_b16 a[124:125], v66 offset:8200
    ds_read_b64_tr_b16 a[126:127], v66 offset:8712
    ds_read_b64_tr_b16 v[188:189], v67 offset:11264
    ds_read_b64_tr_b16 v[190:191], v67 offset:11520
    s_waitcnt lgkmcnt(12)
    s_add_u32 m0, s43, 0
    s_mov_b32 s44, 884736
    buffer_load_dwordx4 v64, s[24:27], s44 offen lds
    s_add_u32 m0, s43, 1024
    s_mov_b32 s44, 903168
    buffer_load_dwordx4 v64, s[24:27], s44 offen lds
    s_add_u32 m0, s43, 2048
    s_mov_b32 s44, 921600
    buffer_load_dwordx4 v64, s[24:27], s44 offen lds
    s_add_u32 m0, s43, 3072
    s_mov_b32 s44, 940032
    buffer_load_dwordx4 v64, s[24:27], s44 offen lds
    s_add_u32 m0, s43, 4096
    s_mov_b32 s44, 884800
    buffer_load_dwordx4 v65, s[24:27], s44 offen lds
    s_add_u32 m0, s43, 5120
    s_mov_b32 s44, 921664
    buffer_load_dwordx4 v65, s[24:27], s44 offen lds
    s_waitcnt vmcnt(24)
    ds_read_b64_tr_b16 a[128:129], v66 offset:12288
    ds_read_b64_tr_b16 a[130:131], v66 offset:12800
    ds_read_b64_tr_b16 a[132:133], v66 offset:12296
    ds_read_b64_tr_b16 a[134:135], v66 offset:12808
    ds_read_b64_tr_b16 v[192:193], v67 offset:16384
    ds_read_b64_tr_b16 v[194:195], v67 offset:16640
    ds_read_b64_tr_b16 a[136:137], v66 offset:14336
    ds_read_b64_tr_b16 a[138:139], v66 offset:14848
    ds_read_b64_tr_b16 a[140:141], v66 offset:14344
    ds_read_b64_tr_b16 a[142:143], v66 offset:14856
    ds_read_b64_tr_b16 v[196:197], v67 offset:17408
    ds_read_b64_tr_b16 v[198:199], v67 offset:17664
    s_waitcnt lgkmcnt(12)
    s_add_u32 m0, s43, 6144
    s_mov_b32 s44, 958464
    buffer_load_dwordx4 v64, s[24:27], s44 offen lds
    s_add_u32 m0, s43, 7168
    s_mov_b32 s44, 976896
    buffer_load_dwordx4 v64, s[24:27], s44 offen lds
    s_add_u32 m0, s43, 8192
    s_mov_b32 s44, 995328
    buffer_load_dwordx4 v64, s[24:27], s44 offen lds
    s_add_u32 m0, s43, 9216
    s_mov_b32 s44, 1013760
    buffer_load_dwordx4 v64, s[24:27], s44 offen lds
    s_add_u32 m0, s43, 10240
    s_mov_b32 s44, 958528
    buffer_load_dwordx4 v65, s[24:27], s44 offen lds
    s_add_u32 m0, s43, 11264
    s_mov_b32 s44, 995392
    buffer_load_dwordx4 v65, s[24:27], s44 offen lds
    s_waitcnt vmcnt(24)
    ds_read_b64_tr_b16 a[144:145], v66 offset:18432
    ds_read_b64_tr_b16 a[146:147], v66 offset:18944
    ds_read_b64_tr_b16 a[148:149], v66 offset:18440
    ds_read_b64_tr_b16 a[150:151], v66 offset:18952
    ds_read_b64_tr_b16 v[200:201], v67 offset:22528
    ds_read_b64_tr_b16 v[202:203], v67 offset:22784
    ds_read_b64_tr_b16 a[152:153], v66 offset:20480
    ds_read_b64_tr_b16 a[154:155], v66 offset:20992
    ds_read_b64_tr_b16 a[156:157], v66 offset:20488
    ds_read_b64_tr_b16 a[158:159], v66 offset:21000
    ds_read_b64_tr_b16 v[204:205], v67 offset:23552
    ds_read_b64_tr_b16 v[206:207], v67 offset:23808
    s_waitcnt lgkmcnt(12)
    s_add_u32 m0, s43, 12288
    s_mov_b32 s44, 1032192
    buffer_load_dwordx4 v64, s[24:27], s44 offen lds
    s_add_u32 m0, s43, 13312
    s_mov_b32 s44, 1050624
    buffer_load_dwordx4 v64, s[24:27], s44 offen lds
    s_add_u32 m0, s43, 14336
    s_mov_b32 s44, 1069056
    buffer_load_dwordx4 v64, s[24:27], s44 offen lds
    s_add_u32 m0, s43, 15360
    s_mov_b32 s44, 1087488
    buffer_load_dwordx4 v64, s[24:27], s44 offen lds
    s_add_u32 m0, s43, 16384
    s_mov_b32 s44, 1032256
    buffer_load_dwordx4 v65, s[24:27], s44 offen lds
    s_add_u32 m0, s43, 17408
    s_mov_b32 s44, 1069120
    buffer_load_dwordx4 v65, s[24:27], s44 offen lds
    s_waitcnt vmcnt(24)
    ds_read_b64_tr_b16 a[160:161], v66 offset:24576
    ds_read_b64_tr_b16 a[162:163], v66 offset:25088
    ds_read_b64_tr_b16 a[164:165], v66 offset:24584
    ds_read_b64_tr_b16 a[166:167], v66 offset:25096
    ds_read_b64_tr_b16 v[208:209], v67 offset:28672
    ds_read_b64_tr_b16 v[210:211], v67 offset:28928
    ds_read_b64_tr_b16 a[168:169], v66 offset:26624
    ds_read_b64_tr_b16 a[170:171], v66 offset:27136
    ds_read_b64_tr_b16 a[172:173], v66 offset:26632
    ds_read_b64_tr_b16 a[174:175], v66 offset:27144
    ds_read_b64_tr_b16 v[212:213], v67 offset:29696
    ds_read_b64_tr_b16 v[214:215], v67 offset:29952
    s_waitcnt lgkmcnt(12)
    s_add_u32 m0, s43, 18432
    s_mov_b32 s44, 1105920
    buffer_load_dwordx4 v64, s[24:27], s44 offen lds
    s_add_u32 m0, s43, 19456
    s_mov_b32 s44, 1124352
    buffer_load_dwordx4 v64, s[24:27], s44 offen lds
    s_add_u32 m0, s43, 20480
    s_mov_b32 s44, 1142784
    buffer_load_dwordx4 v64, s[24:27], s44 offen lds
    s_add_u32 m0, s43, 21504
    s_mov_b32 s44, 1161216
    buffer_load_dwordx4 v64, s[24:27], s44 offen lds
    s_add_u32 m0, s43, 22528
    s_mov_b32 s44, 1105984
    buffer_load_dwordx4 v65, s[24:27], s44 offen lds
    s_add_u32 m0, s43, 23552
    s_mov_b32 s44, 1142848
    buffer_load_dwordx4 v65, s[24:27], s44 offen lds
    s_waitcnt vmcnt(24)
    ds_read_b64_tr_b16 a[176:177], v66 offset:30720
    ds_read_b64_tr_b16 a[178:179], v66 offset:31232
    ds_read_b64_tr_b16 a[180:181], v66 offset:30728
    ds_read_b64_tr_b16 a[182:183], v66 offset:31240
    ds_read_b64_tr_b16 v[216:217], v67 offset:34816
    ds_read_b64_tr_b16 v[218:219], v67 offset:35072
    ds_read_b64_tr_b16 a[184:185], v66 offset:32768
    ds_read_b64_tr_b16 a[186:187], v66 offset:33280
    ds_read_b64_tr_b16 a[188:189], v66 offset:32776
    ds_read_b64_tr_b16 a[190:191], v66 offset:33288
    ds_read_b64_tr_b16 v[220:221], v67 offset:35840
    ds_read_b64_tr_b16 v[222:223], v67 offset:36096
    s_waitcnt vmcnt(18)
    ds_read_b64_tr_b16 a[192:193], v66 offset:0
    ds_read_b64_tr_b16 a[194:195], v66 offset:512
    ds_read_b64_tr_b16 a[196:197], v66 offset:8
    ds_read_b64_tr_b16 a[198:199], v66 offset:520
    ds_read_b64_tr_b16 v[224:225], v67 offset:4096
    ds_read_b64_tr_b16 v[226:227], v67 offset:4352
    ds_read_b64_tr_b16 a[200:201], v66 offset:2048
    ds_read_b64_tr_b16 a[202:203], v66 offset:2560
    ds_read_b64_tr_b16 a[204:205], v66 offset:2056
    ds_read_b64_tr_b16 a[206:207], v66 offset:2568
    ds_read_b64_tr_b16 v[228:229], v67 offset:5120
    ds_read_b64_tr_b16 v[230:231], v67 offset:5376
    s_waitcnt vmcnt(12)
    ds_read_b64_tr_b16 a[208:209], v66 offset:6144
    ds_read_b64_tr_b16 a[210:211], v66 offset:6656
    ds_read_b64_tr_b16 a[212:213], v66 offset:6152
    ds_read_b64_tr_b16 a[214:215], v66 offset:6664
    ds_read_b64_tr_b16 v[232:233], v67 offset:10240
    ds_read_b64_tr_b16 v[234:235], v67 offset:10496
    ds_read_b64_tr_b16 a[216:217], v66 offset:8192
    ds_read_b64_tr_b16 a[218:219], v66 offset:8704
    ds_read_b64_tr_b16 a[220:221], v66 offset:8200
    ds_read_b64_tr_b16 a[222:223], v66 offset:8712
    ds_read_b64_tr_b16 v[236:237], v67 offset:11264
    ds_read_b64_tr_b16 v[238:239], v67 offset:11520
    s_waitcnt vmcnt(6)
    ds_read_b64_tr_b16 a[224:225], v66 offset:12288
    ds_read_b64_tr_b16 a[226:227], v66 offset:12800
    ds_read_b64_tr_b16 a[228:229], v66 offset:12296
    ds_read_b64_tr_b16 a[230:231], v66 offset:12808
    ds_read_b64_tr_b16 v[240:241], v67 offset:16384
    ds_read_b64_tr_b16 v[242:243], v67 offset:16640
    ds_read_b64_tr_b16 a[232:233], v66 offset:14336
    ds_read_b64_tr_b16 a[234:235], v66 offset:14848
    ds_read_b64_tr_b16 a[236:237], v66 offset:14344
    ds_read_b64_tr_b16 a[238:239], v66 offset:14856
    ds_read_b64_tr_b16 v[244:245], v67 offset:17408
    ds_read_b64_tr_b16 v[246:247], v67 offset:17664
    s_waitcnt vmcnt(0)
    ds_read_b64_tr_b16 a[240:241], v66 offset:18432
    ds_read_b64_tr_b16 a[242:243], v66 offset:18944
    ds_read_b64_tr_b16 a[244:245], v66 offset:18440
    ds_read_b64_tr_b16 a[246:247], v66 offset:18952
    ds_read_b64_tr_b16 v[248:249], v67 offset:22528
    ds_read_b64_tr_b16 v[250:251], v67 offset:22784
    ds_read_b64_tr_b16 a[248:249], v66 offset:20480
    ds_read_b64_tr_b16 a[250:251], v66 offset:20992
    ds_read_b64_tr_b16 a[252:253], v66 offset:20488
    ds_read_b64_tr_b16 a[254:255], v66 offset:21000
    ds_read_b64_tr_b16 v[252:253], v67 offset:23552
    ds_read_b64_tr_b16 v[254:255], v67 offset:23808
    s_waitcnt lgkmcnt(0)
    s_cmp_lg_u32 s32, 0
    s_cbranch_scc1 O_iw_ok
    s_mov_b32 s94, 40
O_iw:
    buffer_load_dword v79, off, s[4:7], s94 sc1
    s_sub_u32 s95, s95, 1
    s_cmp_eq_u32 s95, 0
    s_cbranch_scc1 L_end
    s_waitcnt vmcnt(0)
    v_cmp_gt_u32 vcc, 32, v79
    s_cbranch_vccz O_iw_ok
    s_sleep 1
    s_branch O_iw
O_iw_ok:
    s_barrier
O_layer:
    s_mov_b32 s36, s34
    s_mov_b32 s39, 0
    v_mov_b32 v28, 0
O_loop:
    s_lshr_b32 s37, s36, 1
    s_and_b32 s46, s36, 1
    s_lshl_b32 s41, s37, 7
    s_add_u32 s45, s41, 3182592
    s_add_u32 s41, s41, 3170304
    s_lshl_b32 s42, s37, 2
    s_add_u32 s42, s42, s32
    s_lshl_b32 s42, s42, 16
    s_lshl_b32 s43, s46, 8
    s_add_u32 s42, s42, s43
    s_add_u32 s42, s42, 67108864
    s_mul_i32 s44, s37, 36864
    s_add_u32 s43, s43, s44
    s_add_u32 s43, s43, 8388608
    s_mul_i32 s46, s46, s38
    s_add_u32 s44, s44, s46
    v_cmp_gt_u32 vcc, 32, v28
    s_cbranch_vccz O_fl_ok
    s_waitcnt vmcnt(0)
    s_cmp_eq_u32 s39, 0
    s_cbranch_scc1 O_s1
    v_mov_b32 v29, 1
    s_mov_b64 exec, 1
    buffer_atomic_add v29, off, s[8:11], s39
    s_mov_b64 exec, -1
    s_mov_b32 s39, 0
O_s1:
O_fl:
    buffer_load_dword v28, off, s[8:11], s41 sc1
    s_sub_u32 s95, s95, 1
    s_cmp_eq_u32 s95, 0
    s_cbranch_scc1 L_end
    s_waitcnt vmcnt(0)
    v_cmp_gt_u32 vcc, 32, v28
    s_cbranch_vccz O_fl_ok
    s_sleep 1
    s_branch O_fl
O_fl_ok:
    s_add_u32 s41, s36, 3
    s_lshr_b32 s41, s41, 1
    s_lshl_b32 s41, s41, 7
    s_add_u32 s41, s41, 3170304
    buffer_load_dwordx4 v[32:35], v0, s[8:11], s42 offen offset:0 sc1
    buffer_load_dwordx4 v[36:39], v0, s[8:11], s42 offen offset:2048 sc1
    s_add_u32 s42, s42, 4096
    buffer_load_dwordx4 v[40:43], v0, s[8:11], s42 offen offset:0 sc1
    buffer_load_dwordx4 v[44:47], v0, s[8:11], s42 offen offset:2048 sc1
    s_add_u32 s42, s42, 4096
    buffer_load_dwordx4 v[48:51], v0, s[8:11], s42 offen offset:0 sc1
    buffer_load_dwordx4 v[52:55], v0, s[8:11], s42 offen offset:2048 sc1
    s_add_u32 s42, s42, 4096
    buffer_load_dwordx4 v[56:59], v0, s[8:11], s42 offen offset:0 sc1
    buffer_load_dwordx4 v[60:63], v0, s[8:11], s42 offen offset:2048 sc1
    s_add_u32 s42, s42, 4096
    buffer_load_dwordx4 v[64:67], v0, s[8:11], s42 offen offset:0 sc1
    buffer_load_dwordx4 v[68:71], v0, s[8:11], s42 offen offset:2048 sc1
    s_add_u32 s42, s42, 4096
    buffer_load_dwordx4 v[72:75], v0, s[8:11], s42 offen offset:0 sc1
    buffer_load_dwordx4 v[76:79], v0, s[8:11], s42 offen offset:2048 sc1
    s_add_u32 s42, s42, 4096
    buffer_load_dwordx4 v[80:83], v0, s[8:11], s42 offen offset:0 sc1
    buffer_load_dwordx4 v[84:87], v0, s[8:11], s42 offen offset:2048 sc1
    s_add_u32 s42, s42, 4096
    buffer_load_dwordx4 v[88:91], v0, s[8:11], s42 offen offset:0 sc1
    buffer_load_dwordx4 v[92:95], v0, s[8:11], s42 offen offset:2048 sc1
    s_add_u32 s42, s42, 4096
    buffer_load_dwordx4 v[96:99], v0, s[8:11], s42 offen offset:0 sc1
    buffer_load_dwordx4 v[100:103], v0, s[8:11], s42 offen offset:2048 sc1
    s_add_u32 s42, s42, 4096
    buffer_load_dwordx4 v[104:107], v0, s[8:11], s42 offen offset:0 sc1
    buffer_load_dwordx4 v[108:111], v0, s[8:11], s42 offen offset:2048 sc1
    s_add_u32 s42, s42, 4096
    buffer_load_dwordx4 v[112:115], v0, s[8:11], s42 offen offset:0 sc1
    s_waitcnt vmcnt(20)
    v_mfma_f32_16x16x32_bf16 v[8:11], a[0:3], v[32:35], 0
    v_mfma_f32_16x16x32_bf16 v[12:15], a[4:7], v[32:35], 0
    v_mfma_f32_16x16x32_bf16 v[16:19], v[128:131], v[32:35], 0
    buffer_load_dwordx4 v[116:119], v0, s[8:11], s42 offen offset:2048 sc1
    s_add_u32 s42, s42, 4096
    s_waitcnt vmcnt(20)
    v_mfma_f32_16x16x32_bf16 v[8:11], a[8:11], v[36:39], v[8:11]
    v_mfma_f32_16x16x32_bf16 v[12:15], a[12:15], v[36:39], v[12:15]
    v_mfma_f32_16x16x32_bf16 v[16:19], v[132:135], v[36:39], v[16:19]
    buffer_load_dwordx4 v[120:123], v0, s[8:11], s42 offen offset:0 sc1
    s_waitcnt vmcnt(20)
    v_mfma_f32_16x16x32_bf16 v[8:11], a[16:19], v[40:43], v[8:11]
    v_mfma_f32_16x16x32_bf16 v[12:15], a[20:23], v[40:43], v[12:15]
    v_mfma_f32_16x16x32_bf16 v[16:19], v[136:139], v[40:43], v[16:19]
    buffer_load_dwordx4 v[124:127], v0, s[8:11], s42 offen offset:2048 sc1
    s_add_u32 s42, s42, 4096
    s_waitcnt vmcnt(20)
    v_mfma_f32_16x16x32_bf16 v[8:11], a[24:27], v[44:47], v[8:11]
    v_mfma_f32_16x16x32_bf16 v[12:15], a[28:31], v[44:47], v[12:15]
    v_mfma_f32_16x16x32_bf16 v[16:19], v[140:143], v[44:47], v[16:19]
    buffer_load_dwordx4 v[32:35], v0, s[8:11], s42 offen offset:0 sc1
    s_waitcnt vmcnt(20)
    v_mfma_f32_16x16x32_bf16 v[8:11], a[32:35], v[48:51], v[8:11]
    v_mfma_f32_16x16x32_bf16 v[12:15], a[36:39], v[48:51], v[12:15]
    v_mfma_f32_16x16x32_bf16 v[16:19], v[144:147], v[48:51], v[16:19]
    buffer_load_dwordx4 v[36:39], v0, s[8:11], s42 offen offset:2048 sc1
    s_add_u32 s42, s42, 4096
    s_waitcnt vmcnt(20)
    v_mfma_f32_16x16x32_bf16 v[8:11], a[40:43], v[52:55], v[8:11]
    v_mfma_f32_16x16x32_bf16 v[12:15], a[44:47], v[52:55], v[12:15]
    v_mfma_f32_16x16x32_bf16 v[16:19], v[148:151], v[52:55], v[16:19]
    buffer_load_dwordx4 v[40:43], v0, s[8:11], s42 offen offset:0 sc1
    s_waitcnt vmcnt(20)
    v_mfma_f32_16x16x32_bf16 v[8:11], a[48:51], v[56:59], v[8:11]
    v_mfma_f32_16x16x32_bf16 v[12:15], a[52:55], v[56:59], v[12:15]
    v_mfma_f32_16x16x32_bf16 v[16:19], v[152:155], v[56:59], v[16:19]
    buffer_load_dwordx4 v[44:47], v0, s[8:11], s42 offen offset:2048 sc1
    s_add_u32 s42, s42, 4096
    s_waitcnt vmcnt(20)
    v_mfma_f32_16x16x32_bf16 v[8:11], a[56:59], v[60:63], v[8:11]
    v_mfma_f32_16x16x32_bf16 v[12:15], a[60:63], v[60:63], v[12:15]
    v_mfma_f32_16x16x32_bf16 v[16:19], v[156:159], v[60:63], v[16:19]
    buffer_load_dwordx4 v[48:51], v0, s[8:11], s42 offen offset:0 sc1
    s_waitcnt vmcnt(20)
    v_mfma_f32_16x16x32_bf16 v[8:11], a[64:67], v[64:67], v[8:11]
    v_mfma_f32_16x16x32_bf16 v[12:15], a[68:71], v[64:67], v[12:15]
    v_mfma_f32_16x16x32_bf16 v[16:19], v[160:163], v[64:67], v[16:19]
    buffer_load_dwordx4 v[52:55], v0, s[8:11], s42 offen offset:2048 sc1
    s_add_u32 s42, s42, 4096
    s_waitcnt vmcnt(20)
    v_mfma_f32_16x16x32_bf16 v[8:11], a[72:75], v[68:71], v[8:11]
    v_mfma_f32_16x16x32_bf16 v[12:15], a[76:79], v[68:71], v[12:15]
    v_mfma_f32_16x16x32_bf16 v[16:19], v[164:167], v[68:71], v[16:19]
    buffer_load_dwordx4 v[56:59], v0, s[8:11], s42 offen offset:0 sc1
    s_waitcnt vmcnt(20)
    v_mfma_f32_16x16x32_bf16 v[8:11], a[80:83], v[72:75], v[8:11]
    v_mfma_f32_16x16x32_bf16 v[12:15], a[84:87], v[72:75], v[12:15]
    v_mfma_f32_16x16x32_bf16 v[16:19], v[168:171], v[72:75], v[16:19]
    buffer_load_dwordx4 v[60:63], v0, s[8:11], s42 offen offset:2048 sc1
    s_add_u32 s42, s42, 4096
    s_waitcnt vmcnt(20)
    v_mfma_f32_16x16x32_bf16 v[8:11], a[88:91], v[76:79], v[8:11]
    v_mfma_f32_16x16x32_bf16 v[12:15], a[92:95], v[76:79], v[12:15]
    v_mfma_f32_16x16x32_bf16 v[16:19], v[172:175], v[76:79], v[16:19]
    buffer_load_dwordx4 v[20:23], v1, s[28:31], s44 offen sc1
    s_waitcnt vmcnt(20)
    v_mfma_f32_16x16x32_bf16 v[8:11], a[96:99], v[80:83], v[8:11]
    v_mfma_f32_16x16x32_bf16 v[12:15], a[100:103], v[80:83], v[12:15]
    v_mfma_f32_16x16x32_bf16 v[16:19], v[176:179], v[80:83], v[16:19]
    buffer_load_dwordx2 v[24:25], v2, s[28:31], s44 offen sc1
    s_waitcnt vmcnt(20)
    v_mfma_f32_16x16x32_bf16 v[8:11], a[104:107], v[84:87], v[8:11]
    v_mfma_f32_16x16x32_bf16 v[12:15], a[108:111], v[84:87], v[12:15]
    v_mfma_f32_16x16x32_bf16 v[16:19], v[180:183], v[84:87], v[16:19]
    buffer_load_dword v28, off, s[8:11], s41 sc1
    s_waitcnt vmcnt(20)
    v_mfma_f32_16x16x32_bf16 v[8:11], a[112:115], v[88:91], v[8:11]
    v_mfma_f32_16x16x32_bf16 v[12:15], a[116:119], v[88:91], v[12:15]
    v_mfma_f32_16x16x32_bf16 v[16:19], v[184:187], v[88:91], v[16:19]
    s_cmp_eq_u32 s39, 0
    s_cbranch_scc1 O_s3
    v_mov_b32 v29, 1
    s_mov_b64 exec, 1
    buffer_atomic_add v29, off, s[8:11], s39
    s_mov_b64 exec, -1
    s_mov_b32 s39, 0
    s_waitcnt vmcnt(20)
    v_mfma_f32_16x16x32_bf16 v[8:11], a[120:123], v[92:95], v[8:11]
    v_mfma_f32_16x16x32_bf16 v[12:15], a[124:127], v[92:95], v[12:15]
    v_mfma_f32_16x16x32_bf16 v[16:19], v[188:191], v[92:95], v[16:19]
    s_waitcnt vmcnt(19)
    v_mfma_f32_16x16x32_bf16 v[8:11], a[128:131], v[96:99], v[8:11]
    v_mfma_f32_16x16x32_bf16 v[12:15], a[132:135], v[96:99], v[12:15]
    v_mfma_f32_16x16x32_bf16 v[16:19], v[192:195], v[96:99], v[16:19]
    s_waitcnt vmcnt(18)
    v_mfma_f32_16x16x32_bf16 v[8:11], a[136:139], v[100:103], v[8:11]
    v_mfma_f32_16x16x32_bf16 v[12:15], a[140:143], v[100:103], v[12:15]
    v_mfma_f32_16x16x32_bf16 v[16:19], v[196:199], v[100:103], v[16:19]
    s_waitcnt vmcnt(17)
    v_mfma_f32_16x16x32_bf16 v[8:11], a[144:147], v[104:107], v[8:11]
    v_mfma_f32_16x16x32_bf16 v[12:15], a[148:151], v[104:107], v[12:15]
    v_mfma_f32_16x16x32_bf16 v[16:19], v[200:203], v[104:107], v[16:19]
    s_waitcnt vmcnt(16)
    v_mfma_f32_16x16x32_bf16 v[8:11], a[152:155], v[108:111], v[8:11]
    v_mfma_f32_16x16x32_bf16 v[12:15], a[156:159], v[108:111], v[12:15]
    v_mfma_f32_16x16x32_bf16 v[16:19], v[204:207], v[108:111], v[16:19]
    s_waitcnt vmcnt(15)
    v_mfma_f32_16x16x32_bf16 v[8:11], a[160:163], v[112:115], v[8:11]
    v_mfma_f32_16x16x32_bf16 v[12:15], a[164:167], v[112:115], v[12:15]
    v_mfma_f32_16x16x32_bf16 v[16:19], v[208:211], v[112:115], v[16:19]
    s_waitcnt vmcnt(14)
    v_mfma_f32_16x16x32_bf16 v[8:11], a[168:171], v[116:119], v[8:11]
    v_mfma_f32_16x16x32_bf16 v[12:15], a[172:175], v[116:119], v[12:15]
    v_mfma_f32_16x16x32_bf16 v[16:19], v[212:215], v[116:119], v[16:19]
    s_waitcnt vmcnt(13)
    v_mfma_f32_16x16x32_bf16 v[8:11], a[176:179], v[120:123], v[8:11]
    v_mfma_f32_16x16x32_bf16 v[12:15], a[180:183], v[120:123], v[12:15]
    v_mfma_f32_16x16x32_bf16 v[16:19], v[216:219], v[120:123], v[16:19]
    s_waitcnt vmcnt(12)
    v_mfma_f32_16x16x32_bf16 v[8:11], a[184:187], v[124:127], v[8:11]
    v_mfma_f32_16x16x32_bf16 v[12:15], a[188:191], v[124:127], v[12:15]
    v_mfma_f32_16x16x32_bf16 v[16:19], v[220:223], v[124:127], v[16:19]
    s_waitcnt vmcnt(11)
    v_mfma_f32_16x16x32_bf16 v[8:11], a[192:195], v[32:35], v[8:11]
    v_mfma_f32_16x16x32_bf16 v[12:15], a[196:199], v[32:35], v[12:15]
    v_mfma_f32_16x16x32_bf16 v[16:19], v[224:227], v[32:35], v[16:19]
    s_waitcnt vmcnt(10)
    v_mfma_f32_16x16x32_bf16 v[8:11], a[200:203], v[36:39], v[8:11]
    v_mfma_f32_16x16x32_bf16 v[12:15], a[204:207], v[36:39], v[12:15]
    v_mfma_f32_16x16x32_bf16 v[16:19], v[228:231], v[36:39], v[16:19]
    s_waitcnt vmcnt(9)
    v_mfma_f32_16x16x32_bf16 v[8:11], a[208:211], v[40:43], v[8:11]
    v_mfma_f32_16x16x32_bf16 v[12:15], a[212:215], v[40:43], v[12:15]
    v_mfma_f32_16x16x32_bf16 v[16:19], v[232:235], v[40:43], v[16:19]
    s_waitcnt vmcnt(8)
    v_mfma_f32_16x16x32_bf16 v[8:11], a[216:219], v[44:47], v[8:11]
    v_mfma_f32_16x16x32_bf16 v[12:15], a[220:223], v[44:47], v[12:15]
    v_mfma_f32_16x16x32_bf16 v[16:19], v[236:239], v[44:47], v[16:19]
    s_waitcnt vmcnt(7)
    v_mfma_f32_16x16x32_bf16 v[8:11], a[224:227], v[48:51], v[8:11]
    v_mfma_f32_16x16x32_bf16 v[12:15], a[228:231], v[48:51], v[12:15]
    v_mfma_f32_16x16x32_bf16 v[16:19], v[240:243], v[48:51], v[16:19]
    s_waitcnt vmcnt(6)
    v_mfma_f32_16x16x32_bf16 v[8:11], a[232:235], v[52:55], v[8:11]
    v_mfma_f32_16x16x32_bf16 v[12:15], a[236:239], v[52:55], v[12:15]
    v_mfma_f32_16x16x32_bf16 v[16:19], v[244:247], v[52:55], v[16:19]
    s_waitcnt vmcnt(5)
    v_mfma_f32_16x16x32_bf16 v[8:11], a[240:243], v[56:59], v[8:11]
    v_mfma_f32_16x16x32_bf16 v[12:15], a[244:247], v[56:59], v[12:15]
    v_mfma_f32_16x16x32_bf16 v[16:19], v[248:251], v[56:59], v[16:19]
    s_waitcnt vmcnt(4)
    v_mfma_f32_16x16x32_bf16 v[8:11], a[248:251], v[60:63], v[8:11]
    v_mfma_f32_16x16x32_bf16 v[12:15], a[252:255], v[60:63], v[12:15]
    v_mfma_f32_16x16x32_bf16 v[16:19], v[252:255], v[60:63], v[16:19]
    s_waitcnt vmcnt(1)
    s_branch O_s4
O_s3:
    s_waitcnt vmcnt(19)
    v_mfma_f32_16x16x32_bf16 v[8:11], a[120:123], v[92:95], v[8:11]
    v_mfma_f32_16x16x32_bf16 v[12:15], a[124:127], v[92:95], v[12:15]
    v_mfma_f32_16x16x32_bf16 v[16:19], v[188:191], v[92:95], v[16:19]
    s_waitcnt vmcnt(18)
    v_mfma_f32_16x16x32_bf16 v[8:11], a[128:131], v[96:99], v[8:11]
    v_mfma_f32_16x16x32_bf16 v[12:15], a[132:135], v[96:99], v[12:15]
    v_mfma_f32_16x16x32_bf16 v[16:19], v[192:195], v[96:99], v[16:19]
    s_waitcnt vmcnt(17)
    v_mfma_f32_16x16x32_bf16 v[8:11], a[136:139], v[100:103], v[8:11]
    v_mfma_f32_16x16x32_bf16 v[12:15], a[140:143], v[100:103], v[12:15]
    v_mfma_f32_16x16x32_bf16 v[16:19], v[196:199], v[100:103], v[16:19]
    s_waitcnt vmcnt(16)
    v_mfma_f32_16x16x32_bf16 v[8:11], a[144:147], v[104:107], v[8:11]
    v_mfma_f32_16x16x32_bf16 v[12:15], a[148:151], v[104:107], v[12:15]
    v_mfma_f32_16x16x32_bf16 v[16:19], v[200:203], v[104:107], v[16:19]
    s_waitcnt vmcnt(15)
    v_mfma_f32_16x16x32_bf16 v[8:11], a[152:155], v[108:111], v[8:11]
    v_mfma_f32_16x16x32_bf16 v[12:15], a[156:159], v[108:111], v[12:15]
    v_mfma_f32_16x16x32_bf16 v[16:19], v[204:207], v[108:111], v[16:19]
    s_waitcnt vmcnt(14)
    v_mfma_f32_16x16x32_bf16 v[8:11], a[160:163], v[112:115], v[8:11]
    v_mfma_f32_16x16x32_bf16 v[12:15], a[164:167], v[112:115], v[12:15]
    v_mfma_f32_16x16x32_bf16 v[16:19], v[208:211], v[112:115], v[16:19]
    s_waitcnt vmcnt(13)
    v_mfma_f32_16x16x32_bf16 v[8:11], a[168:171], v[116:119], v[8:11]
    v_mfma_f32_16x16x32_bf16 v[12:15], a[172:175], v[116:119], v[12:15]
    v_mfma_f32_16x16x32_bf16 v[16:19], v[212:215], v[116:119], v[16:19]
    s_waitcnt vmcnt(12)
    v_mfma_f32_16x16x32_bf16 v[8:11], a[176:179], v[120:123], v[8:11]
    v_mfma_f32_16x16x32_bf16 v[12:15], a[180:183], v[120:123], v[12:15]
    v_mfma_f32_16x16x32_bf16 v[16:19], v[216:219], v[120:123], v[16:19]
    s_waitcnt vmcnt(11)
    v_mfma_f32_16x16x32_bf16 v[8:11], a[184:187], v[124:127], v[8:11]
    v_mfma_f32_16x16x32_bf16 v[12:15], a[188:191], v[124:127], v[12:15]
    v_mfma_f32_16x16x32_bf16 v[16:19], v[220:223], v[124:127], v[16:19]
    s_waitcnt vmcnt(10)
    v_mfma_f32_16x16x32_bf16 v[8:11], a[192:195], v[32:35], v[8:11]
    v_mfma_f32_16x16x32_bf16 v[12:15], a[196:199], v[32:35], v[12:15]
    v_mfma_f32_16x16x32_bf16 v[16:19], v[224:227], v[32:35], v[16:19]
    s_waitcnt vmcnt(9)
    v_mfma_f32_16x16x32_bf16 v[8:11], a[200:203], v[36:39], v[8:11]
    v_mfma_f32_16x16x32_bf16 v[12:15], a[204:207], v[36:39], v[12:15]
    v_mfma_f32_16x16x32_bf16 v[16:19], v[228:231], v[36:39], v[16:19]
    s_waitcnt vmcnt(8)
    v_mfma_f32_16x16x32_bf16 v[8:11], a[208:211], v[40:43], v[8:11]
    v_mfma_f32_16x16x32_bf16 v[12:15], a[212:215], v[40:43], v[12:15]
    v_mfma_f32_16x16x32_bf16 v[16:19], v[232:235], v[40:43], v[16:19]
    s_waitcnt vmcnt(7)
    v_mfma_f32_16x16x32_bf16 v[8:11], a[216:219], v[44:47], v[8:11]
    v_mfma_f32_16x16x32_bf16 v[12:15], a[220:223], v[44:47], v[12:15]
    v_mfma_f32_16x16x32_bf16 v[16:19], v[236:239], v[44:47], v[16:19]
    s_waitcnt vmcnt(6)
    v_mfma_f32_16x16x32_bf16 v[8:11], a[224:227], v[48:51], v[8:11]
    v_mfma_f32_16x16x32_bf16 v[12:15], a[228:231], v[48:51], v[12:15]
    v_mfma_f32_16x16x32_bf16 v[16:19], v[240:243], v[48:51], v[16:19]
    s_waitcnt vmcnt(5)
    v_mfma_f32_16x16x32_bf16 v[8:11], a[232:235], v[52:55], v[8:11]
    v_mfma_f32_16x16x32_bf16 v[12:15], a[236:239], v[52:55], v[12:15]
    v_mfma_f32_16x16x32_bf16 v[16:19], v[244:247], v[52:55], v[16:19]
    s_waitcnt vmcnt(4)
    v_mfma_f32_16x16x32_bf16 v[8:11], a[240:243], v[56:59], v[8:11]
    v_mfma_f32_16x16x32_bf16 v[12:15], a[244:247], v[56:59], v[12:15]
    v_mfma_f32_16x16x32_bf16 v[16:19], v[248:251], v[56:59], v[16:19]
    s_waitcnt vmcnt(3)
    v_mfma_f32_16x16x32_bf16 v[8:11], a[248:251], v[60:63], v[8:11]
    v_mfma_f32_16x16x32_bf16 v[12:15], a[252:255], v[60:63], v[12:15]
    v_mfma_f32_16x16x32_bf16 v[16:19], v[252:255], v[60:63], v[16:19]
    s_waitcnt vmcnt(0)
O_s4:
    v_xor_b32 v5, 16384, v5
    s_cmp_eq_u32 s32, 0
    s_cbranch_scc1 O_w0
    s_mul_i32 s41, s32, 3072
    v_add_u32 v30, s41, v5
    s_nop 3
    ds_write_b128 v30, v[8:11] offset:0
    ds_write_b128 v30, v[12:15] offset:1024
    ds_write_b128 v30, v[16:19] offset:2048
    s_waitcnt lgkmcnt(0)
    s_barrier
    s_branch O_next
O_w0:
    v_lshlrev_b32 v72, 16, v20
    v_lshlrev_b32 v74, 16, v21
    v_lshlrev_b32 v76, 16, v22
    v_lshlrev_b32 v78, 16, v23
    v_lshlrev_b32 v80, 16, v24
    v_lshlrev_b32 v82, 16, v25
    v_and_b32 v73, 0xffff0000, v20
    v_and_b32 v75, 0xffff0000, v21
    v_and_b32 v77, 0xffff0000, v22
    v_and_b32 v79, 0xffff0000, v23
    v_and_b32 v81, 0xffff0000, v24
    v_and_b32 v83, 0xffff0000, v25
    v_pk_add_f32 v[8:9], v[8:9], v[72:73]
    v_pk_add_f32 v[10:11], v[10:11], v[74:75]
    v_pk_add_f32 v[12:13], v[12:13], v[76:77]
    v_pk_add_f32 v[14:15], v[14:15], v[78:79]
    v_pk_add_f32 v[16:17], v[16:17], v[80:81]
    v_pk_add_f32 v[18:19], v[18:19], v[82:83]
    s_barrier
    ds_read_b128 v[32:35], v5 offset:3072
    ds_read_b128 v[36:39], v5 offset:4096
    ds_read_b128 v[40:43], v5 offset:5120
    ds_read_b128 v[44:47], v5 offset:6144
    ds_read_b128 v[48:51], v5 offset:7168
    ds_read_b128 v[52:55], v5 offset:8192
    ds_read_b128 v[56:59], v5 offset:9216
    ds_read_b128 v[60:63], v5 offset:10240
    ds_read_b128 v[64:67], v5 offset:11264
    s_waitcnt lgkmcnt(6)
    v_pk_add_f32 v[8:9], v[8:9], v[32:33]
    v_pk_add_f32 v[10:11], v[10:11], v[34:35]
    v_pk_add_f32 v[12:13], v[12:13], v[36:37]
    v_pk_add_f32 v[14:15], v[14:15], v[38:39]
    v_pk_add_f32 v[16:17], v[16:17], v[40:41]
    v_pk_add_f32 v[18:19], v[18:19], v[42:43]
    s_waitcnt lgkmcnt(3)
    v_pk_add_f32 v[8:9], v[8:9], v[44:45]
    v_pk_add_f32 v[10:11], v[10:11], v[46:47]
    v_pk_add_f32 v[12:13], v[12:13], v[48:49]
    v_pk_add_f32 v[14:15], v[14:15], v[50:51]
    v_pk_add_f32 v[16:17], v[16:17], v[52:53]
    v_pk_add_f32 v[18:19], v[18:19], v[54:55]
    s_waitcnt lgkmcnt(0)
    v_pk_add_f32 v[8:9], v[8:9], v[56:57]
    v_pk_add_f32 v[10:11], v[10:11], v[58:59]
    v_pk_add_f32 v[12:13], v[12:13], v[60:61]
    v_pk_add_f32 v[14:15], v[14:15], v[62:63]
    v_pk_add_f32 v[16:17], v[16:17], v[64:65]
    v_pk_add_f32 v[18:19], v[18:19], v[66:67]
    v_cvt_pk_bf16_f32 v20, v8, v9
    v_cvt_pk_bf16_f32 v21, v10, v11
    v_cvt_pk_bf16_f32 v22, v12, v13
    v_cvt_pk_bf16_f32 v23, v14, v15
    v_cvt_pk_bf16_f32 v24, v16, v17
    v_cvt_pk_bf16_f32 v25, v18, v19
    buffer_store_dwordx4 v[20:23], v3, s[8:11], s43 offen sc1
    v_mov_b64 v[8:9], v[24:25]
    v_mov_b64 v[10:11], v[24:25]
    s_nop 1
    v_permlane16_swap_b32 v8, v10
    v_permlane16_swap_b32 v9, v11
    buffer_store_dwordx4 v[8:11], v4, s[8:11], s43 offen sc1
    v_dot2_f32_bf16 v26, v20, s40, 0
    v_dot2_f32_bf16 v27, v20, v20, 0
    v_dot2_f32_bf16 v26, v21, s40, v26
    v_dot2_f32_bf16 v27, v21, v21, v27
    v_dot2_f32_bf16 v26, v22, s40, v26
    v_dot2_f32_bf16 v27, v22, v22, v27
    v_dot2_f32_bf16 v26, v23, s40, v26
    v_dot2_f32_bf16 v27, v23, v23, v27
    v_dot2_f32_bf16 v26, v24, s40, v26
    v_dot2_f32_bf16 v27, v24, v24, v27
    v_dot2_f32_bf16 v26, v25, s40, v26
    v_dot2_f32_bf16 v27, v25, v25, v27
    s_nop 2
    v_mov_b32 v12, v26
    v_mov_b32 v13, v27
    s_nop 0
    v_permlane16_swap_b32 v26, v12
    v_permlane16_swap_b32 v27, v13
    v_add_f32 v26, v26, v12
    v_add_f32 v27, v27, v13
    v_mov_b32 v12, v26
    v_mov_b32 v13, v27
    s_nop 0
    v_permlane32_swap_b32 v26, v12
    v_permlane32_swap_b32 v27, v13
    v_add_f32 v26, v26, v12
    v_add_f32 v27, v27, v13
    s_mul_i32 s41, s37, 3072
    s_and_b32 s42, s36, 1
    s_lshl_b32 s42, s42, 7
    s_add_u32 s41, s41, s42
    buffer_store_dwordx2 v[26:27], v6, s[8:11], s41 offen sc1
    s_mov_b32 s39, s45
O_next:
    s_add_u32 s36, s36, 3
    s_cmp_lt_u32 s36, 128
    s_cbranch_scc1 O_loop
    s_waitcnt vmcnt(0)
    s_cmp_eq_u32 s39, 0
    s_cbranch_scc1 O_s2
    v_mov_b32 v29, 1
    s_mov_b64 exec, 1
    buffer_atomic_add v29, off, s[8:11], s39
    s_mov_b64 exec, -1
    s_mov_b32 s39, 0
O_s2:
    s_cmp_lg_u32 s96, 0
    s_cbranch_scc1 L_end
    s_mov_b32 s96, 1
    s_add_u32 s8, s8, 100663296
    s_addc_u32 s9, s9, 0
    s_mov_b32 s10, 167772160
    s_sub_u32 s28, s8, 88080384
    s_subb_u32 s29, s9, 0
    s_mov_b32 s38, 256
    v_mov_b32 v1, v3
    v_mov_b32 v2, v31
    s_branch O_layer
R_a:
    v_mov_b64 v[4:5], 0
    v_mov_b64 v[6:7], 0
    v_lshlrev_b32 v3, 4, v0
    s_and_b32 s40, s33, 15
    s_lshl_b32 s40, s40, 12
    s_lshr_b32 s41, s33, 4
    s_mul_i32 s41, s41, 100663296
    s_add_u32 s41, s41, s40
    s_add_u32 s42, s41, 3145728
    buffer_store_dwordx4 v[4:7], v3, s[8:11], s42 offen sc1
    s_waitcnt vmcnt(0)
    s_barrier
    s_cmp_lg_u32 s32, 0
    s_cbranch_scc1 I_a1
    v_mov_b32 v79, 1
    s_mov_b32 s94, 36
    s_mov_b64 exec, 1
    buffer_atomic_add v79, off, s[4:7], s94
    s_mov_b64 exec, -1
I_a1:
    s_add_u32 s42, s41, 2097152
    buffer_store_dwordx4 v[4:7], v3, s[8:11], s42 offen sc1
    v_add_u32 v12, s40, v3
    s_add_u32 s42, s41, 1048576
    buffer_store_dwordx4 v[4:7], v3, s[8:11], s42 offen sc1
    v_add_u32 v13, 0, v12
    v_lshrrev_b32 v13, 10, v13
    v_mul_u32_u24 v13, 7282, v13
    v_lshrrev_b32 v13, 16, v13
    v_add_u32 v13, 3, v13
    v_bfe_u32 v16, v13, 1, 1
    v_bfe_u32 v17, v13, 1, 1
    v_bfe_u32 v18, v13, 1, 1
    v_bfe_u32 v19, v13, 1, 1
    s_add_u32 s42, s41, 16777216
    buffer_store_dwordx4 v[16:19], v3, s[8:11], s42 offen sc1
    s_add_u32 s42, s41, 1114112
    buffer_store_dwordx4 v[4:7], v3, s[8:11], s42 offen sc1
    v_add_u32 v13, 65536, v12
    v_lshrrev_b32 v13, 10, v13
    v_mul_u32_u24 v13, 7282, v13
    v_lshrrev_b32 v13, 16, v13
    v_add_u32 v13, 3, v13
    v_bfe_u32 v20, v13, 1, 1
    v_bfe_u32 v21, v13, 1, 1
    v_bfe_u32 v22, v13, 1, 1
    v_bfe_u32 v23, v13, 1, 1
    s_add_u32 s42, s41, 16842752
    buffer_store_dwordx4 v[20:23], v3, s[8:11], s42 offen sc1
    s_add_u32 s42, s41, 1179648
    buffer_store_dwordx4 v[4:7], v3, s[8:11], s42 offen sc1
    v_add_u32 v13, 131072, v12
    v_lshrrev_b32 v13, 10, v13
    v_mul_u32_u24 v13, 7282, v13
    v_lshrrev_b32 v13, 16, v13
    v_add_u32 v13, 3, v13
    v_bfe_u32 v24, v13, 1, 1
    v_bfe_u32 v25, v13, 1, 1
    v_bfe_u32 v26, v13, 1, 1
    v_bfe_u32 v27, v13, 1, 1
    s_add_u32 s42, s41, 16908288
    buffer_store_dwordx4 v[24:27], v3, s[8:11], s42 offen sc1
    s_add_u32 s42, s41, 1245184
    buffer_store_dwordx4 v[4:7], v3, s[8:11], s42 offen sc1
    v_add_u32 v13, 196608, v12
    v_lshrrev_b32 v13, 10, v13
    v_mul_u32_u24 v13, 7282, v13
    v_lshrrev_b32 v13, 16, v13
    v_add_u32 v13, 3, v13
    v_bfe_u32 v28, v13, 1, 1
    v_bfe_u32 v29, v13, 1, 1
    v_bfe_u32 v30, v13, 1, 1
    v_bfe_u32 v31, v13, 1, 1
    s_add_u32 s42, s41, 16973824
    buffer_store_dwordx4 v[28:31], v3, s[8:11], s42 offen sc1
    s_add_u32 s42, s41, 1310720
    buffer_store_dwordx4 v[4:7], v3, s[8:11], s42 offen sc1
    v_add_u32 v13, 262144, v12
    v_lshrrev_b32 v13, 10, v13
    v_mul_u32_u24 v13, 7282, v13
    v_lshrrev_b32 v13, 16, v13
    v_add_u32 v13, 3, v13
    v_bfe_u32 v32, v13, 1, 1
    v_bfe_u32 v33, v13, 1, 1
    v_bfe_u32 v34, v13, 1, 1
    v_bfe_u32 v35, v13, 1, 1
    s_add_u32 s42, s41, 17039360
    buffer_store_dwordx4 v[32:35], v3, s[8:11], s42 offen sc1
    s_add_u32 s42, s41, 1376256
    buffer_store_dwordx4 v[4:7], v3, s[8:11], s42 offen sc1
    v_add_u32 v13, 327680, v12
    v_lshrrev_b32 v13, 10, v13
    v_mul_u32_u24 v13, 7282, v13
    v_lshrrev_b32 v13, 16, v13
    v_add_u32 v13, 3, v13
    v_bfe_u32 v36, v13, 1, 1
    v_bfe_u32 v37, v13, 1, 1
    v_bfe_u32 v38, v13, 1, 1
    v_bfe_u32 v39, v13, 1, 1
    s_add_u32 s42, s41, 17104896
    buffer_store_dwordx4 v[36:39], v3, s[8:11], s42 offen sc1
    s_add_u32 s42, s41, 1441792
    buffer_store_dwordx4 v[4:7], v3, s[8:11], s42 offen sc1
    v_add_u32 v13, 393216, v12
    v_lshrrev_b32 v13, 10, v13
    v_mul_u32_u24 v13, 7282, v13
    v_lshrrev_b32 v13, 16, v13
    v_add_u32 v13, 3, v13
    v_bfe_u32 v40, v13, 1, 1
    v_bfe_u32 v41, v13, 1, 1
    v_bfe_u32 v42, v13, 1, 1
    v_bfe_u32 v43, v13, 1, 1
    s_add_u32 s42, s41, 17170432
    buffer_store_dwordx4 v[40:43], v3, s[8:11], s42 offen sc1
    s_add_u32 s42, s41, 1507328
    buffer_store_dwordx4 v[4:7], v3, s[8:11], s42 offen sc1
    v_add_u32 v13, 458752, v12
    v_lshrrev_b32 v13, 10, v13
    v_mul_u32_u24 v13, 7282, v13
    v_lshrrev_b32 v13, 16, v13
    v_add_u32 v13, 3, v13
    v_bfe_u32 v44, v13, 1, 1
    v_bfe_u32 v45, v13, 1, 1
    v_bfe_u32 v46, v13, 1, 1
    v_bfe_u32 v47, v13, 1, 1
    s_add_u32 s42, s41, 17235968
    buffer_store_dwordx4 v[44:47], v3, s[8:11], s42 offen sc1
    s_add_u32 s42, s41, 1572864
    buffer_store_dwordx4 v[4:7], v3, s[8:11], s42 offen sc1
    v_add_u32 v13, 524288, v12
    v_lshrrev_b32 v13, 10, v13
    v_mul_u32_u24 v13, 7282, v13
    v_lshrrev_b32 v13, 16, v13
    v_add_u32 v13, 3, v13
    v_bfe_u32 v48, v13, 1, 1
    v_bfe_u32 v49, v13, 1, 1
    v_bfe_u32 v50, v13, 1, 1
    v_bfe_u32 v51, v13, 1, 1
    s_add_u32 s42, s41, 17301504
    buffer_store_dwordx4 v[48:51], v3, s[8:11], s42 offen sc1
    s_waitcnt vmcnt(0)
    s_barrier
    s_cmp_lg_u32 s32, 0
    s_cbranch_scc1 I_a2
    v_mov_b32 v79, 1
    s_mov_b32 s94, 40
    s_mov_b64 exec, 1
    buffer_atomic_add v79, off, s[4:7], s94
    s_mov_b64 exec, -1
I_a2:
    s_cmp_lg_u32 s32, 0
    s_cbranch_scc1 A_iw_ok
    s_mov_b32 s94, 40
A_iw:
    buffer_load_dword v79, off, s[4:7], s94 sc1
    s_sub_u32 s95, s95, 1
    s_cmp_eq_u32 s95, 0
    s_cbranch_scc1 L_end
    s_waitcnt vmcnt(0)
    v_cmp_gt_u32 vcc, 32, v79
    s_cbranch_vccz A_iw_ok
    s_sleep 1
    s_branch A_iw
A_iw_ok:
    s_barrier
    s_mov_b32 s36, 0
R_h:
    v_mbcnt_lo_u32_b32 v0, -1, 0
    v_mbcnt_hi_u32_b32 v0, -1, v0
    v_lshlrev_b32 v1, 4, v0
    v_lshlrev_b32 v2, 2, v0
    v_add_u32 v2, 65536, v2
    v_and_b32 v6, 31, v0
    v_lshlrev_b32 v5, 2, v6
    v_lshrrev_b32 v7, 5, v0
    v_mul_u32_u24 v7, 304, v7
    v_lshl_add_u32 v7, v6, 4, v7
    v_cmp_lt_u32 vcc, 18, v6
    v_mov_b32 v6, 0x40000000
    s_nop 0
    v_cndmask_b32 v7, v7, v6, vcc
    v_add_u32 v3, 73728, v7
    v_mov_b32 v4, 0xdddd
    v_mov_b32 v17, 0
    v_mov_b32 v19, 0
    v_mov_b32 v20, 0
    v_mov_b32 v22, 0
    v_mov_b32 v29, 0
    v_mov_b32 v31, 0
    v_mov_b32 v32, 0
    v_mov_b32 v34, 0
    s_mov_b32 s52, -1
    s_mov_b32 s53, 0
    v_mov_b32 v180, 0x90000
    s_mov_b32 s40, 135680
    v_writelane_b32 v180, s40, 0
    s_mov_b32 s40, 135681
    v_writelane_b32 v180, s40, 1
    s_mov_b32 s40, 201474
    v_writelane_b32 v180, s40, 2
    s_mov_b32 s40, 196896
    v_writelane_b32 v180, s40, 3
    s_mov_b32 s40, 196897
    v_writelane_b32 v180, s40, 4
    s_mov_b32 s40, 267267
    v_writelane_b32 v180, s40, 5
    s_mov_b32 s40, 262448
    v_writelane_b32 v180, s40, 6
    s_mov_b32 s40, 262449
    v_writelane_b32 v180, s40, 7
    s_mov_b32 s40, 332804
    v_writelane_b32 v180, s40, 8
    s_mov_b32 s40, 328242
    v_writelane_b32 v180, s40, 9
    s_mov_b32 s40, 393792
    v_writelane_b32 v180, s40, 10
    s_mov_b32 s40, 393793
    v_writelane_b32 v180, s40, 11
    s_mov_b32 s40, 393795
    v_writelane_b32 v180, s40, 12
    s_mov_b32 s40, 459104
    v_writelane_b32 v180, s40, 13
    s_mov_b32 s40, 459105
    v_writelane_b32 v180, s40, 14
    s_mov_b32 s40, 532848
    v_writelane_b32 v180, s40, 15
    s_mov_b32 s40, 532849
    v_writelane_b32 v180, s40, 16
    s_mov_b32 s40, 533330
    v_writelane_b32 v180, s40, 17
    s_mov_b32 s40, 533091
    v_writelane_b32 v180, s40, 18
    s_mov_b32 s40, 533572
    v_writelane_b32 v180, s40, 19
    s_mov_b32 s40, 538629
    v_writelane_b32 v180, s40, 20
    s_mov_b32 s40, 538630
    v_writelane_b32 v180, s40, 21
    s_mov_b32 s40, 538631
    v_writelane_b32 v180, s40, 22
    s_mov_b32 s40, 135680
    v_writelane_b32 v180, s40, 24
    s_mov_b32 s40, 201473
    v_writelane_b32 v180, s40, 25
    s_mov_b32 s40, 201474
    v_writelane_b32 v180, s40, 26
    s_mov_b32 s40, 267267
    v_writelane_b32 v180, s40, 27
    s_mov_b32 s40, 262688
    v_writelane_b32 v180, s40, 28
    s_mov_b32 s40, 349188
    v_writelane_b32 v180, s40, 29
    s_mov_b32 s40, 328241
    v_writelane_b32 v180, s40, 30
    s_mov_b32 s40, 410418
    v_writelane_b32 v180, s40, 31
    s_mov_b32 s40, 410179
    v_writelane_b32 v180, s40, 32
    s_mov_b32 s40, 393792
    v_writelane_b32 v180, s40, 33
    s_mov_b32 s40, 475729
    v_writelane_b32 v180, s40, 34
    s_mov_b32 s40, 475488
    v_writelane_b32 v180, s40, 35
    s_mov_b32 s40, 447493
    v_writelane_b32 v180, s40, 37
    s_mov_b32 s40, 513030
    v_writelane_b32 v180, s40, 39
    s_mov_b32 s40, 447044
    v_writelane_b32 v180, s40, 41
BR_layer:
    s_nop 0
    v_readlane_b32 s39, v180, s36
    s_bfe_u32 s34, s39, 0x40004
    s_bfe_u32 s76, s39, 0x40008
    s_add_u32 s76, s76, s34
    s_mul_i32 s65, s34, 6
    s_mov_b32 s68, 0
    v_mov_b32 v181, 1
    v_mov_b32 v208, 163824
    v_lshl_add_u32 v183, s32, 2, v208
BR_phase:
    s_lshr_b32 s40, s39, 16
    s_lshl_b32 s40, s40, 7
    s_add_u32 s40, s40, 3198848
    s_cmp_lg_u32 s32, 0
    s_cbranch_scc1 BR_fl_ok
BR_fl:
    buffer_load_dword v6, off, s[8:11], s40 sc1
    s_sub_u32 s95, s95, 1
    s_cmp_eq_u32 s95, 0
    s_cbranch_scc1 L_end
    s_waitcnt vmcnt(0)
    v_cmp_gt_u32 vcc, 112, v6
    s_cbranch_vccz BR_fl_ok
    s_sleep 1
    s_branch BR_fl
BR_fl_ok:
    s_barrier
BR_more:
    s_lshl_b32 s43, s32, 10
    s_lshl_b32 s40, s34, 13
    s_add_u32 s40, s40, s43
    s_lshl_b32 s41, s33, 16
    s_add_u32 s41, s41, s40
    s_add_u32 s41, s41, 85983232
    s_add_u32 m0, s40, 0
    s_add_u32 s47, s41, 0
    buffer_load_dwordx4 v1, s[8:11], s47 offen sc1 lds
    s_add_u32 m0, s40, 4096
    s_add_u32 s47, s41, 4096
    buffer_load_dwordx4 v1, s[8:11], s47 offen sc1 lds
    s_mul_i32 s40, s34, 9728
    s_add_u32 s40, s40, s43
    s_mul_i32 s41, s33, 77824
    s_add_u32 s41, s41, s40
    s_add_u32 s41, s41, 89128960
    s_add_u32 m0, s40, 73728
    s_add_u32 s47, s41, 0
    buffer_load_dwordx4 v1, s[8:11], s47 offen sc1 lds
    s_add_u32 m0, s40, 77824
    s_add_u32 s47, s41, 4096
    buffer_load_dwordx4 v1, s[8:11], s47 offen sc1 lds
    s_cmp_ge_u32 s32, 2
    s_cbranch_scc1 BR_d2
    s_cmp_eq_u32 s32, 0
    s_cselect_b64 exec, -1, s[52:53]
    s_add_u32 m0, s40, 81920
    s_add_u32 s47, s41, 8192
    buffer_load_dwordx4 v1, s[8:11], s47 offen sc1 lds
    s_mov_b64 exec, -1
    s_branch BR_d3
BR_d2:
    s_lshl_b32 s40, s34, 10
    s_lshl_b32 s41, s33, 13
    s_add_u32 s41, s41, s40
    s_add_u32 m0, s40, 65536
    s_add_u32 s47, s41, 88342528
    buffer_load_dwordx4 v1, s[8:11], s47 offen sc1 lds
BR_d3:
    s_mov_b32 s69, 0
    s_add_u32 s34, s34, 1
    s_lshr_b32 s40, s39, 16
    s_bitcmp1_b32 s39, 15
    s_cselect_b32 s40, s76, s40
    s_cmp_lt_u32 s34, s40
    s_cbranch_scc1 BR_more
    s_and_b32 s48, s39, 7
    s_lshl_b32 s40, s33, 6
    s_lshl_b32 s41, s48, 3
    s_add_u32 s40, s40, s41
    s_add_u32 s40, s40, s32
    s_lshl_b32 s70, s40, 10
    s_add_u32 s70, s70, 83886080
    s_add_u32 s71, s70, 4096
    s_lshl_b32 s72, s40, 7
    s_add_u32 s72, s72, 88080384
    buffer_load_dwordx4 v[128:131], v1, s[8:11], s70 offen sc1
    buffer_load_dword v136, v5, s[8:11], s72 offen offset:0 sc1
    buffer_load_dwordx4 v[132:135], v1, s[8:11], s71 offen sc1
    buffer_load_dword v137, v5, s[8:11], s72 offen offset:512 sc1
    s_waitcnt vmcnt(0)
    s_barrier
BR_task:
    s_mov_b32 s38, s39
    s_add_u32 s36, s36, 1
    s_and_b32 s35, s38, 7
    v_readlane_b32 s39, v180, s36
    s_bfe_u32 s37, s38, 0x40008
    s_bfe_u32 s40, s38, 0x40004
    s_lshl_b32 s41, s40, 13
    v_add_u32 v8, s41, v1
    s_lshl_b32 s41, s40, 10
    v_add_u32 v9, s41, v2
    s_mul_i32 s41, s40, 9728
    v_add_u32 v10, s41, v3
    ds_read_b128 v[100:103], v8 offset:0
    ds_read2st64_b32 v[108:109], v9 offset0:0 offset1:1
    ds_read_b128 v[104:107], v8 offset:1024
    ds_read_b128 v[112:115], v10 offset:0
    ds_read_b128 v[116:119], v10 offset:608
    s_bitcmp1_b32 s38, 12
    s_cbranch_scc0 BR_old
    v_mov_b64 v[36:37], 0
    v_mov_b64 v[38:39], 0
    v_mov_b64 v[40:41], 0
    v_mov_b64 v[42:43], 0
    v_mov_b64 v[44:45], 0
    v_mov_b64 v[46:47], 0
    v_mov_b64 v[52:53], 0
    v_mov_b64 v[54:55], 0
    v_mov_b64 v[56:57], 0
    v_mov_b64 v[58:59], 0
    v_mov_b64 v[60:61], 0
    v_mov_b64 v[62:63], 0
    s_cmp_lg_u32 s35, 0
    s_cbranch_scc1 BR_w0
    v_accvgpr_write_b32 a0, v128
    v_accvgpr_write_b32 a1, v129
    v_accvgpr_write_b32 a2, v130
    v_accvgpr_write_b32 a3, v131
    v_accvgpr_write_b32 a4, v136
    v_accvgpr_write_b32 a5, v132
    v_accvgpr_write_b32 a6, v133
    v_accvgpr_write_b32 a7, v134
    v_accvgpr_write_b32 a8, v135
    v_accvgpr_write_b32 a9, v137
    s_branch BR_wx
BR_w0:
    s_cmp_lg_u32 s35, 1
    s_cbranch_scc1 BR_w1
    v_accvgpr_write_b32 a34, v128
    v_accvgpr_write_b32 a35, v129
    v_accvgpr_write_b32 a36, v130
    v_accvgpr_write_b32 a37, v131
    v_accvgpr_write_b32 a38, v136
    v_accvgpr_write_b32 a39, v132
    v_accvgpr_write_b32 a40, v133
    v_accvgpr_write_b32 a41, v134
    v_accvgpr_write_b32 a42, v135
    v_accvgpr_write_b32 a43, v137
    s_branch BR_wx
BR_w1:
    s_cmp_lg_u32 s35, 2
    s_cbranch_scc1 BR_w2
    v_accvgpr_write_b32 a68, v128
    v_accvgpr_write_b32 a69, v129
    v_accvgpr_write_b32 a70, v130
    v_accvgpr_write_b32 a71, v131
    v_accvgpr_write_b32 a72, v136
    v_accvgpr_write_b32 a73, v132
    v_accvgpr_write_b32 a74, v133
    v_accvgpr_write_b32 a75, v134
    v_accvgpr_write_b32 a76, v135
    v_accvgpr_write_b32 a77, v137
    s_branch BR_wx
BR_w2:
    s_cmp_lg_u32 s35, 3
    s_cbranch_scc1 BR_w3
    v_accvgpr_write_b32 a102, v128
    v_accvgpr_write_b32 a103, v129
    v_accvgpr_write_b32 a104, v130
    v_accvgpr_write_b32 a105, v131
    v_accvgpr_write_b32 a106, v136
    v_accvgpr_write_b32 a107, v132
    v_accvgpr_write_b32 a108, v133
    v_accvgpr_write_b32 a109, v134
    v_accvgpr_write_b32 a110, v135
    v_accvgpr_write_b32 a111, v137
    s_branch BR_wx
BR_w3:
    s_cmp_lg_u32 s35, 4
    s_cbranch_scc1 BR_w4
    v_accvgpr_write_b32 a136, v128
    v_accvgpr_write_b32 a137, v129
    v_accvgpr_write_b32 a138, v130
    v_accvgpr_write_b32 a139, v131
    v_accvgpr_write_b32 a140, v136
    v_accvgpr_write_b32 a141, v132
    v_accvgpr_write_b32 a142, v133
    v_accvgpr_write_b32 a143, v134
    v_accvgpr_write_b32 a144, v135
    v_accvgpr_write_b32 a145, v137
    s_branch BR_wx
BR_w4:
BR_wx:
    s_branch BR_rx
BR_old:
    s_cmp_lg_u32 s35, 0
    s_cbranch_scc1 BR_r0
    v_accvgpr_read_b32 v128, a0
    v_accvgpr_read_b32 v129, a1
    v_accvgpr_read_b32 v130, a2
    v_accvgpr_read_b32 v131, a3
    v_accvgpr_read_b32 v136, a4
    v_accvgpr_read_b32 v132, a5
    v_accvgpr_read_b32 v133, a6
    v_accvgpr_read_b32 v134, a7
    v_accvgpr_read_b32 v135, a8
    v_accvgpr_read_b32 v137, a9
    v_accvgpr_read_b32 v36, a10
    v_accvgpr_read_b32 v37, a11
    v_accvgpr_read_b32 v38, a12
    v_accvgpr_read_b32 v39, a13
    v_accvgpr_read_b32 v40, a14
    v_accvgpr_read_b32 v41, a15
    v_accvgpr_read_b32 v42, a16
    v_accvgpr_read_b32 v43, a17
    v_accvgpr_read_b32 v44, a18
    v_accvgpr_read_b32 v45, a19
    v_accvgpr_read_b32 v46, a20
    v_accvgpr_read_b32 v47, a21
    v_accvgpr_read_b32 v52, a22
    v_accvgpr_read_b32 v53, a23
    v_accvgpr_read_b32 v54, a24
    v_accvgpr_read_b32 v55, a25
    v_accvgpr_read_b32 v56, a26
    v_accvgpr_read_b32 v57, a27
    v_accvgpr_read_b32 v58, a28
    v_accvgpr_read_b32 v59, a29
    v_accvgpr_read_b32 v60, a30
    v_accvgpr_read_b32 v61, a31
    v_accvgpr_read_b32 v62, a32
    v_accvgpr_read_b32 v63, a33
    s_branch BR_rx
BR_r0:
    s_cmp_lg_u32 s35, 1
    s_cbranch_scc1 BR_r1
    v_accvgpr_read_b32 v128, a34
    v_accvgpr_read_b32 v129, a35
    v_accvgpr_read_b32 v130, a36
    v_accvgpr_read_b32 v131, a37
    v_accvgpr_read_b32 v136, a38
    v_accvgpr_read_b32 v132, a39
    v_accvgpr_read_b32 v133, a40
    v_accvgpr_read_b32 v134, a41
    v_accvgpr_read_b32 v135, a42
    v_accvgpr_read_b32 v137, a43
    v_accvgpr_read_b32 v36, a44
    v_accvgpr_read_b32 v37, a45
    v_accvgpr_read_b32 v38, a46
    v_accvgpr_read_b32 v39, a47
    v_accvgpr_read_b32 v40, a48
    v_accvgpr_read_b32 v41, a49
    v_accvgpr_read_b32 v42, a50
    v_accvgpr_read_b32 v43, a51
    v_accvgpr_read_b32 v44, a52
    v_accvgpr_read_b32 v45, a53
    v_accvgpr_read_b32 v46, a54
    v_accvgpr_read_b32 v47, a55
    v_accvgpr_read_b32 v52, a56
    v_accvgpr_read_b32 v53, a57
    v_accvgpr_read_b32 v54, a58
    v_accvgpr_read_b32 v55, a59
    v_accvgpr_read_b32 v56, a60
    v_accvgpr_read_b32 v57, a61
    v_accvgpr_read_b32 v58, a62
    v_accvgpr_read_b32 v59, a63
    v_accvgpr_read_b32 v60, a64
    v_accvgpr_read_b32 v61, a65
    v_accvgpr_read_b32 v62, a66
    v_accvgpr_read_b32 v63, a67
    s_branch BR_rx
BR_r1:
    s_cmp_lg_u32 s35, 2
    s_cbranch_scc1 BR_r2
    v_accvgpr_read_b32 v128, a68
    v_accvgpr_read_b32 v129, a69
    v_accvgpr_read_b32 v130, a70
    v_accvgpr_read_b32 v131, a71
    v_accvgpr_read_b32 v136, a72
    v_accvgpr_read_b32 v132, a73
    v_accvgpr_read_b32 v133, a74
    v_accvgpr_read_b32 v134, a75
    v_accvgpr_read_b32 v135, a76
    v_accvgpr_read_b32 v137, a77
    v_accvgpr_read_b32 v36, a78
    v_accvgpr_read_b32 v37, a79
    v_accvgpr_read_b32 v38, a80
    v_accvgpr_read_b32 v39, a81
    v_accvgpr_read_b32 v40, a82
    v_accvgpr_read_b32 v41, a83
    v_accvgpr_read_b32 v42, a84
    v_accvgpr_read_b32 v43, a85
    v_accvgpr_read_b32 v44, a86
    v_accvgpr_read_b32 v45, a87
    v_accvgpr_read_b32 v46, a88
    v_accvgpr_read_b32 v47, a89
    v_accvgpr_read_b32 v52, a90
    v_accvgpr_read_b32 v53, a91
    v_accvgpr_read_b32 v54, a92
    v_accvgpr_read_b32 v55, a93
    v_accvgpr_read_b32 v56, a94
    v_accvgpr_read_b32 v57, a95
    v_accvgpr_read_b32 v58, a96
    v_accvgpr_read_b32 v59, a97
    v_accvgpr_read_b32 v60, a98
    v_accvgpr_read_b32 v61, a99
    v_accvgpr_read_b32 v62, a100
    v_accvgpr_read_b32 v63, a101
    s_branch BR_rx
BR_r2:
    s_cmp_lg_u32 s35, 3
    s_cbranch_scc1 BR_r3
    v_accvgpr_read_b32 v128, a102
    v_accvgpr_read_b32 v129, a103
    v_accvgpr_read_b32 v130, a104
    v_accvgpr_read_b32 v131, a105
    v_accvgpr_read_b32 v136, a106
    v_accvgpr_read_b32 v132, a107
    v_accvgpr_read_b32 v133, a108
    v_accvgpr_read_b32 v134, a109
    v_accvgpr_read_b32 v135, a110
    v_accvgpr_read_b32 v137, a111
    v_accvgpr_read_b32 v36, a112
    v_accvgpr_read_b32 v37, a113
    v_accvgpr_read_b32 v38, a114
    v_accvgpr_read_b32 v39, a115
    v_accvgpr_read_b32 v40, a116
    v_accvgpr_read_b32 v41, a117
    v_accvgpr_read_b32 v42, a118
    v_accvgpr_read_b32 v43, a119
    v_accvgpr_read_b32 v44, a120
    v_accvgpr_read_b32 v45, a121
    v_accvgpr_read_b32 v46, a122
    v_accvgpr_read_b32 v47, a123
    v_accvgpr_read_b32 v52, a124
    v_accvgpr_read_b32 v53, a125
    v_accvgpr_read_b32 v54, a126
    v_accvgpr_read_b32 v55, a127
    v_accvgpr_read_b32 v56, a128
    v_accvgpr_read_b32 v57, a129
    v_accvgpr_read_b32 v58, a130
    v_accvgpr_read_b32 v59, a131
    v_accvgpr_read_b32 v60, a132
    v_accvgpr_read_b32 v61, a133
    v_accvgpr_read_b32 v62, a134
    v_accvgpr_read_b32 v63, a135
    s_branch BR_rx
BR_r3:
    s_cmp_lg_u32 s35, 4
    s_cbranch_scc1 BR_r4
    v_accvgpr_read_b32 v128, a136
    v_accvgpr_read_b32 v129, a137
    v_accvgpr_read_b32 v130, a138
    v_accvgpr_read_b32 v131, a139
    v_accvgpr_read_b32 v136, a140
    v_accvgpr_read_b32 v132, a141
    v_accvgpr_read_b32 v133, a142
    v_accvgpr_read_b32 v134, a143
    v_accvgpr_read_b32 v135, a144
    v_accvgpr_read_b32 v137, a145
    v_accvgpr_read_b32 v36, a146
    v_accvgpr_read_b32 v37, a147
    v_accvgpr_read_b32 v38, a148
    v_accvgpr_read_b32 v39, a149
    v_accvgpr_read_b32 v40, a150
    v_accvgpr_read_b32 v41, a151
    v_accvgpr_read_b32 v42, a152
    v_accvgpr_read_b32 v43, a153
    v_accvgpr_read_b32 v44, a154
    v_accvgpr_read_b32 v45, a155
    v_accvgpr_read_b32 v46, a156
    v_accvgpr_read_b32 v47, a157
    v_accvgpr_read_b32 v52, a158
    v_accvgpr_read_b32 v53, a159
    v_accvgpr_read_b32 v54, a160
    v_accvgpr_read_b32 v55, a161
    v_accvgpr_read_b32 v56, a162
    v_accvgpr_read_b32 v57, a163
    v_accvgpr_read_b32 v58, a164
    v_accvgpr_read_b32 v59, a165
    v_accvgpr_read_b32 v60, a166
    v_accvgpr_read_b32 v61, a167
    v_accvgpr_read_b32 v62, a168
    v_accvgpr_read_b32 v63, a169
    s_branch BR_rx
BR_r4:
BR_rx:
    v_mov_b64 v[12:13], v[128:129]
    v_mov_b64 v[14:15], v[130:131]
    v_cndmask_b32 v16, 0, v136, s[52:53]
    v_cndmask_b32 v21, 0, v136, s[52:53]
    v_cndmask_b32 v18, v136, 0, s[52:53]
    v_cndmask_b32 v23, v136, 0, s[52:53]
    v_mov_b64 v[24:25], v[132:133]
    v_mov_b64 v[26:27], v[134:135]
    v_cndmask_b32 v28, 0, v137, s[52:53]
    v_cndmask_b32 v33, 0, v137, s[52:53]
    v_cndmask_b32 v30, v137, 0, s[52:53]
    v_cndmask_b32 v35, v137, 0, s[52:53]
    s_waitcnt lgkmcnt(0)
    v_mfma_f32_32x32x16_bf16 v[68:83], v[100:103], v[12:15], 0
    v_mfma_f32_32x32x8_bf16 v[68:83], v[108:109], v[16:17], v[68:83]
    v_mov_b64 v[92:93], 0
    v_mov_b64 v[94:95], 0
    v_mov_b64 v[96:97], 0
    v_mov_b64 v[98:99], 0
    v_mov_b64 v[124:125], 0
    v_mov_b64 v[126:127], 0
    s_add_u32 s40, s34, s96
    s_cmp_lt_u32 s40, 8
    s_cselect_b32 s69, s69, 0
    s_cmp_lt_u32 s69, 112
    s_cbranch_scc1 BR_ns
    s_lshl_b32 s43, s32, 10
    s_lshl_b32 s40, s34, 13
    s_add_u32 s40, s40, s43
    s_lshl_b32 s41, s33, 16
    s_add_u32 s41, s41, s40
    s_add_u32 s41, s41, 85983232
    s_add_u32 m0, s40, 0
    s_add_u32 s47, s41, 0
    buffer_load_dwordx4 v1, s[8:11], s47 offen sc1 lds
    s_add_u32 m0, s40, 4096
    s_add_u32 s47, s41, 4096
    buffer_load_dwordx4 v1, s[8:11], s47 offen sc1 lds
    s_mul_i32 s40, s34, 9728
    s_add_u32 s40, s40, s43
    s_mul_i32 s41, s33, 77824
    s_add_u32 s41, s41, s40
    s_add_u32 s41, s41, 89128960
    s_add_u32 m0, s40, 73728
    s_add_u32 s47, s41, 0
    buffer_load_dwordx4 v1, s[8:11], s47 offen sc1 lds
    s_add_u32 m0, s40, 77824
    s_add_u32 s47, s41, 4096
    buffer_load_dwordx4 v1, s[8:11], s47 offen sc1 lds
    s_cmp_ge_u32 s32, 2
    s_cbranch_scc1 BR_e2
    s_cmp_eq_u32 s32, 0
    s_cselect_b64 exec, -1, s[52:53]
    s_add_u32 m0, s40, 81920
    s_add_u32 s47, s41, 8192
    buffer_load_dwordx4 v1, s[8:11], s47 offen sc1 lds
    s_mov_b64 exec, -1
    s_branch BR_e3
BR_e2:
    s_lshl_b32 s40, s34, 10
    s_lshl_b32 s41, s33, 13
    s_add_u32 s41, s41, s40
    s_add_u32 m0, s40, 65536
    s_add_u32 s47, s41, 88342528
    buffer_load_dwordx4 v1, s[8:11], s47 offen sc1 lds
BR_e3:
    s_add_u32 s34, s34, 1
BR_ns:
    s_lshl_b32 s75, s34, 7
    s_add_u32 s75, s75, 3198976
    buffer_load_dword v182, off, s[8:11], s75 sc1
    v_xor_b32 v183, 16, v183
    v_xor_b32 v208, 16, v208
    s_and_b32 s48, s39, 7
    s_lshr_b32 s40, s39, 16
    s_cmp_gt_u32 s40, s34
    s_cselect_b32 s48, s35, s48
    s_lshl_b32 s40, s33, 6
    s_lshl_b32 s41, s48, 3
    s_add_u32 s40, s40, s41
    s_add_u32 s40, s40, s32
    s_lshl_b32 s70, s40, 10
    s_add_u32 s70, s70, 83886080
    s_add_u32 s71, s70, 4096
    s_lshl_b32 s72, s40, 7
    s_add_u32 s72, s72, 88080384
    v_exp_f32 v68, v68
    v_exp_f32 v69, v69
    v_smfmac_f32_32x32x32_bf16 v[52:67], v[124:127], v[92:99], v4
    ds_read_b128 v[120:123], v10 offset:1216
    v_exp_f32 v70, v70
    v_exp_f32 v71, v71
    v_exp_f32 v72, v72
    v_exp_f32 v73, v73
    v_mfma_f32_32x32x16_bf16 v[84:99], v[100:103], v[24:27], 0
    s_waitcnt lgkmcnt(1)
    v_exp_f32 v74, v74
    v_exp_f32 v75, v75
    v_exp_f32 v76, v76
    v_exp_f32 v77, v77
    v_mfma_f32_32x32x8_bf16 v[84:99], v[108:109], v[28:29], v[84:99]
    v_exp_f32 v78, v78
    v_exp_f32 v79, v79
    v_exp_f32 v80, v80
    v_exp_f32 v81, v81
    v_smfmac_f32_32x32x32_bf16 v[36:51], v[112:115], v[68:75], v4
    ds_read_b128 v[124:127], v10 offset:1824
    v_exp_f32 v82, v82
    v_exp_f32 v83, v83
    v_exp_f32 v84, v84
    v_exp_f32 v85, v85
    v_smfmac_f32_32x32x32_bf16 v[36:51], v[116:119], v[76:83], v4
    ds_read_b128 v[100:103], v8 offset:2048
    v_exp_f32 v86, v86
    v_exp_f32 v87, v87
    v_exp_f32 v88, v88
    v_exp_f32 v89, v89
    v_mfma_f32_32x32x16_bf16 v[68:83], v[104:107], v[12:15], 0
    v_exp_f32 v90, v90
    v_exp_f32 v91, v91
    v_exp_f32 v92, v92
    v_exp_f32 v93, v93
    v_mfma_f32_32x32x8_bf16 v[68:83], v[108:109], v[18:19], v[68:83]
    v_exp_f32 v94, v94
    v_exp_f32 v95, v95
    v_exp_f32 v96, v96
    v_exp_f32 v97, v97
    v_smfmac_f32_32x32x32_bf16 v[52:67], v[112:115], v[84:91], v4
    v_exp_f32 v98, v98
    v_exp_f32 v99, v99
    v_exp_f32 v68, v68
    v_exp_f32 v69, v69
    v_smfmac_f32_32x32x32_bf16 v[52:67], v[116:119], v[92:99], v4
    ds_read_b128 v[112:115], v10 offset:2432
    v_exp_f32 v70, v70
    v_exp_f32 v71, v71
    v_exp_f32 v72, v72
    v_exp_f32 v73, v73
    v_mfma_f32_32x32x16_bf16 v[84:99], v[104:107], v[24:27], 0
    s_waitcnt lgkmcnt(1)
    v_exp_f32 v74, v74
    v_exp_f32 v75, v75
    v_exp_f32 v76, v76
    v_exp_f32 v77, v77
    v_mfma_f32_32x32x8_bf16 v[84:99], v[108:109], v[30:31], v[84:99]
    v_exp_f32 v78, v78
    v_exp_f32 v79, v79
    v_exp_f32 v80, v80
    v_exp_f32 v81, v81
    v_smfmac_f32_32x32x32_bf16 v[36:51], v[120:123], v[68:75], v4
    ds_read_b128 v[116:119], v10 offset:3040
    v_exp_f32 v82, v82
    v_exp_f32 v83, v83
    v_exp_f32 v84, v84
    v_exp_f32 v85, v85
    v_smfmac_f32_32x32x32_bf16 v[36:51], v[124:127], v[76:83], v4
    ds_read_b128 v[104:107], v8 offset:3072
    v_exp_f32 v86, v86
    v_exp_f32 v87, v87
    v_exp_f32 v88, v88
    v_exp_f32 v89, v89
    v_mfma_f32_32x32x16_bf16 v[68:83], v[100:103], v[12:15], 0
    v_exp_f32 v90, v90
    v_exp_f32 v91, v91
    v_exp_f32 v92, v92
    v_exp_f32 v93, v93
    v_mfma_f32_32x32x8_bf16 v[68:83], v[108:109], v[20:21], v[68:83]
    v_exp_f32 v94, v94
    v_exp_f32 v95, v95
    v_exp_f32 v96, v96
    v_exp_f32 v97, v97
    v_smfmac_f32_32x32x32_bf16 v[52:67], v[120:123], v[84:91], v4
    ds_read2st64_b32 v[110:111], v9 offset0:2 offset1:3
    v_exp_f32 v98, v98
    v_exp_f32 v99, v99
    v_exp_f32 v68, v68
    v_exp_f32 v69, v69
    v_smfmac_f32_32x32x32_bf16 v[52:67], v[124:127], v[92:99], v4
    ds_read_b128 v[120:123], v10 offset:3648
    v_exp_f32 v70, v70
    v_exp_f32 v71, v71
    v_exp_f32 v72, v72
    v_exp_f32 v73, v73
    v_mfma_f32_32x32x16_bf16 v[84:99], v[100:103], v[24:27], 0
    s_waitcnt lgkmcnt(1)
    v_exp_f32 v74, v74
    v_exp_f32 v75, v75
    v_exp_f32 v76, v76
    v_exp_f32 v77, v77
    v_mfma_f32_32x32x8_bf16 v[84:99], v[108:109], v[32:33], v[84:99]
    v_exp_f32 v78, v78
    v_exp_f32 v79, v79
    v_exp_f32 v80, v80
    v_exp_f32 v81, v81
    v_smfmac_f32_32x32x32_bf16 v[36:51], v[112:115], v[68:75], v4
    ds_read_b128 v[124:127], v10 offset:4256
    v_exp_f32 v82, v82
    v_exp_f32 v83, v83
    v_exp_f32 v84, v84
    v_exp_f32 v85, v85
    v_smfmac_f32_32x32x32_bf16 v[36:51], v[116:119], v[76:83], v4
    ds_read_b128 v[100:103], v8 offset:4096
    v_exp_f32 v86, v86
    v_exp_f32 v87, v87
    v_exp_f32 v88, v88
    v_exp_f32 v89, v89
    v_mfma_f32_32x32x16_bf16 v[68:83], v[104:107], v[12:15], 0
    v_exp_f32 v90, v90
    v_exp_f32 v91, v91
    v_exp_f32 v92, v92
    v_exp_f32 v93, v93
    v_mfma_f32_32x32x8_bf16 v[68:83], v[108:109], v[22:23], v[68:83]
    v_exp_f32 v94, v94
    v_exp_f32 v95, v95
    v_exp_f32 v96, v96
    v_exp_f32 v97, v97
    v_smfmac_f32_32x32x32_bf16 v[52:67], v[112:115], v[84:91], v4
    v_exp_f32 v98, v98
    v_exp_f32 v99, v99
    s_waitcnt vmcnt(0)
    ds_write_b32 v183, v182
    s_waitcnt lgkmcnt(0)
    s_barrier
    s_cmp_eq_u32 s68, 0
    s_cbranch_scc1 BR_s1
    s_mov_b64 exec, 1
    buffer_atomic_add v181, off, s[8:11], s68
    s_mov_b64 exec, -1
    s_mov_b32 s68, 0
BR_s1:
    ds_read_b32 v182, v208
    v_exp_f32 v68, v68
    v_exp_f32 v69, v69
    v_smfmac_f32_32x32x32_bf16 v[52:67], v[116:119], v[92:99], v4
    ds_read_b128 v[112:115], v10 offset:4864
    v_exp_f32 v70, v70
    v_exp_f32 v71, v71
    v_exp_f32 v72, v72
    v_exp_f32 v73, v73
    v_mfma_f32_32x32x16_bf16 v[84:99], v[104:107], v[24:27], 0
    s_waitcnt lgkmcnt(1)
    v_exp_f32 v74, v74
    v_exp_f32 v75, v75
    v_exp_f32 v76, v76
    v_exp_f32 v77, v77
    v_mfma_f32_32x32x8_bf16 v[84:99], v[108:109], v[34:35], v[84:99]
    v_exp_f32 v78, v78
    v_exp_f32 v79, v79
    v_exp_f32 v80, v80
    v_exp_f32 v81, v81
    v_smfmac_f32_32x32x32_bf16 v[36:51], v[120:123], v[68:75], v4
    ds_read_b128 v[116:119], v10 offset:5472
    v_exp_f32 v82, v82
    v_exp_f32 v83, v83
    v_exp_f32 v84, v84
    v_exp_f32 v85, v85
    v_smfmac_f32_32x32x32_bf16 v[36:51], v[124:127], v[76:83], v4
    ds_read_b128 v[104:107], v8 offset:5120
    v_exp_f32 v86, v86
    v_exp_f32 v87, v87
    v_exp_f32 v88, v88
    v_exp_f32 v89, v89
    v_mfma_f32_32x32x16_bf16 v[68:83], v[100:103], v[12:15], 0
    v_exp_f32 v90, v90
    v_exp_f32 v91, v91
    v_exp_f32 v92, v92
    v_exp_f32 v93, v93
    v_mfma_f32_32x32x8_bf16 v[68:83], v[110:111], v[16:17], v[68:83]
    v_exp_f32 v94, v94
    v_exp_f32 v95, v95
    v_exp_f32 v96, v96
    v_exp_f32 v97, v97
    v_smfmac_f32_32x32x32_bf16 v[52:67], v[120:123], v[84:91], v4
    buffer_load_dwordx4 v[128:131], v1, s[8:11], s70 offen sc1
    v_exp_f32 v98, v98
    v_exp_f32 v99, v99
    v_exp_f32 v68, v68
    v_exp_f32 v69, v69
    v_smfmac_f32_32x32x32_bf16 v[52:67], v[124:127], v[92:99], v4
    ds_read_b128 v[120:123], v10 offset:6080
    v_exp_f32 v70, v70
    v_exp_f32 v71, v71
    v_exp_f32 v72, v72
    v_exp_f32 v73, v73
    v_mfma_f32_32x32x16_bf16 v[84:99], v[100:103], v[24:27], 0
    s_waitcnt lgkmcnt(1)
    v_exp_f32 v74, v74
    v_exp_f32 v75, v75
    v_exp_f32 v76, v76
    v_exp_f32 v77, v77
    v_mfma_f32_32x32x8_bf16 v[84:99], v[110:111], v[28:29], v[84:99]
    v_exp_f32 v78, v78
    v_exp_f32 v79, v79
    v_exp_f32 v80, v80
    v_exp_f32 v81, v81
    v_smfmac_f32_32x32x32_bf16 v[36:51], v[112:115], v[68:75], v4
    ds_read_b128 v[124:127], v10 offset:6688
    v_exp_f32 v82, v82
    v_exp_f32 v83, v83
    v_exp_f32 v84, v84
    v_exp_f32 v85, v85
    v_smfmac_f32_32x32x32_bf16 v[36:51], v[116:119], v[76:83], v4
    ds_read_b128 v[100:103], v8 offset:6144
    v_exp_f32 v86, v86
    v_exp_f32 v87, v87
    v_exp_f32 v88, v88
    v_exp_f32 v89, v89
    v_mfma_f32_32x32x16_bf16 v[68:83], v[104:107], v[12:15], 0
    v_exp_f32 v90, v90
    v_exp_f32 v91, v91
    v_exp_f32 v92, v92
    v_exp_f32 v93, v93
    v_mfma_f32_32x32x8_bf16 v[68:83], v[110:111], v[18:19], v[68:83]
    v_exp_f32 v94, v94
    v_exp_f32 v95, v95
    v_exp_f32 v96, v96
    v_exp_f32 v97, v97
    v_smfmac_f32_32x32x32_bf16 v[52:67], v[112:115], v[84:91], v4
    buffer_load_dwordx4 v[132:135], v1, s[8:11], s71 offen sc1
    v_exp_f32 v98, v98
    v_exp_f32 v99, v99
    v_exp_f32 v68, v68
    v_exp_f32 v69, v69
    v_smfmac_f32_32x32x32_bf16 v[52:67], v[116:119], v[92:99], v4
    ds_read_b128 v[112:115], v10 offset:7296
    v_exp_f32 v70, v70
    v_exp_f32 v71, v71
    v_exp_f32 v72, v72
    v_exp_f32 v73, v73
    v_mfma_f32_32x32x16_bf16 v[84:99], v[104:107], v[24:27], 0
    s_waitcnt lgkmcnt(1)
    v_exp_f32 v74, v74
    v_exp_f32 v75, v75
    v_exp_f32 v76, v76
    v_exp_f32 v77, v77
    v_mfma_f32_32x32x8_bf16 v[84:99], v[110:111], v[30:31], v[84:99]
    v_exp_f32 v78, v78
    v_exp_f32 v79, v79
    v_exp_f32 v80, v80
    v_exp_f32 v81, v81
    v_smfmac_f32_32x32x32_bf16 v[36:51], v[120:123], v[68:75], v4
    ds_read_b128 v[116:119], v10 offset:7904
    v_exp_f32 v82, v82
    v_exp_f32 v83, v83
    v_exp_f32 v84, v84
    v_exp_f32 v85, v85
    v_smfmac_f32_32x32x32_bf16 v[36:51], v[124:127], v[76:83], v4
    ds_read_b128 v[104:107], v8 offset:7168
    v_exp_f32 v86, v86
    v_exp_f32 v87, v87
    v_exp_f32 v88, v88
    v_exp_f32 v89, v89
    v_mfma_f32_32x32x16_bf16 v[68:83], v[100:103], v[12:15], 0
    v_exp_f32 v90, v90
    v_exp_f32 v91, v91
    v_exp_f32 v92, v92
    v_exp_f32 v93, v93
    v_mfma_f32_32x32x8_bf16 v[68:83], v[110:111], v[20:21], v[68:83]
    v_exp_f32 v94, v94
    v_exp_f32 v95, v95
    v_exp_f32 v96, v96
    v_exp_f32 v97, v97
    v_smfmac_f32_32x32x32_bf16 v[52:67], v[120:123], v[84:91], v4
    ds_read2st64_b32 v[108:109], v9 offset0:4 offset1:5
    v_exp_f32 v98, v98
    v_exp_f32 v99, v99
    v_exp_f32 v68, v68
    v_exp_f32 v69, v69
    v_smfmac_f32_32x32x32_bf16 v[52:67], v[124:127], v[92:99], v4
    ds_read_b128 v[120:123], v10 offset:8512
    v_exp_f32 v70, v70
    v_exp_f32 v71, v71
    v_exp_f32 v72, v72
    v_exp_f32 v73, v73
    v_mfma_f32_32x32x16_bf16 v[84:99], v[100:103], v[24:27], 0
    s_waitcnt lgkmcnt(1)
    v_exp_f32 v74, v74
    v_exp_f32 v75, v75
    v_exp_f32 v76, v76
    v_exp_f32 v77, v77
    v_mfma_f32_32x32x8_bf16 v[84:99], v[110:111], v[32:33], v[84:99]
    v_exp_f32 v78, v78
    v_exp_f32 v79, v79
    v_exp_f32 v80, v80
    v_exp_f32 v81, v81
    v_smfmac_f32_32x32x32_bf16 v[36:51], v[112:115], v[68:75], v4
    ds_read_b128 v[124:127], v10 offset:9120
    v_exp_f32 v82, v82
    v_exp_f32 v83, v83
    v_exp_f32 v84, v84
    v_exp_f32 v85, v85
    v_smfmac_f32_32x32x32_bf16 v[36:51], v[116:119], v[76:83], v4
    ds_read_b128 v[100:103], v8 offset:8192
    v_exp_f32 v86, v86
    v_exp_f32 v87, v87
    v_exp_f32 v88, v88
    v_exp_f32 v89, v89
    v_mfma_f32_32x32x16_bf16 v[68:83], v[104:107], v[12:15], 0
    v_exp_f32 v90, v90
    v_exp_f32 v91, v91
    v_exp_f32 v92, v92
    v_exp_f32 v93, v93
    v_mfma_f32_32x32x8_bf16 v[68:83], v[110:111], v[22:23], v[68:83]
    v_exp_f32 v94, v94
    v_exp_f32 v95, v95
    v_exp_f32 v96, v96
    v_exp_f32 v97, v97
    v_smfmac_f32_32x32x32_bf16 v[52:67], v[112:115], v[84:91], v4
    buffer_load_dword v136, v5, s[8:11], s72 offen offset:0 sc1
    buffer_load_dword v137, v5, s[8:11], s72 offen offset:512 sc1
    v_exp_f32 v98, v98
    v_exp_f32 v99, v99
    v_exp_f32 v68, v68
    v_exp_f32 v69, v69
    v_smfmac_f32_32x32x32_bf16 v[52:67], v[116:119], v[92:99], v4
    ds_read_b128 v[112:115], v10 offset:9728
    v_exp_f32 v70, v70
    v_exp_f32 v71, v71
    v_exp_f32 v72, v72
    v_exp_f32 v73, v73
    v_mfma_f32_32x32x16_bf16 v[84:99], v[104:107], v[24:27], 0
    s_waitcnt lgkmcnt(1)
    v_exp_f32 v74, v74
    v_exp_f32 v75, v75
    v_exp_f32 v76, v76
    v_exp_f32 v77, v77
    v_mfma_f32_32x32x8_bf16 v[84:99], v[110:111], v[34:35], v[84:99]
    v_exp_f32 v78, v78
    v_exp_f32 v79, v79
    v_exp_f32 v80, v80
    v_exp_f32 v81, v81
    v_smfmac_f32_32x32x32_bf16 v[36:51], v[120:123], v[68:75], v4
    ds_read_b128 v[116:119], v10 offset:10336
    v_exp_f32 v82, v82
    v_exp_f32 v83, v83
    v_exp_f32 v84, v84
    v_exp_f32 v85, v85
    v_smfmac_f32_32x32x32_bf16 v[36:51], v[124:127], v[76:83], v4
    ds_read_b128 v[104:107], v8 offset:9216
    v_exp_f32 v86, v86
    v_exp_f32 v87, v87
    v_exp_f32 v88, v88
    v_exp_f32 v89, v89
    v_mfma_f32_32x32x16_bf16 v[68:83], v[100:103], v[12:15], 0
    v_exp_f32 v90, v90
    v_exp_f32 v91, v91
    v_exp_f32 v92, v92
    v_exp_f32 v93, v93
    v_mfma_f32_32x32x8_bf16 v[68:83], v[108:109], v[16:17], v[68:83]
    v_exp_f32 v94, v94
    v_exp_f32 v95, v95
    v_exp_f32 v96, v96
    v_exp_f32 v97, v97
    v_smfmac_f32_32x32x32_bf16 v[52:67], v[120:123], v[84:91], v4
    s_sub_u32 s37, s37, 1
    s_cmp_lg_u32 s37, 0
    v_exp_f32 v98, v98
    v_exp_f32 v99, v99
    v_add_u32 v8, 8192, v8
    v_add_u32 v9, 1024, v9
    v_add_u32 v10, 9728, v10
    s_cbranch_scc0 BR_end
BR_loop:
    v_exp_f32 v68, v68
    v_exp_f32 v69, v69
    v_smfmac_f32_32x32x32_bf16 v[52:67], v[124:127], v[92:99], v4
    ds_read_b128 v[120:123], v10 offset:1216
    v_exp_f32 v70, v70
    v_exp_f32 v71, v71
    v_exp_f32 v72, v72
    v_exp_f32 v73, v73
    v_mfma_f32_32x32x16_bf16 v[84:99], v[100:103], v[24:27], 0
    s_waitcnt lgkmcnt(1)
    v_exp_f32 v74, v74
    v_exp_f32 v75, v75
    v_exp_f32 v76, v76
    v_exp_f32 v77, v77
    v_mfma_f32_32x32x8_bf16 v[84:99], v[108:109], v[28:29], v[84:99]
    v_exp_f32 v78, v78
    v_exp_f32 v79, v79
    v_exp_f32 v80, v80
    v_exp_f32 v81, v81
    v_smfmac_f32_32x32x32_bf16 v[36:51], v[112:115], v[68:75], v4
    ds_read_b128 v[124:127], v10 offset:1824
    v_exp_f32 v82, v82
    v_exp_f32 v83, v83
    v_exp_f32 v84, v84
    v_exp_f32 v85, v85
    v_smfmac_f32_32x32x32_bf16 v[36:51], v[116:119], v[76:83], v4
    ds_read_b128 v[100:103], v8 offset:2048
    v_exp_f32 v86, v86
    v_exp_f32 v87, v87
    v_exp_f32 v88, v88
    v_exp_f32 v89, v89
    v_mfma_f32_32x32x16_bf16 v[68:83], v[104:107], v[12:15], 0
    v_exp_f32 v90, v90
    v_exp_f32 v91, v91
    v_exp_f32 v92, v92
    v_exp_f32 v93, v93
    v_mfma_f32_32x32x8_bf16 v[68:83], v[108:109], v[18:19], v[68:83]
    v_exp_f32 v94, v94
    v_exp_f32 v95, v95
    v_exp_f32 v96, v96
    v_exp_f32 v97, v97
    v_smfmac_f32_32x32x32_bf16 v[52:67], v[112:115], v[84:91], v4
    v_exp_f32 v98, v98
    v_exp_f32 v99, v99
    v_exp_f32 v68, v68
    v_exp_f32 v69, v69
    v_smfmac_f32_32x32x32_bf16 v[52:67], v[116:119], v[92:99], v4
    ds_read_b128 v[112:115], v10 offset:2432
    v_exp_f32 v70, v70
    v_exp_f32 v71, v71
    v_exp_f32 v72, v72
    v_exp_f32 v73, v73
    v_mfma_f32_32x32x16_bf16 v[84:99], v[104:107], v[24:27], 0
    s_waitcnt lgkmcnt(1)
    v_exp_f32 v74, v74
    v_exp_f32 v75, v75
    v_exp_f32 v76, v76
    v_exp_f32 v77, v77
    v_mfma_f32_32x32x8_bf16 v[84:99], v[108:109], v[30:31], v[84:99]
    v_exp_f32 v78, v78
    v_exp_f32 v79, v79
    v_exp_f32 v80, v80
    v_exp_f32 v81, v81
    v_smfmac_f32_32x32x32_bf16 v[36:51], v[120:123], v[68:75], v4
    ds_read_b128 v[116:119], v10 offset:3040
    v_exp_f32 v82, v82
    v_exp_f32 v83, v83
    v_exp_f32 v84, v84
    v_exp_f32 v85, v85
    v_smfmac_f32_32x32x32_bf16 v[36:51], v[124:127], v[76:83], v4
    ds_read_b128 v[104:107], v8 offset:3072
    v_exp_f32 v86, v86
    v_exp_f32 v87, v87
    v_exp_f32 v88, v88
    v_exp_f32 v89, v89
    v_mfma_f32_32x32x16_bf16 v[68:83], v[100:103], v[12:15], 0
    v_exp_f32 v90, v90
    v_exp_f32 v91, v91
    v_exp_f32 v92, v92
    v_exp_f32 v93, v93
    v_mfma_f32_32x32x8_bf16 v[68:83], v[108:109], v[20:21], v[68:83]
    v_exp_f32 v94, v94
    v_exp_f32 v95, v95
    v_exp_f32 v96, v96
    v_exp_f32 v97, v97
    v_smfmac_f32_32x32x32_bf16 v[52:67], v[120:123], v[84:91], v4
    ds_read2st64_b32 v[110:111], v9 offset0:2 offset1:3
    v_exp_f32 v98, v98
    v_exp_f32 v99, v99
    v_exp_f32 v68, v68
    v_exp_f32 v69, v69
    v_smfmac_f32_32x32x32_bf16 v[52:67], v[124:127], v[92:99], v4
    ds_read_b128 v[120:123], v10 offset:3648
    v_exp_f32 v70, v70
    v_exp_f32 v71, v71
    v_exp_f32 v72, v72
    v_exp_f32 v73, v73
    v_mfma_f32_32x32x16_bf16 v[84:99], v[100:103], v[24:27], 0
    s_waitcnt lgkmcnt(1)
    v_exp_f32 v74, v74
    v_exp_f32 v75, v75
    v_exp_f32 v76, v76
    v_exp_f32 v77, v77
    v_mfma_f32_32x32x8_bf16 v[84:99], v[108:109], v[32:33], v[84:99]
    v_exp_f32 v78, v78
    v_exp_f32 v79, v79
    v_exp_f32 v80, v80
    v_exp_f32 v81, v81
    v_smfmac_f32_32x32x32_bf16 v[36:51], v[112:115], v[68:75], v4
    ds_read_b128 v[124:127], v10 offset:4256
    v_exp_f32 v82, v82
    v_exp_f32 v83, v83
    v_exp_f32 v84, v84
    v_exp_f32 v85, v85
    v_smfmac_f32_32x32x32_bf16 v[36:51], v[116:119], v[76:83], v4
    ds_read_b128 v[100:103], v8 offset:4096
    v_exp_f32 v86, v86
    v_exp_f32 v87, v87
    v_exp_f32 v88, v88
    v_exp_f32 v89, v89
    v_mfma_f32_32x32x16_bf16 v[68:83], v[104:107], v[12:15], 0
    v_exp_f32 v90, v90
    v_exp_f32 v91, v91
    v_exp_f32 v92, v92
    v_exp_f32 v93, v93
    v_mfma_f32_32x32x8_bf16 v[68:83], v[108:109], v[22:23], v[68:83]
    v_exp_f32 v94, v94
    v_exp_f32 v95, v95
    v_exp_f32 v96, v96
    v_exp_f32 v97, v97
    v_smfmac_f32_32x32x32_bf16 v[52:67], v[112:115], v[84:91], v4
    v_exp_f32 v98, v98
    v_exp_f32 v99, v99
    v_exp_f32 v68, v68
    v_exp_f32 v69, v69
    v_smfmac_f32_32x32x32_bf16 v[52:67], v[116:119], v[92:99], v4
    ds_read_b128 v[112:115], v10 offset:4864
    v_exp_f32 v70, v70
    v_exp_f32 v71, v71
    v_exp_f32 v72, v72
    v_exp_f32 v73, v73
    v_mfma_f32_32x32x16_bf16 v[84:99], v[104:107], v[24:27], 0
    s_waitcnt lgkmcnt(1)
    v_exp_f32 v74, v74
    v_exp_f32 v75, v75
    v_exp_f32 v76, v76
    v_exp_f32 v77, v77
    v_mfma_f32_32x32x8_bf16 v[84:99], v[108:109], v[34:35], v[84:99]
    v_exp_f32 v78, v78
    v_exp_f32 v79, v79
    v_exp_f32 v80, v80
    v_exp_f32 v81, v81
    v_smfmac_f32_32x32x32_bf16 v[36:51], v[120:123], v[68:75], v4
    ds_read_b128 v[116:119], v10 offset:5472
    v_exp_f32 v82, v82
    v_exp_f32 v83, v83
    v_exp_f32 v84, v84
    v_exp_f32 v85, v85
    v_smfmac_f32_32x32x32_bf16 v[36:51], v[124:127], v[76:83], v4
    ds_read_b128 v[104:107], v8 offset:5120
    v_exp_f32 v86, v86
    v_exp_f32 v87, v87
    v_exp_f32 v88, v88
    v_exp_f32 v89, v89
    v_mfma_f32_32x32x16_bf16 v[68:83], v[100:103], v[12:15], 0
    v_exp_f32 v90, v90
    v_exp_f32 v91, v91
    v_exp_f32 v92, v92
    v_exp_f32 v93, v93
    v_mfma_f32_32x32x8_bf16 v[68:83], v[110:111], v[16:17], v[68:83]
    v_exp_f32 v94, v94
    v_exp_f32 v95, v95
    v_exp_f32 v96, v96
    v_exp_f32 v97, v97
    v_smfmac_f32_32x32x32_bf16 v[52:67], v[120:123], v[84:91], v4
    v_exp_f32 v98, v98
    v_exp_f32 v99, v99
    v_exp_f32 v68, v68
    v_exp_f32 v69, v69
    v_smfmac_f32_32x32x32_bf16 v[52:67], v[124:127], v[92:99], v4
    ds_read_b128 v[120:123], v10 offset:6080
    v_exp_f32 v70, v70
    v_exp_f32 v71, v71
    v_exp_f32 v72, v72
    v_exp_f32 v73, v73
    v_mfma_f32_32x32x16_bf16 v[84:99], v[100:103], v[24:27], 0
    s_waitcnt lgkmcnt(1)
    v_exp_f32 v74, v74
    v_exp_f32 v75, v75
    v_exp_f32 v76, v76
    v_exp_f32 v77, v77
    v_mfma_f32_32x32x8_bf16 v[84:99], v[110:111], v[28:29], v[84:99]
    v_exp_f32 v78, v78
    v_exp_f32 v79, v79
    v_exp_f32 v80, v80
    v_exp_f32 v81, v81
    v_smfmac_f32_32x32x32_bf16 v[36:51], v[112:115], v[68:75], v4
    ds_read_b128 v[124:127], v10 offset:6688
    v_exp_f32 v82, v82
    v_exp_f32 v83, v83
    v_exp_f32 v84, v84
    v_exp_f32 v85, v85
    v_smfmac_f32_32x32x32_bf16 v[36:51], v[116:119], v[76:83], v4
    ds_read_b128 v[100:103], v8 offset:6144
    v_exp_f32 v86, v86
    v_exp_f32 v87, v87
    v_exp_f32 v88, v88
    v_exp_f32 v89, v89
    v_mfma_f32_32x32x16_bf16 v[68:83], v[104:107], v[12:15], 0
    v_exp_f32 v90, v90
    v_exp_f32 v91, v91
    v_exp_f32 v92, v92
    v_exp_f32 v93, v93
    v_mfma_f32_32x32x8_bf16 v[68:83], v[110:111], v[18:19], v[68:83]
    v_exp_f32 v94, v94
    v_exp_f32 v95, v95
    v_exp_f32 v96, v96
    v_exp_f32 v97, v97
    v_smfmac_f32_32x32x32_bf16 v[52:67], v[112:115], v[84:91], v4
    v_exp_f32 v98, v98
    v_exp_f32 v99, v99
    v_exp_f32 v68, v68
    v_exp_f32 v69, v69
    v_smfmac_f32_32x32x32_bf16 v[52:67], v[116:119], v[92:99], v4
    ds_read_b128 v[112:115], v10 offset:7296
    v_exp_f32 v70, v70
    v_exp_f32 v71, v71
    v_exp_f32 v72, v72
    v_exp_f32 v73, v73
    v_mfma_f32_32x32x16_bf16 v[84:99], v[104:107], v[24:27], 0
    s_waitcnt lgkmcnt(1)
    v_exp_f32 v74, v74
    v_exp_f32 v75, v75
    v_exp_f32 v76, v76
    v_exp_f32 v77, v77
    v_mfma_f32_32x32x8_bf16 v[84:99], v[110:111], v[30:31], v[84:99]
    v_exp_f32 v78, v78
    v_exp_f32 v79, v79
    v_exp_f32 v80, v80
    v_exp_f32 v81, v81
    v_smfmac_f32_32x32x32_bf16 v[36:51], v[120:123], v[68:75], v4
    ds_read_b128 v[116:119], v10 offset:7904
    v_exp_f32 v82, v82
    v_exp_f32 v83, v83
    v_exp_f32 v84, v84
    v_exp_f32 v85, v85
    v_smfmac_f32_32x32x32_bf16 v[36:51], v[124:127], v[76:83], v4
    ds_read_b128 v[104:107], v8 offset:7168
    v_exp_f32 v86, v86
    v_exp_f32 v87, v87
    v_exp_f32 v88, v88
    v_exp_f32 v89, v89
    v_mfma_f32_32x32x16_bf16 v[68:83], v[100:103], v[12:15], 0
    v_exp_f32 v90, v90
    v_exp_f32 v91, v91
    v_exp_f32 v92, v92
    v_exp_f32 v93, v93
    v_mfma_f32_32x32x8_bf16 v[68:83], v[110:111], v[20:21], v[68:83]
    v_exp_f32 v94, v94
    v_exp_f32 v95, v95
    v_exp_f32 v96, v96
    v_exp_f32 v97, v97
    v_smfmac_f32_32x32x32_bf16 v[52:67], v[120:123], v[84:91], v4
    ds_read2st64_b32 v[108:109], v9 offset0:4 offset1:5
    v_exp_f32 v98, v98
    v_exp_f32 v99, v99
    v_exp_f32 v68, v68
    v_exp_f32 v69, v69
    v_smfmac_f32_32x32x32_bf16 v[52:67], v[124:127], v[92:99], v4
    ds_read_b128 v[120:123], v10 offset:8512
    v_exp_f32 v70, v70
    v_exp_f32 v71, v71
    v_exp_f32 v72, v72
    v_exp_f32 v73, v73
    v_mfma_f32_32x32x16_bf16 v[84:99], v[100:103], v[24:27], 0
    s_waitcnt lgkmcnt(1)
    v_exp_f32 v74, v74
    v_exp_f32 v75, v75
    v_exp_f32 v76, v76
    v_exp_f32 v77, v77
    v_mfma_f32_32x32x8_bf16 v[84:99], v[110:111], v[32:33], v[84:99]
    v_exp_f32 v78, v78
    v_exp_f32 v79, v79
    v_exp_f32 v80, v80
    v_exp_f32 v81, v81
    v_smfmac_f32_32x32x32_bf16 v[36:51], v[112:115], v[68:75], v4
    ds_read_b128 v[124:127], v10 offset:9120
    v_exp_f32 v82, v82
    v_exp_f32 v83, v83
    v_exp_f32 v84, v84
    v_exp_f32 v85, v85
    v_smfmac_f32_32x32x32_bf16 v[36:51], v[116:119], v[76:83], v4
    ds_read_b128 v[100:103], v8 offset:8192
    v_exp_f32 v86, v86
    v_exp_f32 v87, v87
    v_exp_f32 v88, v88
    v_exp_f32 v89, v89
    v_mfma_f32_32x32x16_bf16 v[68:83], v[104:107], v[12:15], 0
    v_exp_f32 v90, v90
    v_exp_f32 v91, v91
    v_exp_f32 v92, v92
    v_exp_f32 v93, v93
    v_mfma_f32_32x32x8_bf16 v[68:83], v[110:111], v[22:23], v[68:83]
    v_exp_f32 v94, v94
    v_exp_f32 v95, v95
    v_exp_f32 v96, v96
    v_exp_f32 v97, v97
    v_smfmac_f32_32x32x32_bf16 v[52:67], v[112:115], v[84:91], v4
    v_exp_f32 v98, v98
    v_exp_f32 v99, v99
    v_exp_f32 v68, v68
    v_exp_f32 v69, v69
    v_smfmac_f32_32x32x32_bf16 v[52:67], v[116:119], v[92:99], v4
    ds_read_b128 v[112:115], v10 offset:9728
    v_exp_f32 v70, v70
    v_exp_f32 v71, v71
    v_exp_f32 v72, v72
    v_exp_f32 v73, v73
    v_mfma_f32_32x32x16_bf16 v[84:99], v[104:107], v[24:27], 0
    s_waitcnt lgkmcnt(1)
    v_exp_f32 v74, v74
    v_exp_f32 v75, v75
    v_exp_f32 v76, v76
    v_exp_f32 v77, v77
    v_mfma_f32_32x32x8_bf16 v[84:99], v[110:111], v[34:35], v[84:99]
    v_exp_f32 v78, v78
    v_exp_f32 v79, v79
    v_exp_f32 v80, v80
    v_exp_f32 v81, v81
    v_smfmac_f32_32x32x32_bf16 v[36:51], v[120:123], v[68:75], v4
    ds_read_b128 v[116:119], v10 offset:10336
    v_exp_f32 v82, v82
    v_exp_f32 v83, v83
    v_exp_f32 v84, v84
    v_exp_f32 v85, v85
    v_smfmac_f32_32x32x32_bf16 v[36:51], v[124:127], v[76:83], v4
    ds_read_b128 v[104:107], v8 offset:9216
    v_exp_f32 v86, v86
    v_exp_f32 v87, v87
    v_exp_f32 v88, v88
    v_exp_f32 v89, v89
    v_mfma_f32_32x32x16_bf16 v[68:83], v[100:103], v[12:15], 0
    v_exp_f32 v90, v90
    v_exp_f32 v91, v91
    v_exp_f32 v92, v92
    v_exp_f32 v93, v93
    v_mfma_f32_32x32x8_bf16 v[68:83], v[108:109], v[16:17], v[68:83]
    v_exp_f32 v94, v94
    v_exp_f32 v95, v95
    v_exp_f32 v96, v96
    v_exp_f32 v97, v97
    v_smfmac_f32_32x32x32_bf16 v[52:67], v[120:123], v[84:91], v4
    s_sub_u32 s37, s37, 1
    s_cmp_lg_u32 s37, 0
    v_exp_f32 v98, v98
    v_exp_f32 v99, v99
    v_add_u32 v8, 8192, v8
    v_add_u32 v9, 1024, v9
    v_add_u32 v10, 9728, v10
    s_cbranch_scc1 BR_loop
BR_end:
    s_nop 1
    v_smfmac_f32_32x32x32_bf16 v[52:67], v[124:127], v[92:99], v4
    s_lshl_b32 s40, s35, 3
    s_add_u32 s40, s40, s32
    s_waitcnt vmcnt(0) lgkmcnt(0)
    v_readfirstlane_b32 s69, v182
    s_bitcmp1_b32 s38, 13
    s_cbranch_scc1 BR_fin
    s_bitcmp1_b32 s38, 14
    s_cbranch_scc1 BR_dump
    s_nop 0
    s_cmp_lg_u32 s35, 0
    s_cbranch_scc1 BR_v0
    v_accvgpr_write_b32 a10, v36
    v_accvgpr_write_b32 a11, v37
    v_accvgpr_write_b32 a12, v38
    v_accvgpr_write_b32 a13, v39
    v_accvgpr_write_b32 a14, v40
    v_accvgpr_write_b32 a15, v41
    v_accvgpr_write_b32 a16, v42
    v_accvgpr_write_b32 a17, v43
    v_accvgpr_write_b32 a18, v44
    v_accvgpr_write_b32 a19, v45
    v_accvgpr_write_b32 a20, v46
    v_accvgpr_write_b32 a21, v47
    v_accvgpr_write_b32 a22, v52
    v_accvgpr_write_b32 a23, v53
    v_accvgpr_write_b32 a24, v54
    v_accvgpr_write_b32 a25, v55
    v_accvgpr_write_b32 a26, v56
    v_accvgpr_write_b32 a27, v57
    v_accvgpr_write_b32 a28, v58
    v_accvgpr_write_b32 a29, v59
    v_accvgpr_write_b32 a30, v60
    v_accvgpr_write_b32 a31, v61
    v_accvgpr_write_b32 a32, v62
    v_accvgpr_write_b32 a33, v63
    s_branch BR_vx
BR_v0:
    s_cmp_lg_u32 s35, 1
    s_cbranch_scc1 BR_v1
    v_accvgpr_write_b32 a44, v36
    v_accvgpr_write_b32 a45, v37
    v_accvgpr_write_b32 a46, v38
    v_accvgpr_write_b32 a47, v39
    v_accvgpr_write_b32 a48, v40
    v_accvgpr_write_b32 a49, v41
    v_accvgpr_write_b32 a50, v42
    v_accvgpr_write_b32 a51, v43
    v_accvgpr_write_b32 a52, v44
    v_accvgpr_write_b32 a53, v45
    v_accvgpr_write_b32 a54, v46
    v_accvgpr_write_b32 a55, v47
    v_accvgpr_write_b32 a56, v52
    v_accvgpr_write_b32 a57, v53
    v_accvgpr_write_b32 a58, v54
    v_accvgpr_write_b32 a59, v55
    v_accvgpr_write_b32 a60, v56
    v_accvgpr_write_b32 a61, v57
    v_accvgpr_write_b32 a62, v58
    v_accvgpr_write_b32 a63, v59
    v_accvgpr_write_b32 a64, v60
    v_accvgpr_write_b32 a65, v61
    v_accvgpr_write_b32 a66, v62
    v_accvgpr_write_b32 a67, v63
    s_branch BR_vx
BR_v1:
    s_cmp_lg_u32 s35, 2
    s_cbranch_scc1 BR_v2
    v_accvgpr_write_b32 a78, v36
    v_accvgpr_write_b32 a79, v37
    v_accvgpr_write_b32 a80, v38
    v_accvgpr_write_b32 a81, v39
    v_accvgpr_write_b32 a82, v40
    v_accvgpr_write_b32 a83, v41
    v_accvgpr_write_b32 a84, v42
    v_accvgpr_write_b32 a85, v43
    v_accvgpr_write_b32 a86, v44
    v_accvgpr_write_b32 a87, v45
    v_accvgpr_write_b32 a88, v46
    v_accvgpr_write_b32 a89, v47
    v_accvgpr_write_b32 a90, v52
    v_accvgpr_write_b32 a91, v53
    v_accvgpr_write_b32 a92, v54
    v_accvgpr_write_b32 a93, v55
    v_accvgpr_write_b32 a94, v56
    v_accvgpr_write_b32 a95, v57
    v_accvgpr_write_b32 a96, v58
    v_accvgpr_write_b32 a97, v59
    v_accvgpr_write_b32 a98, v60
    v_accvgpr_write_b32 a99, v61
    v_accvgpr_write_b32 a100, v62
    v_accvgpr_write_b32 a101, v63
    s_branch BR_vx
BR_v2:
    s_cmp_lg_u32 s35, 3
    s_cbranch_scc1 BR_v3
    v_accvgpr_write_b32 a112, v36
    v_accvgpr_write_b32 a113, v37
    v_accvgpr_write_b32 a114, v38
    v_accvgpr_write_b32 a115, v39
    v_accvgpr_write_b32 a116, v40
    v_accvgpr_write_b32 a117, v41
    v_accvgpr_write_b32 a118, v42
    v_accvgpr_write_b32 a119, v43
    v_accvgpr_write_b32 a120, v44
    v_accvgpr_write_b32 a121, v45
    v_accvgpr_write_b32 a122, v46
    v_accvgpr_write_b32 a123, v47
    v_accvgpr_write_b32 a124, v52
    v_accvgpr_write_b32 a125, v53
    v_accvgpr_write_b32 a126, v54
    v_accvgpr_write_b32 a127, v55
    v_accvgpr_write_b32 a128, v56
    v_accvgpr_write_b32 a129, v57
    v_accvgpr_write_b32 a130, v58
    v_accvgpr_write_b32 a131, v59
    v_accvgpr_write_b32 a132, v60
    v_accvgpr_write_b32 a133, v61
    v_accvgpr_write_b32 a134, v62
    v_accvgpr_write_b32 a135, v63
    s_branch BR_vx
BR_v3:
    s_cmp_lg_u32 s35, 4
    s_cbranch_scc1 BR_v4
    v_accvgpr_write_b32 a146, v36
    v_accvgpr_write_b32 a147, v37
    v_accvgpr_write_b32 a148, v38
    v_accvgpr_write_b32 a149, v39
    v_accvgpr_write_b32 a150, v40
    v_accvgpr_write_b32 a151, v41
    v_accvgpr_write_b32 a152, v42
    v_accvgpr_write_b32 a153, v43
    v_accvgpr_write_b32 a154, v44
    v_accvgpr_write_b32 a155, v45
    v_accvgpr_write_b32 a156, v46
    v_accvgpr_write_b32 a157, v47
    v_accvgpr_write_b32 a158, v52
    v_accvgpr_write_b32 a159, v53
    v_accvgpr_write_b32 a160, v54
    v_accvgpr_write_b32 a161, v55
    v_accvgpr_write_b32 a162, v56
    v_accvgpr_write_b32 a163, v57
    v_accvgpr_write_b32 a164, v58
    v_accvgpr_write_b32 a165, v59
    v_accvgpr_write_b32 a166, v60
    v_accvgpr_write_b32 a167, v61
    v_accvgpr_write_b32 a168, v62
    v_accvgpr_write_b32 a169, v63
    s_branch BR_vx
BR_v4:
BR_vx:
    s_branch BR_next
BR_dump:
    s_add_u32 s40, s40, s65
    s_lshl_b32 s41, s33, 6
    s_add_u32 s40, s40, s41
    s_mul_i32 s40, s40, 3072
    s_add_u32 s40, s40, 20971520
    s_add_u32 s41, s40, 12288
    buffer_store_dwordx4 v[36:39], v1, s[8:11], s40 offen offset:0
    buffer_store_dwordx4 v[40:43], v1, s[8:11], s40 offen offset:1024
    buffer_store_dwordx4 v[44:47], v1, s[8:11], s40 offen offset:2048
    buffer_store_dwordx4 v[52:55], v1, s[8:11], s41 offen offset:0
    buffer_store_dwordx4 v[56:59], v1, s[8:11], s41 offen offset:1024
    buffer_store_dwordx4 v[60:63], v1, s[8:11], s41 offen offset:2048
    s_branch BR_next
BR_fin:
    s_mul_i32 s40, s40, 36864
    s_add_u32 s40, s40, 92274688
    s_lshl_b32 s41, s33, 10
    s_add_u32 s41, s41, s40
    s_lshr_b32 s42, s33, 2
    s_lshl_b32 s42, s42, 9
    s_and_b32 s43, s33, 3
    s_lshl_b32 s43, s43, 2
    s_add_u32 s42, s42, s43
    s_add_u32 s42, s42, s40
    s_add_u32 s42, s42, 32768
    v_mov_b32 v6, v46
    v_mov_b32 v7, v46
    s_nop 1
    v_permlane32_swap_b32 v6, v7
    v_rcp_f32 v7, v6
    s_nop 0
    v_max_f32 v11, v6, v7
    v_cmp_nge_f32 vcc, 0x5d800000, v11
    s_cbranch_vccnz BR_slow0
BR_out0:
    v_mul_f32 v36, v36, v7
    v_mul_f32 v37, v37, v7
    v_mul_f32 v38, v38, v7
    v_mul_f32 v39, v39, v7
    v_mul_f32 v40, v40, v7
    v_mul_f32 v41, v41, v7
    v_mul_f32 v42, v42, v7
    v_mul_f32 v43, v43, v7
    v_mul_f32 v44, v44, v7
    v_mul_f32 v45, v45, v7
    v_cvt_pk_bf16_f32 v36, v36, v37
    v_cvt_pk_bf16_f32 v37, v38, v39
    v_cvt_pk_bf16_f32 v38, v40, v41
    v_cvt_pk_bf16_f32 v39, v42, v43
    v_cvt_pk_bf16_f32 v40, v44, v45
    buffer_store_dwordx4 v[36:39], v1, s[8:11], s41 offen sc1
    s_mov_b32 exec_hi, 0
    buffer_store_dword v40, v1, s[8:11], s42 offen sc1
    s_mov_b32 exec_hi, -1
    s_add_u32 s41, s41, 147456
    s_add_u32 s42, s42, 147456
    v_mov_b32 v6, v62
    v_mov_b32 v7, v62
    s_nop 1
    v_permlane32_swap_b32 v6, v7
    v_rcp_f32 v7, v6
    s_nop 0
    v_max_f32 v11, v6, v7
    v_cmp_nge_f32 vcc, 0x5d800000, v11
    s_cbranch_vccnz BR_slow1
BR_out1:
    v_mul_f32 v52, v52, v7
    v_mul_f32 v53, v53, v7
    v_mul_f32 v54, v54, v7
    v_mul_f32 v55, v55, v7
    v_mul_f32 v56, v56, v7
    v_mul_f32 v57, v57, v7
    v_mul_f32 v58, v58, v7
    v_mul_f32 v59, v59, v7
    v_mul_f32 v60, v60, v7
    v_mul_f32 v61, v61, v7
    v_cvt_pk_bf16_f32 v52, v52, v53
    v_cvt_pk_bf16_f32 v53, v54, v55
    v_cvt_pk_bf16_f32 v54, v56, v57
    v_cvt_pk_bf16_f32 v55, v58, v59
    v_cvt_pk_bf16_f32 v56, v60, v61
    buffer_store_dwordx4 v[52:55], v1, s[8:11], s41 offen sc1
    s_mov_b32 exec_hi, 0
    buffer_store_dword v56, v1, s[8:11], s42 offen sc1
    s_mov_b32 exec_hi, -1
    s_lshl_b32 s40, s35, 7
    s_add_u32 s40, s40, 3201024
    s_cmp_eq_u32 s32, 0
    s_cselect_b32 s68, s40, 0
BR_next:
    s_lshr_b32 s49, s39, 16
    s_cmp_le_u32 s49, s34
    s_cbranch_scc1 BR_task
    s_waitcnt vmcnt(0)
    s_barrier
    s_cmp_eq_u32 s68, 0
    s_cbranch_scc1 BR_s2
    s_mov_b64 exec, 1
    buffer_atomic_add v181, off, s[8:11], s68
    s_mov_b64 exec, -1
    s_mov_b32 s68, 0
BR_s2:
    s_cmp_le_u32 s49, 8
    s_cbranch_scc1 BR_phase
    s_waitcnt vmcnt(0)
    s_cmp_lg_u32 s96, 0
    s_cbranch_scc1 L_end
    s_mov_b32 s96, 1
    s_add_u32 s8, s8, 100663296
    s_addc_u32 s9, s9, 0
    s_mov_b32 s10, 167772160
    s_mov_b32 s36, 24
    s_branch BR_layer
BR_slow0:
    s_nop 15
    v_mov_b32 v6, 0xff800000
    v_mov_b32 v8, v1
    v_mov_b32 v9, v2
    v_mov_b32 v10, v3
    s_mov_b32 s48, 16
BR_p10:
    ds_read2st64_b32 v[108:109], v9 offset0:0 offset1:1
    ds_read_b128 v[100:103], v8 offset:0
    s_waitcnt lgkmcnt(0)
    v_mfma_f32_32x32x16_bf16 v[68:83], v[100:103], v[12:15], 0
    v_mfma_f32_32x32x8_bf16 v[68:83], v[108:109], v[16:17], v[68:83]
    s_nop 11
    v_max3_f32 v6, v6, v68, v69
    v_max3_f32 v6, v6, v70, v71
    v_max3_f32 v6, v6, v72, v73
    v_max3_f32 v6, v6, v74, v75
    v_max3_f32 v6, v6, v76, v77
    v_max3_f32 v6, v6, v78, v79
    v_max3_f32 v6, v6, v80, v81
    v_max3_f32 v6, v6, v82, v83
    ds_read_b128 v[104:107], v8 offset:1024
    s_waitcnt lgkmcnt(0)
    v_mfma_f32_32x32x16_bf16 v[68:83], v[104:107], v[12:15], 0
    v_mfma_f32_32x32x8_bf16 v[68:83], v[108:109], v[18:19], v[68:83]
    s_nop 11
    v_max3_f32 v6, v6, v68, v69
    v_max3_f32 v6, v6, v70, v71
    v_max3_f32 v6, v6, v72, v73
    v_max3_f32 v6, v6, v74, v75
    v_max3_f32 v6, v6, v76, v77
    v_max3_f32 v6, v6, v78, v79
    v_max3_f32 v6, v6, v80, v81
    v_max3_f32 v6, v6, v82, v83
    ds_read_b128 v[100:103], v8 offset:2048
    s_waitcnt lgkmcnt(0)
    v_mfma_f32_32x32x16_bf16 v[68:83], v[100:103], v[12:15], 0
    v_mfma_f32_32x32x8_bf16 v[68:83], v[108:109], v[20:21], v[68:83]
    s_nop 11
    v_max3_f32 v6, v6, v68, v69
    v_max3_f32 v6, v6, v70, v71
    v_max3_f32 v6, v6, v72, v73
    v_max3_f32 v6, v6, v74, v75
    v_max3_f32 v6, v6, v76, v77
    v_max3_f32 v6, v6, v78, v79
    v_max3_f32 v6, v6, v80, v81
    v_max3_f32 v6, v6, v82, v83
    ds_read_b128 v[104:107], v8 offset:3072
    s_waitcnt lgkmcnt(0)
    v_mfma_f32_32x32x16_bf16 v[68:83], v[104:107], v[12:15], 0
    v_mfma_f32_32x32x8_bf16 v[68:83], v[108:109], v[22:23], v[68:83]
    s_nop 11
    v_max3_f32 v6, v6, v68, v69
    v_max3_f32 v6, v6, v70, v71
    v_max3_f32 v6, v6, v72, v73
    v_max3_f32 v6, v6, v74, v75
    v_max3_f32 v6, v6, v76, v77
    v_max3_f32 v6, v6, v78, v79
    v_max3_f32 v6, v6, v80, v81
    v_max3_f32 v6, v6, v82, v83
    v_add_u32 v8, 4096, v8
    v_add_u32 v9, 512, v9
    v_add_u32 v10, 4864, v10
    s_sub_u32 s48, s48, 1
    s_cmp_lg_u32 s48, 0
    s_cbranch_scc1 BR_p10
    s_nop 15
    v_mov_b32 v7, v6
    s_nop 1
    v_permlane32_swap_b32 v6, v7
    v_max_f32 v6, v6, v7
    v_sub_f32 v164, 0, v6
    v_sub_f32 v165, 0, v6
    v_sub_f32 v166, 0, v6
    v_sub_f32 v167, 0, v6
    v_sub_f32 v168, 0, v6
    v_sub_f32 v169, 0, v6
    v_sub_f32 v170, 0, v6
    v_sub_f32 v171, 0, v6
    v_sub_f32 v172, 0, v6
    v_sub_f32 v173, 0, v6
    v_sub_f32 v174, 0, v6
    v_sub_f32 v175, 0, v6
    v_sub_f32 v176, 0, v6
    v_sub_f32 v177, 0, v6
    v_sub_f32 v178, 0, v6
    v_sub_f32 v179, 0, v6
    v_mov_b32 v36, 0
    v_mov_b32 v37, 0
    v_mov_b32 v38, 0
    v_mov_b32 v39, 0
    v_mov_b32 v40, 0
    v_mov_b32 v41, 0
    v_mov_b32 v42, 0
    v_mov_b32 v43, 0
    v_mov_b32 v44, 0
    v_mov_b32 v45, 0
    v_mov_b32 v46, 0
    v_mov_b32 v47, 0
    v_mov_b32 v48, 0
    v_mov_b32 v49, 0
    v_mov_b32 v50, 0
    v_mov_b32 v51, 0
    v_mov_b32 v8, v1
    v_mov_b32 v9, v2
    v_mov_b32 v10, v3
    s_mov_b32 s48, 16
BR_p20:
    ds_read2st64_b32 v[108:109], v9 offset0:0 offset1:1
    ds_read_b128 v[100:103], v8 offset:0
    ds_read_b128 v[112:115], v10 offset:0
    ds_read_b128 v[116:119], v10 offset:608
    s_waitcnt lgkmcnt(0)
    v_mfma_f32_32x32x16_bf16 v[68:83], v[100:103], v[12:15], v[164:179]
    v_mfma_f32_32x32x8_bf16 v[68:83], v[108:109], v[16:17], v[68:83]
    s_nop 11
    v_exp_f32 v68, v68
    v_exp_f32 v69, v69
    v_exp_f32 v70, v70
    v_exp_f32 v71, v71
    v_exp_f32 v72, v72
    v_exp_f32 v73, v73
    v_exp_f32 v74, v74
    v_exp_f32 v75, v75
    v_exp_f32 v76, v76
    v_exp_f32 v77, v77
    v_exp_f32 v78, v78
    v_exp_f32 v79, v79
    v_exp_f32 v80, v80
    v_exp_f32 v81, v81
    v_exp_f32 v82, v82
    v_exp_f32 v83, v83
    v_smfmac_f32_32x32x32_bf16 v[36:51], v[112:115], v[68:75], v4
    s_nop 0
    v_smfmac_f32_32x32x32_bf16 v[36:51], v[116:119], v[76:83], v4
    ds_read_b128 v[104:107], v8 offset:1024
    ds_read_b128 v[120:123], v10 offset:1216
    ds_read_b128 v[124:127], v10 offset:1824
    s_waitcnt lgkmcnt(0)
    v_mfma_f32_32x32x16_bf16 v[68:83], v[104:107], v[12:15], v[164:179]
    v_mfma_f32_32x32x8_bf16 v[68:83], v[108:109], v[18:19], v[68:83]
    s_nop 11
    v_exp_f32 v68, v68
    v_exp_f32 v69, v69
    v_exp_f32 v70, v70
    v_exp_f32 v71, v71
    v_exp_f32 v72, v72
    v_exp_f32 v73, v73
    v_exp_f32 v74, v74
    v_exp_f32 v75, v75
    v_exp_f32 v76, v76
    v_exp_f32 v77, v77
    v_exp_f32 v78, v78
    v_exp_f32 v79, v79
    v_exp_f32 v80, v80
    v_exp_f32 v81, v81
    v_exp_f32 v82, v82
    v_exp_f32 v83, v83
    v_smfmac_f32_32x32x32_bf16 v[36:51], v[120:123], v[68:75], v4
    s_nop 0
    v_smfmac_f32_32x32x32_bf16 v[36:51], v[124:127], v[76:83], v4
    ds_read_b128 v[100:103], v8 offset:2048
    ds_read_b128 v[112:115], v10 offset:2432
    ds_read_b128 v[116:119], v10 offset:3040
    s_waitcnt lgkmcnt(0)
    v_mfma_f32_32x32x16_bf16 v[68:83], v[100:103], v[12:15], v[164:179]
    v_mfma_f32_32x32x8_bf16 v[68:83], v[108:109], v[20:21], v[68:83]
    s_nop 11
    v_exp_f32 v68, v68
    v_exp_f32 v69, v69
    v_exp_f32 v70, v70
    v_exp_f32 v71, v71
    v_exp_f32 v72, v72
    v_exp_f32 v73, v73
    v_exp_f32 v74, v74
    v_exp_f32 v75, v75
    v_exp_f32 v76, v76
    v_exp_f32 v77, v77
    v_exp_f32 v78, v78
    v_exp_f32 v79, v79
    v_exp_f32 v80, v80
    v_exp_f32 v81, v81
    v_exp_f32 v82, v82
    v_exp_f32 v83, v83
    v_smfmac_f32_32x32x32_bf16 v[36:51], v[112:115], v[68:75], v4
    s_nop 0
    v_smfmac_f32_32x32x32_bf16 v[36:51], v[116:119], v[76:83], v4
    ds_read_b128 v[104:107], v8 offset:3072
    ds_read_b128 v[120:123], v10 offset:3648
    ds_read_b128 v[124:127], v10 offset:4256
    s_waitcnt lgkmcnt(0)
    v_mfma_f32_32x32x16_bf16 v[68:83], v[104:107], v[12:15], v[164:179]
    v_mfma_f32_32x32x8_bf16 v[68:83], v[108:109], v[22:23], v[68:83]
    s_nop 11
    v_exp_f32 v68, v68
    v_exp_f32 v69, v69
    v_exp_f32 v70, v70
    v_exp_f32 v71, v71
    v_exp_f32 v72, v72
    v_exp_f32 v73, v73
    v_exp_f32 v74, v74
    v_exp_f32 v75, v75
    v_exp_f32 v76, v76
    v_exp_f32 v77, v77
    v_exp_f32 v78, v78
    v_exp_f32 v79, v79
    v_exp_f32 v80, v80
    v_exp_f32 v81, v81
    v_exp_f32 v82, v82
    v_exp_f32 v83, v83
    v_smfmac_f32_32x32x32_bf16 v[36:51], v[120:123], v[68:75], v4
    s_nop 0
    v_smfmac_f32_32x32x32_bf16 v[36:51], v[124:127], v[76:83], v4
    v_add_u32 v8, 4096, v8
    v_add_u32 v9, 512, v9
    v_add_u32 v10, 4864, v10
    s_sub_u32 s48, s48, 1
    s_cmp_lg_u32 s48, 0
    s_cbranch_scc1 BR_p20
    s_nop 15
    v_mov_b32 v6, v46
    v_mov_b32 v7, v46
    s_nop 1
    v_permlane32_swap_b32 v6, v7
    v_rcp_f32 v7, v6
    s_nop 1
    s_branch BR_out0
BR_slow1:
    s_nop 15
    v_mov_b32 v6, 0xff800000
    v_mov_b32 v8, v1
    v_mov_b32 v9, v2
    v_mov_b32 v10, v3
    s_mov_b32 s48, 16
BR_p11:
    ds_read2st64_b32 v[108:109], v9 offset0:0 offset1:1
    ds_read_b128 v[100:103], v8 offset:0
    s_waitcnt lgkmcnt(0)
    v_mfma_f32_32x32x16_bf16 v[84:99], v[100:103], v[24:27], 0
    v_mfma_f32_32x32x8_bf16 v[84:99], v[108:109], v[28:29], v[84:99]
    s_nop 11
    v_max3_f32 v6, v6, v84, v85
    v_max3_f32 v6, v6, v86, v87
    v_max3_f32 v6, v6, v88, v89
    v_max3_f32 v6, v6, v90, v91
    v_max3_f32 v6, v6, v92, v93
    v_max3_f32 v6, v6, v94, v95
    v_max3_f32 v6, v6, v96, v97
    v_max3_f32 v6, v6, v98, v99
    ds_read_b128 v[104:107], v8 offset:1024
    s_waitcnt lgkmcnt(0)
    v_mfma_f32_32x32x16_bf16 v[84:99], v[104:107], v[24:27], 0
    v_mfma_f32_32x32x8_bf16 v[84:99], v[108:109], v[30:31], v[84:99]
    s_nop 11
    v_max3_f32 v6, v6, v84, v85
    v_max3_f32 v6, v6, v86, v87
    v_max3_f32 v6, v6, v88, v89
    v_max3_f32 v6, v6, v90, v91
    v_max3_f32 v6, v6, v92, v93
    v_max3_f32 v6, v6, v94, v95
    v_max3_f32 v6, v6, v96, v97
    v_max3_f32 v6, v6, v98, v99
    ds_read_b128 v[100:103], v8 offset:2048
    s_waitcnt lgkmcnt(0)
    v_mfma_f32_32x32x16_bf16 v[84:99], v[100:103], v[24:27], 0
    v_mfma_f32_32x32x8_bf16 v[84:99], v[108:109], v[32:33], v[84:99]
    s_nop 11
    v_max3_f32 v6, v6, v84, v85
    v_max3_f32 v6, v6, v86, v87
    v_max3_f32 v6, v6, v88, v89
    v_max3_f32 v6, v6, v90, v91
    v_max3_f32 v6, v6, v92, v93
    v_max3_f32 v6, v6, v94, v95
    v_max3_f32 v6, v6, v96, v97
    v_max3_f32 v6, v6, v98, v99
    ds_read_b128 v[104:107], v8 offset:3072
    s_waitcnt lgkmcnt(0)
    v_mfma_f32_32x32x16_bf16 v[84:99], v[104:107], v[24:27], 0
    v_mfma_f32_32x32x8_bf16 v[84:99], v[108:109], v[34:35], v[84:99]
    s_nop 11
    v_max3_f32 v6, v6, v84, v85
    v_max3_f32 v6, v6, v86, v87
    v_max3_f32 v6, v6, v88, v89
    v_max3_f32 v6, v6, v90, v91
    v_max3_f32 v6, v6, v92, v93
    v_max3_f32 v6, v6, v94, v95
    v_max3_f32 v6, v6, v96, v97
    v_max3_f32 v6, v6, v98, v99
    v_add_u32 v8, 4096, v8
    v_add_u32 v9, 512, v9
    v_add_u32 v10, 4864, v10
    s_sub_u32 s48, s48, 1
    s_cmp_lg_u32 s48, 0
    s_cbranch_scc1 BR_p11
    s_nop 15
    v_mov_b32 v7, v6
    s_nop 1
    v_permlane32_swap_b32 v6, v7
    v_max_f32 v6, v6, v7
    v_sub_f32 v164, 0, v6
    v_sub_f32 v165, 0, v6
    v_sub_f32 v166, 0, v6
    v_sub_f32 v167, 0, v6
    v_sub_f32 v168, 0, v6
    v_sub_f32 v169, 0, v6
    v_sub_f32 v170, 0, v6
    v_sub_f32 v171, 0, v6
    v_sub_f32 v172, 0, v6
    v_sub_f32 v173, 0, v6
    v_sub_f32 v174, 0, v6
    v_sub_f32 v175, 0, v6
    v_sub_f32 v176, 0, v6
    v_sub_f32 v177, 0, v6
    v_sub_f32 v178, 0, v6
    v_sub_f32 v179, 0, v6
    v_mov_b32 v52, 0
    v_mov_b32 v53, 0
    v_mov_b32 v54, 0
    v_mov_b32 v55, 0
    v_mov_b32 v56, 0
    v_mov_b32 v57, 0
    v_mov_b32 v58, 0
    v_mov_b32 v59, 0
    v_mov_b32 v60, 0
    v_mov_b32 v61, 0
    v_mov_b32 v62, 0
    v_mov_b32 v63, 0
    v_mov_b32 v64, 0
    v_mov_b32 v65, 0
    v_mov_b32 v66, 0
    v_mov_b32 v67, 0
    v_mov_b32 v8, v1
    v_mov_b32 v9, v2
    v_mov_b32 v10, v3
    s_mov_b32 s48, 16
BR_p21:
    ds_read2st64_b32 v[108:109], v9 offset0:0 offset1:1
    ds_read_b128 v[100:103], v8 offset:0
    ds_read_b128 v[112:115], v10 offset:0
    ds_read_b128 v[116:119], v10 offset:608
    s_waitcnt lgkmcnt(0)
    v_mfma_f32_32x32x16_bf16 v[84:99], v[100:103], v[24:27], v[164:179]
    v_mfma_f32_32x32x8_bf16 v[84:99], v[108:109], v[28:29], v[84:99]
    s_nop 11
    v_exp_f32 v84, v84
    v_exp_f32 v85, v85
    v_exp_f32 v86, v86
    v_exp_f32 v87, v87
    v_exp_f32 v88, v88
    v_exp_f32 v89, v89
    v_exp_f32 v90, v90
    v_exp_f32 v91, v91
    v_exp_f32 v92, v92
    v_exp_f32 v93, v93
    v_exp_f32 v94, v94
    v_exp_f32 v95, v95
    v_exp_f32 v96, v96
    v_exp_f32 v97, v97
    v_exp_f32 v98, v98
    v_exp_f32 v99, v99
    v_smfmac_f32_32x32x32_bf16 v[52:67], v[112:115], v[84:91], v4
    s_nop 0
    v_smfmac_f32_32x32x32_bf16 v[52:67], v[116:119], v[92:99], v4
    ds_read_b128 v[104:107], v8 offset:1024
    ds_read_b128 v[120:123], v10 offset:1216
    ds_read_b128 v[124:127], v10 offset:1824
    s_waitcnt lgkmcnt(0)
    v_mfma_f32_32x32x16_bf16 v[84:99], v[104:107], v[24:27], v[164:179]
    v_mfma_f32_32x32x8_bf16 v[84:99], v[108:109], v[30:31], v[84:99]
    s_nop 11
    v_exp_f32 v84, v84
    v_exp_f32 v85, v85
    v_exp_f32 v86, v86
    v_exp_f32 v87, v87
    v_exp_f32 v88, v88
    v_exp_f32 v89, v89
    v_exp_f32 v90, v90
    v_exp_f32 v91, v91
    v_exp_f32 v92, v92
    v_exp_f32 v93, v93
    v_exp_f32 v94, v94
    v_exp_f32 v95, v95
    v_exp_f32 v96, v96
    v_exp_f32 v97, v97
    v_exp_f32 v98, v98
    v_exp_f32 v99, v99
    v_smfmac_f32_32x32x32_bf16 v[52:67], v[120:123], v[84:91], v4
    s_nop 0
    v_smfmac_f32_32x32x32_bf16 v[52:67], v[124:127], v[92:99], v4
    ds_read_b128 v[100:103], v8 offset:2048
    ds_read_b128 v[112:115], v10 offset:2432
    ds_read_b128 v[116:119], v10 offset:3040
    s_waitcnt lgkmcnt(0)
    v_mfma_f32_32x32x16_bf16 v[84:99], v[100:103], v[24:27], v[164:179]
    v_mfma_f32_32x32x8_bf16 v[84:99], v[108:109], v[32:33], v[84:99]
    s_nop 11
    v_exp_f32 v84, v84
    v_exp_f32 v85, v85
    v_exp_f32 v86, v86
    v_exp_f32 v87, v87
    v_exp_f32 v88, v88
    v_exp_f32 v89, v89
    v_exp_f32 v90, v90
    v_exp_f32 v91, v91
    v_exp_f32 v92, v92
    v_exp_f32 v93, v93
    v_exp_f32 v94, v94
    v_exp_f32 v95, v95
    v_exp_f32 v96, v96
    v_exp_f32 v97, v97
    v_exp_f32 v98, v98
    v_exp_f32 v99, v99
    v_smfmac_f32_32x32x32_bf16 v[52:67], v[112:115], v[84:91], v4
    s_nop 0
    v_smfmac_f32_32x32x32_bf16 v[52:67], v[116:119], v[92:99], v4
    ds_read_b128 v[104:107], v8 offset:3072
    ds_read_b128 v[120:123], v10 offset:3648
    ds_read_b128 v[124:127], v10 offset:4256
    s_waitcnt lgkmcnt(0)
    v_mfma_f32_32x32x16_bf16 v[84:99], v[104:107], v[24:27], v[164:179]
    v_mfma_f32_32x32x8_bf16 v[84:99], v[108:109], v[34:35], v[84:99]
    s_nop 11
    v_exp_f32 v84, v84
    v_exp_f32 v85, v85
    v_exp_f32 v86, v86
    v_exp_f32 v87, v87
    v_exp_f32 v88, v88
    v_exp_f32 v89, v89
    v_exp_f32 v90, v90
    v_exp_f32 v91, v91
    v_exp_f32 v92, v92
    v_exp_f32 v93, v93
    v_exp_f32 v94, v94
    v_exp_f32 v95, v95
    v_exp_f32 v96, v96
    v_exp_f32 v97, v97
    v_exp_f32 v98, v98
    v_exp_f32 v99, v99
    v_smfmac_f32_32x32x32_bf16 v[52:67], v[120:123], v[84:91], v4
    s_nop 0
    v_smfmac_f32_32x32x32_bf16 v[52:67], v[124:127], v[92:99], v4
    v_add_u32 v8, 4096, v8
    v_add_u32 v9, 512, v9
    v_add_u32 v10, 4864, v10
    s_sub_u32 s48, s48, 1
    s_cmp_lg_u32 s48, 0
    s_cbranch_scc1 BR_p21
    s_nop 15
    v_mov_b32 v6, v62
    v_mov_b32 v7, v62
    s_nop 1
    v_permlane32_swap_b32 v6, v7
    v_rcp_f32 v7, v6
    s_nop 1
    s_branch BR_out1
R_p:
    s_mov_b32 s12, s82
    s_mov_b32 s13, s83
    s_mov_b32 s14, 663552
    s_mov_b32 s15, 0x00020000
    v_and_b32 v0, 63, v0
    s_lshl_b32 s36, s35, 2
    s_add_u32 s36, s36, s32
    s_min_u32 s36, s36, 17
    v_lshlrev_b32 v1, 4, v0
    s_lshl_b32 s40, s36, 6
    v_and_b32 v7, 3, v0
    v_lshlrev_b32 v7, 4, v7
    v_add_u32 v7, s40, v7
    v_bfe_u32 v2, v0, 2, 2
    v_bfe_u32 v6, v0, 4, 1
    v_lshl_add_u32 v2, v6, 3, v2
    v_bfe_u32 v6, v0, 5, 1
    v_lshl_add_u32 v2, v6, 2, v2
    v_mul_u32_u24 v2, 1152, v2
    v_add_u32 v2, v2, v7
    v_bfe_u32 v3, v0, 3, 3
    v_mul_u32_u24 v3, 18, v3
    v_bfe_u32 v6, v0, 2, 1
    v_add3_u32 v3, v3, v6, 16
    v_mul_u32_u24 v3, 1152, v3
    v_add_u32 v3, v3, v7
    s_mul_i32 s41, s32, 36864
    s_add_u32 m0, s41, 0
    s_mov_b32 s43, 0
    buffer_load_dwordx4 v2, s[12:15], s43 offen lds
    s_add_u32 m0, s41, 1024
    s_mov_b32 s43, 20736
    buffer_load_dwordx4 v2, s[12:15], s43 offen lds
    s_add_u32 m0, s41, 2048
    s_mov_b32 s43, 41472
    buffer_load_dwordx4 v2, s[12:15], s43 offen lds
    s_add_u32 m0, s41, 3072
    s_mov_b32 s43, 62208
    buffer_load_dwordx4 v2, s[12:15], s43 offen lds
    s_add_u32 m0, s41, 4096
    s_mov_b32 s43, 82944
    buffer_load_dwordx4 v2, s[12:15], s43 offen lds
    s_add_u32 m0, s41, 5120
    s_mov_b32 s43, 103680
    buffer_load_dwordx4 v2, s[12:15], s43 offen lds
    s_add_u32 m0, s41, 6144
    s_mov_b32 s43, 124416
    buffer_load_dwordx4 v2, s[12:15], s43 offen lds
    s_add_u32 m0, s41, 7168
    s_mov_b32 s43, 145152
    buffer_load_dwordx4 v2, s[12:15], s43 offen lds
    s_add_u32 m0, s41, 8192
    s_mov_b32 s43, 165888
    buffer_load_dwordx4 v2, s[12:15], s43 offen lds
    s_add_u32 m0, s41, 9216
    s_mov_b32 s43, 186624
    buffer_load_dwordx4 v2, s[12:15], s43 offen lds
    s_add_u32 m0, s41, 10240
    s_mov_b32 s43, 207360
    buffer_load_dwordx4 v2, s[12:15], s43 offen lds
    s_add_u32 m0, s41, 11264
    s_mov_b32 s43, 228096
    buffer_load_dwordx4 v2, s[12:15], s43 offen lds
    s_add_u32 m0, s41, 12288
    s_mov_b32 s43, 248832
    buffer_load_dwordx4 v2, s[12:15], s43 offen lds
    s_add_u32 m0, s41, 13312
    s_mov_b32 s43, 269568
    buffer_load_dwordx4 v2, s[12:15], s43 offen lds
    s_add_u32 m0, s41, 14336
    s_mov_b32 s43, 290304
    buffer_load_dwordx4 v2, s[12:15], s43 offen lds
    s_add_u32 m0, s41, 15360
    s_mov_b32 s43, 311040
    buffer_load_dwordx4 v2, s[12:15], s43 offen lds
    s_add_u32 m0, s41, 16384
    s_mov_b32 s43, 331776
    buffer_load_dwordx4 v2, s[12:15], s43 offen lds
    s_add_u32 m0, s41, 17408
    s_mov_b32 s43, 352512
    buffer_load_dwordx4 v2, s[12:15], s43 offen lds
    s_add_u32 m0, s41, 18432
    s_mov_b32 s43, 373248
    buffer_load_dwordx4 v2, s[12:15], s43 offen lds
    s_add_u32 m0, s41, 19456
    s_mov_b32 s43, 393984
    buffer_load_dwordx4 v2, s[12:15], s43 offen lds
    s_add_u32 m0, s41, 20480
    s_mov_b32 s43, 414720
    buffer_load_dwordx4 v2, s[12:15], s43 offen lds
    s_add_u32 m0, s41, 21504
    s_mov_b32 s43, 435456
    buffer_load_dwordx4 v2, s[12:15], s43 offen lds
    s_add_u32 m0, s41, 22528
    s_mov_b32 s43, 456192
    buffer_load_dwordx4 v2, s[12:15], s43 offen lds
    s_add_u32 m0, s41, 23552
    s_mov_b32 s43, 476928
    buffer_load_dwordx4 v2, s[12:15], s43 offen lds
    s_add_u32 m0, s41, 24576
    s_mov_b32 s43, 497664
    buffer_load_dwordx4 v2, s[12:15], s43 offen lds
    s_add_u32 m0, s41, 25600
    s_mov_b32 s43, 518400
    buffer_load_dwordx4 v2, s[12:15], s43 offen lds
    s_add_u32 m0, s41, 26624
    s_mov_b32 s43, 539136
    buffer_load_dwordx4 v2, s[12:15], s43 offen lds
    s_add_u32 m0, s41, 27648
    s_mov_b32 s43, 559872
    buffer_load_dwordx4 v2, s[12:15], s43 offen lds
    s_add_u32 m0, s41, 28672
    s_mov_b32 s43, 580608
    buffer_load_dwordx4 v2, s[12:15], s43 offen lds
    s_add_u32 m0, s41, 29696
    s_mov_b32 s43, 601344
    buffer_load_dwordx4 v2, s[12:15], s43 offen lds
    s_add_u32 m0, s41, 30720
    s_mov_b32 s43, 622080
    buffer_load_dwordx4 v2, s[12:15], s43 offen lds
    s_add_u32 m0, s41, 31744
    s_mov_b32 s43, 642816
    buffer_load_dwordx4 v2, s[12:15], s43 offen lds
    s_add_u32 m0, s41, 32768
    s_mov_b32 s43, 0
    buffer_load_dwordx4 v3, s[12:15], s43 offen lds
    s_add_u32 m0, s41, 33792
    s_mov_b32 s43, 165888
    buffer_load_dwordx4 v3, s[12:15], s43 offen lds
    s_add_u32 m0, s41, 34816
    s_mov_b32 s43, 331776
    buffer_load_dwordx4 v3, s[12:15], s43 offen lds
    s_add_u32 m0, s41, 35840
    s_mov_b32 s43, 497664
    buffer_load_dwordx4 v3, s[12:15], s43 offen lds
    v_bfe_u32 v4, v0, 2, 2
    v_bfe_u32 v6, v0, 5, 1
    v_lshl_add_u32 v4, v6, 3, v4
    v_lshlrev_b32 v4, 6, v4
    v_bfe_u32 v7, v0, 4, 1
    v_lshl_add_u32 v4, v7, 5, v4
    v_bfe_u32 v7, v0, 0, 1
    v_lshl_add_u32 v4, v7, 4, v4
    v_bfe_u32 v7, v0, 1, 1
    v_lshl_add_u32 v4, v7, 3, v4
    v_add_u32 v4, s41, v4
    s_waitcnt vmcnt(0)
    ds_read_b64_tr_b16 a[0:1], v4 offset:0
    ds_read_b64_tr_b16 a[2:3], v4 offset:256
    ds_read_b64_tr_b16 a[4:5], v4 offset:1024
    ds_read_b64_tr_b16 a[6:7], v4 offset:1280
    ds_read_b64_tr_b16 a[8:9], v4 offset:2048
    ds_read_b64_tr_b16 a[10:11], v4 offset:2304
    ds_read_b64_tr_b16 a[12:13], v4 offset:3072
    ds_read_b64_tr_b16 a[14:15], v4 offset:3328
    ds_read_b64_tr_b16 a[16:17], v4 offset:4096
    ds_read_b64_tr_b16 a[18:19], v4 offset:4352
    ds_read_b64_tr_b16 a[20:21], v4 offset:5120
    ds_read_b64_tr_b16 a[22:23], v4 offset:5376
    ds_read_b64_tr_b16 a[24:25], v4 offset:6144
    ds_read_b64_tr_b16 a[26:27], v4 offset:6400
    ds_read_b64_tr_b16 a[28:29], v4 offset:7168
    ds_read_b64_tr_b16 a[30:31], v4 offset:7424
    ds_read_b64_tr_b16 a[32:33], v4 offset:8192
    ds_read_b64_tr_b16 a[34:35], v4 offset:8448
    ds_read_b64_tr_b16 a[36:37], v4 offset:9216
    ds_read_b64_tr_b16 a[38:39], v4 offset:9472
    ds_read_b64_tr_b16 a[40:41], v4 offset:10240
    ds_read_b64_tr_b16 a[42:43], v4 offset:10496
    ds_read_b64_tr_b16 a[44:45], v4 offset:11264
    ds_read_b64_tr_b16 a[46:47], v4 offset:11520
    ds_read_b64_tr_b16 a[48:49], v4 offset:12288
    ds_read_b64_tr_b16 a[50:51], v4 offset:12544
    ds_read_b64_tr_b16 a[52:53], v4 offset:13312
    ds_read_b64_tr_b16 a[54:55], v4 offset:13568
    ds_read_b64_tr_b16 a[56:57], v4 offset:14336
    ds_read_b64_tr_b16 a[58:59], v4 offset:14592
    ds_read_b64_tr_b16 a[60:61], v4 offset:15360
    ds_read_b64_tr_b16 a[62:63], v4 offset:15616
    ds_read_b64_tr_b16 a[64:65], v4 offset:16384
    ds_read_b64_tr_b16 a[66:67], v4 offset:16640
    ds_read_b64_tr_b16 a[68:69], v4 offset:17408
    ds_read_b64_tr_b16 a[70:71], v4 offset:17664
    ds_read_b64_tr_b16 a[72:73], v4 offset:18432
    ds_read_b64_tr_b16 a[74:75], v4 offset:18688
    ds_read_b64_tr_b16 a[76:77], v4 offset:19456
    ds_read_b64_tr_b16 a[78:79], v4 offset:19712
    ds_read_b64_tr_b16 a[80:81], v4 offset:20480
    ds_read_b64_tr_b16 a[82:83], v4 offset:20736
    ds_read_b64_tr_b16 a[84:85], v4 offset:21504
    ds_read_b64_tr_b16 a[86:87], v4 offset:21760
    ds_read_b64_tr_b16 a[88:89], v4 offset:22528
    ds_read_b64_tr_b16 a[90:91], v4 offset:22784
    ds_read_b64_tr_b16 a[92:93], v4 offset:23552
    ds_read_b64_tr_b16 a[94:95], v4 offset:23808
    ds_read_b64_tr_b16 a[96:97], v4 offset:24576
    ds_read_b64_tr_b16 a[98:99], v4 offset:24832
    ds_read_b64_tr_b16 a[100:101], v4 offset:25600
    ds_read_b64_tr_b16 a[102:103], v4 offset:25856
    ds_read_b64_tr_b16 a[104:105], v4 offset:26624
    ds_read_b64_tr_b16 a[106:107], v4 offset:26880
    ds_read_b64_tr_b16 a[108:109], v4 offset:27648
    ds_read_b64_tr_b16 a[110:111], v4 offset:27904
    ds_read_b64_tr_b16 a[112:113], v4 offset:28672
    ds_read_b64_tr_b16 a[114:115], v4 offset:28928
    ds_read_b64_tr_b16 a[116:117], v4 offset:29696
    ds_read_b64_tr_b16 a[118:119], v4 offset:29952
    ds_read_b64_tr_b16 a[120:121], v4 offset:30720
    ds_read_b64_tr_b16 a[122:123], v4 offset:30976
    ds_read_b64_tr_b16 a[124:125], v4 offset:31744
    ds_read_b64_tr_b16 a[126:127], v4 offset:32000
    ds_read_b64_tr_b16 a[128:129], v4 offset:32768
    ds_read_b64_tr_b16 a[130:131], v4 offset:33024
    ds_read_b64_tr_b16 a[132:133], v4 offset:33792
    ds_read_b64_tr_b16 a[134:135], v4 offset:34048
    ds_read_b64_tr_b16 a[136:137], v4 offset:34816
    ds_read_b64_tr_b16 a[138:139], v4 offset:35072
    ds_read_b64_tr_b16 a[140:141], v4 offset:35840
    ds_read_b64_tr_b16 a[142:143], v4 offset:36096
    s_waitcnt lgkmcnt(0)
    s_mul_i32 s42, s36, 36864
    s_add_u32 s42, s42, 130023424
    s_cmp_lg_u32 s34, 0
    s_cbranch_scc1 BO_nc
    buffer_store_dwordx4 a[0:3], v1, s[8:11], s42 offen offset:0
    buffer_store_dwordx4 a[4:7], v1, s[8:11], s42 offen offset:1024
    buffer_store_dwordx4 a[8:11], v1, s[8:11], s42 offen offset:2048
    buffer_store_dwordx4 a[12:15], v1, s[8:11], s42 offen offset:3072
    s_add_u32 s42, s42, 4096
    buffer_store_dwordx4 a[16:19], v1, s[8:11], s42 offen offset:0
    buffer_store_dwordx4 a[20:23], v1, s[8:11], s42 offen offset:1024
    buffer_store_dwordx4 a[24:27], v1, s[8:11], s42 offen offset:2048
    buffer_store_dwordx4 a[28:31], v1, s[8:11], s42 offen offset:3072
    s_add_u32 s42, s42, 4096
    buffer_store_dwordx4 a[32:35], v1, s[8:11], s42 offen offset:0
    buffer_store_dwordx4 a[36:39], v1, s[8:11], s42 offen offset:1024
    buffer_store_dwordx4 a[40:43], v1, s[8:11], s42 offen offset:2048
    buffer_store_dwordx4 a[44:47], v1, s[8:11], s42 offen offset:3072
    s_add_u32 s42, s42, 4096
    buffer_store_dwordx4 a[48:51], v1, s[8:11], s42 offen offset:0
    buffer_store_dwordx4 a[52:55], v1, s[8:11], s42 offen offset:1024
    buffer_store_dwordx4 a[56:59], v1, s[8:11], s42 offen offset:2048
    buffer_store_dwordx4 a[60:63], v1, s[8:11], s42 offen offset:3072
    s_add_u32 s42, s42, 4096
    buffer_store_dwordx4 a[64:67], v1, s[8:11], s42 offen offset:0
    buffer_store_dwordx4 a[68:71], v1, s[8:11], s42 offen offset:1024
    buffer_store_dwordx4 a[72:75], v1, s[8:11], s42 offen offset:2048
    buffer_store_dwordx4 a[76:79], v1, s[8:11], s42 offen offset:3072
    s_add_u32 s42, s42, 4096
    buffer_store_dwordx4 a[80:83], v1, s[8:11], s42 offen offset:0
    buffer_store_dwordx4 a[84:87], v1, s[8:11], s42 offen offset:1024
    buffer_store_dwordx4 a[88:91], v1, s[8:11], s42 offen offset:2048
    buffer_store_dwordx4 a[92:95], v1, s[8:11], s42 offen offset:3072
    s_add_u32 s42, s42, 4096
    buffer_store_dwordx4 a[96:99], v1, s[8:11], s42 offen offset:0
    buffer_store_dwordx4 a[100:103], v1, s[8:11], s42 offen offset:1024
    buffer_store_dwordx4 a[104:107], v1, s[8:11], s42 offen offset:2048
    buffer_store_dwordx4 a[108:111], v1, s[8:11], s42 offen offset:3072
    s_add_u32 s42, s42, 4096
    buffer_store_dwordx4 a[112:115], v1, s[8:11], s42 offen offset:0
    buffer_store_dwordx4 a[116:119], v1, s[8:11], s42 offen offset:1024
    buffer_store_dwordx4 a[120:123], v1, s[8:11], s42 offen offset:2048
    buffer_store_dwordx4 a[124:127], v1, s[8:11], s42 offen offset:3072
    s_add_u32 s42, s42, 4096
    buffer_store_dwordx4 a[128:131], v1, s[8:11], s42 offen offset:0
    buffer_store_dwordx4 a[132:135], v1, s[8:11], s42 offen offset:1024
    buffer_store_dwordx4 a[136:139], v1, s[8:11], s42 offen offset:2048
    buffer_store_dwordx4 a[140:143], v1, s[8:11], s42 offen offset:3072
    s_add_u32 s42, s42, 4096
BO_nc:
    s_cmp_lg_u32 s32, 0
    s_cbranch_scc1 P_iw_ok
    s_mov_b32 s94, 40
P_iw:
    buffer_load_dword v79, off, s[4:7], s94 sc1
    s_sub_u32 s95, s95, 1
    s_cmp_eq_u32 s95, 0
    s_cbranch_scc1 L_end
    s_waitcnt vmcnt(0)
    v_cmp_gt_u32 vcc, 32, v79
    s_cbranch_vccz P_iw_ok
    s_sleep 1
    s_branch P_iw
P_iw_ok:
    s_barrier
    s_mov_b32 s37, s34
    s_mul_i32 s48, s32, 9216
BO_loop:
    s_lshr_b32 s40, s37, 3
    s_lshl_b32 s40, s40, 7
    s_add_u32 s40, s40, 3201024
    s_cmp_lg_u32 s32, 0
    s_cbranch_scc1 BO_fl_ok
BO_fl:
    buffer_load_dword v6, off, s[8:11], s40 sc1
    s_sub_u32 s95, s95, 1
    s_cmp_eq_u32 s95, 0
    s_cbranch_scc1 L_end
    s_waitcnt vmcnt(0)
    v_cmp_gt_u32 vcc, 32, v6
    s_cbranch_vccz BO_fl_ok
    s_sleep 1
    s_branch BO_fl
BO_fl_ok:
    s_barrier
    s_mul_i32 s44, s37, 36864
    s_add_u32 s45, s44, s48
    s_add_u32 s45, s45, 92274688
    s_add_u32 m0, s48, 0
    s_add_u32 s43, s45, 0
    buffer_load_dwordx4 v1, s[8:11], s43 offen offset:0 sc1 lds
    buffer_load_dwordx4 v1, s[8:11], s43 offen offset:1024 sc1 lds
    buffer_load_dwordx4 v1, s[8:11], s43 offen offset:2048 sc1 lds
    buffer_load_dwordx4 v1, s[8:11], s43 offen offset:3072 sc1 lds
    s_add_u32 m0, s48, 4096
    s_add_u32 s43, s45, 4096
    buffer_load_dwordx4 v1, s[8:11], s43 offen offset:0 sc1 lds
    buffer_load_dwordx4 v1, s[8:11], s43 offen offset:1024 sc1 lds
    buffer_load_dwordx4 v1, s[8:11], s43 offen offset:2048 sc1 lds
    buffer_load_dwordx4 v1, s[8:11], s43 offen offset:3072 sc1 lds
    s_add_u32 m0, s48, 8192
    s_add_u32 s43, s45, 8192
    buffer_load_dwordx4 v1, s[8:11], s43 offen offset:0 sc1 lds
    s_lshl_b32 s46, s36, 11
    s_add_u32 s44, s44, s46
    s_add_u32 s45, s44, 8388608
    s_add_u32 s44, s44, 12582912
    buffer_load_dwordx4 v[24:27], v1, s[8:11], s45 offen offset:0 sc1
    buffer_load_dwordx4 v[28:31], v1, s[8:11], s45 offen offset:1024 sc1
    s_waitcnt vmcnt(2)
    s_barrier
    ds_read_b128 v[64:67], v1 offset:0
    ds_read_b128 v[68:71], v1 offset:1024
    ds_read_b128 v[72:75], v1 offset:2048
    ds_read_b128 v[76:79], v1 offset:3072
    ds_read_b128 v[80:83], v1 offset:4096
    s_waitcnt lgkmcnt(4)
    v_mfma_f32_32x32x16_bf16 v[8:23], a[0:3], v[64:67], 0
    ds_read_b128 v[84:87], v1 offset:5120
    s_waitcnt lgkmcnt(4)
    v_mfma_f32_32x32x16_bf16 v[8:23], a[4:7], v[68:71], v[8:23]
    ds_read_b128 v[64:67], v1 offset:6144
    s_waitcnt lgkmcnt(4)
    v_mfma_f32_32x32x16_bf16 v[8:23], a[8:11], v[72:75], v[8:23]
    ds_read_b128 v[68:71], v1 offset:7168
    s_waitcnt lgkmcnt(4)
    v_mfma_f32_32x32x16_bf16 v[8:23], a[12:15], v[76:79], v[8:23]
    ds_read_b128 v[72:75], v1 offset:8192
    s_waitcnt lgkmcnt(4)
    v_mfma_f32_32x32x16_bf16 v[8:23], a[16:19], v[80:83], v[8:23]
    ds_read_b128 v[76:79], v1 offset:9216
    s_waitcnt lgkmcnt(4)
    v_mfma_f32_32x32x16_bf16 v[8:23], a[20:23], v[84:87], v[8:23]
    ds_read_b128 v[80:83], v1 offset:10240
    s_waitcnt lgkmcnt(4)
    v_mfma_f32_32x32x16_bf16 v[8:23], a[24:27], v[64:67], v[8:23]
    ds_read_b128 v[84:87], v1 offset:11264
    s_waitcnt lgkmcnt(4)
    v_mfma_f32_32x32x16_bf16 v[8:23], a[28:31], v[68:71], v[8:23]
    ds_read_b128 v[64:67], v1 offset:12288
    s_waitcnt lgkmcnt(4)
    v_mfma_f32_32x32x16_bf16 v[8:23], a[32:35], v[72:75], v[8:23]
    ds_read_b128 v[68:71], v1 offset:13312
    s_waitcnt lgkmcnt(4)
    v_mfma_f32_32x32x16_bf16 v[8:23], a[36:39], v[76:79], v[8:23]
    ds_read_b128 v[72:75], v1 offset:14336
    s_waitcnt lgkmcnt(4)
    v_mfma_f32_32x32x16_bf16 v[8:23], a[40:43], v[80:83], v[8:23]
    ds_read_b128 v[76:79], v1 offset:15360
    s_waitcnt lgkmcnt(4)
    v_mfma_f32_32x32x16_bf16 v[8:23], a[44:47], v[84:87], v[8:23]
    ds_read_b128 v[80:83], v1 offset:16384
    s_waitcnt lgkmcnt(4)
    v_mfma_f32_32x32x16_bf16 v[8:23], a[48:51], v[64:67], v[8:23]
    ds_read_b128 v[84:87], v1 offset:17408
    s_waitcnt lgkmcnt(4)
    v_mfma_f32_32x32x16_bf16 v[8:23], a[52:55], v[68:71], v[8:23]
    ds_read_b128 v[64:67], v1 offset:18432
    s_waitcnt lgkmcnt(4)
    v_mfma_f32_32x32x16_bf16 v[8:23], a[56:59], v[72:75], v[8:23]
    ds_read_b128 v[68:71], v1 offset:19456
    s_waitcnt lgkmcnt(4)
    v_mfma_f32_32x32x16_bf16 v[8:23], a[60:63], v[76:79], v[8:23]
    ds_read_b128 v[72:75], v1 offset:20480
    s_waitcnt lgkmcnt(4)
    v_mfma_f32_32x32x16_bf16 v[8:23], a[64:67], v[80:83], v[8:23]
    ds_read_b128 v[76:79], v1 offset:21504
    s_waitcnt lgkmcnt(4)
    v_mfma_f32_32x32x16_bf16 v[8:23], a[68:71], v[84:87], v[8:23]
    ds_read_b128 v[80:83], v1 offset:22528
    s_waitcnt lgkmcnt(4)
    v_mfma_f32_32x32x16_bf16 v[8:23], a[72:75], v[64:67], v[8:23]
    ds_read_b128 v[84:87], v1 offset:23552
    s_waitcnt lgkmcnt(4)
    v_mfma_f32_32x32x16_bf16 v[8:23], a[76:79], v[68:71], v[8:23]
    ds_read_b128 v[64:67], v1 offset:24576
    s_waitcnt lgkmcnt(4)
    v_mfma_f32_32x32x16_bf16 v[8:23], a[80:83], v[72:75], v[8:23]
    ds_read_b128 v[68:71], v1 offset:25600
    s_waitcnt vmcnt(0)
    v_lshlrev_b32 v40, 16, v24
    v_and_b32 v41, 0xffff0000, v24
    s_waitcnt lgkmcnt(4)
    v_mfma_f32_32x32x16_bf16 v[8:23], a[84:87], v[76:79], v[8:23]
    ds_read_b128 v[72:75], v1 offset:26624
    v_lshlrev_b32 v42, 16, v25
    v_and_b32 v43, 0xffff0000, v25
    s_waitcnt lgkmcnt(4)
    v_mfma_f32_32x32x16_bf16 v[8:23], a[88:91], v[80:83], v[8:23]
    ds_read_b128 v[76:79], v1 offset:27648
    v_lshlrev_b32 v44, 16, v26
    v_and_b32 v45, 0xffff0000, v26
    s_waitcnt lgkmcnt(4)
    v_mfma_f32_32x32x16_bf16 v[8:23], a[92:95], v[84:87], v[8:23]
    ds_read_b128 v[80:83], v1 offset:28672
    v_lshlrev_b32 v46, 16, v27
    v_and_b32 v47, 0xffff0000, v27
    s_waitcnt lgkmcnt(4)
    v_mfma_f32_32x32x16_bf16 v[8:23], a[96:99], v[64:67], v[8:23]
    ds_read_b128 v[84:87], v1 offset:29696
    v_lshlrev_b32 v48, 16, v28
    v_and_b32 v49, 0xffff0000, v28
    s_waitcnt lgkmcnt(4)
    v_mfma_f32_32x32x16_bf16 v[8:23], a[100:103], v[68:71], v[8:23]
    ds_read_b128 v[64:67], v1 offset:30720
    v_lshlrev_b32 v50, 16, v29
    v_and_b32 v51, 0xffff0000, v29
    s_waitcnt lgkmcnt(4)
    v_mfma_f32_32x32x16_bf16 v[8:23], a[104:107], v[72:75], v[8:23]
    ds_read_b128 v[68:71], v1 offset:31744
    v_lshlrev_b32 v52, 16, v30
    v_and_b32 v53, 0xffff0000, v30
    s_waitcnt lgkmcnt(4)
    v_mfma_f32_32x32x16_bf16 v[8:23], a[108:111], v[76:79], v[8:23]
    ds_read_b128 v[72:75], v1 offset:32768
    v_lshlrev_b32 v54, 16, v31
    v_and_b32 v55, 0xffff0000, v31
    s_waitcnt lgkmcnt(4)
    v_mfma_f32_32x32x16_bf16 v[8:23], a[112:115], v[80:83], v[8:23]
    ds_read_b128 v[76:79], v1 offset:33792
    s_waitcnt lgkmcnt(4)
    v_mfma_f32_32x32x16_bf16 v[8:23], a[116:119], v[84:87], v[8:23]
    ds_read_b128 v[80:83], v1 offset:34816
    s_waitcnt lgkmcnt(4)
    v_mfma_f32_32x32x16_bf16 v[8:23], a[120:123], v[64:67], v[8:23]
    ds_read_b128 v[84:87], v1 offset:35840
    s_waitcnt lgkmcnt(4)
    v_mfma_f32_32x32x16_bf16 v[8:23], a[124:127], v[68:71], v[8:23]
    s_waitcnt lgkmcnt(3)
    v_mfma_f32_32x32x16_bf16 v[8:23], a[128:131], v[72:75], v[8:23]
    s_waitcnt lgkmcnt(2)
    v_mfma_f32_32x32x16_bf16 v[8:23], a[132:135], v[76:79], v[8:23]
    s_waitcnt lgkmcnt(1)
    v_mfma_f32_32x32x16_bf16 v[8:23], a[136:139], v[80:83], v[8:23]
    s_waitcnt lgkmcnt(0)
    v_mfma_f32_32x32x16_bf16 v[8:23], a[140:143], v[84:87], v[8:23]
    s_nop 11
    v_add_f32 v8, v8, v40
    v_add_f32 v9, v9, v41
    v_add_f32 v10, v10, v42
    v_add_f32 v11, v11, v43
    v_add_f32 v12, v12, v44
    v_add_f32 v13, v13, v45
    v_add_f32 v14, v14, v46
    v_add_f32 v15, v15, v47
    v_add_f32 v16, v16, v48
    v_add_f32 v17, v17, v49
    v_add_f32 v18, v18, v50
    v_add_f32 v19, v19, v51
    v_add_f32 v20, v20, v52
    v_add_f32 v21, v21, v53
    v_add_f32 v22, v22, v54
    v_add_f32 v23, v23, v55
    v_cvt_pk_bf16_f32 v24, v8, v9
    v_cvt_pk_bf16_f32 v25, v10, v11
    v_cvt_pk_bf16_f32 v26, v12, v13
    v_cvt_pk_bf16_f32 v27, v14, v15
    v_cvt_pk_bf16_f32 v28, v16, v17
    v_cvt_pk_bf16_f32 v29, v18, v19
    v_cvt_pk_bf16_f32 v30, v20, v21
    v_cvt_pk_bf16_f32 v31, v22, v23
    buffer_store_dwordx4 v[24:27], v1, s[8:11], s44 offen offset:0 sc1
    buffer_store_dwordx4 v[28:31], v1, s[8:11], s44 offen offset:1024 sc1
    s_lshl_b32 s40, s37, 7
    s_add_u32 s40, s40, 3203072
    v_mov_b32 v7, 1
    s_waitcnt vmcnt(0)
    s_barrier
    s_cmp_lg_u32 s32, 1
    s_cbranch_scc1 BO_ns
    s_mov_b64 exec, 1
    buffer_atomic_add v7, off, s[8:11], s40
    s_mov_b64 exec, -1
BO_ns:
    s_add_u32 s37, s37, 5
    s_cmp_lt_u32 s37, 64
    s_cbranch_scc1 BO_loop
    s_branch L_end
R_l:
    s_add_u32 s28, s8, 12582912
    s_addc_u32 s29, s9, 0
    s_cmp_lg_u32 s32, 0
    s_cbranch_scc1 L_iw_ok
    s_mov_b32 s94, 40
L_iw:
    buffer_load_dword v79, off, s[4:7], s94 sc1
    s_sub_u32 s95, s95, 1
    s_cmp_eq_u32 s95, 0
    s_cbranch_scc1 L_end
    s_waitcnt vmcnt(0)
    v_cmp_gt_u32 vcc, 32, v79
    s_cbranch_vccz L_iw_ok
    s_sleep 1
    s_branch L_iw
L_iw_ok:
    s_barrier
LR_loop:
    s_lshl_b32 s40, s34, 7
    s_add_u32 s40, s40, 3203072
    s_cmp_lg_u32 s32, 0
    s_cbranch_scc1 LR_fl_ok
LR_fl:
    buffer_load_dword v6, off, s[8:11], s40 sc1
    s_sub_u32 s95, s95, 1
    s_cmp_eq_u32 s95, 0
    s_cbranch_scc1 L_end
    s_waitcnt vmcnt(0)
    v_cmp_gt_u32 vcc, 5, v6
    s_cbranch_vccz LR_fl_ok
    s_sleep 1
    s_branch LR_fl
LR_fl_ok:
    s_barrier
    v_and_b32 v60, 63, v0
    v_lshlrev_b32 v1, 4, v60
    s_mov_b32 s41, 16
    s_mov_b32 s42, 512
    s_lshl_b32 s43, s42, 3
    s_mul_i32 s44, s32, 9216
    v_and_b32 v61, 7, v60
    v_lshl_add_u32 v61, s32, 3, v61
    v_lshrrev_b32 v62, 3, v60
    v_mul_lo_u32 v2, v61, s41
    v_lshlrev_b32 v61, 4, v61
    v_lshl_add_u32 v61, v62, 9, v61
    v_add_u32 v3, 0, v61
    v_mul_lo_u32 v62, v62, s42
    v_add_u32 v2, v2, v62
    s_mul_i32 s41, s34, 36864
    s_add_u32 m0, s44, 0
    s_nop 0
    buffer_load_dwordx4 v2, s[28:31], s41 offen sc1 lds
    s_add_u32 m0, s44, 1024
    s_add_u32 s41, s41, s43
    buffer_load_dwordx4 v2, s[28:31], s41 offen sc1 lds
    s_add_u32 m0, s44, 2048
    s_add_u32 s41, s41, s43
    buffer_load_dwordx4 v2, s[28:31], s41 offen sc1 lds
    s_add_u32 m0, s44, 3072
    s_add_u32 s41, s41, s43
    buffer_load_dwordx4 v2, s[28:31], s41 offen sc1 lds
    s_add_u32 m0, s44, 4096
    s_add_u32 s41, s41, s43
    buffer_load_dwordx4 v2, s[28:31], s41 offen sc1 lds
    s_add_u32 m0, s44, 5120
    s_add_u32 s41, s41, s43
    buffer_load_dwordx4 v2, s[28:31], s41 offen sc1 lds
    s_add_u32 m0, s44, 6144
    s_add_u32 s41, s41, s43
    buffer_load_dwordx4 v2, s[28:31], s41 offen sc1 lds
    s_add_u32 m0, s44, 7168
    s_add_u32 s41, s41, s43
    buffer_load_dwordx4 v2, s[28:31], s41 offen sc1 lds
    s_add_u32 m0, s44, 8192
    s_add_u32 s41, s41, s43
    buffer_load_dwordx4 v2, s[28:31], s41 offen sc1 lds
    s_mul_i32 s45, s34, 36864
    s_add_u32 s45, s45, 104857600
    s_mov_b32 s46, 0x3f803f80
    s_waitcnt vmcnt(0)
    v_add_u32 v6, s44, v1
    ds_read_b128 v[8:11], v6 offset:0
    ds_read_b128 v[12:15], v6 offset:1024
    ds_read_b128 v[16:19], v6 offset:2048
    ds_read_b128 v[20:23], v6 offset:3072
    ds_read_b128 v[24:27], v6 offset:4096
    ds_read_b128 v[28:31], v6 offset:5120
    ds_read_b128 v[32:35], v6 offset:6144
    ds_read_b128 v[36:39], v6 offset:7168
    ds_read_b128 v[40:43], v6 offset:8192
    v_mov_b32 v6, 0
    v_mov_b32 v44, 0
    s_waitcnt lgkmcnt(8)
    v_dot2_f32_bf16 v6, v8, s46, v6
    v_dot2_f32_bf16 v44, v8, v8, v44
    v_dot2_f32_bf16 v6, v9, s46, v6
    v_dot2_f32_bf16 v44, v9, v9, v44
    v_dot2_f32_bf16 v6, v10, s46, v6
    v_dot2_f32_bf16 v44, v10, v10, v44
    v_dot2_f32_bf16 v6, v11, s46, v6
    v_dot2_f32_bf16 v44, v11, v11, v44
    s_waitcnt lgkmcnt(7)
    v_dot2_f32_bf16 v6, v12, s46, v6
    v_dot2_f32_bf16 v44, v12, v12, v44
    v_dot2_f32_bf16 v6, v13, s46, v6
    v_dot2_f32_bf16 v44, v13, v13, v44
    v_dot2_f32_bf16 v6, v14, s46, v6
    v_dot2_f32_bf16 v44, v14, v14, v44
    v_dot2_f32_bf16 v6, v15, s46, v6
    v_dot2_f32_bf16 v44, v15, v15, v44
    s_waitcnt lgkmcnt(6)
    v_dot2_f32_bf16 v6, v16, s46, v6
    v_dot2_f32_bf16 v44, v16, v16, v44
    v_dot2_f32_bf16 v6, v17, s46, v6
    v_dot2_f32_bf16 v44, v17, v17, v44
    v_dot2_f32_bf16 v6, v18, s46, v6
    v_dot2_f32_bf16 v44, v18, v18, v44
    v_dot2_f32_bf16 v6, v19, s46, v6
    v_dot2_f32_bf16 v44, v19, v19, v44
    s_waitcnt lgkmcnt(5)
    v_dot2_f32_bf16 v6, v20, s46, v6
    v_dot2_f32_bf16 v44, v20, v20, v44
    v_dot2_f32_bf16 v6, v21, s46, v6
    v_dot2_f32_bf16 v44, v21, v21, v44
    v_dot2_f32_bf16 v6, v22, s46, v6
    v_dot2_f32_bf16 v44, v22, v22, v44
    v_dot2_f32_bf16 v6, v23, s46, v6
    v_dot2_f32_bf16 v44, v23, v23, v44
    s_waitcnt lgkmcnt(4)
    v_dot2_f32_bf16 v6, v24, s46, v6
    v_dot2_f32_bf16 v44, v24, v24, v44
    v_dot2_f32_bf16 v6, v25, s46, v6
    v_dot2_f32_bf16 v44, v25, v25, v44
    v_dot2_f32_bf16 v6, v26, s46, v6
    v_dot2_f32_bf16 v44, v26, v26, v44
    v_dot2_f32_bf16 v6, v27, s46, v6
    v_dot2_f32_bf16 v44, v27, v27, v44
    s_waitcnt lgkmcnt(3)
    v_dot2_f32_bf16 v6, v28, s46, v6
    v_dot2_f32_bf16 v44, v28, v28, v44
    v_dot2_f32_bf16 v6, v29, s46, v6
    v_dot2_f32_bf16 v44, v29, v29, v44
    v_dot2_f32_bf16 v6, v30, s46, v6
    v_dot2_f32_bf16 v44, v30, v30, v44
    v_dot2_f32_bf16 v6, v31, s46, v6
    v_dot2_f32_bf16 v44, v31, v31, v44
    s_waitcnt lgkmcnt(2)
    v_dot2_f32_bf16 v6, v32, s46, v6
    v_dot2_f32_bf16 v44, v32, v32, v44
    v_dot2_f32_bf16 v6, v33, s46, v6
    v_dot2_f32_bf16 v44, v33, v33, v44
    v_dot2_f32_bf16 v6, v34, s46, v6
    v_dot2_f32_bf16 v44, v34, v34, v44
    v_dot2_f32_bf16 v6, v35, s46, v6
    v_dot2_f32_bf16 v44, v35, v35, v44
    s_waitcnt lgkmcnt(1)
    v_dot2_f32_bf16 v6, v36, s46, v6
    v_dot2_f32_bf16 v44, v36, v36, v44
    v_dot2_f32_bf16 v6, v37, s46, v6
    v_dot2_f32_bf16 v44, v37, v37, v44
    v_dot2_f32_bf16 v6, v38, s46, v6
    v_dot2_f32_bf16 v44, v38, v38, v44
    v_dot2_f32_bf16 v6, v39, s46, v6
    v_dot2_f32_bf16 v44, v39, v39, v44
    s_waitcnt lgkmcnt(0)
    v_dot2_f32_bf16 v6, v40, s46, v6
    v_dot2_f32_bf16 v44, v40, v40, v44
    v_dot2_f32_bf16 v6, v41, s46, v6
    v_dot2_f32_bf16 v44, v41, v41, v44
    v_dot2_f32_bf16 v6, v42, s46, v6
    v_dot2_f32_bf16 v44, v42, v42, v44
    v_dot2_f32_bf16 v6, v43, s46, v6
    v_dot2_f32_bf16 v44, v43, v43, v44
    s_nop 2
    v_add_f32_dpp v6, v6, v6 row_ror:8 row_mask:0xf bank_mask:0xf
    v_add_f32_dpp v44, v44, v44 row_ror:8 row_mask:0xf bank_mask:0xf
    v_mov_b32 v45, v6
    v_mov_b32 v7, v44
    s_nop 0
    v_permlane16_swap_b32 v6, v45
    v_permlane16_swap_b32 v44, v7
    v_add_f32 v6, v6, v45
    v_add_f32 v44, v44, v7
    v_mov_b32 v45, v6
    v_mov_b32 v7, v44
    s_nop 0
    v_permlane32_swap_b32 v6, v45
    v_permlane32_swap_b32 v44, v7
    v_add_f32 v6, v6, v45
    v_add_f32 v44, v44, v7
    v_mul_f32 v6, 0x3ae38e39, v6
    v_mul_f32 v44, 0x3ae38e39, v44
    v_fma_f32 v44, -v6, v6, v44
    v_max_f32 v44, 0, v44
    v_add_f32 v44, 0x3727c5ac, v44
    v_rsq_f32 v44, v44
    s_nop 0
    v_mul_f32 v45, v6, v44
    v_lshlrev_b32 v6, 16, v8
    v_and_b32 v7, 0xffff0000, v8
    v_pk_fma_f32 v[6:7], v[6:7], v[44:45], v[44:45] op_sel:[0,0,1] op_sel_hi:[1,0,1] neg_lo:[0,0,1] neg_hi:[0,0,1]
    s_nop 0
    v_cvt_pk_bf16_f32 v8, v6, v7
    v_lshlrev_b32 v6, 16, v9
    v_and_b32 v7, 0xffff0000, v9
    v_pk_fma_f32 v[6:7], v[6:7], v[44:45], v[44:45] op_sel:[0,0,1] op_sel_hi:[1,0,1] neg_lo:[0,0,1] neg_hi:[0,0,1]
    s_nop 0
    v_cvt_pk_bf16_f32 v9, v6, v7
    v_lshlrev_b32 v6, 16, v10
    v_and_b32 v7, 0xffff0000, v10
    v_pk_fma_f32 v[6:7], v[6:7], v[44:45], v[44:45] op_sel:[0,0,1] op_sel_hi:[1,0,1] neg_lo:[0,0,1] neg_hi:[0,0,1]
    s_nop 0
    v_cvt_pk_bf16_f32 v10, v6, v7
    v_lshlrev_b32 v6, 16, v11
    v_and_b32 v7, 0xffff0000, v11
    v_pk_fma_f32 v[6:7], v[6:7], v[44:45], v[44:45] op_sel:[0,0,1] op_sel_hi:[1,0,1] neg_lo:[0,0,1] neg_hi:[0,0,1]
    s_nop 0
    v_cvt_pk_bf16_f32 v11, v6, v7
    s_add_u32 s41, s45, 0
    buffer_store_dwordx4 v[8:11], v3, s[8:11], s41 offen sc1
    v_lshlrev_b32 v6, 16, v12
    v_and_b32 v7, 0xffff0000, v12
    v_pk_fma_f32 v[6:7], v[6:7], v[44:45], v[44:45] op_sel:[0,0,1] op_sel_hi:[1,0,1] neg_lo:[0,0,1] neg_hi:[0,0,1]
    s_nop 0
    v_cvt_pk_bf16_f32 v12, v6, v7
    v_lshlrev_b32 v6, 16, v13
    v_and_b32 v7, 0xffff0000, v13
    v_pk_fma_f32 v[6:7], v[6:7], v[44:45], v[44:45] op_sel:[0,0,1] op_sel_hi:[1,0,1] neg_lo:[0,0,1] neg_hi:[0,0,1]
    s_nop 0
    v_cvt_pk_bf16_f32 v13, v6, v7
    v_lshlrev_b32 v6, 16, v14
    v_and_b32 v7, 0xffff0000, v14
    v_pk_fma_f32 v[6:7], v[6:7], v[44:45], v[44:45] op_sel:[0,0,1] op_sel_hi:[1,0,1] neg_lo:[0,0,1] neg_hi:[0,0,1]
    s_nop 0
    v_cvt_pk_bf16_f32 v14, v6, v7
    v_lshlrev_b32 v6, 16, v15
    v_and_b32 v7, 0xffff0000, v15
    v_pk_fma_f32 v[6:7], v[6:7], v[44:45], v[44:45] op_sel:[0,0,1] op_sel_hi:[1,0,1] neg_lo:[0,0,1] neg_hi:[0,0,1]
    s_nop 0
    v_cvt_pk_bf16_f32 v15, v6, v7
    s_add_u32 s41, s45, 4096
    buffer_store_dwordx4 v[12:15], v3, s[8:11], s41 offen sc1
    v_lshlrev_b32 v6, 16, v16
    v_and_b32 v7, 0xffff0000, v16
    v_pk_fma_f32 v[6:7], v[6:7], v[44:45], v[44:45] op_sel:[0,0,1] op_sel_hi:[1,0,1] neg_lo:[0,0,1] neg_hi:[0,0,1]
    s_nop 0
    v_cvt_pk_bf16_f32 v16, v6, v7
    v_lshlrev_b32 v6, 16, v17
    v_and_b32 v7, 0xffff0000, v17
    v_pk_fma_f32 v[6:7], v[6:7], v[44:45], v[44:45] op_sel:[0,0,1] op_sel_hi:[1,0,1] neg_lo:[0,0,1] neg_hi:[0,0,1]
    s_nop 0
    v_cvt_pk_bf16_f32 v17, v6, v7
    v_lshlrev_b32 v6, 16, v18
    v_and_b32 v7, 0xffff0000, v18
    v_pk_fma_f32 v[6:7], v[6:7], v[44:45], v[44:45] op_sel:[0,0,1] op_sel_hi:[1,0,1] neg_lo:[0,0,1] neg_hi:[0,0,1]
    s_nop 0
    v_cvt_pk_bf16_f32 v18, v6, v7
    v_lshlrev_b32 v6, 16, v19
    v_and_b32 v7, 0xffff0000, v19
    v_pk_fma_f32 v[6:7], v[6:7], v[44:45], v[44:45] op_sel:[0,0,1] op_sel_hi:[1,0,1] neg_lo:[0,0,1] neg_hi:[0,0,1]
    s_nop 0
    v_cvt_pk_bf16_f32 v19, v6, v7
    s_add_u32 s41, s45, 8192
    buffer_store_dwordx4 v[16:19], v3, s[8:11], s41 offen sc1
    v_lshlrev_b32 v6, 16, v20
    v_and_b32 v7, 0xffff0000, v20
    v_pk_fma_f32 v[6:7], v[6:7], v[44:45], v[44:45] op_sel:[0,0,1] op_sel_hi:[1,0,1] neg_lo:[0,0,1] neg_hi:[0,0,1]
    s_nop 0
    v_cvt_pk_bf16_f32 v20, v6, v7
    v_lshlrev_b32 v6, 16, v21
    v_and_b32 v7, 0xffff0000, v21
    v_pk_fma_f32 v[6:7], v[6:7], v[44:45], v[44:45] op_sel:[0,0,1] op_sel_hi:[1,0,1] neg_lo:[0,0,1] neg_hi:[0,0,1]
    s_nop 0
    v_cvt_pk_bf16_f32 v21, v6, v7
    v_lshlrev_b32 v6, 16, v22
    v_and_b32 v7, 0xffff0000, v22
    v_pk_fma_f32 v[6:7], v[6:7], v[44:45], v[44:45] op_sel:[0,0,1] op_sel_hi:[1,0,1] neg_lo:[0,0,1] neg_hi:[0,0,1]
    s_nop 0
    v_cvt_pk_bf16_f32 v22, v6, v7
    v_lshlrev_b32 v6, 16, v23
    v_and_b32 v7, 0xffff0000, v23
    v_pk_fma_f32 v[6:7], v[6:7], v[44:45], v[44:45] op_sel:[0,0,1] op_sel_hi:[1,0,1] neg_lo:[0,0,1] neg_hi:[0,0,1]
    s_nop 0
    v_cvt_pk_bf16_f32 v23, v6, v7
    s_add_u32 s41, s45, 12288
    buffer_store_dwordx4 v[20:23], v3, s[8:11], s41 offen sc1
    v_lshlrev_b32 v6, 16, v24
    v_and_b32 v7, 0xffff0000, v24
    v_pk_fma_f32 v[6:7], v[6:7], v[44:45], v[44:45] op_sel:[0,0,1] op_sel_hi:[1,0,1] neg_lo:[0,0,1] neg_hi:[0,0,1]
    s_nop 0
    v_cvt_pk_bf16_f32 v24, v6, v7
    v_lshlrev_b32 v6, 16, v25
    v_and_b32 v7, 0xffff0000, v25
    v_pk_fma_f32 v[6:7], v[6:7], v[44:45], v[44:45] op_sel:[0,0,1] op_sel_hi:[1,0,1] neg_lo:[0,0,1] neg_hi:[0,0,1]
    s_nop 0
    v_cvt_pk_bf16_f32 v25, v6, v7
    v_lshlrev_b32 v6, 16, v26
    v_and_b32 v7, 0xffff0000, v26
    v_pk_fma_f32 v[6:7], v[6:7], v[44:45], v[44:45] op_sel:[0,0,1] op_sel_hi:[1,0,1] neg_lo:[0,0,1] neg_hi:[0,0,1]
    s_nop 0
    v_cvt_pk_bf16_f32 v26, v6, v7
    v_lshlrev_b32 v6, 16, v27
    v_and_b32 v7, 0xffff0000, v27
    v_pk_fma_f32 v[6:7], v[6:7], v[44:45], v[44:45] op_sel:[0,0,1] op_sel_hi:[1,0,1] neg_lo:[0,0,1] neg_hi:[0,0,1]
    s_nop 0
    v_cvt_pk_bf16_f32 v27, v6, v7
    s_add_u32 s41, s45, 16384
    buffer_store_dwordx4 v[24:27], v3, s[8:11], s41 offen sc1
    v_lshlrev_b32 v6, 16, v28
    v_and_b32 v7, 0xffff0000, v28
    v_pk_fma_f32 v[6:7], v[6:7], v[44:45], v[44:45] op_sel:[0,0,1] op_sel_hi:[1,0,1] neg_lo:[0,0,1] neg_hi:[0,0,1]
    s_nop 0
    v_cvt_pk_bf16_f32 v28, v6, v7
    v_lshlrev_b32 v6, 16, v29
    v_and_b32 v7, 0xffff0000, v29
    v_pk_fma_f32 v[6:7], v[6:7], v[44:45], v[44:45] op_sel:[0,0,1] op_sel_hi:[1,0,1] neg_lo:[0,0,1] neg_hi:[0,0,1]
    s_nop 0
    v_cvt_pk_bf16_f32 v29, v6, v7
    v_lshlrev_b32 v6, 16, v30
    v_and_b32 v7, 0xffff0000, v30
    v_pk_fma_f32 v[6:7], v[6:7], v[44:45], v[44:45] op_sel:[0,0,1] op_sel_hi:[1,0,1] neg_lo:[0,0,1] neg_hi:[0,0,1]
    s_nop 0
    v_cvt_pk_bf16_f32 v30, v6, v7
    v_lshlrev_b32 v6, 16, v31
    v_and_b32 v7, 0xffff0000, v31
    v_pk_fma_f32 v[6:7], v[6:7], v[44:45], v[44:45] op_sel:[0,0,1] op_sel_hi:[1,0,1] neg_lo:[0,0,1] neg_hi:[0,0,1]
    s_nop 0
    v_cvt_pk_bf16_f32 v31, v6, v7
    s_add_u32 s41, s45, 20480
    buffer_store_dwordx4 v[28:31], v3, s[8:11], s41 offen sc1
    v_lshlrev_b32 v6, 16, v32
    v_and_b32 v7, 0xffff0000, v32
    v_pk_fma_f32 v[6:7], v[6:7], v[44:45], v[44:45] op_sel:[0,0,1] op_sel_hi:[1,0,1] neg_lo:[0,0,1] neg_hi:[0,0,1]
    s_nop 0
    v_cvt_pk_bf16_f32 v32, v6, v7
    v_lshlrev_b32 v6, 16, v33
    v_and_b32 v7, 0xffff0000, v33
    v_pk_fma_f32 v[6:7], v[6:7], v[44:45], v[44:45] op_sel:[0,0,1] op_sel_hi:[1,0,1] neg_lo:[0,0,1] neg_hi:[0,0,1]
    s_nop 0
    v_cvt_pk_bf16_f32 v33, v6, v7
    v_lshlrev_b32 v6, 16, v34
    v_and_b32 v7, 0xffff0000, v34
    v_pk_fma_f32 v[6:7], v[6:7], v[44:45], v[44:45] op_sel:[0,0,1] op_sel_hi:[1,0,1] neg_lo:[0,0,1] neg_hi:[0,0,1]
    s_nop 0
    v_cvt_pk_bf16_f32 v34, v6, v7
    v_lshlrev_b32 v6, 16, v35
    v_and_b32 v7, 0xffff0000, v35
    v_pk_fma_f32 v[6:7], v[6:7], v[44:45], v[44:45] op_sel:[0,0,1] op_sel_hi:[1,0,1] neg_lo:[0,0,1] neg_hi:[0,0,1]
    s_nop 0
    v_cvt_pk_bf16_f32 v35, v6, v7
    s_add_u32 s41, s45, 24576
    buffer_store_dwordx4 v[32:35], v3, s[8:11], s41 offen sc1
    v_lshlrev_b32 v6, 16, v36
    v_and_b32 v7, 0xffff0000, v36
    v_pk_fma_f32 v[6:7], v[6:7], v[44:45], v[44:45] op_sel:[0,0,1] op_sel_hi:[1,0,1] neg_lo:[0,0,1] neg_hi:[0,0,1]
    s_nop 0
    v_cvt_pk_bf16_f32 v36, v6, v7
    v_lshlrev_b32 v6, 16, v37
    v_and_b32 v7, 0xffff0000, v37
    v_pk_fma_f32 v[6:7], v[6:7], v[44:45], v[44:45] op_sel:[0,0,1] op_sel_hi:[1,0,1] neg_lo:[0,0,1] neg_hi:[0,0,1]
    s_nop 0
    v_cvt_pk_bf16_f32 v37, v6, v7
    v_lshlrev_b32 v6, 16, v38
    v_and_b32 v7, 0xffff0000, v38
    v_pk_fma_f32 v[6:7], v[6:7], v[44:45], v[44:45] op_sel:[0,0,1] op_sel_hi:[1,0,1] neg_lo:[0,0,1] neg_hi:[0,0,1]
    s_nop 0
    v_cvt_pk_bf16_f32 v38, v6, v7
    v_lshlrev_b32 v6, 16, v39
    v_and_b32 v7, 0xffff0000, v39
    v_pk_fma_f32 v[6:7], v[6:7], v[44:45], v[44:45] op_sel:[0,0,1] op_sel_hi:[1,0,1] neg_lo:[0,0,1] neg_hi:[0,0,1]
    s_nop 0
    v_cvt_pk_bf16_f32 v39, v6, v7
    s_add_u32 s41, s45, 28672
    buffer_store_dwordx4 v[36:39], v3, s[8:11], s41 offen sc1
    v_lshlrev_b32 v6, 16, v40
    v_and_b32 v7, 0xffff0000, v40
    v_pk_fma_f32 v[6:7], v[6:7], v[44:45], v[44:45] op_sel:[0,0,1] op_sel_hi:[1,0,1] neg_lo:[0,0,1] neg_hi:[0,0,1]
    s_nop 0
    v_cvt_pk_bf16_f32 v40, v6, v7
    v_lshlrev_b32 v6, 16, v41
    v_and_b32 v7, 0xffff0000, v41
    v_pk_fma_f32 v[6:7], v[6:7], v[44:45], v[44:45] op_sel:[0,0,1] op_sel_hi:[1,0,1] neg_lo:[0,0,1] neg_hi:[0,0,1]
    s_nop 0
    v_cvt_pk_bf16_f32 v41, v6, v7
    v_lshlrev_b32 v6, 16, v42
    v_and_b32 v7, 0xffff0000, v42
    v_pk_fma_f32 v[6:7], v[6:7], v[44:45], v[44:45] op_sel:[0,0,1] op_sel_hi:[1,0,1] neg_lo:[0,0,1] neg_hi:[0,0,1]
    s_nop 0
    v_cvt_pk_bf16_f32 v42, v6, v7
    v_lshlrev_b32 v6, 16, v43
    v_and_b32 v7, 0xffff0000, v43
    v_pk_fma_f32 v[6:7], v[6:7], v[44:45], v[44:45] op_sel:[0,0,1] op_sel_hi:[1,0,1] neg_lo:[0,0,1] neg_hi:[0,0,1]
    s_nop 0
    v_cvt_pk_bf16_f32 v43, v6, v7
    s_add_u32 s41, s45, 32768
    buffer_store_dwordx4 v[40:43], v3, s[8:11], s41 offen sc1
    s_waitcnt vmcnt(0)
    s_barrier
    s_cmp_lg_u32 s32, 0
    s_cbranch_scc1 LR_done
    v_mov_b32 v4, 1
    s_lshl_b32 s41, s34, 2
    s_add_u32 s41, s41, 103858176
    s_mov_b64 exec, 1
    buffer_store_dword v4, off, s[8:11], s41 sc1
    s_mov_b64 exec, -1
LR_done:
    s_add_u32 s34, s34, 7
    s_cmp_lt_u32 s34, 64
    s_cbranch_scc1 LR_loop
    s_branch L_end
R_q:
    s_mov_b32 s28, s66
    s_mov_b32 s29, s67
    s_mov_b32 s30, 9216
    s_mov_b32 s31, 0x00020000
    v_and_b32 v60, 63, v0
    s_lshl_b32 s41, s33, 8
    s_lshl_b32 s42, s32, 6
    s_add_u32 s41, s41, s42
    v_lshrrev_b32 v61, 2, v60
    v_lshlrev_b32 v61, 13, v61
    v_and_b32 v62, 3, v60
    v_lshlrev_b32 v63, 4, v62
    v_add3_u32 v64, v61, v63, s41
    s_mul_i32 s43, s32, 32768
    s_add_u32 m0, s43, 0
    s_mov_b32 s44, 0
    buffer_load_dwordx4 v64, s[16:19], s44 offen  lds
    s_add_u32 m0, s43, 1024
    s_mov_b32 s44, 131072
    buffer_load_dwordx4 v64, s[16:19], s44 offen  lds
    s_add_u32 m0, s43, 2048
    s_mov_b32 s44, 262144
    buffer_load_dwordx4 v64, s[16:19], s44 offen  lds
    s_add_u32 m0, s43, 3072
    s_mov_b32 s44, 393216
    buffer_load_dwordx4 v64, s[16:19], s44 offen  lds
    s_add_u32 m0, s43, 4096
    s_mov_b32 s44, 0
    buffer_load_dwordx4 v64, s[20:23], s44 offen  lds
    s_add_u32 m0, s43, 5120
    s_mov_b32 s44, 131072
    buffer_load_dwordx4 v64, s[20:23], s44 offen  lds
    s_add_u32 m0, s43, 6144
    s_mov_b32 s44, 262144
    buffer_load_dwordx4 v64, s[20:23], s44 offen  lds
    s_add_u32 m0, s43, 7168
    s_mov_b32 s44, 393216
    buffer_load_dwordx4 v64, s[20:23], s44 offen  lds
    s_add_u32 m0, s43, 8192
    s_mov_b32 s44, 0
    buffer_load_dwordx4 v64, s[12:15], s44 offen  lds
    s_add_u32 m0, s43, 9216
    s_mov_b32 s44, 131072
    buffer_load_dwordx4 v64, s[12:15], s44 offen  lds
    s_add_u32 m0, s43, 10240
    s_mov_b32 s44, 262144
    buffer_load_dwordx4 v64, s[12:15], s44 offen  lds
    s_add_u32 m0, s43, 11264
    s_mov_b32 s44, 393216
    buffer_load_dwordx4 v64, s[12:15], s44 offen  lds
    s_add_u32 m0, s43, 12288
    s_mov_b32 s44, 524288
    buffer_load_dwordx4 v64, s[16:19], s44 offen  lds
    s_add_u32 m0, s43, 13312
    s_mov_b32 s44, 655360
    buffer_load_dwordx4 v64, s[16:19], s44 offen  lds
    s_add_u32 m0, s43, 14336
    s_mov_b32 s44, 786432
    buffer_load_dwordx4 v64, s[16:19], s44 offen  lds
    s_add_u32 m0, s43, 15360
    s_mov_b32 s44, 917504
    buffer_load_dwordx4 v64, s[16:19], s44 offen  lds
    s_add_u32 m0, s43, 16384
    s_mov_b32 s44, 524288
    buffer_load_dwordx4 v64, s[20:23], s44 offen  lds
    s_add_u32 m0, s43, 17408
    s_mov_b32 s44, 655360
    buffer_load_dwordx4 v64, s[20:23], s44 offen  lds
    s_add_u32 m0, s43, 18432
    s_mov_b32 s44, 786432
    buffer_load_dwordx4 v64, s[20:23], s44 offen  lds
    s_add_u32 m0, s43, 19456
    s_mov_b32 s44, 917504
    buffer_load_dwordx4 v64, s[20:23], s44 offen  lds
    s_add_u32 m0, s43, 20480
    s_mov_b32 s44, 524288
    buffer_load_dwordx4 v64, s[12:15], s44 offen  lds
    s_add_u32 m0, s43, 21504
    s_mov_b32 s44, 655360
    buffer_load_dwordx4 v64, s[12:15], s44 offen  lds
    s_add_u32 m0, s43, 22528
    s_mov_b32 s44, 786432
    buffer_load_dwordx4 v64, s[12:15], s44 offen  lds
    s_add_u32 m0, s43, 23552
    s_mov_b32 s44, 917504
    buffer_load_dwordx4 v64, s[12:15], s44 offen  lds
    s_add_u32 m0, s43, 24576
    s_mov_b32 s44, 1048576
    buffer_load_dwordx4 v64, s[16:19], s44 offen  lds
    s_add_u32 m0, s43, 25600
    s_mov_b32 s44, 1179648
    buffer_load_dwordx4 v64, s[16:19], s44 offen  lds
    s_add_u32 m0, s43, 26624
    s_mov_b32 s44, 1310720
    buffer_load_dwordx4 v64, s[16:19], s44 offen  lds
    s_add_u32 m0, s43, 27648
    s_mov_b32 s44, 1441792
    buffer_load_dwordx4 v64, s[16:19], s44 offen  lds
    v_bfe_u32 v61, v60, 2, 2
    v_lshrrev_b32 v63, 5, v60
    v_lshl_add_u32 v61, v63, 3, v61
    v_lshlrev_b32 v61, 6, v61
    v_add_u32 v61, s43, v61
    v_bfe_u32 v63, v60, 4, 1
    v_lshl_add_u32 v66, v63, 5, v61
    v_lshl_add_u32 v66, v62, 3, v66
    v_lshl_add_u32 v65, v63, 4, v61
    v_and_b32 v63, 2, v60
    v_lshl_add_u32 v65, v63, 4, v65
    v_and_b32 v63, 1, v60
    v_lshl_add_u32 v65, v63, 3, v65
    s_lshl_b32 s41, s32, 10
    s_add_u32 s41, s41, 122880
    v_mov_b32 v1, s41
    v_bfe_u32 v61, v60, 4, 2
    v_lshl_add_u32 v1, v61, 8, v1
    v_bfe_u32 v61, v60, 1, 1
    v_lshl_add_u32 v1, v61, 7, v1
    v_bfe_u32 v61, v60, 2, 2
    v_lshl_add_u32 v1, v61, 5, v1
    v_bfe_u32 v61, v60, 0, 1
    v_lshl_add_u32 v1, v61, 4, v1
    s_lshl_b32 s41, s32, 9
    s_add_u32 s41, s41, 132096
    v_mov_b32 v6, s41
    v_bfe_u32 v61, v60, 2, 1
    v_lshl_add_u32 v6, v61, 8, v6
    v_bfe_u32 v61, v60, 4, 1
    v_lshl_add_u32 v6, v61, 7, v6
    v_bfe_u32 v61, v60, 3, 1
    v_lshl_add_u32 v6, v61, 6, v6
    v_bfe_u32 v61, v60, 0, 2
    v_lshl_add_u32 v6, v61, 4, v6
    v_bfe_u32 v61, v60, 5, 1
    v_lshl_add_u32 v6, v61, 3, v6
    v_mov_b32 v2, 122880
    v_bfe_u32 v61, v60, 5, 1
    v_lshl_add_u32 v2, v61, 7, v2
    v_bfe_u32 v61, v60, 3, 1
    v_lshl_add_u32 v2, v61, 6, v2
    v_bfe_u32 v61, v60, 0, 2
    v_lshl_add_u32 v2, v61, 4, v2
    v_bfe_u32 v61, v60, 2, 1
    v_bfe_u32 v62, v60, 4, 1
    v_xor_b32 v61, v61, v62
    v_lshl_add_u32 v2, v61, 31, v2
    v_mov_b32 v3, 2048
    v_bfe_u32 v61, v60, 0, 1
    v_lshl_add_u32 v3, v61, 4, v3
    v_bfe_u32 v61, v60, 1, 1
    v_lshl_add_u32 v3, v61, 6, v3
    v_bfe_u32 v61, v60, 2, 1
    v_lshl_add_u32 v3, v61, 8, v3
    v_bfe_u32 v61, v60, 3, 1
    v_lshl_add_u32 v3, v61, 7, v3
    v_bfe_u32 v61, v60, 4, 2
    v_lshl_add_u32 v3, v61, 9, v3
    v_mov_b32 v4, 4096
    v_bfe_u32 v61, v60, 0, 4
    v_lshl_add_u32 v4, v61, 4, v4
    v_bfe_u32 v61, v60, 4, 2
    v_lshl_add_u32 v4, v61, 9, v4
    v_mov_b32 v5, 132096
    v_bfe_u32 v61, v60, 0, 3
    v_lshl_add_u32 v5, v61, 4, v5
    v_bfe_u32 v61, v60, 5, 1
    v_lshl_add_u32 v5, v61, 7, v5
    v_and_b32 v62, 31, v60
    v_lshlrev_b32 v61, 2, v61
    v_sub_u32 v62, v62, v61
    v_cmp_le_i32 s[48:49], 0, v62
    v_cmp_le_i32 s[50:51], 1, v62
    v_cmp_le_i32 s[52:53], 2, v62
    v_cmp_le_i32 s[54:55], 3, v62
    v_cmp_le_i32 s[56:57], 8, v62
    v_cmp_le_i32 s[58:59], 9, v62
    v_cmp_le_i32 s[60:61], 10, v62
    v_cmp_le_i32 s[62:63], 11, v62
    v_cmp_le_i32 s[64:65], 16, v62
    v_cmp_le_i32 s[66:67], 17, v62
    v_cmp_le_i32 s[68:69], 18, v62
    v_cmp_le_i32 s[70:71], 19, v62
    v_cmp_le_i32 s[72:73], 24, v62
    v_cmp_le_i32 s[74:75], 25, v62
    v_cmp_le_i32 s[76:77], 26, v62
    v_cmp_le_i32 s[78:79], 27, v62
    v_mov_b32 v7, 0xceabfb8f
    v_lshlrev_b32 v0, 4, v60
    s_mov_b32 s37, 0x3e0293ee
    s_waitcnt vmcnt(24)
    ds_read_b64_tr_b16 a[4:5], v65 offset:0
    ds_read_b64_tr_b16 a[6:7], v65 offset:256
    ds_read_b64_tr_b16 a[16:17], v65 offset:1024
    ds_read_b64_tr_b16 a[18:19], v65 offset:1280
    ds_read_b64_tr_b16 a[28:29], v65 offset:2048
    ds_read_b64_tr_b16 a[30:31], v65 offset:2304
    ds_read_b64_tr_b16 a[40:41], v65 offset:3072
    ds_read_b64_tr_b16 a[42:43], v65 offset:3328
    s_add_u32 m0, s43, 28672
    s_mov_b32 s44, 1048576
    buffer_load_dwordx4 v64, s[20:23], s44 offen  lds
    s_add_u32 m0, s43, 29696
    s_mov_b32 s44, 1179648
    buffer_load_dwordx4 v64, s[20:23], s44 offen  lds
    s_add_u32 m0, s43, 30720
    s_mov_b32 s44, 1310720
    buffer_load_dwordx4 v64, s[20:23], s44 offen  lds
    s_add_u32 m0, s43, 31744
    s_mov_b32 s44, 1441792
    buffer_load_dwordx4 v64, s[20:23], s44 offen  lds
    s_waitcnt vmcnt(24)
    ds_read_b64_tr_b16 a[8:9], v66 offset:4096
    ds_read_b64_tr_b16 a[10:11], v66 offset:4352
    ds_read_b64_tr_b16 a[20:21], v66 offset:5120
    ds_read_b64_tr_b16 a[22:23], v66 offset:5376
    ds_read_b64_tr_b16 a[32:33], v66 offset:6144
    ds_read_b64_tr_b16 a[34:35], v66 offset:6400
    ds_read_b64_tr_b16 a[44:45], v66 offset:7168
    ds_read_b64_tr_b16 a[46:47], v66 offset:7424
    s_waitcnt lgkmcnt(8)
    s_add_u32 m0, s43, 0
    s_mov_b32 s44, 1048576
    buffer_load_dwordx4 v64, s[12:15], s44 offen  lds
    s_add_u32 m0, s43, 1024
    s_mov_b32 s44, 1179648
    buffer_load_dwordx4 v64, s[12:15], s44 offen  lds
    s_add_u32 m0, s43, 2048
    s_mov_b32 s44, 1310720
    buffer_load_dwordx4 v64, s[12:15], s44 offen  lds
    s_add_u32 m0, s43, 3072
    s_mov_b32 s44, 1441792
    buffer_load_dwordx4 v64, s[12:15], s44 offen  lds
    s_waitcnt vmcnt(24)
    ds_read_b64_tr_b16 a[0:1], v65 offset:8192
    ds_read_b64_tr_b16 a[2:3], v65 offset:8448
    ds_read_b64_tr_b16 a[12:13], v65 offset:9216
    ds_read_b64_tr_b16 a[14:15], v65 offset:9472
    ds_read_b64_tr_b16 a[24:25], v65 offset:10240
    ds_read_b64_tr_b16 a[26:27], v65 offset:10496
    ds_read_b64_tr_b16 a[36:37], v65 offset:11264
    ds_read_b64_tr_b16 a[38:39], v65 offset:11520
    s_waitcnt lgkmcnt(8)
    s_add_u32 m0, s43, 4096
    s_mov_b32 s44, 1572864
    buffer_load_dwordx4 v64, s[16:19], s44 offen  lds
    s_add_u32 m0, s43, 5120
    s_mov_b32 s44, 1703936
    buffer_load_dwordx4 v64, s[16:19], s44 offen  lds
    s_add_u32 m0, s43, 6144
    s_mov_b32 s44, 1835008
    buffer_load_dwordx4 v64, s[16:19], s44 offen  lds
    s_add_u32 m0, s43, 7168
    s_mov_b32 s44, 1966080
    buffer_load_dwordx4 v64, s[16:19], s44 offen  lds
    s_waitcnt vmcnt(24)
    ds_read_b64_tr_b16 a[52:53], v65 offset:12288
    ds_read_b64_tr_b16 a[54:55], v65 offset:12544
    ds_read_b64_tr_b16 a[64:65], v65 offset:13312
    ds_read_b64_tr_b16 a[66:67], v65 offset:13568
    ds_read_b64_tr_b16 a[76:77], v65 offset:14336
    ds_read_b64_tr_b16 a[78:79], v65 offset:14592
    ds_read_b64_tr_b16 a[88:89], v65 offset:15360
    ds_read_b64_tr_b16 a[90:91], v65 offset:15616
    s_waitcnt lgkmcnt(8)
    s_add_u32 m0, s43, 8192
    s_mov_b32 s44, 1572864
    buffer_load_dwordx4 v64, s[20:23], s44 offen  lds
    s_add_u32 m0, s43, 9216
    s_mov_b32 s44, 1703936
    buffer_load_dwordx4 v64, s[20:23], s44 offen  lds
    s_add_u32 m0, s43, 10240
    s_mov_b32 s44, 1835008
    buffer_load_dwordx4 v64, s[20:23], s44 offen  lds
    s_add_u32 m0, s43, 11264
    s_mov_b32 s44, 1966080
    buffer_load_dwordx4 v64, s[20:23], s44 offen  lds
    s_waitcnt vmcnt(24)
    ds_read_b64_tr_b16 a[56:57], v66 offset:16384
    ds_read_b64_tr_b16 a[58:59], v66 offset:16640
    ds_read_b64_tr_b16 a[68:69], v66 offset:17408
    ds_read_b64_tr_b16 a[70:71], v66 offset:17664
    ds_read_b64_tr_b16 a[80:81], v66 offset:18432
    ds_read_b64_tr_b16 a[82:83], v66 offset:18688
    ds_read_b64_tr_b16 a[92:93], v66 offset:19456
    ds_read_b64_tr_b16 a[94:95], v66 offset:19712
    s_waitcnt lgkmcnt(8)
    s_add_u32 m0, s43, 12288
    s_mov_b32 s44, 1572864
    buffer_load_dwordx4 v64, s[12:15], s44 offen  lds
    s_add_u32 m0, s43, 13312
    s_mov_b32 s44, 1703936
    buffer_load_dwordx4 v64, s[12:15], s44 offen  lds
    s_add_u32 m0, s43, 14336
    s_mov_b32 s44, 1835008
    buffer_load_dwordx4 v64, s[12:15], s44 offen  lds
    s_add_u32 m0, s43, 15360
    s_mov_b32 s44, 1966080
    buffer_load_dwordx4 v64, s[12:15], s44 offen  lds
    s_waitcnt vmcnt(24)
    ds_read_b64_tr_b16 a[48:49], v65 offset:20480
    ds_read_b64_tr_b16 a[50:51], v65 offset:20736
    ds_read_b64_tr_b16 a[60:61], v65 offset:21504
    ds_read_b64_tr_b16 a[62:63], v65 offset:21760
    ds_read_b64_tr_b16 a[72:73], v65 offset:22528
    ds_read_b64_tr_b16 a[74:75], v65 offset:22784
    ds_read_b64_tr_b16 a[84:85], v65 offset:23552
    ds_read_b64_tr_b16 a[86:87], v65 offset:23808
    s_waitcnt lgkmcnt(8)
    s_add_u32 m0, s43, 16384
    s_mov_b32 s44, 2097152
    buffer_load_dwordx4 v64, s[16:19], s44 offen  lds
    s_add_u32 m0, s43, 17408
    s_mov_b32 s44, 2228224
    buffer_load_dwordx4 v64, s[16:19], s44 offen  lds
    s_add_u32 m0, s43, 18432
    s_mov_b32 s44, 2359296
    buffer_load_dwordx4 v64, s[16:19], s44 offen  lds
    s_add_u32 m0, s43, 19456
    s_mov_b32 s44, 2490368
    buffer_load_dwordx4 v64, s[16:19], s44 offen  lds
    s_waitcnt vmcnt(24)
    ds_read_b64_tr_b16 a[100:101], v65 offset:24576
    ds_read_b64_tr_b16 a[102:103], v65 offset:24832
    ds_read_b64_tr_b16 a[112:113], v65 offset:25600
    ds_read_b64_tr_b16 a[114:115], v65 offset:25856
    ds_read_b64_tr_b16 a[124:125], v65 offset:26624
    ds_read_b64_tr_b16 a[126:127], v65 offset:26880
    ds_read_b64_tr_b16 a[136:137], v65 offset:27648
    ds_read_b64_tr_b16 a[138:139], v65 offset:27904
    s_waitcnt lgkmcnt(8)
    s_add_u32 m0, s43, 20480
    s_mov_b32 s44, 2097152
    buffer_load_dwordx4 v64, s[20:23], s44 offen  lds
    s_add_u32 m0, s43, 21504
    s_mov_b32 s44, 2228224
    buffer_load_dwordx4 v64, s[20:23], s44 offen  lds
    s_add_u32 m0, s43, 22528
    s_mov_b32 s44, 2359296
    buffer_load_dwordx4 v64, s[20:23], s44 offen  lds
    s_add_u32 m0, s43, 23552
    s_mov_b32 s44, 2490368
    buffer_load_dwordx4 v64, s[20:23], s44 offen  lds
    s_waitcnt vmcnt(24)
    ds_read_b64_tr_b16 a[104:105], v66 offset:28672
    ds_read_b64_tr_b16 a[106:107], v66 offset:28928
    ds_read_b64_tr_b16 a[116:117], v66 offset:29696
    ds_read_b64_tr_b16 a[118:119], v66 offset:29952
    ds_read_b64_tr_b16 a[128:129], v66 offset:30720
    ds_read_b64_tr_b16 a[130:131], v66 offset:30976
    ds_read_b64_tr_b16 a[140:141], v66 offset:31744
    ds_read_b64_tr_b16 a[142:143], v66 offset:32000
    s_waitcnt lgkmcnt(8)
    s_add_u32 m0, s43, 24576
    s_mov_b32 s44, 2097152
    buffer_load_dwordx4 v64, s[12:15], s44 offen  lds
    s_add_u32 m0, s43, 25600
    s_mov_b32 s44, 2228224
    buffer_load_dwordx4 v64, s[12:15], s44 offen  lds
    s_add_u32 m0, s43, 26624
    s_mov_b32 s44, 2359296
    buffer_load_dwordx4 v64, s[12:15], s44 offen  lds
    s_add_u32 m0, s43, 27648
    s_mov_b32 s44, 2490368
    buffer_load_dwordx4 v64, s[12:15], s44 offen  lds
    s_waitcnt vmcnt(24)
    ds_read_b64_tr_b16 a[96:97], v65 offset:0
    ds_read_b64_tr_b16 a[98:99], v65 offset:256
    ds_read_b64_tr_b16 a[108:109], v65 offset:1024
    ds_read_b64_tr_b16 a[110:111], v65 offset:1280
    ds_read_b64_tr_b16 a[120:121], v65 offset:2048
    ds_read_b64_tr_b16 a[122:123], v65 offset:2304
    ds_read_b64_tr_b16 a[132:133], v65 offset:3072
    ds_read_b64_tr_b16 a[134:135], v65 offset:3328
    s_waitcnt lgkmcnt(8)
    s_add_u32 m0, s43, 28672
    s_mov_b32 s44, 2621440
    buffer_load_dwordx4 v64, s[16:19], s44 offen  lds
    s_add_u32 m0, s43, 29696
    s_mov_b32 s44, 2752512
    buffer_load_dwordx4 v64, s[16:19], s44 offen  lds
    s_add_u32 m0, s43, 30720
    s_mov_b32 s44, 2883584
    buffer_load_dwordx4 v64, s[16:19], s44 offen  lds
    s_add_u32 m0, s43, 31744
    s_mov_b32 s44, 3014656
    buffer_load_dwordx4 v64, s[16:19], s44 offen  lds
    s_waitcnt vmcnt(24)
    ds_read_b64_tr_b16 a[148:149], v65 offset:4096
    ds_read_b64_tr_b16 a[150:151], v65 offset:4352
    ds_read_b64_tr_b16 a[160:161], v65 offset:5120
    ds_read_b64_tr_b16 a[162:163], v65 offset:5376
    ds_read_b64_tr_b16 a[172:173], v65 offset:6144
    ds_read_b64_tr_b16 a[174:175], v65 offset:6400
    ds_read_b64_tr_b16 a[184:185], v65 offset:7168
    ds_read_b64_tr_b16 a[186:187], v65 offset:7424
    s_waitcnt lgkmcnt(8)
    s_add_u32 m0, s43, 0
    s_mov_b32 s44, 2621440
    buffer_load_dwordx4 v64, s[20:23], s44 offen  lds
    s_add_u32 m0, s43, 1024
    s_mov_b32 s44, 2752512
    buffer_load_dwordx4 v64, s[20:23], s44 offen  lds
    s_add_u32 m0, s43, 2048
    s_mov_b32 s44, 2883584
    buffer_load_dwordx4 v64, s[20:23], s44 offen  lds
    s_add_u32 m0, s43, 3072
    s_mov_b32 s44, 3014656
    buffer_load_dwordx4 v64, s[20:23], s44 offen  lds
    s_waitcnt vmcnt(24)
    ds_read_b64_tr_b16 a[152:153], v66 offset:8192
    ds_read_b64_tr_b16 a[154:155], v66 offset:8448
    ds_read_b64_tr_b16 a[164:165], v66 offset:9216
    ds_read_b64_tr_b16 a[166:167], v66 offset:9472
    ds_read_b64_tr_b16 a[176:177], v66 offset:10240
    ds_read_b64_tr_b16 a[178:179], v66 offset:10496
    ds_read_b64_tr_b16 a[188:189], v66 offset:11264
    ds_read_b64_tr_b16 a[190:191], v66 offset:11520
    s_waitcnt lgkmcnt(8)
    s_add_u32 m0, s43, 4096
    s_mov_b32 s44, 2621440
    buffer_load_dwordx4 v64, s[12:15], s44 offen  lds
    s_add_u32 m0, s43, 5120
    s_mov_b32 s44, 2752512
    buffer_load_dwordx4 v64, s[12:15], s44 offen  lds
    s_add_u32 m0, s43, 6144
    s_mov_b32 s44, 2883584
    buffer_load_dwordx4 v64, s[12:15], s44 offen  lds
    s_add_u32 m0, s43, 7168
    s_mov_b32 s44, 3014656
    buffer_load_dwordx4 v64, s[12:15], s44 offen  lds
    s_waitcnt vmcnt(24)
    ds_read_b64_tr_b16 a[144:145], v65 offset:12288
    ds_read_b64_tr_b16 a[146:147], v65 offset:12544
    ds_read_b64_tr_b16 a[156:157], v65 offset:13312
    ds_read_b64_tr_b16 a[158:159], v65 offset:13568
    ds_read_b64_tr_b16 a[168:169], v65 offset:14336
    ds_read_b64_tr_b16 a[170:171], v65 offset:14592
    ds_read_b64_tr_b16 a[180:181], v65 offset:15360
    ds_read_b64_tr_b16 a[182:183], v65 offset:15616
    s_waitcnt lgkmcnt(8)
    s_add_u32 m0, s43, 8192
    s_mov_b32 s44, 3145728
    buffer_load_dwordx4 v64, s[16:19], s44 offen  lds
    s_add_u32 m0, s43, 9216
    s_mov_b32 s44, 3276800
    buffer_load_dwordx4 v64, s[16:19], s44 offen  lds
    s_add_u32 m0, s43, 10240
    s_mov_b32 s44, 3407872
    buffer_load_dwordx4 v64, s[16:19], s44 offen  lds
    s_add_u32 m0, s43, 11264
    s_mov_b32 s44, 3538944
    buffer_load_dwordx4 v64, s[16:19], s44 offen  lds
    s_waitcnt vmcnt(24)
    ds_read_b64_tr_b16 a[196:197], v65 offset:16384
    ds_read_b64_tr_b16 a[198:199], v65 offset:16640
    ds_read_b64_tr_b16 a[208:209], v65 offset:17408
    ds_read_b64_tr_b16 a[210:211], v65 offset:17664
    ds_read_b64_tr_b16 a[220:221], v65 offset:18432
    ds_read_b64_tr_b16 a[222:223], v65 offset:18688
    ds_read_b64_tr_b16 a[232:233], v65 offset:19456
    ds_read_b64_tr_b16 a[234:235], v65 offset:19712
    s_waitcnt lgkmcnt(8)
    s_add_u32 m0, s43, 12288
    s_mov_b32 s44, 3145728
    buffer_load_dwordx4 v64, s[20:23], s44 offen  lds
    s_add_u32 m0, s43, 13312
    s_mov_b32 s44, 3276800
    buffer_load_dwordx4 v64, s[20:23], s44 offen  lds
    s_add_u32 m0, s43, 14336
    s_mov_b32 s44, 3407872
    buffer_load_dwordx4 v64, s[20:23], s44 offen  lds
    s_add_u32 m0, s43, 15360
    s_mov_b32 s44, 3538944
    buffer_load_dwordx4 v64, s[20:23], s44 offen  lds
    s_waitcnt vmcnt(24)
    ds_read_b64_tr_b16 a[200:201], v66 offset:20480
    ds_read_b64_tr_b16 a[202:203], v66 offset:20736
    ds_read_b64_tr_b16 a[212:213], v66 offset:21504
    ds_read_b64_tr_b16 a[214:215], v66 offset:21760
    ds_read_b64_tr_b16 a[224:225], v66 offset:22528
    ds_read_b64_tr_b16 a[226:227], v66 offset:22784
    ds_read_b64_tr_b16 a[236:237], v66 offset:23552
    ds_read_b64_tr_b16 a[238:239], v66 offset:23808
    s_waitcnt lgkmcnt(8)
    s_add_u32 m0, s43, 16384
    s_mov_b32 s44, 3145728
    buffer_load_dwordx4 v64, s[12:15], s44 offen  lds
    s_add_u32 m0, s43, 17408
    s_mov_b32 s44, 3276800
    buffer_load_dwordx4 v64, s[12:15], s44 offen  lds
    s_add_u32 m0, s43, 18432
    s_mov_b32 s44, 3407872
    buffer_load_dwordx4 v64, s[12:15], s44 offen  lds
    s_add_u32 m0, s43, 19456
    s_mov_b32 s44, 3538944
    buffer_load_dwordx4 v64, s[12:15], s44 offen  lds
    s_waitcnt vmcnt(24)
    ds_read_b64_tr_b16 a[192:193], v65 offset:24576
    ds_read_b64_tr_b16 a[194:195], v65 offset:24832
    ds_read_b64_tr_b16 a[204:205], v65 offset:25600
    ds_read_b64_tr_b16 a[206:207], v65 offset:25856
    ds_read_b64_tr_b16 a[216:217], v65 offset:26624
    ds_read_b64_tr_b16 a[218:219], v65 offset:26880
    ds_read_b64_tr_b16 a[228:229], v65 offset:27648
    ds_read_b64_tr_b16 a[230:231], v65 offset:27904
    s_waitcnt lgkmcnt(8)
    s_add_u32 m0, s43, 20480
    s_mov_b32 s44, 3670016
    buffer_load_dwordx4 v64, s[16:19], s44 offen  lds
    s_add_u32 m0, s43, 21504
    s_mov_b32 s44, 3801088
    buffer_load_dwordx4 v64, s[16:19], s44 offen  lds
    s_add_u32 m0, s43, 22528
    s_mov_b32 s44, 3932160
    buffer_load_dwordx4 v64, s[16:19], s44 offen  lds
    s_add_u32 m0, s43, 23552
    s_mov_b32 s44, 4063232
    buffer_load_dwordx4 v64, s[16:19], s44 offen  lds
    s_waitcnt vmcnt(24)
    ds_read_b64_tr_b16 a[244:245], v65 offset:28672
    ds_read_b64_tr_b16 a[246:247], v65 offset:28928
    ds_read_b64_tr_b16 v[80:81], v65 offset:29696
    ds_read_b64_tr_b16 v[82:83], v65 offset:29952
    ds_read_b64_tr_b16 v[92:93], v65 offset:30720
    ds_read_b64_tr_b16 v[94:95], v65 offset:30976
    ds_read_b64_tr_b16 v[104:105], v65 offset:31744
    ds_read_b64_tr_b16 v[106:107], v65 offset:32000
    s_waitcnt lgkmcnt(8)
    s_add_u32 m0, s43, 24576
    s_mov_b32 s44, 3670016
    buffer_load_dwordx4 v64, s[20:23], s44 offen  lds
    s_add_u32 m0, s43, 25600
    s_mov_b32 s44, 3801088
    buffer_load_dwordx4 v64, s[20:23], s44 offen  lds
    s_add_u32 m0, s43, 26624
    s_mov_b32 s44, 3932160
    buffer_load_dwordx4 v64, s[20:23], s44 offen  lds
    s_add_u32 m0, s43, 27648
    s_mov_b32 s44, 4063232
    buffer_load_dwordx4 v64, s[20:23], s44 offen  lds
    s_waitcnt vmcnt(24)
    ds_read_b64_tr_b16 a[248:249], v66 offset:0
    ds_read_b64_tr_b16 a[250:251], v66 offset:256
    ds_read_b64_tr_b16 v[84:85], v66 offset:1024
    ds_read_b64_tr_b16 v[86:87], v66 offset:1280
    ds_read_b64_tr_b16 v[96:97], v66 offset:2048
    ds_read_b64_tr_b16 v[98:99], v66 offset:2304
    ds_read_b64_tr_b16 v[108:109], v66 offset:3072
    ds_read_b64_tr_b16 v[110:111], v66 offset:3328
    s_waitcnt lgkmcnt(8)
    s_add_u32 m0, s43, 28672
    s_mov_b32 s44, 3670016
    buffer_load_dwordx4 v64, s[12:15], s44 offen  lds
    s_add_u32 m0, s43, 29696
    s_mov_b32 s44, 3801088
    buffer_load_dwordx4 v64, s[12:15], s44 offen  lds
    s_add_u32 m0, s43, 30720
    s_mov_b32 s44, 3932160
    buffer_load_dwordx4 v64, s[12:15], s44 offen  lds
    s_add_u32 m0, s43, 31744
    s_mov_b32 s44, 4063232
    buffer_load_dwordx4 v64, s[12:15], s44 offen  lds
    s_waitcnt vmcnt(24)
    ds_read_b64_tr_b16 a[240:241], v65 offset:4096
    ds_read_b64_tr_b16 a[242:243], v65 offset:4352
    ds_read_b64_tr_b16 a[252:253], v65 offset:5120
    ds_read_b64_tr_b16 a[254:255], v65 offset:5376
    ds_read_b64_tr_b16 v[88:89], v65 offset:6144
    ds_read_b64_tr_b16 v[90:91], v65 offset:6400
    ds_read_b64_tr_b16 v[100:101], v65 offset:7168
    ds_read_b64_tr_b16 v[102:103], v65 offset:7424
    s_waitcnt lgkmcnt(8)
    s_add_u32 m0, s43, 0
    s_mov_b32 s44, 4194304
    buffer_load_dwordx4 v64, s[16:19], s44 offen  lds
    s_add_u32 m0, s43, 1024
    s_mov_b32 s44, 4325376
    buffer_load_dwordx4 v64, s[16:19], s44 offen  lds
    s_add_u32 m0, s43, 2048
    s_mov_b32 s44, 4456448
    buffer_load_dwordx4 v64, s[16:19], s44 offen  lds
    s_add_u32 m0, s43, 3072
    s_mov_b32 s44, 4587520
    buffer_load_dwordx4 v64, s[16:19], s44 offen  lds
    s_waitcnt vmcnt(24)
    ds_read_b64_tr_b16 v[116:117], v65 offset:8192
    ds_read_b64_tr_b16 v[118:119], v65 offset:8448
    ds_read_b64_tr_b16 v[128:129], v65 offset:9216
    ds_read_b64_tr_b16 v[130:131], v65 offset:9472
    ds_read_b64_tr_b16 v[140:141], v65 offset:10240
    ds_read_b64_tr_b16 v[142:143], v65 offset:10496
    ds_read_b64_tr_b16 v[152:153], v65 offset:11264
    ds_read_b64_tr_b16 v[154:155], v65 offset:11520
    s_waitcnt lgkmcnt(8)
    s_add_u32 m0, s43, 4096
    s_mov_b32 s44, 4194304
    buffer_load_dwordx4 v64, s[20:23], s44 offen  lds
    s_add_u32 m0, s43, 5120
    s_mov_b32 s44, 4325376
    buffer_load_dwordx4 v64, s[20:23], s44 offen  lds
    s_add_u32 m0, s43, 6144
    s_mov_b32 s44, 4456448
    buffer_load_dwordx4 v64, s[20:23], s44 offen  lds
    s_add_u32 m0, s43, 7168
    s_mov_b32 s44, 4587520
    buffer_load_dwordx4 v64, s[20:23], s44 offen  lds
    s_waitcnt vmcnt(24)
    ds_read_b64_tr_b16 v[120:121], v66 offset:12288
    ds_read_b64_tr_b16 v[122:123], v66 offset:12544
    ds_read_b64_tr_b16 v[132:133], v66 offset:13312
    ds_read_b64_tr_b16 v[134:135], v66 offset:13568
    ds_read_b64_tr_b16 v[144:145], v66 offset:14336
    ds_read_b64_tr_b16 v[146:147], v66 offset:14592
    ds_read_b64_tr_b16 v[156:157], v66 offset:15360
    ds_read_b64_tr_b16 v[158:159], v66 offset:15616
    s_waitcnt lgkmcnt(8)
    s_add_u32 m0, s43, 8192
    s_mov_b32 s44, 4194304
    buffer_load_dwordx4 v64, s[12:15], s44 offen  lds
    s_add_u32 m0, s43, 9216
    s_mov_b32 s44, 4325376
    buffer_load_dwordx4 v64, s[12:15], s44 offen  lds
    s_add_u32 m0, s43, 10240
    s_mov_b32 s44, 4456448
    buffer_load_dwordx4 v64, s[12:15], s44 offen  lds
    s_add_u32 m0, s43, 11264
    s_mov_b32 s44, 4587520
    buffer_load_dwordx4 v64, s[12:15], s44 offen  lds
    s_waitcnt vmcnt(24)
    ds_read_b64_tr_b16 v[112:113], v65 offset:16384
    ds_read_b64_tr_b16 v[114:115], v65 offset:16640
    ds_read_b64_tr_b16 v[124:125], v65 offset:17408
    ds_read_b64_tr_b16 v[126:127], v65 offset:17664
    ds_read_b64_tr_b16 v[136:137], v65 offset:18432
    ds_read_b64_tr_b16 v[138:139], v65 offset:18688
    ds_read_b64_tr_b16 v[148:149], v65 offset:19456
    ds_read_b64_tr_b16 v[150:151], v65 offset:19712
    s_waitcnt vmcnt(20)
    ds_read_b64_tr_b16 v[164:165], v65 offset:20480
    ds_read_b64_tr_b16 v[166:167], v65 offset:20736
    ds_read_b64_tr_b16 v[176:177], v65 offset:21504
    ds_read_b64_tr_b16 v[178:179], v65 offset:21760
    ds_read_b64_tr_b16 v[188:189], v65 offset:22528
    ds_read_b64_tr_b16 v[190:191], v65 offset:22784
    ds_read_b64_tr_b16 v[200:201], v65 offset:23552
    ds_read_b64_tr_b16 v[202:203], v65 offset:23808
    s_waitcnt vmcnt(16)
    ds_read_b64_tr_b16 v[168:169], v66 offset:24576
    ds_read_b64_tr_b16 v[170:171], v66 offset:24832
    ds_read_b64_tr_b16 v[180:181], v66 offset:25600
    ds_read_b64_tr_b16 v[182:183], v66 offset:25856
    ds_read_b64_tr_b16 v[192:193], v66 offset:26624
    ds_read_b64_tr_b16 v[194:195], v66 offset:26880
    ds_read_b64_tr_b16 v[204:205], v66 offset:27648
    ds_read_b64_tr_b16 v[206:207], v66 offset:27904
    s_waitcnt vmcnt(12)
    ds_read_b64_tr_b16 v[160:161], v65 offset:28672
    ds_read_b64_tr_b16 v[162:163], v65 offset:28928
    ds_read_b64_tr_b16 v[172:173], v65 offset:29696
    ds_read_b64_tr_b16 v[174:175], v65 offset:29952
    ds_read_b64_tr_b16 v[184:185], v65 offset:30720
    ds_read_b64_tr_b16 v[186:187], v65 offset:30976
    ds_read_b64_tr_b16 v[196:197], v65 offset:31744
    ds_read_b64_tr_b16 v[198:199], v65 offset:32000
    s_waitcnt vmcnt(8)
    ds_read_b64_tr_b16 v[212:213], v65 offset:0
    ds_read_b64_tr_b16 v[214:215], v65 offset:256
    ds_read_b64_tr_b16 v[224:225], v65 offset:1024
    ds_read_b64_tr_b16 v[226:227], v65 offset:1280
    ds_read_b64_tr_b16 v[236:237], v65 offset:2048
    ds_read_b64_tr_b16 v[238:239], v65 offset:2304
    ds_read_b64_tr_b16 v[248:249], v65 offset:3072
    ds_read_b64_tr_b16 v[250:251], v65 offset:3328
    s_waitcnt vmcnt(4)
    ds_read_b64_tr_b16 v[216:217], v66 offset:4096
    ds_read_b64_tr_b16 v[218:219], v66 offset:4352
    ds_read_b64_tr_b16 v[228:229], v66 offset:5120
    ds_read_b64_tr_b16 v[230:231], v66 offset:5376
    ds_read_b64_tr_b16 v[240:241], v66 offset:6144
    ds_read_b64_tr_b16 v[242:243], v66 offset:6400
    ds_read_b64_tr_b16 v[252:253], v66 offset:7168
    ds_read_b64_tr_b16 v[254:255], v66 offset:7424
    s_waitcnt vmcnt(0)
    ds_read_b64_tr_b16 v[208:209], v65 offset:8192
    ds_read_b64_tr_b16 v[210:211], v65 offset:8448
    ds_read_b64_tr_b16 v[220:221], v65 offset:9216
    ds_read_b64_tr_b16 v[222:223], v65 offset:9472
    ds_read_b64_tr_b16 v[232:233], v65 offset:10240
    ds_read_b64_tr_b16 v[234:235], v65 offset:10496
    ds_read_b64_tr_b16 v[244:245], v65 offset:11264
    ds_read_b64_tr_b16 v[246:247], v65 offset:11520
    s_waitcnt lgkmcnt(0)
    s_waitcnt vmcnt(0) lgkmcnt(0)
    s_barrier
    v_mov_b32 v77, 163836
    s_cmp_lg_u32 s32, 0
    s_cbranch_scc1 Q_cm
    s_mov_b64 exec, 1
    ds_write_b32 v77, v79
    s_mov_b64 exec, -1
    s_waitcnt lgkmcnt(0)
Q_cm:
    s_barrier
    ds_read_b32 v77, v77
    s_waitcnt lgkmcnt(0)
    v_readfirstlane_b32 s94, v77
    s_barrier
    s_and_b32 s94, s94, s93
    s_cbranch_scc1 A_over
    s_cmp_lg_u32 s32, 0
    s_cbranch_scc1 Q_iw_ok
    s_mov_b32 s94, 40
Q_iw:
    buffer_load_dword v79, off, s[4:7], s94 sc1
    s_sub_u32 s95, s95, 1
    s_cmp_eq_u32 s95, 0
    s_cbranch_scc1 L_end
    s_waitcnt vmcnt(0)
    v_cmp_gt_u32 vcc, 32, v79
    s_cbranch_vccz Q_iw_ok
    s_sleep 1
    s_branch Q_iw
Q_iw_ok:
    s_barrier
Q_layer:
    s_mov_b32 s35, s34
    s_mov_b32 s40, 36864
    s_mov_b32 s38, 61440
    s_mov_b32 s39, 0
    s_mov_b32 s12, 0
    s_lshl_b32 s45, s35, 2
    s_add_u32 s45, s45, 3194880
    s_cmp_lg_u32 s96, 0
    s_cbranch_scc1 Q_ln
Q_x0:
    buffer_load_dword v8, off, s[8:11], s45 sc1
    s_sub_u32 s95, s95, 1
    s_cmp_eq_u32 s95, 0
    s_cbranch_scc1 L_end
    s_waitcnt vmcnt(0)
    v_cmp_gt_u32 vcc, 1, v8
    s_cbranch_vccz Q_x0_ok
    s_sleep 1
    s_branch Q_x0
Q_x0_ok:
    s_mul_i32 s24, s35, 36864
    s_mul_i32 s25, s32, 9216
    s_add_u32 s24, s24, s25
    s_add_u32 s24, s24, 4194304
    s_add_u32 m0, s25, 0
    s_add_u32 s26, s24, 0
    buffer_load_dwordx4 v0, s[8:11], s26 offen offset:0 sc1 lds
    buffer_load_dwordx4 v0, s[8:11], s26 offen offset:1024 sc1 lds
    buffer_load_dwordx4 v0, s[8:11], s26 offen offset:2048 sc1 lds
    buffer_load_dwordx4 v0, s[8:11], s26 offen offset:3072 sc1 lds
    s_add_u32 m0, s25, 4096
    s_add_u32 s26, s24, 4096
    buffer_load_dwordx4 v0, s[8:11], s26 offen offset:0 sc1 lds
    buffer_load_dwordx4 v0, s[8:11], s26 offen offset:1024 sc1 lds
    buffer_load_dwordx4 v0, s[8:11], s26 offen offset:2048 sc1 lds
    buffer_load_dwordx4 v0, s[8:11], s26 offen offset:3072 sc1 lds
    s_add_u32 m0, s25, 8192
    s_add_u32 s26, s24, 8192
    buffer_load_dwordx4 v0, s[8:11], s26 offen offset:0 sc1 lds
    s_waitcnt vmcnt(0)
    s_barrier
    s_branch Q_loop
Q_ln:
    s_sub_u32 s20, s8, 100663296
    s_subb_u32 s21, s9, 0
    s_mov_b32 s22, 100663296
    v_lshrrev_b32 v12, 4, v0
    s_mov_b32 s19, 16
    s_mov_b32 s24, 512
    s_lshl_b32 s17, s24, 3
    s_mul_i32 s18, s32, 9216
    v_and_b32 v13, 7, v12
    v_lshl_add_u32 v13, s32, 3, v13
    v_lshrrev_b32 v14, 3, v12
    v_mul_lo_u32 v10, v13, s19
    v_lshlrev_b32 v13, 4, v13
    v_lshl_add_u32 v13, v14, 9, v13
    v_add_u32 v11, 0, v13
    v_mul_lo_u32 v14, v14, s24
    v_add_u32 v10, v10, v14
    v_add_u32 v10, 12582912, v10
    s_add_u32 s18, s18, 36864
    s_mov_b32 s25, 0x3f803f80
    s_lshl_b32 s19, s35, 7
    s_add_u32 s19, s19, 3203072
Q_x1:
    buffer_load_dword v8, off, s[20:23], s19 sc1
    s_sub_u32 s95, s95, 1
    s_cmp_eq_u32 s95, 0
    s_cbranch_scc1 L_end
    s_waitcnt vmcnt(0)
    v_cmp_gt_u32 vcc, 5, v8
    s_cbranch_vccz Q_x1_ok
    s_sleep 1
    s_branch Q_x1
Q_x1_ok:
    s_mul_i32 s19, s35, 36864
    s_add_u32 m0, s18, 0
    s_nop 0
    buffer_load_dwordx4 v10, s[20:23], s19 offen sc1 lds
    s_add_u32 m0, s18, 1024
    s_add_u32 s19, s19, s17
    buffer_load_dwordx4 v10, s[20:23], s19 offen sc1 lds
    s_add_u32 m0, s18, 2048
    s_add_u32 s19, s19, s17
    buffer_load_dwordx4 v10, s[20:23], s19 offen sc1 lds
    s_add_u32 m0, s18, 3072
    s_add_u32 s19, s19, s17
    buffer_load_dwordx4 v10, s[20:23], s19 offen sc1 lds
    s_add_u32 m0, s18, 4096
    s_add_u32 s19, s19, s17
    buffer_load_dwordx4 v10, s[20:23], s19 offen sc1 lds
    s_add_u32 m0, s18, 5120
    s_add_u32 s19, s19, s17
    buffer_load_dwordx4 v10, s[20:23], s19 offen sc1 lds
    s_add_u32 m0, s18, 6144
    s_add_u32 s19, s19, s17
    buffer_load_dwordx4 v10, s[20:23], s19 offen sc1 lds
    s_add_u32 m0, s18, 7168
    s_add_u32 s19, s19, s17
    buffer_load_dwordx4 v10, s[20:23], s19 offen sc1 lds
    s_add_u32 m0, s18, 8192
    s_add_u32 s19, s19, s17
    buffer_load_dwordx4 v10, s[20:23], s19 offen sc1 lds
    s_waitcnt vmcnt(0)
    v_add_u32 v52, s18, v0
    ds_read_b128 v[16:19], v52 offset:0
    ds_read_b128 v[20:23], v52 offset:1024
    ds_read_b128 v[24:27], v52 offset:2048
    ds_read_b128 v[28:31], v52 offset:3072
    ds_read_b128 v[32:35], v52 offset:4096
    ds_read_b128 v[36:39], v52 offset:5120
    ds_read_b128 v[40:43], v52 offset:6144
    ds_read_b128 v[44:47], v52 offset:7168
    ds_read_b128 v[48:51], v52 offset:8192
    v_mov_b32 v52, 0
    v_mov_b32 v54, 0
    s_waitcnt lgkmcnt(8)
    v_dot2_f32_bf16 v52, v16, s25, v52
    v_dot2_f32_bf16 v54, v16, v16, v54
    v_dot2_f32_bf16 v52, v17, s25, v52
    v_dot2_f32_bf16 v54, v17, v17, v54
    v_dot2_f32_bf16 v52, v18, s25, v52
    v_dot2_f32_bf16 v54, v18, v18, v54
    v_dot2_f32_bf16 v52, v19, s25, v52
    v_dot2_f32_bf16 v54, v19, v19, v54
    s_waitcnt lgkmcnt(7)
    v_dot2_f32_bf16 v52, v20, s25, v52
    v_dot2_f32_bf16 v54, v20, v20, v54
    v_dot2_f32_bf16 v52, v21, s25, v52
    v_dot2_f32_bf16 v54, v21, v21, v54
    v_dot2_f32_bf16 v52, v22, s25, v52
    v_dot2_f32_bf16 v54, v22, v22, v54
    v_dot2_f32_bf16 v52, v23, s25, v52
    v_dot2_f32_bf16 v54, v23, v23, v54
    s_waitcnt lgkmcnt(6)
    v_dot2_f32_bf16 v52, v24, s25, v52
    v_dot2_f32_bf16 v54, v24, v24, v54
    v_dot2_f32_bf16 v52, v25, s25, v52
    v_dot2_f32_bf16 v54, v25, v25, v54
    v_dot2_f32_bf16 v52, v26, s25, v52
    v_dot2_f32_bf16 v54, v26, v26, v54
    v_dot2_f32_bf16 v52, v27, s25, v52
    v_dot2_f32_bf16 v54, v27, v27, v54
    s_waitcnt lgkmcnt(5)
    v_dot2_f32_bf16 v52, v28, s25, v52
    v_dot2_f32_bf16 v54, v28, v28, v54
    v_dot2_f32_bf16 v52, v29, s25, v52
    v_dot2_f32_bf16 v54, v29, v29, v54
    v_dot2_f32_bf16 v52, v30, s25, v52
    v_dot2_f32_bf16 v54, v30, v30, v54
    v_dot2_f32_bf16 v52, v31, s25, v52
    v_dot2_f32_bf16 v54, v31, v31, v54
    s_waitcnt lgkmcnt(4)
    v_dot2_f32_bf16 v52, v32, s25, v52
    v_dot2_f32_bf16 v54, v32, v32, v54
    v_dot2_f32_bf16 v52, v33, s25, v52
    v_dot2_f32_bf16 v54, v33, v33, v54
    v_dot2_f32_bf16 v52, v34, s25, v52
    v_dot2_f32_bf16 v54, v34, v34, v54
    v_dot2_f32_bf16 v52, v35, s25, v52
    v_dot2_f32_bf16 v54, v35, v35, v54
    s_waitcnt lgkmcnt(3)
    v_dot2_f32_bf16 v52, v36, s25, v52
    v_dot2_f32_bf16 v54, v36, v36, v54
    v_dot2_f32_bf16 v52, v37, s25, v52
    v_dot2_f32_bf16 v54, v37, v37, v54
    v_dot2_f32_bf16 v52, v38, s25, v52
    v_dot2_f32_bf16 v54, v38, v38, v54
    v_dot2_f32_bf16 v52, v39, s25, v52
    v_dot2_f32_bf16 v54, v39, v39, v54
    s_waitcnt lgkmcnt(2)
    v_dot2_f32_bf16 v52, v40, s25, v52
    v_dot2_f32_bf16 v54, v40, v40, v54
    v_dot2_f32_bf16 v52, v41, s25, v52
    v_dot2_f32_bf16 v54, v41, v41, v54
    v_dot2_f32_bf16 v52, v42, s25, v52
    v_dot2_f32_bf16 v54, v42, v42, v54
    v_dot2_f32_bf16 v52, v43, s25, v52
    v_dot2_f32_bf16 v54, v43, v43, v54
    s_waitcnt lgkmcnt(1)
    v_dot2_f32_bf16 v52, v44, s25, v52
    v_dot2_f32_bf16 v54, v44, v44, v54
    v_dot2_f32_bf16 v52, v45, s25, v52
    v_dot2_f32_bf16 v54, v45, v45, v54
    v_dot2_f32_bf16 v52, v46, s25, v52
    v_dot2_f32_bf16 v54, v46, v46, v54
    v_dot2_f32_bf16 v52, v47, s25, v52
    v_dot2_f32_bf16 v54, v47, v47, v54
    s_waitcnt lgkmcnt(0)
    v_dot2_f32_bf16 v52, v48, s25, v52
    v_dot2_f32_bf16 v54, v48, v48, v54
    v_dot2_f32_bf16 v52, v49, s25, v52
    v_dot2_f32_bf16 v54, v49, v49, v54
    v_dot2_f32_bf16 v52, v50, s25, v52
    v_dot2_f32_bf16 v54, v50, v50, v54
    v_dot2_f32_bf16 v52, v51, s25, v52
    v_dot2_f32_bf16 v54, v51, v51, v54
    s_nop 2
    v_add_f32_dpp v52, v52, v52 row_ror:8 row_mask:0xf bank_mask:0xf
    v_add_f32_dpp v54, v54, v54 row_ror:8 row_mask:0xf bank_mask:0xf
    v_mov_b32 v55, v52
    v_mov_b32 v53, v54
    s_nop 0
    v_permlane16_swap_b32 v52, v55
    v_permlane16_swap_b32 v54, v53
    v_add_f32 v52, v52, v55
    v_add_f32 v54, v54, v53
    v_mov_b32 v55, v52
    v_mov_b32 v53, v54
    s_nop 0
    v_permlane32_swap_b32 v52, v55
    v_permlane32_swap_b32 v54, v53
    v_add_f32 v52, v52, v55
    v_add_f32 v54, v54, v53
    v_mul_f32 v52, 0x3ae38e39, v52
    v_mul_f32 v54, 0x3ae38e39, v54
    v_fma_f32 v54, -v52, v52, v54
    v_max_f32 v54, 0, v54
    v_add_f32 v54, 0x3727c5ac, v54
    v_rsq_f32 v54, v54
    s_nop 0
    v_mul_f32 v55, v52, v54
    v_lshlrev_b32 v52, 16, v16
    v_and_b32 v53, 0xffff0000, v16
    v_pk_fma_f32 v[52:53], v[52:53], v[54:55], v[54:55] op_sel:[0,0,1] op_sel_hi:[1,0,1] neg_lo:[0,0,1] neg_hi:[0,0,1]
    s_nop 0
    v_cvt_pk_bf16_f32 v16, v52, v53
    v_lshlrev_b32 v52, 16, v17
    v_and_b32 v53, 0xffff0000, v17
    v_pk_fma_f32 v[52:53], v[52:53], v[54:55], v[54:55] op_sel:[0,0,1] op_sel_hi:[1,0,1] neg_lo:[0,0,1] neg_hi:[0,0,1]
    s_nop 0
    v_cvt_pk_bf16_f32 v17, v52, v53
    v_lshlrev_b32 v52, 16, v18
    v_and_b32 v53, 0xffff0000, v18
    v_pk_fma_f32 v[52:53], v[52:53], v[54:55], v[54:55] op_sel:[0,0,1] op_sel_hi:[1,0,1] neg_lo:[0,0,1] neg_hi:[0,0,1]
    s_nop 0
    v_cvt_pk_bf16_f32 v18, v52, v53
    v_lshlrev_b32 v52, 16, v19
    v_and_b32 v53, 0xffff0000, v19
    v_pk_fma_f32 v[52:53], v[52:53], v[54:55], v[54:55] op_sel:[0,0,1] op_sel_hi:[1,0,1] neg_lo:[0,0,1] neg_hi:[0,0,1]
    s_nop 0
    v_cvt_pk_bf16_f32 v19, v52, v53
    ds_write_b128 v11, v[16:19] offset:0
    v_lshlrev_b32 v52, 16, v20
    v_and_b32 v53, 0xffff0000, v20
    v_pk_fma_f32 v[52:53], v[52:53], v[54:55], v[54:55] op_sel:[0,0,1] op_sel_hi:[1,0,1] neg_lo:[0,0,1] neg_hi:[0,0,1]
    s_nop 0
    v_cvt_pk_bf16_f32 v20, v52, v53
    v_lshlrev_b32 v52, 16, v21
    v_and_b32 v53, 0xffff0000, v21
    v_pk_fma_f32 v[52:53], v[52:53], v[54:55], v[54:55] op_sel:[0,0,1] op_sel_hi:[1,0,1] neg_lo:[0,0,1] neg_hi:[0,0,1]
    s_nop 0
    v_cvt_pk_bf16_f32 v21, v52, v53
    v_lshlrev_b32 v52, 16, v22
    v_and_b32 v53, 0xffff0000, v22
    v_pk_fma_f32 v[52:53], v[52:53], v[54:55], v[54:55] op_sel:[0,0,1] op_sel_hi:[1,0,1] neg_lo:[0,0,1] neg_hi:[0,0,1]
    s_nop 0
    v_cvt_pk_bf16_f32 v22, v52, v53
    v_lshlrev_b32 v52, 16, v23
    v_and_b32 v53, 0xffff0000, v23
    v_pk_fma_f32 v[52:53], v[52:53], v[54:55], v[54:55] op_sel:[0,0,1] op_sel_hi:[1,0,1] neg_lo:[0,0,1] neg_hi:[0,0,1]
    s_nop 0
    v_cvt_pk_bf16_f32 v23, v52, v53
    ds_write_b128 v11, v[20:23] offset:4096
    v_lshlrev_b32 v52, 16, v24
    v_and_b32 v53, 0xffff0000, v24
    v_pk_fma_f32 v[52:53], v[52:53], v[54:55], v[54:55] op_sel:[0,0,1] op_sel_hi:[1,0,1] neg_lo:[0,0,1] neg_hi:[0,0,1]
    s_nop 0
    v_cvt_pk_bf16_f32 v24, v52, v53
    v_lshlrev_b32 v52, 16, v25
    v_and_b32 v53, 0xffff0000, v25
    v_pk_fma_f32 v[52:53], v[52:53], v[54:55], v[54:55] op_sel:[0,0,1] op_sel_hi:[1,0,1] neg_lo:[0,0,1] neg_hi:[0,0,1]
    s_nop 0
    v_cvt_pk_bf16_f32 v25, v52, v53
    v_lshlrev_b32 v52, 16, v26
    v_and_b32 v53, 0xffff0000, v26
    v_pk_fma_f32 v[52:53], v[52:53], v[54:55], v[54:55] op_sel:[0,0,1] op_sel_hi:[1,0,1] neg_lo:[0,0,1] neg_hi:[0,0,1]
    s_nop 0
    v_cvt_pk_bf16_f32 v26, v52, v53
    v_lshlrev_b32 v52, 16, v27
    v_and_b32 v53, 0xffff0000, v27
    v_pk_fma_f32 v[52:53], v[52:53], v[54:55], v[54:55] op_sel:[0,0,1] op_sel_hi:[1,0,1] neg_lo:[0,0,1] neg_hi:[0,0,1]
    s_nop 0
    v_cvt_pk_bf16_f32 v27, v52, v53
    ds_write_b128 v11, v[24:27] offset:8192
    v_lshlrev_b32 v52, 16, v28
    v_and_b32 v53, 0xffff0000, v28
    v_pk_fma_f32 v[52:53], v[52:53], v[54:55], v[54:55] op_sel:[0,0,1] op_sel_hi:[1,0,1] neg_lo:[0,0,1] neg_hi:[0,0,1]
    s_nop 0
    v_cvt_pk_bf16_f32 v28, v52, v53
    v_lshlrev_b32 v52, 16, v29
    v_and_b32 v53, 0xffff0000, v29
    v_pk_fma_f32 v[52:53], v[52:53], v[54:55], v[54:55] op_sel:[0,0,1] op_sel_hi:[1,0,1] neg_lo:[0,0,1] neg_hi:[0,0,1]
    s_nop 0
    v_cvt_pk_bf16_f32 v29, v52, v53
    v_lshlrev_b32 v52, 16, v30
    v_and_b32 v53, 0xffff0000, v30
    v_pk_fma_f32 v[52:53], v[52:53], v[54:55], v[54:55] op_sel:[0,0,1] op_sel_hi:[1,0,1] neg_lo:[0,0,1] neg_hi:[0,0,1]
    s_nop 0
    v_cvt_pk_bf16_f32 v30, v52, v53
    v_lshlrev_b32 v52, 16, v31
    v_and_b32 v53, 0xffff0000, v31
    v_pk_fma_f32 v[52:53], v[52:53], v[54:55], v[54:55] op_sel:[0,0,1] op_sel_hi:[1,0,1] neg_lo:[0,0,1] neg_hi:[0,0,1]
    s_nop 0
    v_cvt_pk_bf16_f32 v31, v52, v53
    ds_write_b128 v11, v[28:31] offset:12288
    v_lshlrev_b32 v52, 16, v32
    v_and_b32 v53, 0xffff0000, v32
    v_pk_fma_f32 v[52:53], v[52:53], v[54:55], v[54:55] op_sel:[0,0,1] op_sel_hi:[1,0,1] neg_lo:[0,0,1] neg_hi:[0,0,1]
    s_nop 0
    v_cvt_pk_bf16_f32 v32, v52, v53
    v_lshlrev_b32 v52, 16, v33
    v_and_b32 v53, 0xffff0000, v33
    v_pk_fma_f32 v[52:53], v[52:53], v[54:55], v[54:55] op_sel:[0,0,1] op_sel_hi:[1,0,1] neg_lo:[0,0,1] neg_hi:[0,0,1]
    s_nop 0
    v_cvt_pk_bf16_f32 v33, v52, v53
    v_lshlrev_b32 v52, 16, v34
    v_and_b32 v53, 0xffff0000, v34
    v_pk_fma_f32 v[52:53], v[52:53], v[54:55], v[54:55] op_sel:[0,0,1] op_sel_hi:[1,0,1] neg_lo:[0,0,1] neg_hi:[0,0,1]
    s_nop 0
    v_cvt_pk_bf16_f32 v34, v52, v53
    v_lshlrev_b32 v52, 16, v35
    v_and_b32 v53, 0xffff0000, v35
    v_pk_fma_f32 v[52:53], v[52:53], v[54:55], v[54:55] op_sel:[0,0,1] op_sel_hi:[1,0,1] neg_lo:[0,0,1] neg_hi:[0,0,1]
    s_nop 0
    v_cvt_pk_bf16_f32 v35, v52, v53
    ds_write_b128 v11, v[32:35] offset:16384
    v_lshlrev_b32 v52, 16, v36
    v_and_b32 v53, 0xffff0000, v36
    v_pk_fma_f32 v[52:53], v[52:53], v[54:55], v[54:55] op_sel:[0,0,1] op_sel_hi:[1,0,1] neg_lo:[0,0,1] neg_hi:[0,0,1]
    s_nop 0
    v_cvt_pk_bf16_f32 v36, v52, v53
    v_lshlrev_b32 v52, 16, v37
    v_and_b32 v53, 0xffff0000, v37
    v_pk_fma_f32 v[52:53], v[52:53], v[54:55], v[54:55] op_sel:[0,0,1] op_sel_hi:[1,0,1] neg_lo:[0,0,1] neg_hi:[0,0,1]
    s_nop 0
    v_cvt_pk_bf16_f32 v37, v52, v53
    v_lshlrev_b32 v52, 16, v38
    v_and_b32 v53, 0xffff0000, v38
    v_pk_fma_f32 v[52:53], v[52:53], v[54:55], v[54:55] op_sel:[0,0,1] op_sel_hi:[1,0,1] neg_lo:[0,0,1] neg_hi:[0,0,1]
    s_nop 0
    v_cvt_pk_bf16_f32 v38, v52, v53
    v_lshlrev_b32 v52, 16, v39
    v_and_b32 v53, 0xffff0000, v39
    v_pk_fma_f32 v[52:53], v[52:53], v[54:55], v[54:55] op_sel:[0,0,1] op_sel_hi:[1,0,1] neg_lo:[0,0,1] neg_hi:[0,0,1]
    s_nop 0
    v_cvt_pk_bf16_f32 v39, v52, v53
    ds_write_b128 v11, v[36:39] offset:20480
    v_lshlrev_b32 v52, 16, v40
    v_and_b32 v53, 0xffff0000, v40
    v_pk_fma_f32 v[52:53], v[52:53], v[54:55], v[54:55] op_sel:[0,0,1] op_sel_hi:[1,0,1] neg_lo:[0,0,1] neg_hi:[0,0,1]
    s_nop 0
    v_cvt_pk_bf16_f32 v40, v52, v53
    v_lshlrev_b32 v52, 16, v41
    v_and_b32 v53, 0xffff0000, v41
    v_pk_fma_f32 v[52:53], v[52:53], v[54:55], v[54:55] op_sel:[0,0,1] op_sel_hi:[1,0,1] neg_lo:[0,0,1] neg_hi:[0,0,1]
    s_nop 0
    v_cvt_pk_bf16_f32 v41, v52, v53
    v_lshlrev_b32 v52, 16, v42
    v_and_b32 v53, 0xffff0000, v42
    v_pk_fma_f32 v[52:53], v[52:53], v[54:55], v[54:55] op_sel:[0,0,1] op_sel_hi:[1,0,1] neg_lo:[0,0,1] neg_hi:[0,0,1]
    s_nop 0
    v_cvt_pk_bf16_f32 v42, v52, v53
    v_lshlrev_b32 v52, 16, v43
    v_and_b32 v53, 0xffff0000, v43
    v_pk_fma_f32 v[52:53], v[52:53], v[54:55], v[54:55] op_sel:[0,0,1] op_sel_hi:[1,0,1] neg_lo:[0,0,1] neg_hi:[0,0,1]
    s_nop 0
    v_cvt_pk_bf16_f32 v43, v52, v53
    ds_write_b128 v11, v[40:43] offset:24576
    v_lshlrev_b32 v52, 16, v44
    v_and_b32 v53, 0xffff0000, v44
    v_pk_fma_f32 v[52:53], v[52:53], v[54:55], v[54:55] op_sel:[0,0,1] op_sel_hi:[1,0,1] neg_lo:[0,0,1] neg_hi:[0,0,1]
    s_nop 0
    v_cvt_pk_bf16_f32 v44, v52, v53
    v_lshlrev_b32 v52, 16, v45
    v_and_b32 v53, 0xffff0000, v45
    v_pk_fma_f32 v[52:53], v[52:53], v[54:55], v[54:55] op_sel:[0,0,1] op_sel_hi:[1,0,1] neg_lo:[0,0,1] neg_hi:[0,0,1]
    s_nop 0
    v_cvt_pk_bf16_f32 v45, v52, v53
    v_lshlrev_b32 v52, 16, v46
    v_and_b32 v53, 0xffff0000, v46
    v_pk_fma_f32 v[52:53], v[52:53], v[54:55], v[54:55] op_sel:[0,0,1] op_sel_hi:[1,0,1] neg_lo:[0,0,1] neg_hi:[0,0,1]
    s_nop 0
    v_cvt_pk_bf16_f32 v46, v52, v53
    v_lshlrev_b32 v52, 16, v47
    v_and_b32 v53, 0xffff0000, v47
    v_pk_fma_f32 v[52:53], v[52:53], v[54:55], v[54:55] op_sel:[0,0,1] op_sel_hi:[1,0,1] neg_lo:[0,0,1] neg_hi:[0,0,1]
    s_nop 0
    v_cvt_pk_bf16_f32 v47, v52, v53
    ds_write_b128 v11, v[44:47] offset:28672
    v_lshlrev_b32 v52, 16, v48
    v_and_b32 v53, 0xffff0000, v48
    v_pk_fma_f32 v[52:53], v[52:53], v[54:55], v[54:55] op_sel:[0,0,1] op_sel_hi:[1,0,1] neg_lo:[0,0,1] neg_hi:[0,0,1]
    s_nop 0
    v_cvt_pk_bf16_f32 v48, v52, v53
    v_lshlrev_b32 v52, 16, v49
    v_and_b32 v53, 0xffff0000, v49
    v_pk_fma_f32 v[52:53], v[52:53], v[54:55], v[54:55] op_sel:[0,0,1] op_sel_hi:[1,0,1] neg_lo:[0,0,1] neg_hi:[0,0,1]
    s_nop 0
    v_cvt_pk_bf16_f32 v49, v52, v53
    v_lshlrev_b32 v52, 16, v50
    v_and_b32 v53, 0xffff0000, v50
    v_pk_fma_f32 v[52:53], v[52:53], v[54:55], v[54:55] op_sel:[0,0,1] op_sel_hi:[1,0,1] neg_lo:[0,0,1] neg_hi:[0,0,1]
    s_nop 0
    v_cvt_pk_bf16_f32 v50, v52, v53
    v_lshlrev_b32 v52, 16, v51
    v_and_b32 v53, 0xffff0000, v51
    v_pk_fma_f32 v[52:53], v[52:53], v[54:55], v[54:55] op_sel:[0,0,1] op_sel_hi:[1,0,1] neg_lo:[0,0,1] neg_hi:[0,0,1]
    s_nop 0
    v_cvt_pk_bf16_f32 v51, v52, v53
    ds_write_b128 v11, v[48:51] offset:32768
    s_waitcnt lgkmcnt(0)
    s_barrier
Q_loop:
    s_cmp_ge_u32 s35, 64
    s_cbranch_scc0 Q_gemm
    s_sub_u32 s36, s35, 6
    s_max_i32 s36, s36, 0
    s_mul_i32 s14, s36, 9216
    s_add_u32 s16, s14, 16785408
    s_lshl_b32 s15, s32, 10
    s_add_u32 s14, s14, s15
    s_add_u32 s14, s14, 16777216
    s_add_u32 s15, s14, 4096
    buffer_load_dwordx4 v[68:71], v0, s[8:11], s14 offen sc1
    buffer_load_dwordx4 v[72:75], v0, s[8:11], s15 offen sc1
    buffer_load_dwordx4 v[76:79], v0, s[8:11], s16 offen sc1
    s_branch Q_attn
Q_gemm:
    ds_read_b128 v[52:55], v0 offset:0
    ds_read_b128 v[56:59], v0 offset:1024
    ds_read_b128 v[48:51], v0 offset:2048
    s_waitcnt lgkmcnt(2)
    v_mfma_f32_32x32x16_bf16 v[60:75], a[4:7], v[52:55], 0
    ds_read_b128 v[44:47], v0 offset:3072
    v_mfma_f32_32x32x16_bf16 v[28:43], v[52:55], a[8:11], 0
    s_and_b32 s41, s35, 15
    s_lshl_b32 s41, s41, 5
    s_add_u32 s41, s41, s33
    s_lshl_b32 s41, s41, 2
    s_waitcnt lgkmcnt(2)
    v_mfma_f32_32x32x16_bf16 v[60:75], a[16:19], v[56:59], v[60:75]
    ds_read_b128 v[52:55], v0 offset:4096
    v_mfma_f32_32x32x16_bf16 v[28:43], v[56:59], a[20:23], v[28:43]
    s_add_u32 s41, s41, s32
    s_lshl_b32 s41, s41, 12
    s_add_u32 s41, s41, 33554432
    s_mul_i32 s46, s32, 6144
    s_waitcnt lgkmcnt(2)
    v_mfma_f32_32x32x16_bf16 v[60:75], a[28:31], v[48:51], v[60:75]
    ds_read_b128 v[56:59], v0 offset:5120
    v_mfma_f32_32x32x16_bf16 v[28:43], v[48:51], a[32:35], v[28:43]
    s_add_u32 s46, s46, s40
    v_add_u32 v10, s46, v0
    s_lshl_b32 s43, s33, 6
    s_add_u32 s43, s43, s35
    s_waitcnt lgkmcnt(2)
    v_mfma_f32_32x32x16_bf16 v[60:75], a[40:43], v[44:47], v[60:75]
    ds_read_b128 v[48:51], v0 offset:6144
    v_mfma_f32_32x32x16_bf16 v[28:43], v[44:47], a[44:47], v[28:43]
    s_lshl_b32 s43, s43, 2
    s_add_u32 s43, s43, 3149824
    s_add_u32 s42, s35, 3
    s_min_u32 s42, s42, 63
    s_waitcnt lgkmcnt(2)
    v_mfma_f32_32x32x16_bf16 v[60:75], a[52:55], v[52:55], v[60:75]
    ds_read_b128 v[44:47], v0 offset:7168
    v_mfma_f32_32x32x16_bf16 v[28:43], v[52:55], a[56:59], v[28:43]
    s_lshl_b32 s13, s42, 2
    s_add_u32 s13, s13, 3194880
    s_waitcnt lgkmcnt(2)
    v_mfma_f32_32x32x16_bf16 v[60:75], a[64:67], v[56:59], v[60:75]
    ds_read_b128 v[52:55], v0 offset:8192
    v_mfma_f32_32x32x16_bf16 v[28:43], v[56:59], a[68:71], v[28:43]
    s_waitcnt lgkmcnt(2)
    v_mfma_f32_32x32x16_bf16 v[60:75], a[76:79], v[48:51], v[60:75]
    ds_read_b128 v[56:59], v0 offset:9216
    v_mfma_f32_32x32x16_bf16 v[28:43], v[48:51], a[80:83], v[28:43]
    s_waitcnt lgkmcnt(2)
    v_mfma_f32_32x32x16_bf16 v[60:75], a[88:91], v[44:47], v[60:75]
    ds_read_b128 v[48:51], v0 offset:10240
    v_mfma_f32_32x32x16_bf16 v[28:43], v[44:47], a[92:95], v[28:43]
    s_waitcnt lgkmcnt(2)
    v_mfma_f32_32x32x16_bf16 v[60:75], a[100:103], v[52:55], v[60:75]
    ds_read_b128 v[44:47], v0 offset:11264
    v_mfma_f32_32x32x16_bf16 v[28:43], v[52:55], a[104:107], v[28:43]
    s_waitcnt lgkmcnt(2)
    v_mfma_f32_32x32x16_bf16 v[60:75], a[112:115], v[56:59], v[60:75]
    ds_read_b128 v[52:55], v0 offset:12288
    v_mfma_f32_32x32x16_bf16 v[28:43], v[56:59], a[116:119], v[28:43]
    s_waitcnt lgkmcnt(2)
    v_mfma_f32_32x32x16_bf16 v[60:75], a[124:127], v[48:51], v[60:75]
    ds_read_b128 v[56:59], v0 offset:13312
    v_mfma_f32_32x32x16_bf16 v[28:43], v[48:51], a[128:131], v[28:43]
    s_waitcnt lgkmcnt(2)
    v_mfma_f32_32x32x16_bf16 v[60:75], a[136:139], v[44:47], v[60:75]
    ds_read_b128 v[48:51], v0 offset:14336
    v_mfma_f32_32x32x16_bf16 v[28:43], v[44:47], a[140:143], v[28:43]
    s_waitcnt lgkmcnt(2)
    v_mfma_f32_32x32x16_bf16 v[60:75], a[148:151], v[52:55], v[60:75]
    ds_read_b128 v[44:47], v0 offset:15360
    v_mfma_f32_32x32x16_bf16 v[28:43], v[52:55], a[152:155], v[28:43]
    s_waitcnt lgkmcnt(2)
    v_mfma_f32_32x32x16_bf16 v[60:75], a[160:163], v[56:59], v[60:75]
    ds_read_b128 v[52:55], v0 offset:16384
    v_mfma_f32_32x32x16_bf16 v[28:43], v[56:59], a[164:167], v[28:43]
    s_waitcnt lgkmcnt(2)
    v_mfma_f32_32x32x16_bf16 v[60:75], a[172:175], v[48:51], v[60:75]
    ds_read_b128 v[56:59], v0 offset:17408
    v_mfma_f32_32x32x16_bf16 v[28:43], v[48:51], a[176:179], v[28:43]
    s_waitcnt lgkmcnt(2)
    v_mfma_f32_32x32x16_bf16 v[60:75], a[184:187], v[44:47], v[60:75]
    ds_read_b128 v[48:51], v0 offset:18432
    v_mfma_f32_32x32x16_bf16 v[28:43], v[44:47], a[188:191], v[28:43]
    s_waitcnt lgkmcnt(2)
    v_mfma_f32_32x32x16_bf16 v[60:75], a[196:199], v[52:55], v[60:75]
    ds_read_b128 v[44:47], v0 offset:19456
    v_mfma_f32_32x32x16_bf16 v[28:43], v[52:55], a[200:203], v[28:43]
    s_waitcnt lgkmcnt(2)
    v_mfma_f32_32x32x16_bf16 v[60:75], a[208:211], v[56:59], v[60:75]
    ds_read_b128 v[52:55], v0 offset:20480
    v_mfma_f32_32x32x16_bf16 v[28:43], v[56:59], a[212:215], v[28:43]
    s_waitcnt lgkmcnt(2)
    v_mfma_f32_32x32x16_bf16 v[60:75], a[220:223], v[48:51], v[60:75]
    ds_read_b128 v[56:59], v0 offset:21504
    v_mfma_f32_32x32x16_bf16 v[28:43], v[48:51], a[224:227], v[28:43]
    s_waitcnt lgkmcnt(2)
    v_mfma_f32_32x32x16_bf16 v[60:75], a[232:235], v[44:47], v[60:75]
    ds_read_b128 v[48:51], v0 offset:22528
    v_mfma_f32_32x32x16_bf16 v[28:43], v[44:47], a[236:239], v[28:43]
    s_waitcnt lgkmcnt(2)
    v_mfma_f32_32x32x16_bf16 v[60:75], a[244:247], v[52:55], v[60:75]
    ds_read_b128 v[44:47], v0 offset:23552
    v_mfma_f32_32x32x16_bf16 v[28:43], v[52:55], a[248:251], v[28:43]
    s_waitcnt lgkmcnt(2)
    v_mfma_f32_32x32x16_bf16 v[60:75], v[80:83], v[56:59], v[60:75]
    ds_read_b128 v[52:55], v0 offset:24576
    v_mfma_f32_32x32x16_bf16 v[28:43], v[56:59], v[84:87], v[28:43]
    s_waitcnt lgkmcnt(2)
    v_mfma_f32_32x32x16_bf16 v[60:75], v[92:95], v[48:51], v[60:75]
    ds_read_b128 v[56:59], v0 offset:25600
    v_mfma_f32_32x32x16_bf16 v[28:43], v[48:51], v[96:99], v[28:43]
    s_waitcnt vmcnt(0)
    s_barrier
    s_cmp_lg_u32 s32, 0
    s_cbranch_scc1 Q_so
    s_cmp_eq_u32 s39, 0
    s_cbranch_scc1 Q_so
    v_mov_b32 v8, 1
    s_mov_b64 exec, 1
    buffer_atomic_add v8, off, s[8:11], s39
    s_mov_b64 exec, -1
Q_so:
    s_mov_b32 s39, 0
    s_waitcnt lgkmcnt(2)
    v_mfma_f32_32x32x16_bf16 v[60:75], v[104:107], v[44:47], v[60:75]
    ds_read_b128 v[48:51], v0 offset:26624
    v_mfma_f32_32x32x16_bf16 v[28:43], v[44:47], v[108:111], v[28:43]
    s_waitcnt lgkmcnt(2)
    v_mfma_f32_32x32x16_bf16 v[60:75], v[116:119], v[52:55], v[60:75]
    ds_read_b128 v[44:47], v0 offset:27648
    v_mfma_f32_32x32x16_bf16 v[28:43], v[52:55], v[120:123], v[28:43]
    s_waitcnt lgkmcnt(2)
    v_mfma_f32_32x32x16_bf16 v[60:75], v[128:131], v[56:59], v[60:75]
    ds_read_b128 v[52:55], v0 offset:28672
    v_mfma_f32_32x32x16_bf16 v[28:43], v[56:59], v[132:135], v[28:43]
    s_waitcnt lgkmcnt(2)
    v_mfma_f32_32x32x16_bf16 v[60:75], v[140:143], v[48:51], v[60:75]
    ds_read_b128 v[56:59], v0 offset:29696
    v_mfma_f32_32x32x16_bf16 v[28:43], v[48:51], v[144:147], v[28:43]
    s_waitcnt lgkmcnt(2)
    v_mfma_f32_32x32x16_bf16 v[60:75], v[152:155], v[44:47], v[60:75]
    ds_read_b128 v[48:51], v0 offset:30720
    v_mfma_f32_32x32x16_bf16 v[28:43], v[44:47], v[156:159], v[28:43]
    s_waitcnt lgkmcnt(2)
    v_mfma_f32_32x32x16_bf16 v[60:75], v[164:167], v[52:55], v[60:75]
    ds_read_b128 v[44:47], v0 offset:31744
    v_mfma_f32_32x32x16_bf16 v[28:43], v[52:55], v[168:171], v[28:43]
    s_waitcnt lgkmcnt(2)
    v_mfma_f32_32x32x16_bf16 v[60:75], v[176:179], v[56:59], v[60:75]
    ds_read_b128 v[52:55], v0 offset:32768
    v_mfma_f32_32x32x16_bf16 v[28:43], v[56:59], v[180:183], v[28:43]
    s_waitcnt lgkmcnt(2)
    v_mfma_f32_32x32x16_bf16 v[60:75], v[188:191], v[48:51], v[60:75]
    ds_read_b128 v[56:59], v0 offset:33792
    v_mfma_f32_32x32x16_bf16 v[28:43], v[48:51], v[192:195], v[28:43]
    s_waitcnt lgkmcnt(2)
    v_mfma_f32_32x32x16_bf16 v[60:75], v[200:203], v[44:47], v[60:75]
    ds_read_b128 v[48:51], v0 offset:34816
    v_mfma_f32_32x32x16_bf16 v[28:43], v[44:47], v[204:207], v[28:43]
    s_waitcnt lgkmcnt(2)
    v_mfma_f32_32x32x16_bf16 v[60:75], v[212:215], v[52:55], v[60:75]
    ds_read_b128 v[44:47], v0 offset:35840
    v_mfma_f32_32x32x16_bf16 v[28:43], v[52:55], v[216:219], v[28:43]
    s_waitcnt lgkmcnt(2)
    v_mfma_f32_32x32x16_bf16 v[60:75], v[224:227], v[56:59], v[60:75]
    ds_read_b128 v[52:55], v0 offset:0
    v_mfma_f32_32x32x16_bf16 v[28:43], v[56:59], v[228:231], v[28:43]
    s_waitcnt lgkmcnt(2)
    v_mfma_f32_32x32x16_bf16 v[60:75], v[236:239], v[48:51], v[60:75]
    ds_read_b128 v[56:59], v0 offset:1024
    v_mfma_f32_32x32x16_bf16 v[28:43], v[48:51], v[240:243], v[28:43]
    s_waitcnt lgkmcnt(2)
    v_mfma_f32_32x32x16_bf16 v[60:75], v[248:251], v[44:47], v[60:75]
    ds_read_b128 v[48:51], v0 offset:2048
    v_mfma_f32_32x32x16_bf16 v[28:43], v[44:47], v[252:255], v[28:43]
    s_waitcnt lgkmcnt(2)
    v_mfma_f32_32x32x16_bf16 v[12:27], a[0:3], v[52:55], 0
    ds_read_b128 v[44:47], v0 offset:3072
    s_waitcnt lgkmcnt(2)
    v_mfma_f32_32x32x16_bf16 v[12:27], a[12:15], v[56:59], v[12:27]
    ds_read_b128 v[52:55], v0 offset:4096
    v_mul_f32 v60, s37, v60
    v_mul_f32 v61, s37, v61
    v_mul_f32 v62, s37, v62
    v_mul_f32 v63, s37, v63
    s_waitcnt lgkmcnt(2)
    v_mfma_f32_32x32x16_bf16 v[12:27], a[24:27], v[48:51], v[12:27]
    ds_read_b128 v[56:59], v0 offset:5120
    v_mul_f32 v64, s37, v64
    v_mul_f32 v65, s37, v65
    v_mul_f32 v66, s37, v66
    v_mul_f32 v67, s37, v67
    s_waitcnt lgkmcnt(2)
    v_mfma_f32_32x32x16_bf16 v[12:27], a[36:39], v[44:47], v[12:27]
    ds_read_b128 v[48:51], v0 offset:6144
    v_cvt_pk_bf16_f32 v60, v60, v61
    v_cvt_pk_bf16_f32 v61, v62, v63
    v_cvt_pk_bf16_f32 v62, v64, v65
    v_cvt_pk_bf16_f32 v63, v66, v67
    s_waitcnt lgkmcnt(2)
    v_mfma_f32_32x32x16_bf16 v[12:27], a[48:51], v[52:55], v[12:27]
    ds_read_b128 v[44:47], v0 offset:7168
    ds_write_b128 v10, v[60:63] offset:2048
    s_waitcnt lgkmcnt(3)
    v_mfma_f32_32x32x16_bf16 v[12:27], a[60:63], v[56:59], v[12:27]
    ds_read_b128 v[52:55], v0 offset:8192
    v_mul_f32 v68, s37, v68
    v_mul_f32 v69, s37, v69
    v_mul_f32 v70, s37, v70
    v_mul_f32 v71, s37, v71
    s_waitcnt lgkmcnt(3)
    v_mfma_f32_32x32x16_bf16 v[12:27], a[72:75], v[48:51], v[12:27]
    ds_read_b128 v[56:59], v0 offset:9216
    v_mul_f32 v72, s37, v72
    v_mul_f32 v73, s37, v73
    v_mul_f32 v74, s37, v74
    v_mul_f32 v75, s37, v75
    s_waitcnt lgkmcnt(3)
    v_mfma_f32_32x32x16_bf16 v[12:27], a[84:87], v[44:47], v[12:27]
    ds_read_b128 v[48:51], v0 offset:10240
    v_cvt_pk_bf16_f32 v60, v68, v69
    v_cvt_pk_bf16_f32 v61, v70, v71
    v_cvt_pk_bf16_f32 v62, v72, v73
    v_cvt_pk_bf16_f32 v63, v74, v75
    s_waitcnt lgkmcnt(2)
    v_mfma_f32_32x32x16_bf16 v[12:27], a[96:99], v[52:55], v[12:27]
    ds_read_b128 v[44:47], v0 offset:11264
    ds_write_b128 v10, v[60:63] offset:3072
    s_waitcnt lgkmcnt(3)
    v_mfma_f32_32x32x16_bf16 v[12:27], a[108:111], v[56:59], v[12:27]
    ds_read_b128 v[52:55], v0 offset:12288
    v_add_u32 v11, s46, v3
    ds_read_b128 v[64:67], v11
    ds_read_b128 v[60:63], v11 offset:32
    s_waitcnt lgkmcnt(5)
    v_mfma_f32_32x32x16_bf16 v[12:27], a[120:123], v[48:51], v[12:27]
    ds_read_b128 v[56:59], v0 offset:13312
    v_cvt_pk_bf16_f32 v28, v28, v29
    v_cvt_pk_bf16_f32 v29, v30, v31
    v_cvt_pk_bf16_f32 v30, v32, v33
    v_cvt_pk_bf16_f32 v31, v34, v35
    s_waitcnt lgkmcnt(5)
    v_mfma_f32_32x32x16_bf16 v[12:27], a[132:135], v[44:47], v[12:27]
    ds_read_b128 v[48:51], v0 offset:14336
    s_waitcnt lgkmcnt(3)
    buffer_store_dwordx4 v[64:67], v0, s[8:11], s41 offen offset:0 sc1
    v_mfma_f32_32x32x16_bf16 v[12:27], a[144:147], v[52:55], v[12:27]
    ds_read_b128 v[44:47], v0 offset:15360
    ds_write_b128 v10, v[28:31] offset:4096
    s_waitcnt lgkmcnt(3)
    v_mfma_f32_32x32x16_bf16 v[12:27], a[156:159], v[56:59], v[12:27]
    ds_read_b128 v[52:55], v0 offset:16384
    v_cvt_pk_bf16_f32 v28, v36, v37
    v_cvt_pk_bf16_f32 v29, v38, v39
    v_cvt_pk_bf16_f32 v30, v40, v41
    v_cvt_pk_bf16_f32 v31, v42, v43
    s_waitcnt lgkmcnt(3)
    v_mfma_f32_32x32x16_bf16 v[12:27], a[168:171], v[48:51], v[12:27]
    ds_read_b128 v[56:59], v0 offset:17408
    buffer_store_dwordx4 v[60:63], v0, s[8:11], s41 offen offset:1024 sc1
    s_waitcnt lgkmcnt(3)
    v_mfma_f32_32x32x16_bf16 v[12:27], a[180:183], v[44:47], v[12:27]
    ds_read_b128 v[48:51], v0 offset:18432
    ds_write_b128 v10, v[28:31] offset:5120
    s_waitcnt lgkmcnt(3)
    v_mfma_f32_32x32x16_bf16 v[12:27], a[192:195], v[52:55], v[12:27]
    ds_read_b128 v[44:47], v0 offset:19456
    v_add_u32 v11, s46, v4
    ds_read2_b64 v[28:31], v11 offset0:1 offset1:32
    ds_read2_b64 v[32:35], v11 offset0:0 offset1:33
    s_waitcnt lgkmcnt(5)
    v_mfma_f32_32x32x16_bf16 v[12:27], a[204:207], v[56:59], v[12:27]
    ds_read_b128 v[52:55], v0 offset:20480
    s_sub_u32 s36, s35, 6
    s_max_i32 s36, s36, 0
    s_mul_i32 s14, s36, 9216
    s_add_u32 s16, s14, 16785408
    s_waitcnt lgkmcnt(5)
    v_mfma_f32_32x32x16_bf16 v[12:27], a[216:219], v[48:51], v[12:27]
    ds_read_b128 v[56:59], v0 offset:21504
    s_waitcnt lgkmcnt(3)
    buffer_store_dwordx4 v[28:31], v0, s[8:11], s41 offen offset:2048 sc1
    v_mfma_f32_32x32x16_bf16 v[12:27], a[228:231], v[44:47], v[12:27]
    ds_read_b128 v[48:51], v0 offset:22528
    s_lshl_b32 s15, s32, 10
    s_add_u32 s14, s14, s15
    s_add_u32 s14, s14, 16777216
    s_add_u32 s15, s14, 4096
    s_waitcnt lgkmcnt(2)
    v_mfma_f32_32x32x16_bf16 v[12:27], a[240:243], v[52:55], v[12:27]
    ds_read_b128 v[44:47], v0 offset:23552
    buffer_store_dwordx4 v[32:35], v0, s[8:11], s41 offen offset:3072 sc1
    s_waitcnt lgkmcnt(2)
    v_mfma_f32_32x32x16_bf16 v[12:27], a[252:255], v[56:59], v[12:27]
    ds_read_b128 v[52:55], v0 offset:24576
    s_waitcnt lgkmcnt(2)
    v_mfma_f32_32x32x16_bf16 v[12:27], v[88:91], v[48:51], v[12:27]
    ds_read_b128 v[56:59], v0 offset:25600
    buffer_load_dword v8, off, s[8:11], s13 sc1
    s_waitcnt lgkmcnt(2)
    v_mfma_f32_32x32x16_bf16 v[12:27], v[100:103], v[44:47], v[12:27]
    ds_read_b128 v[48:51], v0 offset:26624
    s_waitcnt lgkmcnt(2)
    v_mfma_f32_32x32x16_bf16 v[12:27], v[112:115], v[52:55], v[12:27]
    ds_read_b128 v[44:47], v0 offset:27648
    s_waitcnt lgkmcnt(2)
    v_mfma_f32_32x32x16_bf16 v[12:27], v[124:127], v[56:59], v[12:27]
    ds_read_b128 v[52:55], v0 offset:28672
    buffer_load_dwordx4 v[68:71], v0, s[8:11], s14 offen sc1
    s_waitcnt lgkmcnt(2)
    v_mfma_f32_32x32x16_bf16 v[12:27], v[136:139], v[48:51], v[12:27]
    ds_read_b128 v[56:59], v0 offset:29696
    s_waitcnt lgkmcnt(2)
    v_mfma_f32_32x32x16_bf16 v[12:27], v[148:151], v[44:47], v[12:27]
    ds_read_b128 v[48:51], v0 offset:30720
    buffer_load_dwordx4 v[72:75], v0, s[8:11], s15 offen sc1
    s_waitcnt lgkmcnt(2)
    v_mfma_f32_32x32x16_bf16 v[12:27], v[160:163], v[52:55], v[12:27]
    ds_read_b128 v[44:47], v0 offset:31744
    s_waitcnt lgkmcnt(2)
    v_mfma_f32_32x32x16_bf16 v[12:27], v[172:175], v[56:59], v[12:27]
    ds_read_b128 v[52:55], v0 offset:32768
    buffer_load_dwordx4 v[76:79], v0, s[8:11], s16 offen sc1
    s_waitcnt lgkmcnt(2)
    v_mfma_f32_32x32x16_bf16 v[12:27], v[184:187], v[48:51], v[12:27]
    ds_read_b128 v[56:59], v0 offset:33792
    s_waitcnt lgkmcnt(2)
    v_mfma_f32_32x32x16_bf16 v[12:27], v[196:199], v[44:47], v[12:27]
    ds_read_b128 v[48:51], v0 offset:34816
    s_waitcnt lgkmcnt(2)
    v_mfma_f32_32x32x16_bf16 v[12:27], v[208:211], v[52:55], v[12:27]
    ds_read_b128 v[44:47], v0 offset:35840
    s_waitcnt lgkmcnt(2)
    v_mfma_f32_32x32x16_bf16 v[12:27], v[220:223], v[56:59], v[12:27]
    s_waitcnt lgkmcnt(1)
    v_mfma_f32_32x32x16_bf16 v[12:27], v[232:235], v[48:51], v[12:27]
    s_waitcnt lgkmcnt(0)
    v_mfma_f32_32x32x16_bf16 v[12:27], v[244:247], v[44:47], v[12:27]
    s_nop 11
    v_cvt_pk_bf16_f32 v12, v12, v13
    v_cvt_pk_bf16_f32 v13, v14, v15
    v_cvt_pk_bf16_f32 v14, v16, v17
    v_cvt_pk_bf16_f32 v15, v18, v19
    ds_write_b128 v10, v[12:15] offset:0
    v_cvt_pk_bf16_f32 v12, v20, v21
    v_cvt_pk_bf16_f32 v13, v22, v23
    v_cvt_pk_bf16_f32 v14, v24, v25
    v_cvt_pk_bf16_f32 v15, v26, v27
    ds_write_b128 v10, v[12:15] offset:1024
    s_mov_b32 s27, s42
    s_cmp_eq_u32 s32, 1
    s_cselect_b32 s12, s43, 0
    s_cmp_lt_u32 s35, 6
    s_cbranch_scc0 Q_attn
    s_waitcnt vmcnt(0) lgkmcnt(0)
    v_cmp_ne_u32 vcc, 0, v8
    s_barrier
    s_cmp_eq_u32 s12, 0
    s_cbranch_scc1 Q_k0k
    v_mov_b32 v8, 1
    s_mov_b64 exec, 1
    buffer_store_dword v8, off, s[8:11], s12 sc1
    s_mov_b64 exec, -1
    s_mov_b32 s12, 0
Q_k0k:
    s_cbranch_vccnz Q_k0_ok
Q_k0:
    buffer_load_dword v8, off, s[8:11], s13 sc1
    s_sub_u32 s95, s95, 1
    s_cmp_eq_u32 s95, 0
    s_cbranch_scc1 L_end
    s_waitcnt vmcnt(0)
    v_cmp_gt_u32 vcc, 1, v8
    s_cbranch_vccz Q_k0_ok
    s_sleep 1
    s_branch Q_k0
Q_k0_ok:
    s_mul_i32 s24, s27, 36864
    s_mul_i32 s25, s32, 9216
    s_add_u32 s24, s24, s25
    s_add_u32 s24, s24, 4194304
    s_add_u32 m0, s25, 0
    s_add_u32 s26, s24, 0
    buffer_load_dwordx4 v0, s[8:11], s26 offen offset:0 sc1 lds
    buffer_load_dwordx4 v0, s[8:11], s26 offen offset:1024 sc1 lds
    buffer_load_dwordx4 v0, s[8:11], s26 offen offset:2048 sc1 lds
    buffer_load_dwordx4 v0, s[8:11], s26 offen offset:3072 sc1 lds
    s_add_u32 m0, s25, 4096
    s_add_u32 s26, s24, 4096
    buffer_load_dwordx4 v0, s[8:11], s26 offen offset:0 sc1 lds
    buffer_load_dwordx4 v0, s[8:11], s26 offen offset:1024 sc1 lds
    buffer_load_dwordx4 v0, s[8:11], s26 offen offset:2048 sc1 lds
    buffer_load_dwordx4 v0, s[8:11], s26 offen offset:3072 sc1 lds
    s_add_u32 m0, s25, 8192
    s_add_u32 s26, s24, 8192
    buffer_load_dwordx4 v0, s[8:11], s26 offen offset:0 sc1 lds
    s_waitcnt vmcnt(0)
    s_barrier
    s_branch Q_next
Q_attn:
    s_and_b32 s43, s36, 63
    s_lshl_b32 s43, s43, 5
    s_add_u32 s43, s43, s33
    s_lshl_b32 s43, s43, 2
    s_add_u32 s43, s43, s32
    s_lshl_b32 s43, s43, 11
    s_add_u32 s43, s43, 67108864
    s_lshl_b32 s45, s32, 10
    v_add_u32 v10, s38, v0
    ds_read_b128 v[64:67], v10 offset:0
    ds_read_b128 v[52:55], v10 offset:2048
    ds_read_b128 v[48:51], v10 offset:1024
    ds_read_b128 v[44:47], v10 offset:3072
    ds_read_b128 v[60:63], v10 offset:6144
    ds_read_b128 v[56:59], v10 offset:8192
    s_waitcnt lgkmcnt(4)
    v_mfma_f32_32x32x16_bf16 v[12:27], v[52:55], v[64:67], 0
    ds_read_b128 v[64:67], v10 offset:7168
    ds_read_b128 v[52:55], v10 offset:9216
    s_waitcnt lgkmcnt(4)
    v_mfma_f32_32x32x16_bf16 v[12:27], v[44:47], v[48:51], v[12:27]
    ds_read_b128 v[48:51], v10 offset:12288
    ds_read_b128 v[44:47], v10 offset:14336
    s_waitcnt lgkmcnt(4)
    v_mfma_f32_32x32x16_bf16 v[12:27], v[56:59], v[60:63], v[12:27]
    ds_read_b128 v[60:63], v10 offset:13312
    ds_read_b128 v[56:59], v10 offset:15360
    s_waitcnt lgkmcnt(4)
    v_mfma_f32_32x32x16_bf16 v[12:27], v[52:55], v[64:67], v[12:27]
    ds_read_b128 v[64:67], v10 offset:18432
    ds_read_b128 v[52:55], v10 offset:20480
    s_waitcnt lgkmcnt(4)
    v_mfma_f32_32x32x16_bf16 v[12:27], v[44:47], v[48:51], v[12:27]
    ds_read_b128 v[48:51], v10 offset:19456
    ds_read_b128 v[44:47], v10 offset:21504
    s_waitcnt lgkmcnt(4)
    v_mfma_f32_32x32x16_bf16 v[12:27], v[56:59], v[60:63], v[12:27]
    s_waitcnt lgkmcnt(2)
    v_mfma_f32_32x32x16_bf16 v[12:27], v[52:55], v[64:67], v[12:27]
    s_waitcnt lgkmcnt(0)
    v_mfma_f32_32x32x16_bf16 v[12:27], v[44:47], v[48:51], v[12:27]
    s_waitcnt vmcnt(0) lgkmcnt(0)
    v_cmp_ne_u32 vcc, 0, v8
    s_barrier
    s_cmp_eq_u32 s12, 0
    s_cbranch_scc1 Q_k1k
    v_mov_b32 v8, 1
    s_mov_b64 exec, 1
    buffer_store_dword v8, off, s[8:11], s12 sc1
    s_mov_b64 exec, -1
    s_mov_b32 s12, 0
Q_k1k:
    s_cbranch_vccnz Q_k1_ok
Q_k1:
    buffer_load_dword v8, off, s[8:11], s13 sc1
    s_sub_u32 s95, s95, 1
    s_cmp_eq_u32 s95, 0
    s_cbranch_scc1 L_end
    s_waitcnt vmcnt(0)
    v_cmp_gt_u32 vcc, 1, v8
    s_cbranch_vccz Q_k1_ok
    s_sleep 1
    s_branch Q_k1
Q_k1_ok:
    s_add_u32 s47, s36, 1
    s_bfe_u32 s47, s47, 0x10001
    v_subrev_u32 v11, s45, v1
    s_cmp_eq_u32 s36, 0
    s_cbranch_scc1 Q_m0
Q_mc:
    v_bitop3_b32 v29, v68, v70, s47 bitop3:0x7e
    v_bitop3_b32 v28, v72, v74, s47 bitop3:0x7e
    v_or_b32 v29, v29, v28
    v_bitop3_b32 v28, v76, v78, s47 bitop3:0x7e
    v_bitop3_b32 v29, v29, v28, 1 bitop3:0xa8
    v_cmp_ne_u32 vcc, 0, v29
    s_cbranch_vccz Q_mw
Q_mp:
    buffer_load_dword v29, off, s[8:11], s15 sc1
    s_sub_u32 s95, s95, 1
    s_cmp_eq_u32 s95, 0
    s_cbranch_scc1 L_end
    s_waitcnt vmcnt(0)
    v_xor_b32 v29, s47, v29
    v_and_b32 v29, 1, v29
    v_cmp_ne_u32 vcc, 0, v29
    s_cbranch_vccnz Q_mp
    buffer_load_dwordx4 v[68:71], v0, s[8:11], s14 offen sc1
    buffer_load_dwordx4 v[72:75], v0, s[8:11], s15 offen sc1
    buffer_load_dwordx4 v[76:79], v0, s[8:11], s16 offen sc1
    s_sub_u32 s95, s95, 1
    s_cmp_eq_u32 s95, 0
    s_cbranch_scc1 L_end
    s_waitcnt vmcnt(0)
    s_branch Q_mc
Q_m0:
    v_bfe_u32 v29, v1, 4, 3
    v_mul_u32_u24 v29, 1152, v29
    v_bfe_u32 v28, v1, 7, 3
    v_lshl_add_u32 v29, v28, 4, v29
    s_lshl_b32 s45, s32, 7
    buffer_load_dwordx4 v[68:71], v29, s[28:31], s45 offen
    buffer_load_dwordx4 v[72:75], v29, s[28:31], s45 offen offset:512
    buffer_load_dwordx4 v[76:79], v29, s[28:31], 0 offen offset:1024
    s_waitcnt vmcnt(0)
Q_mw:
    ds_write_b128 v1, v[68:71]
    ds_write_b128 v1, v[72:75] offset:4096
    ds_write_b128 v11, v[76:79] offset:8192
    s_waitcnt lgkmcnt(0)
    s_barrier
    ds_read_b128 v[28:31], v2 offset:0
    ds_read_b128 v[52:55], v2 offset:256
    ds_read_b128 v[32:35], v2 offset:512
    ds_read_b128 v[48:51], v2 offset:768
    ds_read_b128 v[56:59], v2 offset:1024
    s_mul_i32 s24, s27, 36864
    s_mul_i32 s25, s32, 9216
    s_add_u32 s24, s24, s25
    s_add_u32 s24, s24, 4194304
    s_mul_i32 s45, s32, 6144
    s_waitcnt lgkmcnt(4)
    v_mfma_f32_16x16x32_bf16 v[40:43], a[4:7], v[28:31], 0
    ds_read_b128 v[60:63], v2 offset:1280
    v_cndmask_b32 v12, v7, v12, s[48:49]
    v_mfma_f32_16x16x32_bf16 v[36:39], v[28:31], a[8:11], 0
    v_cndmask_b32 v13, v7, v13, s[50:51]
    v_cndmask_b32 v14, v7, v14, s[52:53]
    s_waitcnt lgkmcnt(4)
    v_mfma_f32_16x16x32_bf16 v[40:43], a[16:19], v[52:55], v[40:43]
    ds_read_b128 v[28:31], v2 offset:1536
    v_cndmask_b32 v15, v7, v15, s[54:55]
    v_mfma_f32_16x16x32_bf16 v[36:39], v[52:55], a[20:23], v[36:39]
    s_add_u32 m0, s25, 0
    s_add_u32 s26, s24, 0
    buffer_load_dwordx4 v0, s[8:11], s26 offen offset:0 sc1 lds
    v_cndmask_b32 v16, v7, v16, s[56:57]
    v_cndmask_b32 v17, v7, v17, s[58:59]
    s_waitcnt lgkmcnt(4)
    v_mfma_f32_16x16x32_bf16 v[40:43], a[28:31], v[32:35], v[40:43]
    ds_read_b128 v[52:55], v2 offset:1792
    v_cndmask_b32 v18, v7, v18, s[60:61]
    v_mfma_f32_16x16x32_bf16 v[36:39], v[32:35], a[32:35], v[36:39]
    v_cndmask_b32 v19, v7, v19, s[62:63]
    v_cndmask_b32 v20, v7, v20, s[64:65]
    s_waitcnt lgkmcnt(4)
    v_mfma_f32_16x16x32_bf16 v[40:43], a[40:43], v[48:51], v[40:43]
    ds_read_b128 v[32:35], v2 offset:2048
    v_cndmask_b32 v21, v7, v21, s[66:67]
    v_mfma_f32_16x16x32_bf16 v[36:39], v[48:51], a[44:47], v[36:39]
    buffer_load_dwordx4 v0, s[8:11], s26 offen offset:1024 sc1 lds
    v_cndmask_b32 v22, v7, v22, s[68:69]
    v_cndmask_b32 v23, v7, v23, s[70:71]
    s_waitcnt lgkmcnt(4)
    v_mfma_f32_16x16x32_bf16 v[40:43], a[52:55], v[56:59], v[40:43]
    ds_read_b128 v[48:51], v2 offset:2304
    v_cndmask_b32 v24, v7, v24, s[72:73]
    v_mfma_f32_16x16x32_bf16 v[36:39], v[56:59], a[56:59], v[36:39]
    v_cndmask_b32 v25, v7, v25, s[74:75]
    v_cndmask_b32 v26, v7, v26, s[76:77]
    s_waitcnt lgkmcnt(4)
    v_mfma_f32_16x16x32_bf16 v[40:43], a[64:67], v[60:63], v[40:43]
    ds_read_b128 v[56:59], v2 offset:2560
    v_cndmask_b32 v27, v7, v27, s[78:79]
    v_mfma_f32_16x16x32_bf16 v[36:39], v[60:63], a[68:71], v[36:39]
    buffer_load_dwordx4 v0, s[8:11], s26 offen offset:2048 sc1 lds
    v_max3_f32 v11, v12, v13, v14
    v_max3_f32 v11, v11, v15, v16
    s_waitcnt lgkmcnt(4)
    v_mfma_f32_16x16x32_bf16 v[40:43], a[76:79], v[28:31], v[40:43]
    ds_read_b128 v[60:63], v2 offset:2816
    v_max3_f32 v11, v11, v17, v18
    v_mfma_f32_16x16x32_bf16 v[36:39], v[28:31], a[80:83], v[36:39]
    v_max3_f32 v11, v11, v19, v20
    v_max3_f32 v11, v11, v21, v22
    s_waitcnt lgkmcnt(4)
    v_mfma_f32_16x16x32_bf16 v[40:43], a[88:91], v[52:55], v[40:43]
    ds_read_b128 v[28:31], v2 offset:3072
    v_max3_f32 v11, v11, v23, v24
    v_mfma_f32_16x16x32_bf16 v[36:39], v[52:55], a[92:95], v[36:39]
    buffer_load_dwordx4 v0, s[8:11], s26 offen offset:3072 sc1 lds
    v_max3_f32 v11, v11, v25, v26
    v_max_f32 v11, v11, v27
    s_waitcnt lgkmcnt(4)
    v_mfma_f32_16x16x32_bf16 v[40:43], a[100:103], v[32:35], v[40:43]
    ds_read_b128 v[52:55], v2 offset:3328
    v_mov_b32 v46, v11
    v_mfma_f32_16x16x32_bf16 v[36:39], v[32:35], a[104:107], v[36:39]
    s_waitcnt lgkmcnt(4)
    v_add_u32 v64, s45, v10
    v_mfma_f32_16x16x32_bf16 v[40:43], a[112:115], v[48:51], v[40:43]
    ds_read_b128 v[32:35], v2 offset:3584
    v_permlane32_swap_b32 v11, v46
    v_mfma_f32_16x16x32_bf16 v[36:39], v[48:51], a[116:119], v[36:39]
    s_add_u32 m0, s25, 4096
    s_add_u32 s26, s24, 4096
    buffer_load_dwordx4 v0, s[8:11], s26 offen offset:0 sc1 lds
    s_waitcnt lgkmcnt(4)
    v_max_f32 v11, v11, v46
    v_mfma_f32_16x16x32_bf16 v[40:43], a[124:127], v[56:59], v[40:43]
    ds_read_b128 v[48:51], v2 offset:3840
    v_sub_f32 v12, v12, v11
    v_mfma_f32_16x16x32_bf16 v[36:39], v[56:59], a[128:131], v[36:39]
    s_waitcnt lgkmcnt(4)
    v_exp_f32 v12, v12
    v_mfma_f32_16x16x32_bf16 v[40:43], a[136:139], v[60:63], v[40:43]
    ds_read_b128 v[56:59], v2 offset:4096
    v_sub_f32 v13, v13, v11
    v_mfma_f32_16x16x32_bf16 v[36:39], v[60:63], a[140:143], v[36:39]
    buffer_load_dwordx4 v0, s[8:11], s26 offen offset:1024 sc1 lds
    s_waitcnt lgkmcnt(4)
    v_exp_f32 v13, v13
    v_mfma_f32_16x16x32_bf16 v[40:43], a[148:151], v[28:31], v[40:43]
    ds_read_b128 v[60:63], v2 offset:4352
    v_sub_f32 v14, v14, v11
    v_mfma_f32_16x16x32_bf16 v[36:39], v[28:31], a[152:155], v[36:39]
    s_waitcnt lgkmcnt(4)
    v_exp_f32 v14, v14
    v_mfma_f32_16x16x32_bf16 v[40:43], a[160:163], v[52:55], v[40:43]
    ds_read_b128 v[28:31], v2 offset:4608
    v_sub_f32 v15, v15, v11
    v_mfma_f32_16x16x32_bf16 v[36:39], v[52:55], a[164:167], v[36:39]
    buffer_load_dwordx4 v0, s[8:11], s26 offen offset:2048 sc1 lds
    s_waitcnt lgkmcnt(4)
    v_exp_f32 v15, v15
    v_mfma_f32_16x16x32_bf16 v[40:43], a[172:175], v[32:35], v[40:43]
    ds_read_b128 v[52:55], v2 offset:4864
    v_sub_f32 v16, v16, v11
    v_mfma_f32_16x16x32_bf16 v[36:39], v[32:35], a[176:179], v[36:39]
    s_waitcnt lgkmcnt(4)
    v_exp_f32 v16, v16
    v_mfma_f32_16x16x32_bf16 v[40:43], a[184:187], v[48:51], v[40:43]
    ds_read_b128 v[32:35], v2 offset:5120
    v_sub_f32 v17, v17, v11
    v_mfma_f32_16x16x32_bf16 v[36:39], v[48:51], a[188:191], v[36:39]
    buffer_load_dwordx4 v0, s[8:11], s26 offen offset:3072 sc1 lds
    s_waitcnt lgkmcnt(4)
    v_exp_f32 v17, v17
    v_mfma_f32_16x16x32_bf16 v[40:43], a[196:199], v[56:59], v[40:43]
    ds_read_b128 v[48:51], v2 offset:5376
    v_sub_f32 v18, v18, v11
    v_mfma_f32_16x16x32_bf16 v[36:39], v[56:59], a[200:203], v[36:39]
    s_waitcnt lgkmcnt(4)
    v_exp_f32 v18, v18
    v_mfma_f32_16x16x32_bf16 v[40:43], a[208:211], v[60:63], v[40:43]
    ds_read_b128 v[56:59], v2 offset:5632
    v_sub_f32 v19, v19, v11
    v_mfma_f32_16x16x32_bf16 v[36:39], v[60:63], a[212:215], v[36:39]
    s_add_u32 m0, s25, 8192
    s_add_u32 s26, s24, 8192
    buffer_load_dwordx4 v0, s[8:11], s26 offen offset:0 sc1 lds
    s_waitcnt lgkmcnt(4)
    v_exp_f32 v19, v19
    v_mfma_f32_16x16x32_bf16 v[40:43], a[220:223], v[28:31], v[40:43]
    ds_read_b128 v[60:63], v2 offset:5888
    v_sub_f32 v20, v20, v11
    v_mfma_f32_16x16x32_bf16 v[36:39], v[28:31], a[224:227], v[36:39]
    s_waitcnt lgkmcnt(4)
    v_exp_f32 v20, v20
    v_mfma_f32_16x16x32_bf16 v[40:43], a[232:235], v[52:55], v[40:43]
    ds_read_b128 v[28:31], v2 offset:6144
    v_sub_f32 v21, v21, v11
    v_mfma_f32_16x16x32_bf16 v[36:39], v[52:55], a[236:239], v[36:39]
    s_waitcnt lgkmcnt(4)
    v_exp_f32 v21, v21
    v_mfma_f32_16x16x32_bf16 v[40:43], a[244:247], v[32:35], v[40:43]
    ds_read_b128 v[52:55], v2 offset:6400
    v_sub_f32 v22, v22, v11
    v_mfma_f32_16x16x32_bf16 v[36:39], v[32:35], a[248:251], v[36:39]
    s_waitcnt lgkmcnt(4)
    v_exp_f32 v22, v22
    v_mfma_f32_16x16x32_bf16 v[40:43], v[80:83], v[48:51], v[40:43]
    ds_read_b128 v[32:35], v2 offset:6656
    v_sub_f32 v23, v23, v11
    v_mfma_f32_16x16x32_bf16 v[36:39], v[48:51], v[84:87], v[36:39]
    s_waitcnt lgkmcnt(4)
    v_exp_f32 v23, v23
    v_mfma_f32_16x16x32_bf16 v[40:43], v[92:95], v[56:59], v[40:43]
    ds_read_b128 v[48:51], v2 offset:6912
    v_sub_f32 v24, v24, v11
    v_mfma_f32_16x16x32_bf16 v[36:39], v[56:59], v[96:99], v[36:39]
    s_waitcnt lgkmcnt(4)
    v_exp_f32 v24, v24
    v_mfma_f32_16x16x32_bf16 v[40:43], v[104:107], v[60:63], v[40:43]
    ds_read_b128 v[56:59], v2 offset:7168
    v_sub_f32 v25, v25, v11
    v_mfma_f32_16x16x32_bf16 v[36:39], v[60:63], v[108:111], v[36:39]
    s_waitcnt lgkmcnt(4)
    v_exp_f32 v25, v25
    v_mfma_f32_16x16x32_bf16 v[40:43], v[116:119], v[28:31], v[40:43]
    ds_read_b128 v[60:63], v2 offset:7424
    v_sub_f32 v26, v26, v11
    v_mfma_f32_16x16x32_bf16 v[36:39], v[28:31], v[120:123], v[36:39]
    s_waitcnt lgkmcnt(4)
    v_exp_f32 v26, v26
    v_mfma_f32_16x16x32_bf16 v[40:43], v[128:131], v[52:55], v[40:43]
    ds_read_b128 v[28:31], v2 offset:7680
    v_sub_f32 v27, v27, v11
    v_mfma_f32_16x16x32_bf16 v[36:39], v[52:55], v[132:135], v[36:39]
    s_waitcnt lgkmcnt(4)
    v_exp_f32 v27, v27
    v_mfma_f32_16x16x32_bf16 v[40:43], v[140:143], v[32:35], v[40:43]
    ds_read_b128 v[52:55], v2 offset:7936
    v_add_f32 v70, v12, v13
    v_mfma_f32_16x16x32_bf16 v[36:39], v[32:35], v[144:147], v[36:39]
    v_add_f32 v70, v70, v14
    v_add_f32 v70, v70, v15
    s_waitcnt lgkmcnt(4)
    v_mfma_f32_16x16x32_bf16 v[40:43], v[152:155], v[48:51], v[40:43]
    ds_read_b128 v[32:35], v2 offset:8192
    v_add_f32 v70, v70, v16
    v_mfma_f32_16x16x32_bf16 v[36:39], v[48:51], v[156:159], v[36:39]
    v_add_f32 v70, v70, v17
    v_add_f32 v70, v70, v18
    s_waitcnt lgkmcnt(4)
    v_mfma_f32_16x16x32_bf16 v[40:43], v[164:167], v[56:59], v[40:43]
    ds_read_b128 v[48:51], v2 offset:8448
    v_add_f32 v70, v70, v19
    v_mfma_f32_16x16x32_bf16 v[36:39], v[56:59], v[168:171], v[36:39]
    v_add_f32 v70, v70, v20
    v_add_f32 v70, v70, v21
    s_waitcnt lgkmcnt(4)
    v_mfma_f32_16x16x32_bf16 v[40:43], v[176:179], v[60:63], v[40:43]
    ds_read_b128 v[56:59], v2 offset:8704
    v_add_f32 v70, v70, v22
    v_mfma_f32_16x16x32_bf16 v[36:39], v[60:63], v[180:183], v[36:39]
    v_add_f32 v70, v70, v23
    v_add_f32 v70, v70, v24
    s_waitcnt lgkmcnt(4)
    v_mfma_f32_16x16x32_bf16 v[40:43], v[188:191], v[28:31], v[40:43]
    ds_read_b128 v[60:63], v2 offset:8960
    v_add_f32 v70, v70, v25
    v_mfma_f32_16x16x32_bf16 v[36:39], v[28:31], v[192:195], v[36:39]
    v_add_f32 v70, v70, v26
    v_add_f32 v70, v70, v27
    s_waitcnt lgkmcnt(4)
    v_mfma_f32_16x16x32_bf16 v[40:43], v[200:203], v[52:55], v[40:43]
    ds_read_b128 v[44:47], v64 offset:4096
    v_cvt_pk_bf16_f32 v28, v12, v13
    v_mfma_f32_16x16x32_bf16 v[36:39], v[52:55], v[204:207], v[36:39]
    v_cvt_pk_bf16_f32 v29, v14, v15
    v_cvt_pk_bf16_f32 v30, v16, v17
    s_waitcnt lgkmcnt(4)
    v_mfma_f32_16x16x32_bf16 v[40:43], v[212:215], v[32:35], v[40:43]
    ds_read_b128 v[52:55], v64 offset:5120
    v_cvt_pk_bf16_f32 v31, v18, v19
    v_mfma_f32_16x16x32_bf16 v[36:39], v[32:35], v[216:219], v[36:39]
    v_cvt_pk_bf16_f32 v32, v20, v21
    v_cvt_pk_bf16_f32 v33, v22, v23
    s_waitcnt lgkmcnt(4)
    v_mfma_f32_16x16x32_bf16 v[40:43], v[224:227], v[48:51], v[40:43]
    ds_read_b128 v[64:67], v10 offset:0
    v_cvt_pk_bf16_f32 v34, v24, v25
    v_mfma_f32_16x16x32_bf16 v[36:39], v[48:51], v[228:231], v[36:39]
    s_waitcnt lgkmcnt(4)
    v_cvt_pk_bf16_f32 v35, v26, v27
    v_mfma_f32_16x16x32_bf16 v[40:43], v[236:239], v[56:59], v[40:43]
    ds_read_b128 v[48:51], v10 offset:1024
    v_mfma_f32_16x16x32_bf16 v[36:39], v[56:59], v[240:243], v[36:39]
    s_waitcnt lgkmcnt(4)
    v_mfma_f32_16x16x32_bf16 v[40:43], v[248:251], v[60:63], v[40:43]
    v_mfma_f32_16x16x32_bf16 v[36:39], v[60:63], v[252:255], v[36:39]
    s_waitcnt lgkmcnt(3)
    v_mfma_f32_32x32x16_bf16 v[12:27], v[44:47], v[28:31], 0
    v_mul_f32 v40, s37, v40
    v_mul_f32 v41, s37, v41
    v_mul_f32 v42, s37, v42
    v_mul_f32 v43, s37, v43
    v_cvt_pk_bf16_f32 v40, v40, v41
    v_cvt_pk_bf16_f32 v41, v42, v43
    ds_write_b64 v6, v[40:41]
    s_waitcnt lgkmcnt(3)
    v_mfma_f32_32x32x16_bf16 v[12:27], v[52:55], v[32:35], v[12:27]
    v_cvt_pk_bf16_f32 v68, v36, v37
    v_cvt_pk_bf16_f32 v69, v38, v39
    s_waitcnt lgkmcnt(0)
    s_barrier
    ds_read_b128 v[52:55], v5 offset:0
    ds_read_b128 v[44:47], v5 offset:256
    ds_read_b128 v[60:63], v10 offset:6144
    ds_read_b128 v[56:59], v5 offset:512
    s_waitcnt lgkmcnt(3)
    v_mfma_f32_32x32x16_bf16 v[28:43], v[52:55], v[64:67], 0
    ds_read_b128 v[64:67], v10 offset:7168
    ds_read_b128 v[52:55], v5 offset:768
    s_waitcnt lgkmcnt(4)
    v_mfma_f32_32x32x16_bf16 v[28:43], v[44:47], v[48:51], v[28:43]
    ds_read_b128 v[48:51], v10 offset:12288
    ds_read_b128 v[44:47], v5 offset:1024
    s_waitcnt lgkmcnt(4)
    v_mfma_f32_32x32x16_bf16 v[28:43], v[56:59], v[60:63], v[28:43]
    ds_read_b128 v[60:63], v10 offset:13312
    ds_read_b128 v[56:59], v5 offset:1280
    s_waitcnt lgkmcnt(4)
    v_mfma_f32_32x32x16_bf16 v[28:43], v[52:55], v[64:67], v[28:43]
    ds_read_b128 v[64:67], v10 offset:18432
    ds_read_b128 v[52:55], v5 offset:1536
    s_waitcnt lgkmcnt(4)
    v_mfma_f32_32x32x16_bf16 v[28:43], v[44:47], v[48:51], v[28:43]
    ds_read_b128 v[48:51], v10 offset:19456
    ds_read_b128 v[44:47], v5 offset:1792
    s_waitcnt lgkmcnt(4)
    v_mfma_f32_32x32x16_bf16 v[28:43], v[56:59], v[60:63], v[28:43]
    s_waitcnt lgkmcnt(2)
    v_mfma_f32_32x32x16_bf16 v[28:43], v[52:55], v[64:67], v[28:43]
    s_waitcnt lgkmcnt(0)
    v_mfma_f32_32x32x16_bf16 v[28:43], v[44:47], v[48:51], v[28:43]
    s_waitcnt vmcnt(0)
    s_barrier
    s_nop 9
    v_max3_f32 v10, v11, v28, v29
    v_max3_f32 v10, v10, v30, v31
    v_mov_b32 v46, v10
    s_nop 1
    v_permlane32_swap_b32 v10, v46
    v_max_f32 v10, v10, v46
    v_sub_f32 v28, v28, v10
    v_sub_f32 v29, v29, v10
    v_sub_f32 v30, v30, v10
    v_sub_f32 v31, v31, v10
    v_sub_f32 v11, v11, v10
    v_exp_f32 v28, v28
    v_exp_f32 v29, v29
    v_exp_f32 v30, v30
    v_exp_f32 v31, v31
    v_exp_f32 v11, v11
    v_cvt_pk_bf16_f32 v44, v28, v29
    v_cvt_pk_bf16_f32 v45, v30, v31
    v_add_f32 v46, v28, v29
    v_add_f32 v46, v46, v30
    v_add_f32 v46, v46, v31
    v_mfma_f32_32x32x8_bf16 v[28:43], v[68:69], v[44:45], 0
    v_fma_f32 v70, v70, v11, v46
    v_mov_b32 v46, v70
    s_nop 1
    v_permlane32_swap_b32 v70, v46
    v_add_f32 v70, v70, v46
    v_rcp_f32 v70, v70
    s_nop 0
    v_mul_f32 v11, v11, v70
    v_mul_f32 v12, v12, v11
    v_mul_f32 v13, v13, v11
    v_mul_f32 v14, v14, v11
    v_mul_f32 v15, v15, v11
    v_mul_f32 v16, v16, v11
    v_mul_f32 v17, v17, v11
    v_mul_f32 v18, v18, v11
    v_mul_f32 v19, v19, v11
    v_mul_f32 v20, v20, v11
    v_mul_f32 v21, v21, v11
    v_mul_f32 v22, v22, v11
    v_mul_f32 v23, v23, v11
    v_mul_f32 v24, v24, v11
    v_mul_f32 v25, v25, v11
    v_mul_f32 v26, v26, v11
    v_mul_f32 v27, v27, v11
    v_fma_f32 v12, v28, v70, v12
    v_fma_f32 v13, v29, v70, v13
    v_fma_f32 v14, v30, v70, v14
    v_fma_f32 v15, v31, v70, v15
    v_fma_f32 v16, v32, v70, v16
    v_fma_f32 v17, v33, v70, v17
    v_fma_f32 v18, v34, v70, v18
    v_fma_f32 v19, v35, v70, v19
    v_cvt_pk_bf16_f32 v12, v12, v13
    v_cvt_pk_bf16_f32 v13, v14, v15
    v_cvt_pk_bf16_f32 v14, v16, v17
    v_cvt_pk_bf16_f32 v15, v18, v19
    buffer_store_dwordx4 v[12:15], v0, s[8:11], s43 offen offset:0 sc1
    v_fma_f32 v20, v36, v70, v20
    v_fma_f32 v21, v37, v70, v21
    v_fma_f32 v22, v38, v70, v22
    v_fma_f32 v23, v39, v70, v23
    v_fma_f32 v24, v40, v70, v24
    v_fma_f32 v25, v41, v70, v25
    v_fma_f32 v26, v42, v70, v26
    v_fma_f32 v27, v43, v70, v27
    v_cvt_pk_bf16_f32 v12, v20, v21
    v_cvt_pk_bf16_f32 v13, v22, v23
    v_cvt_pk_bf16_f32 v14, v24, v25
    v_cvt_pk_bf16_f32 v15, v26, v27
    buffer_store_dwordx4 v[12:15], v0, s[8:11], s43 offen offset:1024 sc1
    s_lshl_b32 s39, s36, 7
    s_add_u32 s39, s39, 3170304
    s_cmp_ge_u32 s35, 61
    s_cbranch_scc0 Q_next
    s_waitcnt vmcnt(0)
    s_barrier
    s_cmp_lg_u32 s32, 0
    s_cbranch_scc1 Q_so3
    s_cmp_eq_u32 s39, 0
    s_cbranch_scc1 Q_so3
    v_mov_b32 v8, 1
    s_mov_b64 exec, 1
    buffer_atomic_add v8, off, s[8:11], s39
    s_mov_b64 exec, -1
Q_so3:
Q_next:
    s_add_u32 s35, s35, 3
    s_mov_b32 s40, s38
    s_add_u32 s38, s38, 24576
    s_cmp_eq_u32 s38, 110592
    s_cselect_b32 s38, 36864, s38
    s_cmp_lt_u32 s35, 70
    s_cbranch_scc1 Q_loop
    s_lshl_b32 s36, s34, 1
    s_add_u32 s36, s36, 35
    s_mul_i32 s41, s34, s96
    s_cmp_lg_u32 s41, 0
    s_cbranch_scc1 R_h
    s_cmp_lg_u32 s96, 0
    s_cbranch_scc1 L_end
    s_mov_b32 s96, 1
    s_add_u32 s8, s8, 100663296
    s_addc_u32 s9, s9, 0
    s_mov_b32 s10, 167772160
    s_branch Q_layer
R_team:
    s_mov_b32 s33, s97
    s_mov_b32 s28, s66
    s_mov_b32 s29, s67
    s_mov_b32 s30, 9216
    s_mov_b32 s31, 0x00020000
    s_cmp_eq_u32 s32, 0
    s_cbranch_scc1 T0_pro
    s_cmp_eq_u32 s32, 1
    s_cbranch_scc1 T1_pro
    s_cmp_eq_u32 s32, 2
    s_cbranch_scc1 T2_pro
T3_pro:
    v_and_b32 v2, 63, v0
    v_and_b32 v3, 15, v0
    v_lshrrev_b32 v4, 4, v2
    s_mul_i32 s54, s33, 147456
    v_bfe_u32 v5, v2, 5, 1
    v_lshlrev_b32 v5, 3, v5
    v_bfe_u32 v6, v2, 4, 1
    v_lshl_add_u32 v5, v6, 1, v5
    v_mul_u32_u24 v5, 1152, v5
    v_lshlrev_b32 v6, 2, v3
    v_add3_u32 v9, v5, v6, s54
    v_and_b32 v7, 3, v2
    v_lshlrev_b32 v7, 4, v7
    v_bfe_u32 v5, v2, 3, 1
    v_lshlrev_b32 v5, 3, v5
    v_lshl_add_u32 v5, v4, 1, v5
    v_bfe_u32 v6, v2, 2, 1
    v_add_u32 v5, v5, v6
    s_lshl_b32 s55, s33, 8
    s_add_u32 s55, s55, 192
    v_lshlrev_b32 v5, 13, v5
    v_add3_u32 v8, v5, v7, s55
    v_lshlrev_b32 v5, 4, v6
    v_bfe_u32 v6, v2, 3, 1
    v_lshl_add_u32 v5, v6, 2, v5
    v_add_u32 v5, v5, v4
    v_bfe_u32 v6, v2, 1, 1
    v_lshl_add_u32 v5, v6, 6, v5
    v_mul_u32_u24 v5, 1152, v5
    v_and_b32 v6, 16, v7
    v_add3_u32 v26, v5, v6, s54
    v_lshrrev_b32 v5, 2, v3
    v_lshl_add_u32 v5, v4, 3, v5
    v_lshlrev_b32 v5, 6, v5
    v_lshrrev_b32 v6, 1, v7
    v_add_u32 v5, v5, v6
    v_add_u32 v27, 110592, v5
    v_add_u32 v28, 159744, v5
    v_lshlrev_b32 v5, 4, v2
    v_add_u32 v0, 110592, v5
    v_add_u32 v1, 147456, v5
    s_mov_b32 s54, 0x05040100
    s_mov_b32 s55, 0x07060302
    s_barrier
    s_mov_b32 m0, 159744
    s_mov_b32 s57, 1120
    buffer_load_dwordx4 v26, s[24:27], s57 offen lds
    s_mov_b32 m0, 160768
    s_mov_b32 s57, 10336
    buffer_load_dwordx4 v26, s[24:27], s57 offen lds
    s_mov_b32 m0, 161792
    s_mov_b32 s57, 37984
    buffer_load_dwordx4 v26, s[24:27], s57 offen lds
    s_mov_b32 m0, 162816
    s_mov_b32 s57, 47200
    buffer_load_dwordx4 v26, s[24:27], s57 offen lds
    s_mov_b32 m0, 143360
    s_mov_b32 s57, 0
    buffer_load_dwordx4 v8, s[20:23], s57 offen  lds
    s_mov_b32 m0, 144384
    s_mov_b32 s57, 131072
    buffer_load_dwordx4 v8, s[20:23], s57 offen  lds
    s_mov_b32 m0, 145408
    s_mov_b32 s57, 262144
    buffer_load_dwordx4 v8, s[20:23], s57 offen  lds
    s_mov_b32 m0, 146432
    s_mov_b32 s57, 393216
    buffer_load_dwordx4 v8, s[20:23], s57 offen  lds
    s_mov_b32 m0, 139264
    s_mov_b32 s57, 524288
    buffer_load_dwordx4 v8, s[20:23], s57 offen  lds
    s_mov_b32 m0, 140288
    s_mov_b32 s57, 655360
    buffer_load_dwordx4 v8, s[20:23], s57 offen  lds
    s_mov_b32 m0, 141312
    s_mov_b32 s57, 786432
    buffer_load_dwordx4 v8, s[20:23], s57 offen  lds
    s_mov_b32 m0, 142336
    s_mov_b32 s57, 917504
    buffer_load_dwordx4 v8, s[20:23], s57 offen  lds
    s_mov_b32 s57, 192
    buffer_load_dword v30, v9, s[24:27], s57 offen offset:0
    buffer_load_dword v31, v9, s[24:27], s57 offen offset:256
    s_mov_b32 s57, 18624
    buffer_load_dword v32, v9, s[24:27], s57 offen offset:0
    buffer_load_dword v33, v9, s[24:27], s57 offen offset:256
    s_mov_b32 s57, 4800
    buffer_load_dword v34, v9, s[24:27], s57 offen offset:0
    buffer_load_dword v35, v9, s[24:27], s57 offen offset:256
    s_mov_b32 s57, 23232
    buffer_load_dword v36, v9, s[24:27], s57 offen offset:0
    buffer_load_dword v37, v9, s[24:27], s57 offen offset:256
    s_mov_b32 s57, 1344
    buffer_load_dword v38, v9, s[24:27], s57 offen offset:0
    buffer_load_dword v39, v9, s[24:27], s57 offen offset:256
    s_mov_b32 s57, 19776
    buffer_load_dword v40, v9, s[24:27], s57 offen offset:0
    buffer_load_dword v41, v9, s[24:27], s57 offen offset:256
    s_mov_b32 s57, 5952
    buffer_load_dword v42, v9, s[24:27], s57 offen offset:0
    buffer_load_dword v43, v9, s[24:27], s57 offen offset:256
    s_mov_b32 s57, 24384
    buffer_load_dword v44, v9, s[24:27], s57 offen offset:0
    buffer_load_dword v45, v9, s[24:27], s57 offen offset:256
    s_mov_b32 s57, 37056
    buffer_load_dword v46, v9, s[24:27], s57 offen offset:0
    buffer_load_dword v47, v9, s[24:27], s57 offen offset:256
    s_mov_b32 s57, 55488
    buffer_load_dword v48, v9, s[24:27], s57 offen offset:0
    buffer_load_dword v49, v9, s[24:27], s57 offen offset:256
    s_mov_b32 s57, 41664
    buffer_load_dword v50, v9, s[24:27], s57 offen offset:0
    buffer_load_dword v51, v9, s[24:27], s57 offen offset:256
    s_mov_b32 s57, 60096
    buffer_load_dword v52, v9, s[24:27], s57 offen offset:0
    buffer_load_dword v53, v9, s[24:27], s57 offen offset:256
    s_mov_b32 s57, 38208
    buffer_load_dword v54, v9, s[24:27], s57 offen offset:0
    buffer_load_dword v55, v9, s[24:27], s57 offen offset:256
    s_mov_b32 s57, 56640
    buffer_load_dword v56, v9, s[24:27], s57 offen offset:0
    buffer_load_dword v57, v9, s[24:27], s57 offen offset:256
    s_mov_b32 s57, 42816
    buffer_load_dword v58, v9, s[24:27], s57 offen offset:0
    buffer_load_dword v59, v9, s[24:27], s57 offen offset:256
    s_mov_b32 s57, 61248
    buffer_load_dword v60, v9, s[24:27], s57 offen offset:0
    buffer_load_dword v61, v9, s[24:27], s57 offen offset:256
    s_waitcnt vmcnt(40)
    ds_read_b64_tr_b16 v[240:241], v28 offset:0
    ds_read_b64_tr_b16 v[242:243], v28 offset:256
    ds_read_b64_tr_b16 v[244:245], v28 offset:2048
    ds_read_b64_tr_b16 v[246:247], v28 offset:2304
    ds_read_b64_tr_b16 v[248:249], v28 offset:32
    ds_read_b64_tr_b16 v[250:251], v28 offset:288
    ds_read_b64_tr_b16 v[252:253], v28 offset:2080
    ds_read_b64_tr_b16 v[254:255], v28 offset:2336
    s_waitcnt lgkmcnt(0)
    s_barrier
    s_mov_b32 m0, 159744
    s_mov_b32 s57, 1048576
    buffer_load_dwordx4 v8, s[20:23], s57 offen  lds
    s_mov_b32 m0, 160768
    s_mov_b32 s57, 1179648
    buffer_load_dwordx4 v8, s[20:23], s57 offen  lds
    s_mov_b32 m0, 161792
    s_mov_b32 s57, 1310720
    buffer_load_dwordx4 v8, s[20:23], s57 offen  lds
    s_mov_b32 m0, 162816
    s_mov_b32 s57, 1441792
    buffer_load_dwordx4 v8, s[20:23], s57 offen  lds
    s_waitcnt vmcnt(40)
    ds_read_b64_tr_b16 a[112:113], v27 offset:32768
    ds_read_b64_tr_b16 a[114:115], v27 offset:33024
    ds_read_b64_tr_b16 a[116:117], v27 offset:34816
    ds_read_b64_tr_b16 a[118:119], v27 offset:35072
    ds_read_b64_tr_b16 a[120:121], v27 offset:32800
    ds_read_b64_tr_b16 a[122:123], v27 offset:33056
    ds_read_b64_tr_b16 a[124:125], v27 offset:34848
    ds_read_b64_tr_b16 a[126:127], v27 offset:35104
    s_waitcnt lgkmcnt(0)
    s_barrier
    s_mov_b32 m0, 143360
    s_mov_b32 s57, 1572864
    buffer_load_dwordx4 v8, s[20:23], s57 offen  lds
    s_mov_b32 m0, 144384
    s_mov_b32 s57, 1703936
    buffer_load_dwordx4 v8, s[20:23], s57 offen  lds
    s_mov_b32 m0, 145408
    s_mov_b32 s57, 1835008
    buffer_load_dwordx4 v8, s[20:23], s57 offen  lds
    s_mov_b32 m0, 146432
    s_mov_b32 s57, 1966080
    buffer_load_dwordx4 v8, s[20:23], s57 offen  lds
    s_waitcnt vmcnt(40)
    ds_read_b64_tr_b16 a[144:145], v27 offset:28672
    ds_read_b64_tr_b16 a[146:147], v27 offset:28928
    ds_read_b64_tr_b16 a[148:149], v27 offset:30720
    ds_read_b64_tr_b16 a[150:151], v27 offset:30976
    ds_read_b64_tr_b16 a[152:153], v27 offset:28704
    ds_read_b64_tr_b16 a[154:155], v27 offset:28960
    ds_read_b64_tr_b16 a[156:157], v27 offset:30752
    ds_read_b64_tr_b16 a[158:159], v27 offset:31008
    s_waitcnt lgkmcnt(0)
    s_barrier
    s_mov_b32 m0, 122880
    s_mov_b32 s57, 2097152
    buffer_load_dwordx4 v8, s[20:23], s57 offen  lds
    s_mov_b32 m0, 123904
    s_mov_b32 s57, 2228224
    buffer_load_dwordx4 v8, s[20:23], s57 offen  lds
    s_mov_b32 m0, 124928
    s_mov_b32 s57, 2359296
    buffer_load_dwordx4 v8, s[20:23], s57 offen  lds
    s_mov_b32 m0, 125952
    s_mov_b32 s57, 2490368
    buffer_load_dwordx4 v8, s[20:23], s57 offen  lds
    s_waitcnt vmcnt(8)
    ds_read_b64_tr_b16 a[192:193], v28 offset:0
    ds_read_b64_tr_b16 a[194:195], v28 offset:256
    ds_read_b64_tr_b16 a[196:197], v28 offset:2048
    ds_read_b64_tr_b16 a[198:199], v28 offset:2304
    ds_read_b64_tr_b16 a[200:201], v28 offset:32
    ds_read_b64_tr_b16 a[202:203], v28 offset:288
    ds_read_b64_tr_b16 a[204:205], v28 offset:2080
    ds_read_b64_tr_b16 a[206:207], v28 offset:2336
    s_waitcnt lgkmcnt(0)
    s_barrier
    s_mov_b32 m0, 159744
    s_mov_b32 s57, 2621440
    buffer_load_dwordx4 v8, s[20:23], s57 offen  lds
    s_mov_b32 m0, 160768
    s_mov_b32 s57, 2752512
    buffer_load_dwordx4 v8, s[20:23], s57 offen  lds
    s_mov_b32 m0, 161792
    s_mov_b32 s57, 2883584
    buffer_load_dwordx4 v8, s[20:23], s57 offen  lds
    s_mov_b32 m0, 162816
    s_mov_b32 s57, 3014656
    buffer_load_dwordx4 v8, s[20:23], s57 offen  lds
    s_waitcnt vmcnt(8)
    ds_read_b64_tr_b16 a[16:17], v27 offset:32768
    ds_read_b64_tr_b16 a[18:19], v27 offset:33024
    ds_read_b64_tr_b16 a[20:21], v27 offset:34816
    ds_read_b64_tr_b16 a[22:23], v27 offset:35072
    ds_read_b64_tr_b16 a[24:25], v27 offset:32800
    ds_read_b64_tr_b16 a[26:27], v27 offset:33056
    ds_read_b64_tr_b16 a[28:29], v27 offset:34848
    ds_read_b64_tr_b16 a[30:31], v27 offset:35104
    s_waitcnt lgkmcnt(0)
    s_barrier
    s_mov_b32 m0, 143360
    s_mov_b32 s57, 3145728
    buffer_load_dwordx4 v8, s[20:23], s57 offen  lds
    s_mov_b32 m0, 144384
    s_mov_b32 s57, 3276800
    buffer_load_dwordx4 v8, s[20:23], s57 offen  lds
    s_mov_b32 m0, 145408
    s_mov_b32 s57, 3407872
    buffer_load_dwordx4 v8, s[20:23], s57 offen  lds
    s_mov_b32 m0, 146432
    s_mov_b32 s57, 3538944
    buffer_load_dwordx4 v8, s[20:23], s57 offen  lds
    s_waitcnt vmcnt(8)
    ds_read_b64_tr_b16 v[10:11], v27 offset:12288
    ds_read_b64_tr_b16 v[12:13], v27 offset:12544
    ds_read_b64_tr_b16 v[14:15], v27 offset:14336
    ds_read_b64_tr_b16 v[16:17], v27 offset:14592
    ds_read_b64_tr_b16 v[18:19], v27 offset:12320
    ds_read_b64_tr_b16 v[20:21], v27 offset:12576
    ds_read_b64_tr_b16 v[22:23], v27 offset:14368
    ds_read_b64_tr_b16 v[24:25], v27 offset:14624
    s_waitcnt lgkmcnt(0)
    ds_write_b128 v0, v[10:13] offset:12288
    ds_write_b128 v0, v[14:17] offset:13312
    ds_write_b128 v0, v[18:21] offset:14336
    ds_write_b128 v0, v[22:25] offset:15360
    s_barrier
    s_mov_b32 m0, 139264
    s_mov_b32 s57, 3670016
    buffer_load_dwordx4 v8, s[20:23], s57 offen  lds
    s_mov_b32 m0, 140288
    s_mov_b32 s57, 3801088
    buffer_load_dwordx4 v8, s[20:23], s57 offen  lds
    s_mov_b32 m0, 141312
    s_mov_b32 s57, 3932160
    buffer_load_dwordx4 v8, s[20:23], s57 offen  lds
    s_mov_b32 m0, 142336
    s_mov_b32 s57, 4063232
    buffer_load_dwordx4 v8, s[20:23], s57 offen  lds
    v_perm_b32 v10, v32, v30, s54
    v_perm_b32 v18, v36, v34, s54
    v_perm_b32 v12, v40, v38, s54
    v_perm_b32 v20, v44, v42, s54
    v_perm_b32 v14, v48, v46, s54
    v_perm_b32 v22, v52, v50, s54
    v_perm_b32 v16, v56, v54, s54
    v_perm_b32 v24, v60, v58, s54
    v_perm_b32 v19, v32, v30, s55
    v_perm_b32 v11, v36, v34, s55
    v_perm_b32 v21, v40, v38, s55
    v_perm_b32 v13, v44, v42, s55
    v_perm_b32 v23, v48, v46, s55
    v_perm_b32 v15, v52, v50, s55
    v_perm_b32 v25, v56, v54, s55
    v_perm_b32 v17, v60, v58, s55
    ds_write_b128 v0, v[10:13] offset:0
    ds_write_b128 v0, v[14:17] offset:1024
    ds_write_b128 v0, v[18:21] offset:2048
    ds_write_b128 v0, v[22:25] offset:3072
    v_perm_b32 v160, v33, v31, s54
    v_perm_b32 v168, v37, v35, s54
    v_perm_b32 v162, v41, v39, s54
    v_perm_b32 v170, v45, v43, s54
    v_perm_b32 v164, v49, v47, s54
    v_perm_b32 v172, v53, v51, s54
    v_perm_b32 v166, v57, v55, s54
    v_perm_b32 v174, v61, v59, s54
    v_perm_b32 v169, v33, v31, s55
    v_perm_b32 v161, v37, v35, s55
    v_perm_b32 v171, v41, v39, s55
    v_perm_b32 v163, v45, v43, s55
    v_perm_b32 v173, v49, v47, s55
    v_perm_b32 v165, v53, v51, s55
    v_perm_b32 v175, v57, v55, s55
    v_perm_b32 v167, v61, v59, s55
    s_waitcnt vmcnt(8)
    ds_read_b64_tr_b16 v[80:81], v28 offset:0
    ds_read_b64_tr_b16 v[82:83], v28 offset:256
    ds_read_b64_tr_b16 v[84:85], v28 offset:2048
    ds_read_b64_tr_b16 v[86:87], v28 offset:2304
    ds_read_b64_tr_b16 v[88:89], v28 offset:32
    ds_read_b64_tr_b16 v[90:91], v28 offset:288
    ds_read_b64_tr_b16 v[92:93], v28 offset:2080
    ds_read_b64_tr_b16 v[94:95], v28 offset:2336
    s_waitcnt lgkmcnt(0)
    s_barrier
    s_mov_b32 m0, 126976
    s_mov_b32 s57, 4194304
    buffer_load_dwordx4 v8, s[20:23], s57 offen  lds
    s_mov_b32 m0, 128000
    s_mov_b32 s57, 4325376
    buffer_load_dwordx4 v8, s[20:23], s57 offen  lds
    s_mov_b32 m0, 129024
    s_mov_b32 s57, 4456448
    buffer_load_dwordx4 v8, s[20:23], s57 offen  lds
    s_mov_b32 m0, 130048
    s_mov_b32 s57, 4587520
    buffer_load_dwordx4 v8, s[20:23], s57 offen  lds
    s_mov_b32 s57, 73920
    buffer_load_dword v30, v9, s[24:27], s57 offen offset:0
    buffer_load_dword v31, v9, s[24:27], s57 offen offset:256
    s_mov_b32 s57, 92352
    buffer_load_dword v32, v9, s[24:27], s57 offen offset:0
    buffer_load_dword v33, v9, s[24:27], s57 offen offset:256
    s_mov_b32 s57, 78528
    buffer_load_dword v34, v9, s[24:27], s57 offen offset:0
    buffer_load_dword v35, v9, s[24:27], s57 offen offset:256
    s_mov_b32 s57, 96960
    buffer_load_dword v36, v9, s[24:27], s57 offen offset:0
    buffer_load_dword v37, v9, s[24:27], s57 offen offset:256
    s_mov_b32 s57, 75072
    buffer_load_dword v38, v9, s[24:27], s57 offen offset:0
    buffer_load_dword v39, v9, s[24:27], s57 offen offset:256
    s_mov_b32 s57, 93504
    buffer_load_dword v40, v9, s[24:27], s57 offen offset:0
    buffer_load_dword v41, v9, s[24:27], s57 offen offset:256
    s_mov_b32 s57, 79680
    buffer_load_dword v42, v9, s[24:27], s57 offen offset:0
    buffer_load_dword v43, v9, s[24:27], s57 offen offset:256
    s_mov_b32 s57, 98112
    buffer_load_dword v44, v9, s[24:27], s57 offen offset:0
    buffer_load_dword v45, v9, s[24:27], s57 offen offset:256
    s_mov_b32 s57, 110784
    buffer_load_dword v46, v9, s[24:27], s57 offen offset:0
    buffer_load_dword v47, v9, s[24:27], s57 offen offset:256
    s_mov_b32 s57, 129216
    buffer_load_dword v48, v9, s[24:27], s57 offen offset:0
    buffer_load_dword v49, v9, s[24:27], s57 offen offset:256
    s_mov_b32 s57, 115392
    buffer_load_dword v50, v9, s[24:27], s57 offen offset:0
    buffer_load_dword v51, v9, s[24:27], s57 offen offset:256
    s_mov_b32 s57, 133824
    buffer_load_dword v52, v9, s[24:27], s57 offen offset:0
    buffer_load_dword v53, v9, s[24:27], s57 offen offset:256
    s_mov_b32 s57, 111936
    buffer_load_dword v54, v9, s[24:27], s57 offen offset:0
    buffer_load_dword v55, v9, s[24:27], s57 offen offset:256
    s_mov_b32 s57, 130368
    buffer_load_dword v56, v9, s[24:27], s57 offen offset:0
    buffer_load_dword v57, v9, s[24:27], s57 offen offset:256
    s_mov_b32 s57, 116544
    buffer_load_dword v58, v9, s[24:27], s57 offen offset:0
    buffer_load_dword v59, v9, s[24:27], s57 offen offset:256
    s_mov_b32 s57, 134976
    buffer_load_dword v60, v9, s[24:27], s57 offen offset:0
    buffer_load_dword v61, v9, s[24:27], s57 offen offset:256
    s_waitcnt vmcnt(40)
    ds_read_b64_tr_b16 v[128:129], v27 offset:32768
    ds_read_b64_tr_b16 v[130:131], v27 offset:33024
    ds_read_b64_tr_b16 v[132:133], v27 offset:34816
    ds_read_b64_tr_b16 v[134:135], v27 offset:35072
    ds_read_b64_tr_b16 v[136:137], v27 offset:32800
    ds_read_b64_tr_b16 v[138:139], v27 offset:33056
    ds_read_b64_tr_b16 v[140:141], v27 offset:34848
    ds_read_b64_tr_b16 v[142:143], v27 offset:35104
    s_waitcnt lgkmcnt(0)
    s_barrier
    s_mov_b32 m0, 159744
    s_mov_b32 s57, 0
    buffer_load_dwordx4 v8, s[12:15], s57 offen  lds
    s_mov_b32 m0, 160768
    s_mov_b32 s57, 131072
    buffer_load_dwordx4 v8, s[12:15], s57 offen  lds
    s_mov_b32 m0, 161792
    s_mov_b32 s57, 262144
    buffer_load_dwordx4 v8, s[12:15], s57 offen  lds
    s_mov_b32 m0, 162816
    s_mov_b32 s57, 393216
    buffer_load_dwordx4 v8, s[12:15], s57 offen  lds
    s_waitcnt vmcnt(40)
    ds_read_b64_tr_b16 a[64:65], v27 offset:28672
    ds_read_b64_tr_b16 a[66:67], v27 offset:28928
    ds_read_b64_tr_b16 a[68:69], v27 offset:30720
    ds_read_b64_tr_b16 a[70:71], v27 offset:30976
    ds_read_b64_tr_b16 a[72:73], v27 offset:28704
    ds_read_b64_tr_b16 a[74:75], v27 offset:28960
    ds_read_b64_tr_b16 a[76:77], v27 offset:30752
    ds_read_b64_tr_b16 a[78:79], v27 offset:31008
    s_waitcnt lgkmcnt(0)
    s_barrier
    s_mov_b32 m0, 131072
    s_mov_b32 s57, 524288
    buffer_load_dwordx4 v8, s[12:15], s57 offen  lds
    s_mov_b32 m0, 132096
    s_mov_b32 s57, 655360
    buffer_load_dwordx4 v8, s[12:15], s57 offen  lds
    s_mov_b32 m0, 133120
    s_mov_b32 s57, 786432
    buffer_load_dwordx4 v8, s[12:15], s57 offen  lds
    s_mov_b32 m0, 134144
    s_mov_b32 s57, 917504
    buffer_load_dwordx4 v8, s[12:15], s57 offen  lds
    s_waitcnt vmcnt(40)
    ds_read_b64_tr_b16 v[10:11], v27 offset:16384
    ds_read_b64_tr_b16 v[12:13], v27 offset:16640
    ds_read_b64_tr_b16 v[14:15], v27 offset:18432
    ds_read_b64_tr_b16 v[16:17], v27 offset:18688
    ds_read_b64_tr_b16 v[18:19], v27 offset:16416
    ds_read_b64_tr_b16 v[20:21], v27 offset:16672
    ds_read_b64_tr_b16 v[22:23], v27 offset:18464
    ds_read_b64_tr_b16 v[24:25], v27 offset:18720
    s_waitcnt lgkmcnt(0)
    ds_write_b128 v0, v[10:13] offset:16384
    ds_write_b128 v0, v[14:17] offset:17408
    ds_write_b128 v0, v[18:21] offset:18432
    ds_write_b128 v0, v[22:25] offset:19456
    s_barrier
    s_mov_b32 m0, 143360
    s_mov_b32 s57, 1048576
    buffer_load_dwordx4 v8, s[12:15], s57 offen  lds
    s_mov_b32 m0, 144384
    s_mov_b32 s57, 1179648
    buffer_load_dwordx4 v8, s[12:15], s57 offen  lds
    s_mov_b32 m0, 145408
    s_mov_b32 s57, 1310720
    buffer_load_dwordx4 v8, s[12:15], s57 offen  lds
    s_mov_b32 m0, 146432
    s_mov_b32 s57, 1441792
    buffer_load_dwordx4 v8, s[12:15], s57 offen  lds
    s_waitcnt vmcnt(8)
    ds_read_b64_tr_b16 a[80:81], v28 offset:0
    ds_read_b64_tr_b16 a[82:83], v28 offset:256
    ds_read_b64_tr_b16 a[84:85], v28 offset:2048
    ds_read_b64_tr_b16 a[86:87], v28 offset:2304
    ds_read_b64_tr_b16 a[88:89], v28 offset:32
    ds_read_b64_tr_b16 a[90:91], v28 offset:288
    ds_read_b64_tr_b16 a[92:93], v28 offset:2080
    ds_read_b64_tr_b16 a[94:95], v28 offset:2336
    s_waitcnt lgkmcnt(0)
    s_barrier
    s_mov_b32 m0, 135168
    s_mov_b32 s57, 1572864
    buffer_load_dwordx4 v8, s[12:15], s57 offen  lds
    s_mov_b32 m0, 136192
    s_mov_b32 s57, 1703936
    buffer_load_dwordx4 v8, s[12:15], s57 offen  lds
    s_mov_b32 m0, 137216
    s_mov_b32 s57, 1835008
    buffer_load_dwordx4 v8, s[12:15], s57 offen  lds
    s_mov_b32 m0, 138240
    s_mov_b32 s57, 1966080
    buffer_load_dwordx4 v8, s[12:15], s57 offen  lds
    s_waitcnt vmcnt(8)
    ds_read_b64_tr_b16 v[10:11], v27 offset:20480
    ds_read_b64_tr_b16 v[12:13], v27 offset:20736
    ds_read_b64_tr_b16 v[14:15], v27 offset:22528
    ds_read_b64_tr_b16 v[16:17], v27 offset:22784
    ds_read_b64_tr_b16 v[18:19], v27 offset:20512
    ds_read_b64_tr_b16 v[20:21], v27 offset:20768
    ds_read_b64_tr_b16 v[22:23], v27 offset:22560
    ds_read_b64_tr_b16 v[24:25], v27 offset:22816
    s_waitcnt lgkmcnt(0)
    ds_write_b128 v0, v[10:13] offset:20480
    ds_write_b128 v0, v[14:17] offset:21504
    ds_write_b128 v0, v[18:21] offset:22528
    ds_write_b128 v0, v[22:25] offset:23552
    s_barrier
    s_mov_b32 m0, 139264
    s_mov_b32 s57, 2097152
    buffer_load_dwordx4 v8, s[12:15], s57 offen  lds
    s_mov_b32 m0, 140288
    s_mov_b32 s57, 2228224
    buffer_load_dwordx4 v8, s[12:15], s57 offen  lds
    s_mov_b32 m0, 141312
    s_mov_b32 s57, 2359296
    buffer_load_dwordx4 v8, s[12:15], s57 offen  lds
    s_mov_b32 m0, 142336
    s_mov_b32 s57, 2490368
    buffer_load_dwordx4 v8, s[12:15], s57 offen  lds
    s_waitcnt vmcnt(8)
    ds_read_b64_tr_b16 a[160:161], v27 offset:32768
    ds_read_b64_tr_b16 a[162:163], v27 offset:33024
    ds_read_b64_tr_b16 a[164:165], v27 offset:34816
    ds_read_b64_tr_b16 a[166:167], v27 offset:35072
    ds_read_b64_tr_b16 a[168:169], v27 offset:32800
    ds_read_b64_tr_b16 a[170:171], v27 offset:33056
    ds_read_b64_tr_b16 a[172:173], v27 offset:34848
    ds_read_b64_tr_b16 a[174:175], v27 offset:35104
    s_waitcnt lgkmcnt(0)
    s_barrier
    s_mov_b32 m0, 159744
    s_mov_b32 s57, 2621440
    buffer_load_dwordx4 v8, s[12:15], s57 offen  lds
    s_mov_b32 m0, 160768
    s_mov_b32 s57, 2752512
    buffer_load_dwordx4 v8, s[12:15], s57 offen  lds
    s_mov_b32 m0, 161792
    s_mov_b32 s57, 2883584
    buffer_load_dwordx4 v8, s[12:15], s57 offen  lds
    s_mov_b32 m0, 162816
    s_mov_b32 s57, 3014656
    buffer_load_dwordx4 v8, s[12:15], s57 offen  lds
    v_perm_b32 v208, v32, v30, s54
    v_perm_b32 v216, v36, v34, s54
    v_perm_b32 v210, v40, v38, s54
    v_perm_b32 v218, v44, v42, s54
    v_perm_b32 v212, v48, v46, s54
    v_perm_b32 v220, v52, v50, s54
    v_perm_b32 v214, v56, v54, s54
    v_perm_b32 v222, v60, v58, s54
    v_perm_b32 v217, v32, v30, s55
    v_perm_b32 v209, v36, v34, s55
    v_perm_b32 v219, v40, v38, s55
    v_perm_b32 v211, v44, v42, s55
    v_perm_b32 v221, v48, v46, s55
    v_perm_b32 v213, v52, v50, s55
    v_perm_b32 v223, v56, v54, s55
    v_perm_b32 v215, v60, v58, s55
    v_perm_b32 v10, v33, v31, s54
    v_perm_b32 v18, v37, v35, s54
    v_perm_b32 v12, v41, v39, s54
    v_perm_b32 v20, v45, v43, s54
    v_perm_b32 v14, v49, v47, s54
    v_perm_b32 v22, v53, v51, s54
    v_perm_b32 v16, v57, v55, s54
    v_perm_b32 v24, v61, v59, s54
    v_perm_b32 v19, v33, v31, s55
    v_perm_b32 v11, v37, v35, s55
    v_perm_b32 v21, v41, v39, s55
    v_perm_b32 v13, v45, v43, s55
    v_perm_b32 v23, v49, v47, s55
    v_perm_b32 v15, v53, v51, s55
    v_perm_b32 v25, v57, v55, s55
    v_perm_b32 v17, v61, v59, s55
    ds_write_b128 v0, v[10:13] offset:4096
    ds_write_b128 v0, v[14:17] offset:5120
    ds_write_b128 v0, v[18:21] offset:6144
    ds_write_b128 v0, v[22:25] offset:7168
    s_waitcnt vmcnt(8)
    ds_read_b64_tr_b16 v[10:11], v27 offset:24576
    ds_read_b64_tr_b16 v[12:13], v27 offset:24832
    ds_read_b64_tr_b16 v[14:15], v27 offset:26624
    ds_read_b64_tr_b16 v[16:17], v27 offset:26880
    ds_read_b64_tr_b16 v[18:19], v27 offset:24608
    ds_read_b64_tr_b16 v[20:21], v27 offset:24864
    ds_read_b64_tr_b16 v[22:23], v27 offset:26656
    ds_read_b64_tr_b16 v[24:25], v27 offset:26912
    s_waitcnt lgkmcnt(0)
    ds_write_b128 v0, v[10:13] offset:24576
    ds_write_b128 v0, v[14:17] offset:25600
    ds_write_b128 v0, v[18:21] offset:26624
    ds_write_b128 v0, v[22:25] offset:27648
    s_barrier
    s_mov_b32 m0, 143360
    s_mov_b32 s57, 3145728
    buffer_load_dwordx4 v8, s[12:15], s57 offen  lds
    s_mov_b32 m0, 144384
    s_mov_b32 s57, 3276800
    buffer_load_dwordx4 v8, s[12:15], s57 offen  lds
    s_mov_b32 m0, 145408
    s_mov_b32 s57, 3407872
    buffer_load_dwordx4 v8, s[12:15], s57 offen  lds
    s_mov_b32 m0, 146432
    s_mov_b32 s57, 3538944
    buffer_load_dwordx4 v8, s[12:15], s57 offen  lds
    s_mov_b32 s57, 704
    buffer_load_dword v30, v9, s[24:27], s57 offen offset:0
    buffer_load_dword v31, v9, s[24:27], s57 offen offset:256
    s_mov_b32 s57, 19136
    buffer_load_dword v32, v9, s[24:27], s57 offen offset:0
    buffer_load_dword v33, v9, s[24:27], s57 offen offset:256
    s_mov_b32 s57, 5312
    buffer_load_dword v34, v9, s[24:27], s57 offen offset:0
    buffer_load_dword v35, v9, s[24:27], s57 offen offset:256
    s_mov_b32 s57, 23744
    buffer_load_dword v36, v9, s[24:27], s57 offen offset:0
    buffer_load_dword v37, v9, s[24:27], s57 offen offset:256
    s_mov_b32 s57, 1856
    buffer_load_dword v38, v9, s[24:27], s57 offen offset:0
    buffer_load_dword v39, v9, s[24:27], s57 offen offset:256
    s_mov_b32 s57, 20288
    buffer_load_dword v40, v9, s[24:27], s57 offen offset:0
    buffer_load_dword v41, v9, s[24:27], s57 offen offset:256
    s_mov_b32 s57, 6464
    buffer_load_dword v42, v9, s[24:27], s57 offen offset:0
    buffer_load_dword v43, v9, s[24:27], s57 offen offset:256
    s_mov_b32 s57, 24896
    buffer_load_dword v44, v9, s[24:27], s57 offen offset:0
    buffer_load_dword v45, v9, s[24:27], s57 offen offset:256
    s_mov_b32 s57, 37568
    buffer_load_dword v46, v9, s[24:27], s57 offen offset:0
    buffer_load_dword v47, v9, s[24:27], s57 offen offset:256
    s_mov_b32 s57, 56000
    buffer_load_dword v48, v9, s[24:27], s57 offen offset:0
    buffer_load_dword v49, v9, s[24:27], s57 offen offset:256
    s_mov_b32 s57, 42176
    buffer_load_dword v50, v9, s[24:27], s57 offen offset:0
    buffer_load_dword v51, v9, s[24:27], s57 offen offset:256
    s_mov_b32 s57, 60608
    buffer_load_dword v52, v9, s[24:27], s57 offen offset:0
    buffer_load_dword v53, v9, s[24:27], s57 offen offset:256
    s_mov_b32 s57, 38720
    buffer_load_dword v54, v9, s[24:27], s57 offen offset:0
    buffer_load_dword v55, v9, s[24:27], s57 offen offset:256
    s_mov_b32 s57, 57152
    buffer_load_dword v56, v9, s[24:27], s57 offen offset:0
    buffer_load_dword v57, v9, s[24:27], s57 offen offset:256
    s_mov_b32 s57, 43328
    buffer_load_dword v58, v9, s[24:27], s57 offen offset:0
    buffer_load_dword v59, v9, s[24:27], s57 offen offset:256
    s_mov_b32 s57, 61760
    buffer_load_dword v60, v9, s[24:27], s57 offen offset:0
    buffer_load_dword v61, v9, s[24:27], s57 offen offset:256
    s_waitcnt vmcnt(40)
    ds_read_b64_tr_b16 v[10:11], v27 offset:28672
    ds_read_b64_tr_b16 v[12:13], v27 offset:28928
    ds_read_b64_tr_b16 v[14:15], v27 offset:30720
    ds_read_b64_tr_b16 v[16:17], v27 offset:30976
    ds_read_b64_tr_b16 v[18:19], v27 offset:28704
    ds_read_b64_tr_b16 v[20:21], v27 offset:28960
    ds_read_b64_tr_b16 v[22:23], v27 offset:30752
    ds_read_b64_tr_b16 v[24:25], v27 offset:31008
    s_waitcnt lgkmcnt(0)
    ds_write_b128 v0, v[10:13] offset:28672
    ds_write_b128 v0, v[14:17] offset:29696
    ds_write_b128 v0, v[18:21] offset:30720
    ds_write_b128 v0, v[22:25] offset:31744
    s_barrier
    s_waitcnt vmcnt(36)
    ds_read_b64_tr_b16 a[224:225], v28 offset:0
    ds_read_b64_tr_b16 a[226:227], v28 offset:256
    ds_read_b64_tr_b16 a[228:229], v28 offset:2048
    ds_read_b64_tr_b16 a[230:231], v28 offset:2304
    ds_read_b64_tr_b16 a[232:233], v28 offset:32
    ds_read_b64_tr_b16 a[234:235], v28 offset:288
    ds_read_b64_tr_b16 a[236:237], v28 offset:2080
    ds_read_b64_tr_b16 a[238:239], v28 offset:2336
    s_waitcnt lgkmcnt(0)
    s_barrier
    s_mov_b32 m0, 159744
    s_mov_b32 s57, 3670016
    buffer_load_dwordx4 v8, s[12:15], s57 offen  lds
    s_mov_b32 m0, 160768
    s_mov_b32 s57, 3801088
    buffer_load_dwordx4 v8, s[12:15], s57 offen  lds
    s_mov_b32 m0, 161792
    s_mov_b32 s57, 3932160
    buffer_load_dwordx4 v8, s[12:15], s57 offen  lds
    s_mov_b32 m0, 162816
    s_mov_b32 s57, 4063232
    buffer_load_dwordx4 v8, s[12:15], s57 offen  lds
    s_waitcnt vmcnt(36)
    ds_read_b64_tr_b16 v[96:97], v27 offset:32768
    ds_read_b64_tr_b16 v[98:99], v27 offset:33024
    ds_read_b64_tr_b16 v[100:101], v27 offset:34816
    ds_read_b64_tr_b16 v[102:103], v27 offset:35072
    ds_read_b64_tr_b16 v[104:105], v27 offset:32800
    ds_read_b64_tr_b16 v[106:107], v27 offset:33056
    ds_read_b64_tr_b16 v[108:109], v27 offset:34848
    ds_read_b64_tr_b16 v[110:111], v27 offset:35104
    s_waitcnt lgkmcnt(0)
    s_barrier
    s_mov_b32 m0, 143360
    s_mov_b32 s57, 4194304
    buffer_load_dwordx4 v8, s[12:15], s57 offen  lds
    s_mov_b32 m0, 144384
    s_mov_b32 s57, 4325376
    buffer_load_dwordx4 v8, s[12:15], s57 offen  lds
    s_mov_b32 m0, 145408
    s_mov_b32 s57, 4456448
    buffer_load_dwordx4 v8, s[12:15], s57 offen  lds
    s_mov_b32 m0, 146432
    s_mov_b32 s57, 4587520
    buffer_load_dwordx4 v8, s[12:15], s57 offen  lds
    s_waitcnt vmcnt(4)
    ds_read_b64_tr_b16 a[32:33], v28 offset:0
    ds_read_b64_tr_b16 a[34:35], v28 offset:256
    ds_read_b64_tr_b16 a[36:37], v28 offset:2048
    ds_read_b64_tr_b16 a[38:39], v28 offset:2304
    ds_read_b64_tr_b16 a[40:41], v28 offset:32
    ds_read_b64_tr_b16 a[42:43], v28 offset:288
    ds_read_b64_tr_b16 a[44:45], v28 offset:2080
    ds_read_b64_tr_b16 a[46:47], v28 offset:2336
    s_waitcnt lgkmcnt(0)
    s_barrier
    s_mov_b32 m0, 159744
    s_mov_b32 s57, 0
    buffer_load_dwordx4 v8, s[16:19], s57 offen  lds
    s_mov_b32 m0, 160768
    s_mov_b32 s57, 131072
    buffer_load_dwordx4 v8, s[16:19], s57 offen  lds
    s_mov_b32 m0, 161792
    s_mov_b32 s57, 262144
    buffer_load_dwordx4 v8, s[16:19], s57 offen  lds
    s_mov_b32 m0, 162816
    s_mov_b32 s57, 393216
    buffer_load_dwordx4 v8, s[16:19], s57 offen  lds
    s_waitcnt vmcnt(4)
    ds_read_b64_tr_b16 v[144:145], v27 offset:32768
    ds_read_b64_tr_b16 v[146:147], v27 offset:33024
    ds_read_b64_tr_b16 v[148:149], v27 offset:34816
    ds_read_b64_tr_b16 v[150:151], v27 offset:35072
    ds_read_b64_tr_b16 v[152:153], v27 offset:32800
    ds_read_b64_tr_b16 v[154:155], v27 offset:33056
    ds_read_b64_tr_b16 v[156:157], v27 offset:34848
    ds_read_b64_tr_b16 v[158:159], v27 offset:35104
    s_waitcnt lgkmcnt(0)
    s_barrier
    s_mov_b32 m0, 143360
    s_mov_b32 s57, 524288
    buffer_load_dwordx4 v8, s[16:19], s57 offen  lds
    s_mov_b32 m0, 144384
    s_mov_b32 s57, 655360
    buffer_load_dwordx4 v8, s[16:19], s57 offen  lds
    s_mov_b32 m0, 145408
    s_mov_b32 s57, 786432
    buffer_load_dwordx4 v8, s[16:19], s57 offen  lds
    s_mov_b32 m0, 146432
    s_mov_b32 s57, 917504
    buffer_load_dwordx4 v8, s[16:19], s57 offen  lds
    s_waitcnt vmcnt(4)
    ds_read_b64_tr_b16 a[96:97], v28 offset:0
    ds_read_b64_tr_b16 a[98:99], v28 offset:256
    ds_read_b64_tr_b16 a[100:101], v28 offset:2048
    ds_read_b64_tr_b16 a[102:103], v28 offset:2304
    ds_read_b64_tr_b16 a[104:105], v28 offset:32
    ds_read_b64_tr_b16 a[106:107], v28 offset:288
    ds_read_b64_tr_b16 a[108:109], v28 offset:2080
    ds_read_b64_tr_b16 a[110:111], v28 offset:2336
    s_waitcnt lgkmcnt(0)
    s_barrier
    s_mov_b32 m0, 159744
    s_mov_b32 s57, 1048576
    buffer_load_dwordx4 v8, s[16:19], s57 offen  lds
    s_mov_b32 m0, 160768
    s_mov_b32 s57, 1179648
    buffer_load_dwordx4 v8, s[16:19], s57 offen  lds
    s_mov_b32 m0, 161792
    s_mov_b32 s57, 1310720
    buffer_load_dwordx4 v8, s[16:19], s57 offen  lds
    s_mov_b32 m0, 162816
    s_mov_b32 s57, 1441792
    buffer_load_dwordx4 v8, s[16:19], s57 offen  lds
    v_perm_b32 v176, v32, v30, s54
    v_perm_b32 v184, v36, v34, s54
    v_perm_b32 v178, v40, v38, s54
    v_perm_b32 v186, v44, v42, s54
    v_perm_b32 v180, v48, v46, s54
    v_perm_b32 v188, v52, v50, s54
    v_perm_b32 v182, v56, v54, s54
    v_perm_b32 v190, v60, v58, s54
    v_perm_b32 v185, v32, v30, s55
    v_perm_b32 v177, v36, v34, s55
    v_perm_b32 v187, v40, v38, s55
    v_perm_b32 v179, v44, v42, s55
    v_perm_b32 v189, v48, v46, s55
    v_perm_b32 v181, v52, v50, s55
    v_perm_b32 v191, v56, v54, s55
    v_perm_b32 v183, v60, v58, s55
    v_perm_b32 v192, v33, v31, s54
    v_perm_b32 v200, v37, v35, s54
    v_perm_b32 v194, v41, v39, s54
    v_perm_b32 v202, v45, v43, s54
    v_perm_b32 v196, v49, v47, s54
    v_perm_b32 v204, v53, v51, s54
    v_perm_b32 v198, v57, v55, s54
    v_perm_b32 v206, v61, v59, s54
    v_perm_b32 v201, v33, v31, s55
    v_perm_b32 v193, v37, v35, s55
    v_perm_b32 v203, v41, v39, s55
    v_perm_b32 v195, v45, v43, s55
    v_perm_b32 v205, v49, v47, s55
    v_perm_b32 v197, v53, v51, s55
    v_perm_b32 v207, v57, v55, s55
    v_perm_b32 v199, v61, v59, s55
    s_waitcnt vmcnt(4)
    ds_read_b64_tr_b16 a[128:129], v27 offset:32768
    ds_read_b64_tr_b16 a[130:131], v27 offset:33024
    ds_read_b64_tr_b16 a[132:133], v27 offset:34816
    ds_read_b64_tr_b16 a[134:135], v27 offset:35072
    ds_read_b64_tr_b16 a[136:137], v27 offset:32800
    ds_read_b64_tr_b16 a[138:139], v27 offset:33056
    ds_read_b64_tr_b16 a[140:141], v27 offset:34848
    ds_read_b64_tr_b16 a[142:143], v27 offset:35104
    s_waitcnt lgkmcnt(0)
    s_barrier
    s_mov_b32 m0, 143360
    s_mov_b32 s57, 1572864
    buffer_load_dwordx4 v8, s[16:19], s57 offen  lds
    s_mov_b32 m0, 144384
    s_mov_b32 s57, 1703936
    buffer_load_dwordx4 v8, s[16:19], s57 offen  lds
    s_mov_b32 m0, 145408
    s_mov_b32 s57, 1835008
    buffer_load_dwordx4 v8, s[16:19], s57 offen  lds
    s_mov_b32 m0, 146432
    s_mov_b32 s57, 1966080
    buffer_load_dwordx4 v8, s[16:19], s57 offen  lds
    s_mov_b32 s57, 74432
    buffer_load_dword v30, v9, s[24:27], s57 offen offset:0
    buffer_load_dword v31, v9, s[24:27], s57 offen offset:256
    s_mov_b32 s57, 92864
    buffer_load_dword v32, v9, s[24:27], s57 offen offset:0
    buffer_load_dword v33, v9, s[24:27], s57 offen offset:256
    s_mov_b32 s57, 79040
    buffer_load_dword v34, v9, s[24:27], s57 offen offset:0
    buffer_load_dword v35, v9, s[24:27], s57 offen offset:256
    s_mov_b32 s57, 97472
    buffer_load_dword v36, v9, s[24:27], s57 offen offset:0
    buffer_load_dword v37, v9, s[24:27], s57 offen offset:256
    s_mov_b32 s57, 75584
    buffer_load_dword v38, v9, s[24:27], s57 offen offset:0
    buffer_load_dword v39, v9, s[24:27], s57 offen offset:256
    s_mov_b32 s57, 94016
    buffer_load_dword v40, v9, s[24:27], s57 offen offset:0
    buffer_load_dword v41, v9, s[24:27], s57 offen offset:256
    s_mov_b32 s57, 80192
    buffer_load_dword v42, v9, s[24:27], s57 offen offset:0
    buffer_load_dword v43, v9, s[24:27], s57 offen offset:256
    s_mov_b32 s57, 98624
    buffer_load_dword v44, v9, s[24:27], s57 offen offset:0
    buffer_load_dword v45, v9, s[24:27], s57 offen offset:256
    s_mov_b32 s57, 111296
    buffer_load_dword v46, v9, s[24:27], s57 offen offset:0
    buffer_load_dword v47, v9, s[24:27], s57 offen offset:256
    s_mov_b32 s57, 129728
    buffer_load_dword v48, v9, s[24:27], s57 offen offset:0
    buffer_load_dword v49, v9, s[24:27], s57 offen offset:256
    s_mov_b32 s57, 115904
    buffer_load_dword v50, v9, s[24:27], s57 offen offset:0
    buffer_load_dword v51, v9, s[24:27], s57 offen offset:256
    s_mov_b32 s57, 134336
    buffer_load_dword v52, v9, s[24:27], s57 offen offset:0
    buffer_load_dword v53, v9, s[24:27], s57 offen offset:256
    s_mov_b32 s57, 112448
    buffer_load_dword v54, v9, s[24:27], s57 offen offset:0
    buffer_load_dword v55, v9, s[24:27], s57 offen offset:256
    s_mov_b32 s57, 130880
    buffer_load_dword v56, v9, s[24:27], s57 offen offset:0
    buffer_load_dword v57, v9, s[24:27], s57 offen offset:256
    s_mov_b32 s57, 117056
    buffer_load_dword v58, v9, s[24:27], s57 offen offset:0
    buffer_load_dword v59, v9, s[24:27], s57 offen offset:256
    s_mov_b32 s57, 135488
    buffer_load_dword v60, v9, s[24:27], s57 offen offset:0
    buffer_load_dword v61, v9, s[24:27], s57 offen offset:256
    s_waitcnt vmcnt(36)
    ds_read_b64_tr_b16 a[176:177], v28 offset:0
    ds_read_b64_tr_b16 a[178:179], v28 offset:256
    ds_read_b64_tr_b16 a[180:181], v28 offset:2048
    ds_read_b64_tr_b16 a[182:183], v28 offset:2304
    ds_read_b64_tr_b16 a[184:185], v28 offset:32
    ds_read_b64_tr_b16 a[186:187], v28 offset:288
    ds_read_b64_tr_b16 a[188:189], v28 offset:2080
    ds_read_b64_tr_b16 a[190:191], v28 offset:2336
    s_waitcnt lgkmcnt(0)
    s_barrier
    s_mov_b32 m0, 159744
    s_mov_b32 s57, 2097152
    buffer_load_dwordx4 v8, s[16:19], s57 offen  lds
    s_mov_b32 m0, 160768
    s_mov_b32 s57, 2228224
    buffer_load_dwordx4 v8, s[16:19], s57 offen  lds
    s_mov_b32 m0, 161792
    s_mov_b32 s57, 2359296
    buffer_load_dwordx4 v8, s[16:19], s57 offen  lds
    s_mov_b32 m0, 162816
    s_mov_b32 s57, 2490368
    buffer_load_dwordx4 v8, s[16:19], s57 offen  lds
    buffer_load_dword v76, off, s[4:7], 0 offset:40 sc1
    v_lshlrev_b32 v75, 6, v2
    s_mov_b32 s57, 12288
    buffer_load_dword v75, v75, s[28:31], s57 offen
    s_waitcnt vmcnt(38)
    ds_read_b64_tr_b16 a[0:1], v27 offset:32768
    ds_read_b64_tr_b16 a[2:3], v27 offset:33024
    ds_read_b64_tr_b16 a[4:5], v27 offset:34816
    ds_read_b64_tr_b16 a[6:7], v27 offset:35072
    ds_read_b64_tr_b16 a[8:9], v27 offset:32800
    ds_read_b64_tr_b16 a[10:11], v27 offset:33056
    ds_read_b64_tr_b16 a[12:13], v27 offset:34848
    ds_read_b64_tr_b16 a[14:15], v27 offset:35104
    s_waitcnt lgkmcnt(0)
    s_barrier
    s_mov_b32 m0, 143360
    s_mov_b32 s57, 2621440
    buffer_load_dwordx4 v8, s[16:19], s57 offen  lds
    s_mov_b32 m0, 144384
    s_mov_b32 s57, 2752512
    buffer_load_dwordx4 v8, s[16:19], s57 offen  lds
    s_mov_b32 m0, 145408
    s_mov_b32 s57, 2883584
    buffer_load_dwordx4 v8, s[16:19], s57 offen  lds
    s_mov_b32 m0, 146432
    s_mov_b32 s57, 3014656
    buffer_load_dwordx4 v8, s[16:19], s57 offen  lds
    s_waitcnt vmcnt(6)
    ds_read_b64_tr_b16 a[208:209], v28 offset:0
    ds_read_b64_tr_b16 a[210:211], v28 offset:256
    ds_read_b64_tr_b16 a[212:213], v28 offset:2048
    ds_read_b64_tr_b16 a[214:215], v28 offset:2304
    ds_read_b64_tr_b16 a[216:217], v28 offset:32
    ds_read_b64_tr_b16 a[218:219], v28 offset:288
    ds_read_b64_tr_b16 a[220:221], v28 offset:2080
    ds_read_b64_tr_b16 a[222:223], v28 offset:2336
    s_waitcnt lgkmcnt(0)
    s_barrier
    s_mov_b32 m0, 159744
    s_mov_b32 s57, 3145728
    buffer_load_dwordx4 v8, s[16:19], s57 offen  lds
    s_mov_b32 m0, 160768
    s_mov_b32 s57, 3276800
    buffer_load_dwordx4 v8, s[16:19], s57 offen  lds
    s_mov_b32 m0, 161792
    s_mov_b32 s57, 3407872
    buffer_load_dwordx4 v8, s[16:19], s57 offen  lds
    s_mov_b32 m0, 162816
    s_mov_b32 s57, 3538944
    buffer_load_dwordx4 v8, s[16:19], s57 offen  lds
    s_waitcnt vmcnt(4)
    ds_read_b64_tr_b16 a[240:241], v27 offset:32768
    ds_read_b64_tr_b16 a[242:243], v27 offset:33024
    ds_read_b64_tr_b16 a[244:245], v27 offset:34816
    ds_read_b64_tr_b16 a[246:247], v27 offset:35072
    ds_read_b64_tr_b16 a[248:249], v27 offset:32800
    ds_read_b64_tr_b16 a[250:251], v27 offset:33056
    ds_read_b64_tr_b16 a[252:253], v27 offset:34848
    ds_read_b64_tr_b16 a[254:255], v27 offset:35104
    s_waitcnt lgkmcnt(0)
    s_barrier
    s_mov_b32 m0, 143360
    s_mov_b32 s57, 3670016
    buffer_load_dwordx4 v8, s[16:19], s57 offen  lds
    s_mov_b32 m0, 144384
    s_mov_b32 s57, 3801088
    buffer_load_dwordx4 v8, s[16:19], s57 offen  lds
    s_mov_b32 m0, 145408
    s_mov_b32 s57, 3932160
    buffer_load_dwordx4 v8, s[16:19], s57 offen  lds
    s_mov_b32 m0, 146432
    s_mov_b32 s57, 4063232
    buffer_load_dwordx4 v8, s[16:19], s57 offen  lds
    s_waitcnt vmcnt(4)
    ds_read_b64_tr_b16 v[112:113], v28 offset:0
    ds_read_b64_tr_b16 v[114:115], v28 offset:256
    ds_read_b64_tr_b16 v[116:117], v28 offset:2048
    ds_read_b64_tr_b16 v[118:119], v28 offset:2304
    ds_read_b64_tr_b16 v[120:121], v28 offset:32
    ds_read_b64_tr_b16 v[122:123], v28 offset:288
    ds_read_b64_tr_b16 v[124:125], v28 offset:2080
    ds_read_b64_tr_b16 v[126:127], v28 offset:2336
    s_waitcnt lgkmcnt(0)
    s_barrier
    s_waitcnt vmcnt(0)
    ds_read_b64_tr_b16 a[48:49], v27 offset:32768
    ds_read_b64_tr_b16 a[50:51], v27 offset:33024
    ds_read_b64_tr_b16 a[52:53], v27 offset:34816
    ds_read_b64_tr_b16 a[54:55], v27 offset:35072
    ds_read_b64_tr_b16 a[56:57], v27 offset:32800
    ds_read_b64_tr_b16 a[58:59], v27 offset:33056
    ds_read_b64_tr_b16 a[60:61], v27 offset:34848
    ds_read_b64_tr_b16 a[62:63], v27 offset:35104
    s_waitcnt lgkmcnt(0)
    s_barrier
    s_mov_b32 m0, 143360
    s_mov_b32 s57, 4194304
    buffer_load_dwordx4 v8, s[16:19], s57 offen  lds
    s_mov_b32 m0, 144384
    s_mov_b32 s57, 4325376
    buffer_load_dwordx4 v8, s[16:19], s57 offen  lds
    s_mov_b32 m0, 145408
    s_mov_b32 s57, 4456448
    buffer_load_dwordx4 v8, s[16:19], s57 offen  lds
    s_mov_b32 m0, 146432
    s_mov_b32 s57, 4587520
    buffer_load_dwordx4 v8, s[16:19], s57 offen  lds
    v_perm_b32 v224, v32, v30, s54
    v_perm_b32 v232, v36, v34, s54
    v_perm_b32 v226, v40, v38, s54
    v_perm_b32 v234, v44, v42, s54
    v_perm_b32 v228, v48, v46, s54
    v_perm_b32 v236, v52, v50, s54
    v_perm_b32 v230, v56, v54, s54
    v_perm_b32 v238, v60, v58, s54
    v_perm_b32 v233, v32, v30, s55
    v_perm_b32 v225, v36, v34, s55
    v_perm_b32 v235, v40, v38, s55
    v_perm_b32 v227, v44, v42, s55
    v_perm_b32 v237, v48, v46, s55
    v_perm_b32 v229, v52, v50, s55
    v_perm_b32 v239, v56, v54, s55
    v_perm_b32 v231, v60, v58, s55
    v_perm_b32 v10, v33, v31, s54
    v_perm_b32 v18, v37, v35, s54
    v_perm_b32 v12, v41, v39, s54
    v_perm_b32 v20, v45, v43, s54
    v_perm_b32 v14, v49, v47, s54
    v_perm_b32 v22, v53, v51, s54
    v_perm_b32 v16, v57, v55, s54
    v_perm_b32 v24, v61, v59, s54
    v_perm_b32 v19, v33, v31, s55
    v_perm_b32 v11, v37, v35, s55
    v_perm_b32 v21, v41, v39, s55
    v_perm_b32 v13, v45, v43, s55
    v_perm_b32 v23, v49, v47, s55
    v_perm_b32 v15, v53, v51, s55
    v_perm_b32 v25, v57, v55, s55
    v_perm_b32 v17, v61, v59, s55
    ds_write_b128 v0, v[10:13] offset:8192
    ds_write_b128 v0, v[14:17] offset:9216
    ds_write_b128 v0, v[18:21] offset:10240
    ds_write_b128 v0, v[22:25] offset:11264
    s_waitcnt vmcnt(0)
    ds_read_b64_tr_b16 v[10:11], v27 offset:32768
    ds_read_b64_tr_b16 v[12:13], v27 offset:33024
    ds_read_b64_tr_b16 v[14:15], v27 offset:34816
    ds_read_b64_tr_b16 v[16:17], v27 offset:35072
    ds_read_b64_tr_b16 v[18:19], v27 offset:32800
    ds_read_b64_tr_b16 v[20:21], v27 offset:33056
    ds_read_b64_tr_b16 v[22:23], v27 offset:34848
    ds_read_b64_tr_b16 v[24:25], v27 offset:35104
    s_waitcnt lgkmcnt(0)
    ds_write_b128 v0, v[10:13] offset:32768
    ds_write_b128 v0, v[14:17] offset:33792
    ds_write_b128 v0, v[18:21] offset:34816
    ds_write_b128 v0, v[22:25] offset:35840
    v_mov_b32 v60, v2
    v_mov_b32 v61, v3
    v_mov_b32 v62, v4
    v_and_b32 v63, 2, v60
    v_cmp_eq_u32 vcc, 0, v63
    v_mov_b32 v64, 0x5e5eeeee
    v_mov_b32 v65, 0x04044444
    v_cndmask_b32 v4, v64, v65, vcc
    s_lshl_b32 s54, s33, 6
    s_add_u32 s55, s54, 49152
    v_lshrrev_b32 v63, 3, v60
    v_lshlrev_b32 v63, 11, v63
    v_and_b32 v64, 7, v60
    v_lshlrev_b32 v64, 3, v64
    v_add3_u32 v5, v63, v64, s55
    v_lshrrev_b32 v63, 2, v61
    v_lshlrev_b32 v63, 8, v63
    v_lshl_add_u32 v63, v62, 6, v63
    v_and_b32 v64, 3, v61
    v_lshl_add_u32 v7, v64, 4, v63
    v_and_b32 v63, 2, v61
    v_lshlrev_b32 v63, 4, v63
    v_lshl_add_u32 v63, v62, 4, v63
    v_and_b32 v64, 1, v61
    v_lshl_add_u32 v63, v64, 3, v63
    v_and_b32 v64, 0x2c, v60
    v_cmp_eq_u32 vcc, 0, v64
    v_mov_b32 v64, 0x7ffff000
    s_nop 0
    v_cndmask_b32 v6, v64, v63, vcc
    s_bfe_u32 s54, s33, 0x20001
    s_lshl_b32 s54, s54, 8
    s_and_b32 s55, s33, 1
    s_lshr_b32 s56, s33, 3
    s_lshl_b32 s18, s56, 1
    s_add_u32 s18, s18, s55
    s_and_b32 s17, s18, 3
    s_lshl_b32 s18, s18, 5
    s_add_u32 s18, s18, s54
    s_add_u32 s18, s18, 8192
    s_lshl_b32 s17, s17, 6
    s_add_u32 s17, s17, s54
    s_lshr_b32 s56, s56, 1
    s_lshl_b32 s56, s56, 10
    s_add_u32 s17, s17, s56
    s_add_u32 s17, s17, 6144
    v_lshrrev_b32 v63, 3, v61
    v_lshlrev_b32 v63, 8, v63
    v_lshl_add_u32 v63, v62, 6, v63
    v_and_b32 v64, 4, v61
    v_lshl_add_u32 v63, v64, 3, v63
    v_and_b32 v64, 3, v61
    v_lshl_add_u32 v63, v64, 2, v63
    v_add_u32 v8, 163328, v63
    v_and_b32 v63, 1, v61
    v_lshlrev_b32 v63, 4, v63
    v_mov_b32 v64, 0x3f80
    v_lshlrev_b32 v63, v63, v64
    v_and_b32 v64, 14, v61
    v_lshlrev_b32 v65, 2, v62
    v_cmp_eq_u32 vcc, v64, v65
    s_nop 1
    v_cndmask_b32 v2, 0, v63, vcc
    v_bfe_u32 v65, v60, 4, 1
    v_lshlrev_b32 v65, 3, v65
    v_bfe_u32 v66, v60, 5, 1
    v_lshl_add_u32 v65, v66, 2, v65
    v_or_b32 v65, 2, v65
    v_cmp_eq_u32 vcc, v64, v65
    s_nop 1
    v_cndmask_b32 v3, 0, v63, vcc
    s_waitcnt vmcnt(0) lgkmcnt(0)
    s_waitcnt vmcnt(0) lgkmcnt(0)
    s_barrier
    v_mov_b32 v77, 163836
    s_cmp_lg_u32 s32, 0
    s_cbranch_scc1 T3_cm
    s_mov_b64 exec, 1
    ds_write_b32 v77, v79
    s_mov_b64 exec, -1
    s_waitcnt lgkmcnt(0)
T3_cm:
    s_barrier
    ds_read_b32 v77, v77
    s_waitcnt lgkmcnt(0)
    v_readfirstlane_b32 s94, v77
    s_barrier
    s_and_b32 s94, s94, s93
    s_cbranch_scc1 A_over
    v_cmp_gt_u32 vcc, 32, v76
    s_cbranch_vccz T3_iw_ok
    s_mov_b32 s94, 40
T3_iw:
    buffer_load_dword v76, off, s[4:7], s94 sc1
    s_sub_u32 s95, s95, 1
    s_cmp_eq_u32 s95, 0
    s_cbranch_scc1 L_end
    s_waitcnt vmcnt(0)
    v_cmp_gt_u32 vcc, 32, v76
    s_cbranch_vccz T3_iw_ok
    s_sleep 1
    s_branch T3_iw
T3_iw_ok:
T3_layer:
    v_bfe_u32 v63, v1, 6, 2
    v_bfe_u32 v64, v1, 4, 1
    v_lshl_add_u32 v63, v63, 1, v64
    v_mul_u32_u24 v63, 1152, v63
    v_bfe_u32 v64, v1, 8, 2
    v_lshl_add_u32 v63, v64, 5, v63
    v_bfe_u32 v64, v1, 5, 1
    v_lshl_add_u32 v63, v64, 4, v63
    buffer_load_dwordx4 v[28:31], v63, s[28:31], 0 offen offset:384
    buffer_load_dwordx4 v[72:75], v63, s[28:31], 0 offen offset:896
    buffer_load_dwordx4 v[68:71], v63, s[28:31], 0 offen offset:1024
    s_lshl_b32 s12, s33, 8
    s_add_u32 s12, s12, 3149824
    buffer_load_dwordx2 v[76:77], off, s[8:11], s12 sc1
    s_lshl_b32 s43, s33, 10
    s_add_u32 s43, s43, 17891328
    s_waitcnt vmcnt(1)
    buffer_store_dwordx4 v[68:71], v7, s[8:11], s43 offen
    ds_read_b128 v[10:13], v0 offset:24576
    ds_read_b128 v[14:17], v0 offset:25600
    ds_read_b128 v[18:21], v0 offset:26624
    ds_read_b128 v[22:25], v0 offset:27648
    v_mov_b64 v[60:61], v[72:73]
    v_mov_b64 v[62:63], v[74:75]
    v_mov_b64 v[32:33], 0
    v_mov_b64 v[34:35], 0
    v_mov_b64 v[36:37], 0
    v_mov_b64 v[38:39], 0
    v_mov_b64 v[40:41], 0
    v_mov_b64 v[42:43], 0
    v_mov_b64 v[44:45], 0
    v_mov_b64 v[46:47], 0
    v_mov_b64 v[48:49], 0
    v_mov_b64 v[50:51], 0
    v_mov_b64 v[52:53], 0
    v_mov_b64 v[54:55], 0
    s_mov_b32 s34, 0
    s_mov_b32 s35, 20000
    s_mov_b32 s36, 1
    s_mov_b32 s60, 0
    s_mov_b32 s61, 0
    s_mov_b32 s3, 0x5d800000
    s_mov_b32 s13, 0
    s_mov_b32 s14, 0x3f80
    s_mov_b32 s15, 3145728
    s_lshl_b32 s16, s33, 2
    s_add_u32 s16, s16, s15
    s_mov_b32 s37, 1343488
    s_mov_b32 s41, 2113536
    s_lshl_b32 s49, s33, 11
    s_add_u32 s49, s49, 49152
    s_lshl_b32 s19, s33, 10
    s_add_u32 s19, s19, 114688
    s_lshl_b32 s54, s33, 14
    s_add_u32 s44, s54, 33419264
    s_add_u32 s25, s44, 81920
    s_sub_u32 s45, s44, 442368
    s_mov_b32 s46, 16629760
    s_cmp_lt_u32 s33, 18
    s_cselect_b32 s47, 0, 18
    s_sub_u32 s47, s33, s47
    s_lshl_b32 s47, s47, 9
    s_add_u32 s47, s47, 73728
    s_mov_b32 s48, 0x3e0293ee
    s_mov_b32 s50, 0x33333333
    s_mov_b32 s51, 0x33333333
    s_mov_b32 s52, 0x3f803f80
    s_mov_b32 s53, 0x3f803f80
    s_mov_b32 s62, 0x11111111
    s_mov_b32 s63, 0x11111111
    s_mov_b32 m0, 158720
    v_lshlrev_b32 v78, 2, v1
    s_waitcnt lgkmcnt(0)
    s_waitcnt vmcnt(1)
    v_min_u32 v76, v76, v77
T3_kv:
    v_cmp_eq_u32 vcc, 0, v76
    s_cbranch_vccz T3_kv_ok
    buffer_load_dwordx2 v[76:77], off, s[8:11], s12 sc1
    s_sub_u32 s95, s95, 1
    s_cmp_eq_u32 s95, 0
    s_cbranch_scc1 L_end
    s_waitcnt vmcnt(0)
    v_min_u32 v76, v76, v77
    s_branch T3_kv
T3_kv_ok:
    buffer_load_dword v9, v78, s[8:11], s45 offen sc1
    s_add_u32 s12, s12, 8
    s_mul_i32 s54, s33, 18432
    s_add_u32 s54, s54, 471040
    buffer_load_dword v9, v78, s[8:11], s54 offen sc1
    s_branch T3_head
T2_pro:
    v_and_b32 v2, 63, v0
    v_and_b32 v3, 15, v0
    v_lshrrev_b32 v4, 4, v2
    s_mul_i32 s54, s33, 147456
    v_bfe_u32 v5, v2, 5, 1
    v_lshlrev_b32 v5, 3, v5
    v_bfe_u32 v6, v2, 4, 1
    v_lshl_add_u32 v5, v6, 1, v5
    v_mul_u32_u24 v5, 1152, v5
    v_lshlrev_b32 v6, 2, v3
    v_add3_u32 v9, v5, v6, s54
    v_and_b32 v7, 3, v2
    v_lshlrev_b32 v7, 4, v7
    v_bfe_u32 v5, v2, 3, 1
    v_lshlrev_b32 v5, 3, v5
    v_lshl_add_u32 v5, v4, 1, v5
    v_bfe_u32 v6, v2, 2, 1
    v_add_u32 v5, v5, v6
    s_lshl_b32 s55, s33, 8
    s_add_u32 s55, s55, 128
    v_lshlrev_b32 v5, 13, v5
    v_add3_u32 v8, v5, v7, s55
    v_lshlrev_b32 v5, 4, v6
    v_bfe_u32 v6, v2, 3, 1
    v_lshl_add_u32 v5, v6, 2, v5
    v_add_u32 v5, v5, v4
    v_bfe_u32 v6, v2, 1, 1
    v_lshl_add_u32 v5, v6, 6, v5
    v_mul_u32_u24 v5, 1152, v5
    v_and_b32 v6, 16, v7
    v_add3_u32 v26, v5, v6, s54
    v_lshrrev_b32 v5, 2, v3
    v_lshl_add_u32 v5, v4, 3, v5
    v_lshlrev_b32 v5, 6, v5
    v_lshrrev_b32 v6, 1, v7
    v_add_u32 v5, v5, v6
    v_add_u32 v27, 73728, v5
    v_add_u32 v28, 155648, v5
    v_lshlrev_b32 v5, 4, v2
    v_add_u32 v0, 73728, v5
    v_add_u32 v1, 147456, v5
    s_mov_b32 s54, 0x05040100
    s_mov_b32 s55, 0x07060302
    s_barrier
    s_mov_b32 m0, 155648
    s_mov_b32 s57, 1088
    buffer_load_dwordx4 v26, s[24:27], s57 offen lds
    s_mov_b32 m0, 156672
    s_mov_b32 s57, 10304
    buffer_load_dwordx4 v26, s[24:27], s57 offen lds
    s_mov_b32 m0, 157696
    s_mov_b32 s57, 37952
    buffer_load_dwordx4 v26, s[24:27], s57 offen lds
    s_mov_b32 m0, 158720
    s_mov_b32 s57, 47168
    buffer_load_dwordx4 v26, s[24:27], s57 offen lds
    s_mov_b32 m0, 106496
    s_mov_b32 s57, 0
    buffer_load_dwordx4 v8, s[20:23], s57 offen  lds
    s_mov_b32 m0, 107520
    s_mov_b32 s57, 131072
    buffer_load_dwordx4 v8, s[20:23], s57 offen  lds
    s_mov_b32 m0, 108544
    s_mov_b32 s57, 262144
    buffer_load_dwordx4 v8, s[20:23], s57 offen  lds
    s_mov_b32 m0, 109568
    s_mov_b32 s57, 393216
    buffer_load_dwordx4 v8, s[20:23], s57 offen  lds
    s_mov_b32 m0, 102400
    s_mov_b32 s57, 524288
    buffer_load_dwordx4 v8, s[20:23], s57 offen  lds
    s_mov_b32 m0, 103424
    s_mov_b32 s57, 655360
    buffer_load_dwordx4 v8, s[20:23], s57 offen  lds
    s_mov_b32 m0, 104448
    s_mov_b32 s57, 786432
    buffer_load_dwordx4 v8, s[20:23], s57 offen  lds
    s_mov_b32 m0, 105472
    s_mov_b32 s57, 917504
    buffer_load_dwordx4 v8, s[20:23], s57 offen  lds
    s_mov_b32 s57, 128
    buffer_load_dword v30, v9, s[24:27], s57 offen offset:0
    buffer_load_dword v31, v9, s[24:27], s57 offen offset:256
    s_mov_b32 s57, 18560
    buffer_load_dword v32, v9, s[24:27], s57 offen offset:0
    buffer_load_dword v33, v9, s[24:27], s57 offen offset:256
    s_mov_b32 s57, 4736
    buffer_load_dword v34, v9, s[24:27], s57 offen offset:0
    buffer_load_dword v35, v9, s[24:27], s57 offen offset:256
    s_mov_b32 s57, 23168
    buffer_load_dword v36, v9, s[24:27], s57 offen offset:0
    buffer_load_dword v37, v9, s[24:27], s57 offen offset:256
    s_mov_b32 s57, 1280
    buffer_load_dword v38, v9, s[24:27], s57 offen offset:0
    buffer_load_dword v39, v9, s[24:27], s57 offen offset:256
    s_mov_b32 s57, 19712
    buffer_load_dword v40, v9, s[24:27], s57 offen offset:0
    buffer_load_dword v41, v9, s[24:27], s57 offen offset:256
    s_mov_b32 s57, 5888
    buffer_load_dword v42, v9, s[24:27], s57 offen offset:0
    buffer_load_dword v43, v9, s[24:27], s57 offen offset:256
    s_mov_b32 s57, 24320
    buffer_load_dword v44, v9, s[24:27], s57 offen offset:0
    buffer_load_dword v45, v9, s[24:27], s57 offen offset:256
    s_mov_b32 s57, 36992
    buffer_load_dword v46, v9, s[24:27], s57 offen offset:0
    buffer_load_dword v47, v9, s[24:27], s57 offen offset:256
    s_mov_b32 s57, 55424
    buffer_load_dword v48, v9, s[24:27], s57 offen offset:0
    buffer_load_dword v49, v9, s[24:27], s57 offen offset:256
    s_mov_b32 s57, 41600
    buffer_load_dword v50, v9, s[24:27], s57 offen offset:0
    buffer_load_dword v51, v9, s[24:27], s57 offen offset:256
    s_mov_b32 s57, 60032
    buffer_load_dword v52, v9, s[24:27], s57 offen offset:0
    buffer_load_dword v53, v9, s[24:27], s57 offen offset:256
    s_mov_b32 s57, 38144
    buffer_load_dword v54, v9, s[24:27], s57 offen offset:0
    buffer_load_dword v55, v9, s[24:27], s57 offen offset:256
    s_mov_b32 s57, 56576
    buffer_load_dword v56, v9, s[24:27], s57 offen offset:0
    buffer_load_dword v57, v9, s[24:27], s57 offen offset:256
    s_mov_b32 s57, 42752
    buffer_load_dword v58, v9, s[24:27], s57 offen offset:0
    buffer_load_dword v59, v9, s[24:27], s57 offen offset:256
    s_mov_b32 s57, 61184
    buffer_load_dword v60, v9, s[24:27], s57 offen offset:0
    buffer_load_dword v61, v9, s[24:27], s57 offen offset:256
    s_waitcnt vmcnt(40)
    ds_read_b64_tr_b16 v[240:241], v28 offset:0
    ds_read_b64_tr_b16 v[242:243], v28 offset:256
    ds_read_b64_tr_b16 v[244:245], v28 offset:2048
    ds_read_b64_tr_b16 v[246:247], v28 offset:2304
    ds_read_b64_tr_b16 v[248:249], v28 offset:32
    ds_read_b64_tr_b16 v[250:251], v28 offset:288
    ds_read_b64_tr_b16 v[252:253], v28 offset:2080
    ds_read_b64_tr_b16 v[254:255], v28 offset:2336
    s_waitcnt lgkmcnt(0)
    s_barrier
    s_mov_b32 m0, 155648
    s_mov_b32 s57, 1048576
    buffer_load_dwordx4 v8, s[20:23], s57 offen  lds
    s_mov_b32 m0, 156672
    s_mov_b32 s57, 1179648
    buffer_load_dwordx4 v8, s[20:23], s57 offen  lds
    s_mov_b32 m0, 157696
    s_mov_b32 s57, 1310720
    buffer_load_dwordx4 v8, s[20:23], s57 offen  lds
    s_mov_b32 m0, 158720
    s_mov_b32 s57, 1441792
    buffer_load_dwordx4 v8, s[20:23], s57 offen  lds
    s_waitcnt vmcnt(40)
    ds_read_b64_tr_b16 a[144:145], v27 offset:32768
    ds_read_b64_tr_b16 a[146:147], v27 offset:33024
    ds_read_b64_tr_b16 a[148:149], v27 offset:34816
    ds_read_b64_tr_b16 a[150:151], v27 offset:35072
    ds_read_b64_tr_b16 a[152:153], v27 offset:32800
    ds_read_b64_tr_b16 a[154:155], v27 offset:33056
    ds_read_b64_tr_b16 a[156:157], v27 offset:34848
    ds_read_b64_tr_b16 a[158:159], v27 offset:35104
    s_waitcnt lgkmcnt(0)
    s_barrier
    s_mov_b32 m0, 106496
    s_mov_b32 s57, 1572864
    buffer_load_dwordx4 v8, s[20:23], s57 offen  lds
    s_mov_b32 m0, 107520
    s_mov_b32 s57, 1703936
    buffer_load_dwordx4 v8, s[20:23], s57 offen  lds
    s_mov_b32 m0, 108544
    s_mov_b32 s57, 1835008
    buffer_load_dwordx4 v8, s[20:23], s57 offen  lds
    s_mov_b32 m0, 109568
    s_mov_b32 s57, 1966080
    buffer_load_dwordx4 v8, s[20:23], s57 offen  lds
    s_waitcnt vmcnt(40)
    ds_read_b64_tr_b16 a[192:193], v27 offset:28672
    ds_read_b64_tr_b16 a[194:195], v27 offset:28928
    ds_read_b64_tr_b16 a[196:197], v27 offset:30720
    ds_read_b64_tr_b16 a[198:199], v27 offset:30976
    ds_read_b64_tr_b16 a[200:201], v27 offset:28704
    ds_read_b64_tr_b16 a[202:203], v27 offset:28960
    ds_read_b64_tr_b16 a[204:205], v27 offset:30752
    ds_read_b64_tr_b16 a[206:207], v27 offset:31008
    s_waitcnt lgkmcnt(0)
    s_barrier
    s_mov_b32 m0, 102400
    s_mov_b32 s57, 2097152
    buffer_load_dwordx4 v8, s[20:23], s57 offen  lds
    s_mov_b32 m0, 103424
    s_mov_b32 s57, 2228224
    buffer_load_dwordx4 v8, s[20:23], s57 offen  lds
    s_mov_b32 m0, 104448
    s_mov_b32 s57, 2359296
    buffer_load_dwordx4 v8, s[20:23], s57 offen  lds
    s_mov_b32 m0, 105472
    s_mov_b32 s57, 2490368
    buffer_load_dwordx4 v8, s[20:23], s57 offen  lds
    s_waitcnt vmcnt(8)
    ds_read_b64_tr_b16 a[16:17], v28 offset:0
    ds_read_b64_tr_b16 a[18:19], v28 offset:256
    ds_read_b64_tr_b16 a[20:21], v28 offset:2048
    ds_read_b64_tr_b16 a[22:23], v28 offset:2304
    ds_read_b64_tr_b16 a[24:25], v28 offset:32
    ds_read_b64_tr_b16 a[26:27], v28 offset:288
    ds_read_b64_tr_b16 a[28:29], v28 offset:2080
    ds_read_b64_tr_b16 a[30:31], v28 offset:2336
    s_waitcnt lgkmcnt(0)
    s_barrier
    s_mov_b32 m0, 155648
    s_mov_b32 s57, 2621440
    buffer_load_dwordx4 v8, s[20:23], s57 offen  lds
    s_mov_b32 m0, 156672
    s_mov_b32 s57, 2752512
    buffer_load_dwordx4 v8, s[20:23], s57 offen  lds
    s_mov_b32 m0, 157696
    s_mov_b32 s57, 2883584
    buffer_load_dwordx4 v8, s[20:23], s57 offen  lds
    s_mov_b32 m0, 158720
    s_mov_b32 s57, 3014656
    buffer_load_dwordx4 v8, s[20:23], s57 offen  lds
    s_waitcnt vmcnt(8)
    ds_read_b64_tr_b16 a[112:113], v27 offset:32768
    ds_read_b64_tr_b16 a[114:115], v27 offset:33024
    ds_read_b64_tr_b16 a[116:117], v27 offset:34816
    ds_read_b64_tr_b16 a[118:119], v27 offset:35072
    ds_read_b64_tr_b16 a[120:121], v27 offset:32800
    ds_read_b64_tr_b16 a[122:123], v27 offset:33056
    ds_read_b64_tr_b16 a[124:125], v27 offset:34848
    ds_read_b64_tr_b16 a[126:127], v27 offset:35104
    s_waitcnt lgkmcnt(0)
    s_barrier
    s_mov_b32 m0, 106496
    s_mov_b32 s57, 3145728
    buffer_load_dwordx4 v8, s[20:23], s57 offen  lds
    s_mov_b32 m0, 107520
    s_mov_b32 s57, 3276800
    buffer_load_dwordx4 v8, s[20:23], s57 offen  lds
    s_mov_b32 m0, 108544
    s_mov_b32 s57, 3407872
    buffer_load_dwordx4 v8, s[20:23], s57 offen  lds
    s_mov_b32 m0, 109568
    s_mov_b32 s57, 3538944
    buffer_load_dwordx4 v8, s[20:23], s57 offen  lds
    s_waitcnt vmcnt(8)
    ds_read_b64_tr_b16 v[80:81], v27 offset:28672
    ds_read_b64_tr_b16 v[82:83], v27 offset:28928
    ds_read_b64_tr_b16 v[84:85], v27 offset:30720
    ds_read_b64_tr_b16 v[86:87], v27 offset:30976
    ds_read_b64_tr_b16 v[88:89], v27 offset:28704
    ds_read_b64_tr_b16 v[90:91], v27 offset:28960
    ds_read_b64_tr_b16 v[92:93], v27 offset:30752
    ds_read_b64_tr_b16 v[94:95], v27 offset:31008
    s_waitcnt lgkmcnt(0)
    s_barrier
    s_mov_b32 m0, 86016
    s_mov_b32 s57, 3670016
    buffer_load_dwordx4 v8, s[20:23], s57 offen  lds
    s_mov_b32 m0, 87040
    s_mov_b32 s57, 3801088
    buffer_load_dwordx4 v8, s[20:23], s57 offen  lds
    s_mov_b32 m0, 88064
    s_mov_b32 s57, 3932160
    buffer_load_dwordx4 v8, s[20:23], s57 offen  lds
    s_mov_b32 m0, 89088
    s_mov_b32 s57, 4063232
    buffer_load_dwordx4 v8, s[20:23], s57 offen  lds
    v_perm_b32 v10, v32, v30, s54
    v_perm_b32 v18, v36, v34, s54
    v_perm_b32 v12, v40, v38, s54
    v_perm_b32 v20, v44, v42, s54
    v_perm_b32 v14, v48, v46, s54
    v_perm_b32 v22, v52, v50, s54
    v_perm_b32 v16, v56, v54, s54
    v_perm_b32 v24, v60, v58, s54
    v_perm_b32 v19, v32, v30, s55
    v_perm_b32 v11, v36, v34, s55
    v_perm_b32 v21, v40, v38, s55
    v_perm_b32 v13, v44, v42, s55
    v_perm_b32 v23, v48, v46, s55
    v_perm_b32 v15, v52, v50, s55
    v_perm_b32 v25, v56, v54, s55
    v_perm_b32 v17, v60, v58, s55
    ds_write_b128 v0, v[10:13] offset:0
    ds_write_b128 v0, v[14:17] offset:1024
    ds_write_b128 v0, v[18:21] offset:2048
    ds_write_b128 v0, v[22:25] offset:3072
    v_perm_b32 v160, v33, v31, s54
    v_perm_b32 v168, v37, v35, s54
    v_perm_b32 v162, v41, v39, s54
    v_perm_b32 v170, v45, v43, s54
    v_perm_b32 v164, v49, v47, s54
    v_perm_b32 v172, v53, v51, s54
    v_perm_b32 v166, v57, v55, s54
    v_perm_b32 v174, v61, v59, s54
    v_perm_b32 v169, v33, v31, s55
    v_perm_b32 v161, v37, v35, s55
    v_perm_b32 v171, v41, v39, s55
    v_perm_b32 v163, v45, v43, s55
    v_perm_b32 v173, v49, v47, s55
    v_perm_b32 v165, v53, v51, s55
    v_perm_b32 v175, v57, v55, s55
    v_perm_b32 v167, v61, v59, s55
    s_waitcnt vmcnt(8)
    ds_read_b64_tr_b16 v[128:129], v28 offset:0
    ds_read_b64_tr_b16 v[130:131], v28 offset:256
    ds_read_b64_tr_b16 v[132:133], v28 offset:2048
    ds_read_b64_tr_b16 v[134:135], v28 offset:2304
    ds_read_b64_tr_b16 v[136:137], v28 offset:32
    ds_read_b64_tr_b16 v[138:139], v28 offset:288
    ds_read_b64_tr_b16 v[140:141], v28 offset:2080
    ds_read_b64_tr_b16 v[142:143], v28 offset:2336
    s_waitcnt lgkmcnt(0)
    s_barrier
    s_mov_b32 m0, 90112
    s_mov_b32 s57, 4194304
    buffer_load_dwordx4 v8, s[20:23], s57 offen  lds
    s_mov_b32 m0, 91136
    s_mov_b32 s57, 4325376
    buffer_load_dwordx4 v8, s[20:23], s57 offen  lds
    s_mov_b32 m0, 92160
    s_mov_b32 s57, 4456448
    buffer_load_dwordx4 v8, s[20:23], s57 offen  lds
    s_mov_b32 m0, 93184
    s_mov_b32 s57, 4587520
    buffer_load_dwordx4 v8, s[20:23], s57 offen  lds
    s_mov_b32 s57, 73856
    buffer_load_dword v30, v9, s[24:27], s57 offen offset:0
    buffer_load_dword v31, v9, s[24:27], s57 offen offset:256
    s_mov_b32 s57, 92288
    buffer_load_dword v32, v9, s[24:27], s57 offen offset:0
    buffer_load_dword v33, v9, s[24:27], s57 offen offset:256
    s_mov_b32 s57, 78464
    buffer_load_dword v34, v9, s[24:27], s57 offen offset:0
    buffer_load_dword v35, v9, s[24:27], s57 offen offset:256
    s_mov_b32 s57, 96896
    buffer_load_dword v36, v9, s[24:27], s57 offen offset:0
    buffer_load_dword v37, v9, s[24:27], s57 offen offset:256
    s_mov_b32 s57, 75008
    buffer_load_dword v38, v9, s[24:27], s57 offen offset:0
    buffer_load_dword v39, v9, s[24:27], s57 offen offset:256
    s_mov_b32 s57, 93440
    buffer_load_dword v40, v9, s[24:27], s57 offen offset:0
    buffer_load_dword v41, v9, s[24:27], s57 offen offset:256
    s_mov_b32 s57, 79616
    buffer_load_dword v42, v9, s[24:27], s57 offen offset:0
    buffer_load_dword v43, v9, s[24:27], s57 offen offset:256
    s_mov_b32 s57, 98048
    buffer_load_dword v44, v9, s[24:27], s57 offen offset:0
    buffer_load_dword v45, v9, s[24:27], s57 offen offset:256
    s_mov_b32 s57, 110720
    buffer_load_dword v46, v9, s[24:27], s57 offen offset:0
    buffer_load_dword v47, v9, s[24:27], s57 offen offset:256
    s_mov_b32 s57, 129152
    buffer_load_dword v48, v9, s[24:27], s57 offen offset:0
    buffer_load_dword v49, v9, s[24:27], s57 offen offset:256
    s_mov_b32 s57, 115328
    buffer_load_dword v50, v9, s[24:27], s57 offen offset:0
    buffer_load_dword v51, v9, s[24:27], s57 offen offset:256
    s_mov_b32 s57, 133760
    buffer_load_dword v52, v9, s[24:27], s57 offen offset:0
    buffer_load_dword v53, v9, s[24:27], s57 offen offset:256
    s_mov_b32 s57, 111872
    buffer_load_dword v54, v9, s[24:27], s57 offen offset:0
    buffer_load_dword v55, v9, s[24:27], s57 offen offset:256
    s_mov_b32 s57, 130304
    buffer_load_dword v56, v9, s[24:27], s57 offen offset:0
    buffer_load_dword v57, v9, s[24:27], s57 offen offset:256
    s_mov_b32 s57, 116480
    buffer_load_dword v58, v9, s[24:27], s57 offen offset:0
    buffer_load_dword v59, v9, s[24:27], s57 offen offset:256
    s_mov_b32 s57, 134912
    buffer_load_dword v60, v9, s[24:27], s57 offen offset:0
    buffer_load_dword v61, v9, s[24:27], s57 offen offset:256
    s_waitcnt vmcnt(40)
    ds_read_b64_tr_b16 a[64:65], v27 offset:32768
    ds_read_b64_tr_b16 a[66:67], v27 offset:33024
    ds_read_b64_tr_b16 a[68:69], v27 offset:34816
    ds_read_b64_tr_b16 a[70:71], v27 offset:35072
    ds_read_b64_tr_b16 a[72:73], v27 offset:32800
    ds_read_b64_tr_b16 a[74:75], v27 offset:33056
    ds_read_b64_tr_b16 a[76:77], v27 offset:34848
    ds_read_b64_tr_b16 a[78:79], v27 offset:35104
    s_waitcnt lgkmcnt(0)
    s_barrier
    s_mov_b32 m0, 94208
    s_mov_b32 s57, 0
    buffer_load_dwordx4 v8, s[12:15], s57 offen  lds
    s_mov_b32 m0, 95232
    s_mov_b32 s57, 131072
    buffer_load_dwordx4 v8, s[12:15], s57 offen  lds
    s_mov_b32 m0, 96256
    s_mov_b32 s57, 262144
    buffer_load_dwordx4 v8, s[12:15], s57 offen  lds
    s_mov_b32 m0, 97280
    s_mov_b32 s57, 393216
    buffer_load_dwordx4 v8, s[12:15], s57 offen  lds
    s_waitcnt vmcnt(40)
    ds_read_b64_tr_b16 v[10:11], v27 offset:12288
    ds_read_b64_tr_b16 v[12:13], v27 offset:12544
    ds_read_b64_tr_b16 v[14:15], v27 offset:14336
    ds_read_b64_tr_b16 v[16:17], v27 offset:14592
    ds_read_b64_tr_b16 v[18:19], v27 offset:12320
    ds_read_b64_tr_b16 v[20:21], v27 offset:12576
    ds_read_b64_tr_b16 v[22:23], v27 offset:14368
    ds_read_b64_tr_b16 v[24:25], v27 offset:14624
    s_waitcnt lgkmcnt(0)
    ds_write_b128 v0, v[10:13] offset:12288
    ds_write_b128 v0, v[14:17] offset:13312
    ds_write_b128 v0, v[18:21] offset:14336
    ds_write_b128 v0, v[22:25] offset:15360
    s_barrier
    s_mov_b32 m0, 155648
    s_mov_b32 s57, 524288
    buffer_load_dwordx4 v8, s[12:15], s57 offen  lds
    s_mov_b32 m0, 156672
    s_mov_b32 s57, 655360
    buffer_load_dwordx4 v8, s[12:15], s57 offen  lds
    s_mov_b32 m0, 157696
    s_mov_b32 s57, 786432
    buffer_load_dwordx4 v8, s[12:15], s57 offen  lds
    s_mov_b32 m0, 158720
    s_mov_b32 s57, 917504
    buffer_load_dwordx4 v8, s[12:15], s57 offen  lds
    s_waitcnt vmcnt(40)
    ds_read_b64_tr_b16 v[10:11], v27 offset:16384
    ds_read_b64_tr_b16 v[12:13], v27 offset:16640
    ds_read_b64_tr_b16 v[14:15], v27 offset:18432
    ds_read_b64_tr_b16 v[16:17], v27 offset:18688
    ds_read_b64_tr_b16 v[18:19], v27 offset:16416
    ds_read_b64_tr_b16 v[20:21], v27 offset:16672
    ds_read_b64_tr_b16 v[22:23], v27 offset:18464
    ds_read_b64_tr_b16 v[24:25], v27 offset:18720
    s_waitcnt lgkmcnt(0)
    ds_write_b128 v0, v[10:13] offset:16384
    ds_write_b128 v0, v[14:17] offset:17408
    ds_write_b128 v0, v[18:21] offset:18432
    ds_write_b128 v0, v[22:25] offset:19456
    s_barrier
    s_mov_b32 m0, 98304
    s_mov_b32 s57, 1048576
    buffer_load_dwordx4 v8, s[12:15], s57 offen  lds
    s_mov_b32 m0, 99328
    s_mov_b32 s57, 1179648
    buffer_load_dwordx4 v8, s[12:15], s57 offen  lds
    s_mov_b32 m0, 100352
    s_mov_b32 s57, 1310720
    buffer_load_dwordx4 v8, s[12:15], s57 offen  lds
    s_mov_b32 m0, 101376
    s_mov_b32 s57, 1441792
    buffer_load_dwordx4 v8, s[12:15], s57 offen  lds
    s_waitcnt vmcnt(8)
    ds_read_b64_tr_b16 v[10:11], v27 offset:20480
    ds_read_b64_tr_b16 v[12:13], v27 offset:20736
    ds_read_b64_tr_b16 v[14:15], v27 offset:22528
    ds_read_b64_tr_b16 v[16:17], v27 offset:22784
    ds_read_b64_tr_b16 v[18:19], v27 offset:20512
    ds_read_b64_tr_b16 v[20:21], v27 offset:20768
    ds_read_b64_tr_b16 v[22:23], v27 offset:22560
    ds_read_b64_tr_b16 v[24:25], v27 offset:22816
    s_waitcnt lgkmcnt(0)
    ds_write_b128 v0, v[10:13] offset:20480
    ds_write_b128 v0, v[14:17] offset:21504
    ds_write_b128 v0, v[18:21] offset:22528
    ds_write_b128 v0, v[22:25] offset:23552
    s_barrier
    s_mov_b32 m0, 106496
    s_mov_b32 s57, 1572864
    buffer_load_dwordx4 v8, s[12:15], s57 offen  lds
    s_mov_b32 m0, 107520
    s_mov_b32 s57, 1703936
    buffer_load_dwordx4 v8, s[12:15], s57 offen  lds
    s_mov_b32 m0, 108544
    s_mov_b32 s57, 1835008
    buffer_load_dwordx4 v8, s[12:15], s57 offen  lds
    s_mov_b32 m0, 109568
    s_mov_b32 s57, 1966080
    buffer_load_dwordx4 v8, s[12:15], s57 offen  lds
    s_waitcnt vmcnt(8)
    ds_read_b64_tr_b16 a[160:161], v28 offset:0
    ds_read_b64_tr_b16 a[162:163], v28 offset:256
    ds_read_b64_tr_b16 a[164:165], v28 offset:2048
    ds_read_b64_tr_b16 a[166:167], v28 offset:2304
    ds_read_b64_tr_b16 a[168:169], v28 offset:32
    ds_read_b64_tr_b16 a[170:171], v28 offset:288
    ds_read_b64_tr_b16 a[172:173], v28 offset:2080
    ds_read_b64_tr_b16 a[174:175], v28 offset:2336
    s_waitcnt lgkmcnt(0)
    s_barrier
    s_mov_b32 m0, 155648
    s_mov_b32 s57, 2097152
    buffer_load_dwordx4 v8, s[12:15], s57 offen  lds
    s_mov_b32 m0, 156672
    s_mov_b32 s57, 2228224
    buffer_load_dwordx4 v8, s[12:15], s57 offen  lds
    s_mov_b32 m0, 157696
    s_mov_b32 s57, 2359296
    buffer_load_dwordx4 v8, s[12:15], s57 offen  lds
    s_mov_b32 m0, 158720
    s_mov_b32 s57, 2490368
    buffer_load_dwordx4 v8, s[12:15], s57 offen  lds
    s_waitcnt vmcnt(8)
    ds_read_b64_tr_b16 v[10:11], v27 offset:24576
    ds_read_b64_tr_b16 v[12:13], v27 offset:24832
    ds_read_b64_tr_b16 v[14:15], v27 offset:26624
    ds_read_b64_tr_b16 v[16:17], v27 offset:26880
    ds_read_b64_tr_b16 v[18:19], v27 offset:24608
    ds_read_b64_tr_b16 v[20:21], v27 offset:24864
    ds_read_b64_tr_b16 v[22:23], v27 offset:26656
    ds_read_b64_tr_b16 v[24:25], v27 offset:26912
    s_waitcnt lgkmcnt(0)
    ds_write_b128 v0, v[10:13] offset:24576
    ds_write_b128 v0, v[14:17] offset:25600
    ds_write_b128 v0, v[18:21] offset:26624
    ds_write_b128 v0, v[22:25] offset:27648
    s_barrier
    s_mov_b32 m0, 102400
    s_mov_b32 s57, 2621440
    buffer_load_dwordx4 v8, s[12:15], s57 offen  lds
    s_mov_b32 m0, 103424
    s_mov_b32 s57, 2752512
    buffer_load_dwordx4 v8, s[12:15], s57 offen  lds
    s_mov_b32 m0, 104448
    s_mov_b32 s57, 2883584
    buffer_load_dwordx4 v8, s[12:15], s57 offen  lds
    s_mov_b32 m0, 105472
    s_mov_b32 s57, 3014656
    buffer_load_dwordx4 v8, s[12:15], s57 offen  lds
    v_perm_b32 v208, v32, v30, s54
    v_perm_b32 v216, v36, v34, s54
    v_perm_b32 v210, v40, v38, s54
    v_perm_b32 v218, v44, v42, s54
    v_perm_b32 v212, v48, v46, s54
    v_perm_b32 v220, v52, v50, s54
    v_perm_b32 v214, v56, v54, s54
    v_perm_b32 v222, v60, v58, s54
    v_perm_b32 v217, v32, v30, s55
    v_perm_b32 v209, v36, v34, s55
    v_perm_b32 v219, v40, v38, s55
    v_perm_b32 v211, v44, v42, s55
    v_perm_b32 v221, v48, v46, s55
    v_perm_b32 v213, v52, v50, s55
    v_perm_b32 v223, v56, v54, s55
    v_perm_b32 v215, v60, v58, s55
    v_perm_b32 v10, v33, v31, s54
    v_perm_b32 v18, v37, v35, s54
    v_perm_b32 v12, v41, v39, s54
    v_perm_b32 v20, v45, v43, s54
    v_perm_b32 v14, v49, v47, s54
    v_perm_b32 v22, v53, v51, s54
    v_perm_b32 v16, v57, v55, s54
    v_perm_b32 v24, v61, v59, s54
    v_perm_b32 v19, v33, v31, s55
    v_perm_b32 v11, v37, v35, s55
    v_perm_b32 v21, v41, v39, s55
    v_perm_b32 v13, v45, v43, s55
    v_perm_b32 v23, v49, v47, s55
    v_perm_b32 v15, v53, v51, s55
    v_perm_b32 v25, v57, v55, s55
    v_perm_b32 v17, v61, v59, s55
    ds_write_b128 v0, v[10:13] offset:4096
    ds_write_b128 v0, v[14:17] offset:5120
    ds_write_b128 v0, v[18:21] offset:6144
    ds_write_b128 v0, v[22:25] offset:7168
    s_waitcnt vmcnt(8)
    ds_read_b64_tr_b16 a[80:81], v27 offset:32768
    ds_read_b64_tr_b16 a[82:83], v27 offset:33024
    ds_read_b64_tr_b16 a[84:85], v27 offset:34816
    ds_read_b64_tr_b16 a[86:87], v27 offset:35072
    ds_read_b64_tr_b16 a[88:89], v27 offset:32800
    ds_read_b64_tr_b16 a[90:91], v27 offset:33056
    ds_read_b64_tr_b16 a[92:93], v27 offset:34848
    ds_read_b64_tr_b16 a[94:95], v27 offset:35104
    s_waitcnt lgkmcnt(0)
    s_barrier
    s_mov_b32 m0, 106496
    s_mov_b32 s57, 3145728
    buffer_load_dwordx4 v8, s[12:15], s57 offen  lds
    s_mov_b32 m0, 107520
    s_mov_b32 s57, 3276800
    buffer_load_dwordx4 v8, s[12:15], s57 offen  lds
    s_mov_b32 m0, 108544
    s_mov_b32 s57, 3407872
    buffer_load_dwordx4 v8, s[12:15], s57 offen  lds
    s_mov_b32 m0, 109568
    s_mov_b32 s57, 3538944
    buffer_load_dwordx4 v8, s[12:15], s57 offen  lds
    s_mov_b32 s57, 640
    buffer_load_dword v30, v9, s[24:27], s57 offen offset:0
    buffer_load_dword v31, v9, s[24:27], s57 offen offset:256
    s_mov_b32 s57, 19072
    buffer_load_dword v32, v9, s[24:27], s57 offen offset:0
    buffer_load_dword v33, v9, s[24:27], s57 offen offset:256
    s_mov_b32 s57, 5248
    buffer_load_dword v34, v9, s[24:27], s57 offen offset:0
    buffer_load_dword v35, v9, s[24:27], s57 offen offset:256
    s_mov_b32 s57, 23680
    buffer_load_dword v36, v9, s[24:27], s57 offen offset:0
    buffer_load_dword v37, v9, s[24:27], s57 offen offset:256
    s_mov_b32 s57, 1792
    buffer_load_dword v38, v9, s[24:27], s57 offen offset:0
    buffer_load_dword v39, v9, s[24:27], s57 offen offset:256
    s_mov_b32 s57, 20224
    buffer_load_dword v40, v9, s[24:27], s57 offen offset:0
    buffer_load_dword v41, v9, s[24:27], s57 offen offset:256
    s_mov_b32 s57, 6400
    buffer_load_dword v42, v9, s[24:27], s57 offen offset:0
    buffer_load_dword v43, v9, s[24:27], s57 offen offset:256
    s_mov_b32 s57, 24832
    buffer_load_dword v44, v9, s[24:27], s57 offen offset:0
    buffer_load_dword v45, v9, s[24:27], s57 offen offset:256
    s_mov_b32 s57, 37504
    buffer_load_dword v46, v9, s[24:27], s57 offen offset:0
    buffer_load_dword v47, v9, s[24:27], s57 offen offset:256
    s_mov_b32 s57, 55936
    buffer_load_dword v48, v9, s[24:27], s57 offen offset:0
    buffer_load_dword v49, v9, s[24:27], s57 offen offset:256
    s_mov_b32 s57, 42112
    buffer_load_dword v50, v9, s[24:27], s57 offen offset:0
    buffer_load_dword v51, v9, s[24:27], s57 offen offset:256
    s_mov_b32 s57, 60544
    buffer_load_dword v52, v9, s[24:27], s57 offen offset:0
    buffer_load_dword v53, v9, s[24:27], s57 offen offset:256
    s_mov_b32 s57, 38656
    buffer_load_dword v54, v9, s[24:27], s57 offen offset:0
    buffer_load_dword v55, v9, s[24:27], s57 offen offset:256
    s_mov_b32 s57, 57088
    buffer_load_dword v56, v9, s[24:27], s57 offen offset:0
    buffer_load_dword v57, v9, s[24:27], s57 offen offset:256
    s_mov_b32 s57, 43264
    buffer_load_dword v58, v9, s[24:27], s57 offen offset:0
    buffer_load_dword v59, v9, s[24:27], s57 offen offset:256
    s_mov_b32 s57, 61696
    buffer_load_dword v60, v9, s[24:27], s57 offen offset:0
    buffer_load_dword v61, v9, s[24:27], s57 offen offset:256
    s_waitcnt vmcnt(40)
    ds_read_b64_tr_b16 a[224:225], v28 offset:0
    ds_read_b64_tr_b16 a[226:227], v28 offset:256
    ds_read_b64_tr_b16 a[228:229], v28 offset:2048
    ds_read_b64_tr_b16 a[230:231], v28 offset:2304
    ds_read_b64_tr_b16 a[232:233], v28 offset:32
    ds_read_b64_tr_b16 a[234:235], v28 offset:288
    ds_read_b64_tr_b16 a[236:237], v28 offset:2080
    ds_read_b64_tr_b16 a[238:239], v28 offset:2336
    s_waitcnt lgkmcnt(0)
    s_barrier
    s_waitcnt vmcnt(36)
    ds_read_b64_tr_b16 v[96:97], v27 offset:28672
    ds_read_b64_tr_b16 v[98:99], v27 offset:28928
    ds_read_b64_tr_b16 v[100:101], v27 offset:30720
    ds_read_b64_tr_b16 v[102:103], v27 offset:30976
    ds_read_b64_tr_b16 v[104:105], v27 offset:28704
    ds_read_b64_tr_b16 v[106:107], v27 offset:28960
    ds_read_b64_tr_b16 v[108:109], v27 offset:30752
    ds_read_b64_tr_b16 v[110:111], v27 offset:31008
    s_waitcnt lgkmcnt(0)
    s_barrier
    s_mov_b32 m0, 102400
    s_mov_b32 s57, 3670016
    buffer_load_dwordx4 v8, s[12:15], s57 offen  lds
    s_mov_b32 m0, 103424
    s_mov_b32 s57, 3801088
    buffer_load_dwordx4 v8, s[12:15], s57 offen  lds
    s_mov_b32 m0, 104448
    s_mov_b32 s57, 3932160
    buffer_load_dwordx4 v8, s[12:15], s57 offen  lds
    s_mov_b32 m0, 105472
    s_mov_b32 s57, 4063232
    buffer_load_dwordx4 v8, s[12:15], s57 offen  lds
    s_mov_b32 m0, 155648
    s_mov_b32 s57, 4194304
    buffer_load_dwordx4 v8, s[12:15], s57 offen  lds
    s_mov_b32 m0, 156672
    s_mov_b32 s57, 4325376
    buffer_load_dwordx4 v8, s[12:15], s57 offen  lds
    s_mov_b32 m0, 157696
    s_mov_b32 s57, 4456448
    buffer_load_dwordx4 v8, s[12:15], s57 offen  lds
    s_mov_b32 m0, 158720
    s_mov_b32 s57, 4587520
    buffer_load_dwordx4 v8, s[12:15], s57 offen  lds
    s_waitcnt vmcnt(40)
    ds_read_b64_tr_b16 a[32:33], v27 offset:32768
    ds_read_b64_tr_b16 a[34:35], v27 offset:33024
    ds_read_b64_tr_b16 a[36:37], v27 offset:34816
    ds_read_b64_tr_b16 a[38:39], v27 offset:35072
    ds_read_b64_tr_b16 a[40:41], v27 offset:32800
    ds_read_b64_tr_b16 a[42:43], v27 offset:33056
    ds_read_b64_tr_b16 a[44:45], v27 offset:34848
    ds_read_b64_tr_b16 a[46:47], v27 offset:35104
    s_waitcnt lgkmcnt(0)
    s_barrier
    s_mov_b32 m0, 106496
    s_mov_b32 s57, 0
    buffer_load_dwordx4 v8, s[16:19], s57 offen  lds
    s_mov_b32 m0, 107520
    s_mov_b32 s57, 131072
    buffer_load_dwordx4 v8, s[16:19], s57 offen  lds
    s_mov_b32 m0, 108544
    s_mov_b32 s57, 262144
    buffer_load_dwordx4 v8, s[16:19], s57 offen  lds
    s_mov_b32 m0, 109568
    s_mov_b32 s57, 393216
    buffer_load_dwordx4 v8, s[16:19], s57 offen  lds
    s_waitcnt vmcnt(8)
    ds_read_b64_tr_b16 v[10:11], v27 offset:28672
    ds_read_b64_tr_b16 v[12:13], v27 offset:28928
    ds_read_b64_tr_b16 v[14:15], v27 offset:30720
    ds_read_b64_tr_b16 v[16:17], v27 offset:30976
    ds_read_b64_tr_b16 v[18:19], v27 offset:28704
    ds_read_b64_tr_b16 v[20:21], v27 offset:28960
    ds_read_b64_tr_b16 v[22:23], v27 offset:30752
    ds_read_b64_tr_b16 v[24:25], v27 offset:31008
    s_waitcnt lgkmcnt(0)
    ds_write_b128 v0, v[10:13] offset:28672
    ds_write_b128 v0, v[14:17] offset:29696
    ds_write_b128 v0, v[18:21] offset:30720
    ds_write_b128 v0, v[22:25] offset:31744
    s_barrier
    s_waitcnt vmcnt(4)
    ds_read_b64_tr_b16 v[144:145], v28 offset:0
    ds_read_b64_tr_b16 v[146:147], v28 offset:256
    ds_read_b64_tr_b16 v[148:149], v28 offset:2048
    ds_read_b64_tr_b16 v[150:151], v28 offset:2304
    ds_read_b64_tr_b16 v[152:153], v28 offset:32
    ds_read_b64_tr_b16 v[154:155], v28 offset:288
    ds_read_b64_tr_b16 v[156:157], v28 offset:2080
    ds_read_b64_tr_b16 v[158:159], v28 offset:2336
    s_waitcnt lgkmcnt(0)
    s_barrier
    s_mov_b32 m0, 155648
    s_mov_b32 s57, 524288
    buffer_load_dwordx4 v8, s[16:19], s57 offen  lds
    s_mov_b32 m0, 156672
    s_mov_b32 s57, 655360
    buffer_load_dwordx4 v8, s[16:19], s57 offen  lds
    s_mov_b32 m0, 157696
    s_mov_b32 s57, 786432
    buffer_load_dwordx4 v8, s[16:19], s57 offen  lds
    s_mov_b32 m0, 158720
    s_mov_b32 s57, 917504
    buffer_load_dwordx4 v8, s[16:19], s57 offen  lds
    s_waitcnt vmcnt(4)
    ds_read_b64_tr_b16 a[128:129], v27 offset:32768
    ds_read_b64_tr_b16 a[130:131], v27 offset:33024
    ds_read_b64_tr_b16 a[132:133], v27 offset:34816
    ds_read_b64_tr_b16 a[134:135], v27 offset:35072
    ds_read_b64_tr_b16 a[136:137], v27 offset:32800
    ds_read_b64_tr_b16 a[138:139], v27 offset:33056
    ds_read_b64_tr_b16 a[140:141], v27 offset:34848
    ds_read_b64_tr_b16 a[142:143], v27 offset:35104
    s_waitcnt lgkmcnt(0)
    s_barrier
    s_mov_b32 m0, 106496
    s_mov_b32 s57, 1048576
    buffer_load_dwordx4 v8, s[16:19], s57 offen  lds
    s_mov_b32 m0, 107520
    s_mov_b32 s57, 1179648
    buffer_load_dwordx4 v8, s[16:19], s57 offen  lds
    s_mov_b32 m0, 108544
    s_mov_b32 s57, 1310720
    buffer_load_dwordx4 v8, s[16:19], s57 offen  lds
    s_mov_b32 m0, 109568
    s_mov_b32 s57, 1441792
    buffer_load_dwordx4 v8, s[16:19], s57 offen  lds
    v_perm_b32 v176, v32, v30, s54
    v_perm_b32 v184, v36, v34, s54
    v_perm_b32 v178, v40, v38, s54
    v_perm_b32 v186, v44, v42, s54
    v_perm_b32 v180, v48, v46, s54
    v_perm_b32 v188, v52, v50, s54
    v_perm_b32 v182, v56, v54, s54
    v_perm_b32 v190, v60, v58, s54
    v_perm_b32 v185, v32, v30, s55
    v_perm_b32 v177, v36, v34, s55
    v_perm_b32 v187, v40, v38, s55
    v_perm_b32 v179, v44, v42, s55
    v_perm_b32 v189, v48, v46, s55
    v_perm_b32 v181, v52, v50, s55
    v_perm_b32 v191, v56, v54, s55
    v_perm_b32 v183, v60, v58, s55
    v_perm_b32 v192, v33, v31, s54
    v_perm_b32 v200, v37, v35, s54
    v_perm_b32 v194, v41, v39, s54
    v_perm_b32 v202, v45, v43, s54
    v_perm_b32 v196, v49, v47, s54
    v_perm_b32 v204, v53, v51, s54
    v_perm_b32 v198, v57, v55, s54
    v_perm_b32 v206, v61, v59, s54
    v_perm_b32 v201, v33, v31, s55
    v_perm_b32 v193, v37, v35, s55
    v_perm_b32 v203, v41, v39, s55
    v_perm_b32 v195, v45, v43, s55
    v_perm_b32 v205, v49, v47, s55
    v_perm_b32 v197, v53, v51, s55
    v_perm_b32 v207, v57, v55, s55
    v_perm_b32 v199, v61, v59, s55
    s_waitcnt vmcnt(4)
    ds_read_b64_tr_b16 a[176:177], v28 offset:0
    ds_read_b64_tr_b16 a[178:179], v28 offset:256
    ds_read_b64_tr_b16 a[180:181], v28 offset:2048
    ds_read_b64_tr_b16 a[182:183], v28 offset:2304
    ds_read_b64_tr_b16 a[184:185], v28 offset:32
    ds_read_b64_tr_b16 a[186:187], v28 offset:288
    ds_read_b64_tr_b16 a[188:189], v28 offset:2080
    ds_read_b64_tr_b16 a[190:191], v28 offset:2336
    s_waitcnt lgkmcnt(0)
    s_barrier
    s_mov_b32 m0, 155648
    s_mov_b32 s57, 1572864
    buffer_load_dwordx4 v8, s[16:19], s57 offen  lds
    s_mov_b32 m0, 156672
    s_mov_b32 s57, 1703936
    buffer_load_dwordx4 v8, s[16:19], s57 offen  lds
    s_mov_b32 m0, 157696
    s_mov_b32 s57, 1835008
    buffer_load_dwordx4 v8, s[16:19], s57 offen  lds
    s_mov_b32 m0, 158720
    s_mov_b32 s57, 1966080
    buffer_load_dwordx4 v8, s[16:19], s57 offen  lds
    s_mov_b32 s57, 74368
    buffer_load_dword v30, v9, s[24:27], s57 offen offset:0
    buffer_load_dword v31, v9, s[24:27], s57 offen offset:256
    s_mov_b32 s57, 92800
    buffer_load_dword v32, v9, s[24:27], s57 offen offset:0
    buffer_load_dword v33, v9, s[24:27], s57 offen offset:256
    s_mov_b32 s57, 78976
    buffer_load_dword v34, v9, s[24:27], s57 offen offset:0
    buffer_load_dword v35, v9, s[24:27], s57 offen offset:256
    s_mov_b32 s57, 97408
    buffer_load_dword v36, v9, s[24:27], s57 offen offset:0
    buffer_load_dword v37, v9, s[24:27], s57 offen offset:256
    s_mov_b32 s57, 75520
    buffer_load_dword v38, v9, s[24:27], s57 offen offset:0
    buffer_load_dword v39, v9, s[24:27], s57 offen offset:256
    s_mov_b32 s57, 93952
    buffer_load_dword v40, v9, s[24:27], s57 offen offset:0
    buffer_load_dword v41, v9, s[24:27], s57 offen offset:256
    s_mov_b32 s57, 80128
    buffer_load_dword v42, v9, s[24:27], s57 offen offset:0
    buffer_load_dword v43, v9, s[24:27], s57 offen offset:256
    s_mov_b32 s57, 98560
    buffer_load_dword v44, v9, s[24:27], s57 offen offset:0
    buffer_load_dword v45, v9, s[24:27], s57 offen offset:256
    s_mov_b32 s57, 111232
    buffer_load_dword v46, v9, s[24:27], s57 offen offset:0
    buffer_load_dword v47, v9, s[24:27], s57 offen offset:256
    s_mov_b32 s57, 129664
    buffer_load_dword v48, v9, s[24:27], s57 offen offset:0
    buffer_load_dword v49, v9, s[24:27], s57 offen offset:256
    s_mov_b32 s57, 115840
    buffer_load_dword v50, v9, s[24:27], s57 offen offset:0
    buffer_load_dword v51, v9, s[24:27], s57 offen offset:256
    s_mov_b32 s57, 134272
    buffer_load_dword v52, v9, s[24:27], s57 offen offset:0
    buffer_load_dword v53, v9, s[24:27], s57 offen offset:256
    s_mov_b32 s57, 112384
    buffer_load_dword v54, v9, s[24:27], s57 offen offset:0
    buffer_load_dword v55, v9, s[24:27], s57 offen offset:256
    s_mov_b32 s57, 130816
    buffer_load_dword v56, v9, s[24:27], s57 offen offset:0
    buffer_load_dword v57, v9, s[24:27], s57 offen offset:256
    s_mov_b32 s57, 116992
    buffer_load_dword v58, v9, s[24:27], s57 offen offset:0
    buffer_load_dword v59, v9, s[24:27], s57 offen offset:256
    s_mov_b32 s57, 135424
    buffer_load_dword v60, v9, s[24:27], s57 offen offset:0
    buffer_load_dword v61, v9, s[24:27], s57 offen offset:256
    s_waitcnt vmcnt(36)
    ds_read_b64_tr_b16 a[0:1], v27 offset:32768
    ds_read_b64_tr_b16 a[2:3], v27 offset:33024
    ds_read_b64_tr_b16 a[4:5], v27 offset:34816
    ds_read_b64_tr_b16 a[6:7], v27 offset:35072
    ds_read_b64_tr_b16 a[8:9], v27 offset:32800
    ds_read_b64_tr_b16 a[10:11], v27 offset:33056
    ds_read_b64_tr_b16 a[12:13], v27 offset:34848
    ds_read_b64_tr_b16 a[14:15], v27 offset:35104
    s_waitcnt lgkmcnt(0)
    s_barrier
    s_mov_b32 m0, 106496
    s_mov_b32 s57, 2097152
    buffer_load_dwordx4 v8, s[16:19], s57 offen  lds
    s_mov_b32 m0, 107520
    s_mov_b32 s57, 2228224
    buffer_load_dwordx4 v8, s[16:19], s57 offen  lds
    s_mov_b32 m0, 108544
    s_mov_b32 s57, 2359296
    buffer_load_dwordx4 v8, s[16:19], s57 offen  lds
    s_mov_b32 m0, 109568
    s_mov_b32 s57, 2490368
    buffer_load_dwordx4 v8, s[16:19], s57 offen  lds
    buffer_load_dword v76, off, s[4:7], 0 offset:40 sc1
    v_lshlrev_b32 v75, 6, v2
    s_mov_b32 s57, 8192
    buffer_load_dword v75, v75, s[28:31], s57 offen
    s_waitcnt vmcnt(38)
    ds_read_b64_tr_b16 a[96:97], v28 offset:0
    ds_read_b64_tr_b16 a[98:99], v28 offset:256
    ds_read_b64_tr_b16 a[100:101], v28 offset:2048
    ds_read_b64_tr_b16 a[102:103], v28 offset:2304
    ds_read_b64_tr_b16 a[104:105], v28 offset:32
    ds_read_b64_tr_b16 a[106:107], v28 offset:288
    ds_read_b64_tr_b16 a[108:109], v28 offset:2080
    ds_read_b64_tr_b16 a[110:111], v28 offset:2336
    s_waitcnt lgkmcnt(0)
    s_barrier
    s_mov_b32 m0, 155648
    s_mov_b32 s57, 2621440
    buffer_load_dwordx4 v8, s[16:19], s57 offen  lds
    s_mov_b32 m0, 156672
    s_mov_b32 s57, 2752512
    buffer_load_dwordx4 v8, s[16:19], s57 offen  lds
    s_mov_b32 m0, 157696
    s_mov_b32 s57, 2883584
    buffer_load_dwordx4 v8, s[16:19], s57 offen  lds
    s_mov_b32 m0, 158720
    s_mov_b32 s57, 3014656
    buffer_load_dwordx4 v8, s[16:19], s57 offen  lds
    s_waitcnt vmcnt(6)
    ds_read_b64_tr_b16 a[240:241], v27 offset:32768
    ds_read_b64_tr_b16 a[242:243], v27 offset:33024
    ds_read_b64_tr_b16 a[244:245], v27 offset:34816
    ds_read_b64_tr_b16 a[246:247], v27 offset:35072
    ds_read_b64_tr_b16 a[248:249], v27 offset:32800
    ds_read_b64_tr_b16 a[250:251], v27 offset:33056
    ds_read_b64_tr_b16 a[252:253], v27 offset:34848
    ds_read_b64_tr_b16 a[254:255], v27 offset:35104
    s_waitcnt lgkmcnt(0)
    s_barrier
    s_mov_b32 m0, 106496
    s_mov_b32 s57, 3145728
    buffer_load_dwordx4 v8, s[16:19], s57 offen  lds
    s_mov_b32 m0, 107520
    s_mov_b32 s57, 3276800
    buffer_load_dwordx4 v8, s[16:19], s57 offen  lds
    s_mov_b32 m0, 108544
    s_mov_b32 s57, 3407872
    buffer_load_dwordx4 v8, s[16:19], s57 offen  lds
    s_mov_b32 m0, 109568
    s_mov_b32 s57, 3538944
    buffer_load_dwordx4 v8, s[16:19], s57 offen  lds
    s_waitcnt vmcnt(4)
    ds_read_b64_tr_b16 v[112:113], v28 offset:0
    ds_read_b64_tr_b16 v[114:115], v28 offset:256
    ds_read_b64_tr_b16 v[116:117], v28 offset:2048
    ds_read_b64_tr_b16 v[118:119], v28 offset:2304
    ds_read_b64_tr_b16 v[120:121], v28 offset:32
    ds_read_b64_tr_b16 v[122:123], v28 offset:288
    ds_read_b64_tr_b16 v[124:125], v28 offset:2080
    ds_read_b64_tr_b16 v[126:127], v28 offset:2336
    s_waitcnt lgkmcnt(0)
    s_barrier
    s_mov_b32 m0, 155648
    s_mov_b32 s57, 3670016
    buffer_load_dwordx4 v8, s[16:19], s57 offen  lds
    s_mov_b32 m0, 156672
    s_mov_b32 s57, 3801088
    buffer_load_dwordx4 v8, s[16:19], s57 offen  lds
    s_mov_b32 m0, 157696
    s_mov_b32 s57, 3932160
    buffer_load_dwordx4 v8, s[16:19], s57 offen  lds
    s_mov_b32 m0, 158720
    s_mov_b32 s57, 4063232
    buffer_load_dwordx4 v8, s[16:19], s57 offen  lds
    s_waitcnt vmcnt(4)
    ds_read_b64_tr_b16 a[48:49], v27 offset:32768
    ds_read_b64_tr_b16 a[50:51], v27 offset:33024
    ds_read_b64_tr_b16 a[52:53], v27 offset:34816
    ds_read_b64_tr_b16 a[54:55], v27 offset:35072
    ds_read_b64_tr_b16 a[56:57], v27 offset:32800
    ds_read_b64_tr_b16 a[58:59], v27 offset:33056
    ds_read_b64_tr_b16 a[60:61], v27 offset:34848
    ds_read_b64_tr_b16 a[62:63], v27 offset:35104
    s_waitcnt lgkmcnt(0)
    s_barrier
    s_mov_b32 m0, 106496
    s_mov_b32 s57, 4194304
    buffer_load_dwordx4 v8, s[16:19], s57 offen  lds
    s_mov_b32 m0, 107520
    s_mov_b32 s57, 4325376
    buffer_load_dwordx4 v8, s[16:19], s57 offen  lds
    s_mov_b32 m0, 108544
    s_mov_b32 s57, 4456448
    buffer_load_dwordx4 v8, s[16:19], s57 offen  lds
    s_mov_b32 m0, 109568
    s_mov_b32 s57, 4587520
    buffer_load_dwordx4 v8, s[16:19], s57 offen  lds
    s_waitcnt vmcnt(4)
    ds_read_b64_tr_b16 a[208:209], v28 offset:0
    ds_read_b64_tr_b16 a[210:211], v28 offset:256
    ds_read_b64_tr_b16 a[212:213], v28 offset:2048
    ds_read_b64_tr_b16 a[214:215], v28 offset:2304
    ds_read_b64_tr_b16 a[216:217], v28 offset:32
    ds_read_b64_tr_b16 a[218:219], v28 offset:288
    ds_read_b64_tr_b16 a[220:221], v28 offset:2080
    ds_read_b64_tr_b16 a[222:223], v28 offset:2336
    s_waitcnt lgkmcnt(0)
    s_barrier
    v_perm_b32 v224, v32, v30, s54
    v_perm_b32 v232, v36, v34, s54
    v_perm_b32 v226, v40, v38, s54
    v_perm_b32 v234, v44, v42, s54
    v_perm_b32 v228, v48, v46, s54
    v_perm_b32 v236, v52, v50, s54
    v_perm_b32 v230, v56, v54, s54
    v_perm_b32 v238, v60, v58, s54
    v_perm_b32 v233, v32, v30, s55
    v_perm_b32 v225, v36, v34, s55
    v_perm_b32 v235, v40, v38, s55
    v_perm_b32 v227, v44, v42, s55
    v_perm_b32 v237, v48, v46, s55
    v_perm_b32 v229, v52, v50, s55
    v_perm_b32 v239, v56, v54, s55
    v_perm_b32 v231, v60, v58, s55
    v_perm_b32 v10, v33, v31, s54
    v_perm_b32 v18, v37, v35, s54
    v_perm_b32 v12, v41, v39, s54
    v_perm_b32 v20, v45, v43, s54
    v_perm_b32 v14, v49, v47, s54
    v_perm_b32 v22, v53, v51, s54
    v_perm_b32 v16, v57, v55, s54
    v_perm_b32 v24, v61, v59, s54
    v_perm_b32 v19, v33, v31, s55
    v_perm_b32 v11, v37, v35, s55
    v_perm_b32 v21, v41, v39, s55
    v_perm_b32 v13, v45, v43, s55
    v_perm_b32 v23, v49, v47, s55
    v_perm_b32 v15, v53, v51, s55
    v_perm_b32 v25, v57, v55, s55
    v_perm_b32 v17, v61, v59, s55
    ds_write_b128 v0, v[10:13] offset:8192
    ds_write_b128 v0, v[14:17] offset:9216
    ds_write_b128 v0, v[18:21] offset:10240
    ds_write_b128 v0, v[22:25] offset:11264
    s_waitcnt vmcnt(0)
    ds_read_b64_tr_b16 v[10:11], v27 offset:32768
    ds_read_b64_tr_b16 v[12:13], v27 offset:33024
    ds_read_b64_tr_b16 v[14:15], v27 offset:34816
    ds_read_b64_tr_b16 v[16:17], v27 offset:35072
    ds_read_b64_tr_b16 v[18:19], v27 offset:32800
    ds_read_b64_tr_b16 v[20:21], v27 offset:33056
    ds_read_b64_tr_b16 v[22:23], v27 offset:34848
    ds_read_b64_tr_b16 v[24:25], v27 offset:35104
    s_waitcnt lgkmcnt(0)
    ds_write_b128 v0, v[10:13] offset:32768
    ds_write_b128 v0, v[14:17] offset:33792
    ds_write_b128 v0, v[18:21] offset:34816
    ds_write_b128 v0, v[22:25] offset:35840
    v_mov_b32 v60, v2
    v_mov_b32 v61, v3
    v_mov_b32 v62, v4
    v_and_b32 v63, 2, v60
    v_cmp_eq_u32 vcc, 0, v63
    v_mov_b32 v64, 0x5e5eeeee
    v_mov_b32 v65, 0x04044444
    v_cndmask_b32 v4, v64, v65, vcc
    s_lshl_b32 s54, s33, 6
    s_add_u32 s55, s54, 32768
    v_lshrrev_b32 v63, 3, v60
    v_lshlrev_b32 v63, 11, v63
    v_and_b32 v64, 7, v60
    v_lshlrev_b32 v64, 3, v64
    v_add3_u32 v5, v63, v64, s55
    v_lshrrev_b32 v63, 2, v61
    v_lshlrev_b32 v63, 8, v63
    v_lshl_add_u32 v63, v62, 6, v63
    v_and_b32 v64, 3, v61
    v_lshl_add_u32 v7, v64, 4, v63
    v_and_b32 v63, 2, v61
    v_lshlrev_b32 v63, 4, v63
    v_lshl_add_u32 v63, v62, 4, v63
    v_and_b32 v64, 1, v61
    v_lshl_add_u32 v63, v64, 3, v63
    v_and_b32 v64, 0x2c, v60
    v_cmp_eq_u32 vcc, 0, v64
    v_mov_b32 v64, 0x7ffff000
    s_nop 0
    v_cndmask_b32 v6, v64, v63, vcc
    s_bfe_u32 s54, s33, 0x20001
    s_lshl_b32 s54, s54, 8
    s_and_b32 s55, s33, 1
    s_lshr_b32 s56, s33, 3
    s_lshl_b32 s18, s56, 1
    s_add_u32 s18, s18, s55
    s_and_b32 s17, s18, 3
    s_lshl_b32 s18, s18, 5
    s_add_u32 s18, s18, s54
    s_add_u32 s18, s18, 8192
    s_lshl_b32 s17, s17, 6
    s_add_u32 s17, s17, s54
    s_lshr_b32 s56, s56, 1
    s_lshl_b32 s56, s56, 10
    s_add_u32 s17, s17, s56
    s_add_u32 s17, s17, 4096
    v_lshrrev_b32 v63, 3, v61
    v_lshlrev_b32 v63, 8, v63
    v_lshl_add_u32 v63, v62, 6, v63
    v_and_b32 v64, 4, v61
    v_lshl_add_u32 v63, v64, 3, v63
    v_and_b32 v64, 3, v61
    v_lshl_add_u32 v63, v64, 2, v63
    v_add_u32 v8, 162816, v63
    v_and_b32 v63, 1, v61
    v_lshlrev_b32 v63, 4, v63
    v_mov_b32 v64, 0x3f80
    v_lshlrev_b32 v63, v63, v64
    v_and_b32 v64, 14, v61
    v_lshlrev_b32 v65, 2, v62
    v_cmp_eq_u32 vcc, v64, v65
    s_nop 1
    v_cndmask_b32 v2, 0, v63, vcc
    v_bfe_u32 v65, v60, 4, 1
    v_lshlrev_b32 v65, 3, v65
    v_bfe_u32 v66, v60, 5, 1
    v_lshl_add_u32 v65, v66, 2, v65
    v_or_b32 v65, 2, v65
    v_cmp_eq_u32 vcc, v64, v65
    s_nop 1
    v_cndmask_b32 v3, 0, v63, vcc
    s_waitcnt vmcnt(0) lgkmcnt(0)
    s_waitcnt vmcnt(0) lgkmcnt(0)
    s_barrier
    v_mov_b32 v77, 163836
    s_cmp_lg_u32 s32, 0
    s_cbranch_scc1 T2_cm
    s_mov_b64 exec, 1
    ds_write_b32 v77, v79
    s_mov_b64 exec, -1
    s_waitcnt lgkmcnt(0)
T2_cm:
    s_barrier
    ds_read_b32 v77, v77
    s_waitcnt lgkmcnt(0)
    v_readfirstlane_b32 s94, v77
    s_barrier
    s_and_b32 s94, s94, s93
    s_cbranch_scc1 A_over
    v_cmp_gt_u32 vcc, 32, v76
    s_cbranch_vccz T2_iw_ok
    s_mov_b32 s94, 40
T2_iw:
    buffer_load_dword v76, off, s[4:7], s94 sc1
    s_sub_u32 s95, s95, 1
    s_cmp_eq_u32 s95, 0
    s_cbranch_scc1 L_end
    s_waitcnt vmcnt(0)
    v_cmp_gt_u32 vcc, 32, v76
    s_cbranch_vccz T2_iw_ok
    s_sleep 1
    s_branch T2_iw
T2_iw_ok:
T2_layer:
    v_bfe_u32 v63, v1, 6, 2
    v_bfe_u32 v64, v1, 4, 1
    v_lshl_add_u32 v63, v63, 1, v64
    v_mul_u32_u24 v63, 1152, v63
    v_bfe_u32 v64, v1, 8, 2
    v_lshl_add_u32 v63, v64, 5, v63
    v_bfe_u32 v64, v1, 5, 1
    v_lshl_add_u32 v63, v64, 4, v63
    buffer_load_dwordx4 v[28:31], v63, s[28:31], 0 offen offset:256
    buffer_load_dwordx4 v[72:75], v63, s[28:31], 0 offen offset:768
    buffer_load_dwordx4 v[68:71], v63, s[28:31], 0 offen offset:1024
    s_lshl_b32 s12, s33, 8
    s_add_u32 s12, s12, 3149824
    buffer_load_dwordx2 v[76:77], off, s[8:11], s12 sc1
    ds_read_b128 v[10:13], v0 offset:24576
    ds_read_b128 v[14:17], v0 offset:25600
    ds_read_b128 v[18:21], v0 offset:26624
    ds_read_b128 v[22:25], v0 offset:27648
    s_waitcnt vmcnt(2)
    v_mov_b64 v[60:61], v[72:73]
    v_mov_b64 v[62:63], v[74:75]
    v_mov_b64 v[32:33], 0
    v_mov_b64 v[34:35], 0
    v_mov_b64 v[36:37], 0
    v_mov_b64 v[38:39], 0
    v_mov_b64 v[40:41], 0
    v_mov_b64 v[42:43], 0
    v_mov_b64 v[44:45], 0
    v_mov_b64 v[46:47], 0
    v_mov_b64 v[48:49], 0
    v_mov_b64 v[50:51], 0
    v_mov_b64 v[52:53], 0
    v_mov_b64 v[54:55], 0
    s_mov_b32 s34, 0
    s_mov_b32 s35, 20000
    s_mov_b32 s36, 1
    s_mov_b32 s60, 0
    s_mov_b32 s61, 0
    s_mov_b32 s3, 0x5d800000
    s_mov_b32 s13, 0
    s_mov_b32 s14, 0x3f80
    s_mov_b32 s15, 3145728
    s_lshl_b32 s16, s33, 2
    s_add_u32 s16, s16, s15
    s_mov_b32 s37, 1343488
    s_mov_b32 s41, 2113536
    s_lshl_b32 s49, s33, 11
    s_add_u32 s49, s49, 4294950912
    s_lshl_b32 s19, s33, 10
    s_add_u32 s19, s19, 114688
    s_lshl_b32 s54, s33, 14
    s_add_u32 s44, s54, 33415168
    s_add_u32 s25, s44, 81920
    s_sub_u32 s45, s44, 442368
    s_mov_b32 s46, 16629760
    s_cmp_lt_u32 s33, 18
    s_cselect_b32 s47, 0, 18
    s_sub_u32 s47, s33, s47
    s_lshl_b32 s47, s47, 9
    s_add_u32 s47, s47, 73728
    s_mov_b32 s48, 0x3e0293ee
    s_mov_b32 s50, 0x33333333
    s_mov_b32 s51, 0x33333333
    s_mov_b32 s52, 0x3f803f80
    s_mov_b32 s53, 0x3f803f80
    s_mov_b32 s62, 0x11111111
    s_mov_b32 s63, 0x11111111
    s_mov_b32 m0, 157696
    v_lshlrev_b32 v78, 2, v1
    s_waitcnt lgkmcnt(0)
    s_waitcnt vmcnt(0)
    v_min_u32 v76, v76, v77
T2_kv:
    v_cmp_eq_u32 vcc, 0, v76
    s_cbranch_vccz T2_kv_ok
    buffer_load_dwordx2 v[76:77], off, s[8:11], s12 sc1
    s_sub_u32 s95, s95, 1
    s_cmp_eq_u32 s95, 0
    s_cbranch_scc1 L_end
    s_waitcnt vmcnt(0)
    v_min_u32 v76, v76, v77
    s_branch T2_kv
T2_kv_ok:
    buffer_load_dword v9, v78, s[8:11], s45 offen sc1
    s_add_u32 s12, s12, 8
    s_mul_i32 s54, s33, 18432
    s_add_u32 s54, s54, 466944
    buffer_load_dword v9, v78, s[8:11], s54 offen sc1
    s_branch T2_head
T1_pro:
    v_and_b32 v2, 63, v0
    v_and_b32 v3, 15, v0
    v_lshrrev_b32 v4, 4, v2
    s_mul_i32 s54, s33, 147456
    v_bfe_u32 v5, v2, 5, 1
    v_lshlrev_b32 v5, 3, v5
    v_bfe_u32 v6, v2, 4, 1
    v_lshl_add_u32 v5, v6, 1, v5
    v_mul_u32_u24 v5, 1152, v5
    v_lshlrev_b32 v6, 2, v3
    v_add3_u32 v9, v5, v6, s54
    v_and_b32 v7, 3, v2
    v_lshlrev_b32 v7, 4, v7
    v_bfe_u32 v5, v2, 3, 1
    v_lshlrev_b32 v5, 3, v5
    v_lshl_add_u32 v5, v4, 1, v5
    v_bfe_u32 v6, v2, 2, 1
    v_add_u32 v5, v5, v6
    s_lshl_b32 s55, s33, 8
    s_add_u32 s55, s55, 64
    v_lshlrev_b32 v5, 13, v5
    v_add3_u32 v8, v5, v7, s55
    v_lshlrev_b32 v5, 4, v6
    v_bfe_u32 v6, v2, 3, 1
    v_lshl_add_u32 v5, v6, 2, v5
    v_add_u32 v5, v5, v4
    v_bfe_u32 v6, v2, 1, 1
    v_lshl_add_u32 v5, v6, 6, v5
    v_mul_u32_u24 v5, 1152, v5
    v_and_b32 v6, 16, v7
    v_add3_u32 v26, v5, v6, s54
    v_lshrrev_b32 v5, 2, v3
    v_lshl_add_u32 v5, v4, 3, v5
    v_lshlrev_b32 v5, 6, v5
    v_lshrrev_b32 v6, 1, v7
    v_add_u32 v5, v5, v6
    v_add_u32 v27, 36864, v5
    v_add_u32 v28, 151552, v5
    v_lshlrev_b32 v5, 4, v2
    v_add_u32 v0, 36864, v5
    v_add_u32 v1, 147456, v5
    s_mov_b32 s54, 0x05040100
    s_mov_b32 s55, 0x07060302
    s_barrier
    s_mov_b32 m0, 151552
    s_mov_b32 s57, 1056
    buffer_load_dwordx4 v26, s[24:27], s57 offen lds
    s_mov_b32 m0, 152576
    s_mov_b32 s57, 10272
    buffer_load_dwordx4 v26, s[24:27], s57 offen lds
    s_mov_b32 m0, 153600
    s_mov_b32 s57, 37920
    buffer_load_dwordx4 v26, s[24:27], s57 offen lds
    s_mov_b32 m0, 154624
    s_mov_b32 s57, 47136
    buffer_load_dwordx4 v26, s[24:27], s57 offen lds
    s_mov_b32 m0, 69632
    s_mov_b32 s57, 0
    buffer_load_dwordx4 v8, s[20:23], s57 offen  lds
    s_mov_b32 m0, 70656
    s_mov_b32 s57, 131072
    buffer_load_dwordx4 v8, s[20:23], s57 offen  lds
    s_mov_b32 m0, 71680
    s_mov_b32 s57, 262144
    buffer_load_dwordx4 v8, s[20:23], s57 offen  lds
    s_mov_b32 m0, 72704
    s_mov_b32 s57, 393216
    buffer_load_dwordx4 v8, s[20:23], s57 offen  lds
    s_mov_b32 m0, 65536
    s_mov_b32 s57, 524288
    buffer_load_dwordx4 v8, s[20:23], s57 offen  lds
    s_mov_b32 m0, 66560
    s_mov_b32 s57, 655360
    buffer_load_dwordx4 v8, s[20:23], s57 offen  lds
    s_mov_b32 m0, 67584
    s_mov_b32 s57, 786432
    buffer_load_dwordx4 v8, s[20:23], s57 offen  lds
    s_mov_b32 m0, 68608
    s_mov_b32 s57, 917504
    buffer_load_dwordx4 v8, s[20:23], s57 offen  lds
    s_mov_b32 s57, 64
    buffer_load_dword v30, v9, s[24:27], s57 offen offset:0
    buffer_load_dword v31, v9, s[24:27], s57 offen offset:256
    s_mov_b32 s57, 18496
    buffer_load_dword v32, v9, s[24:27], s57 offen offset:0
    buffer_load_dword v33, v9, s[24:27], s57 offen offset:256
    s_mov_b32 s57, 4672
    buffer_load_dword v34, v9, s[24:27], s57 offen offset:0
    buffer_load_dword v35, v9, s[24:27], s57 offen offset:256
    s_mov_b32 s57, 23104
    buffer_load_dword v36, v9, s[24:27], s57 offen offset:0
    buffer_load_dword v37, v9, s[24:27], s57 offen offset:256
    s_mov_b32 s57, 1216
    buffer_load_dword v38, v9, s[24:27], s57 offen offset:0
    buffer_load_dword v39, v9, s[24:27], s57 offen offset:256
    s_mov_b32 s57, 19648
    buffer_load_dword v40, v9, s[24:27], s57 offen offset:0
    buffer_load_dword v41, v9, s[24:27], s57 offen offset:256
    s_mov_b32 s57, 5824
    buffer_load_dword v42, v9, s[24:27], s57 offen offset:0
    buffer_load_dword v43, v9, s[24:27], s57 offen offset:256
    s_mov_b32 s57, 24256
    buffer_load_dword v44, v9, s[24:27], s57 offen offset:0
    buffer_load_dword v45, v9, s[24:27], s57 offen offset:256
    s_mov_b32 s57, 36928
    buffer_load_dword v46, v9, s[24:27], s57 offen offset:0
    buffer_load_dword v47, v9, s[24:27], s57 offen offset:256
    s_mov_b32 s57, 55360
    buffer_load_dword v48, v9, s[24:27], s57 offen offset:0
    buffer_load_dword v49, v9, s[24:27], s57 offen offset:256
    s_mov_b32 s57, 41536
    buffer_load_dword v50, v9, s[24:27], s57 offen offset:0
    buffer_load_dword v51, v9, s[24:27], s57 offen offset:256
    s_mov_b32 s57, 59968
    buffer_load_dword v52, v9, s[24:27], s57 offen offset:0
    buffer_load_dword v53, v9, s[24:27], s57 offen offset:256
    s_mov_b32 s57, 38080
    buffer_load_dword v54, v9, s[24:27], s57 offen offset:0
    buffer_load_dword v55, v9, s[24:27], s57 offen offset:256
    s_mov_b32 s57, 56512
    buffer_load_dword v56, v9, s[24:27], s57 offen offset:0
    buffer_load_dword v57, v9, s[24:27], s57 offen offset:256
    s_mov_b32 s57, 42688
    buffer_load_dword v58, v9, s[24:27], s57 offen offset:0
    buffer_load_dword v59, v9, s[24:27], s57 offen offset:256
    s_mov_b32 s57, 61120
    buffer_load_dword v60, v9, s[24:27], s57 offen offset:0
    buffer_load_dword v61, v9, s[24:27], s57 offen offset:256
    s_waitcnt vmcnt(40)
    ds_read_b64_tr_b16 v[240:241], v28 offset:0
    ds_read_b64_tr_b16 v[242:243], v28 offset:256
    ds_read_b64_tr_b16 v[244:245], v28 offset:2048
    ds_read_b64_tr_b16 v[246:247], v28 offset:2304
    ds_read_b64_tr_b16 v[248:249], v28 offset:32
    ds_read_b64_tr_b16 v[250:251], v28 offset:288
    ds_read_b64_tr_b16 v[252:253], v28 offset:2080
    ds_read_b64_tr_b16 v[254:255], v28 offset:2336
    s_waitcnt lgkmcnt(0)
    s_barrier
    s_mov_b32 m0, 151552
    s_mov_b32 s57, 1048576
    buffer_load_dwordx4 v8, s[20:23], s57 offen  lds
    s_mov_b32 m0, 152576
    s_mov_b32 s57, 1179648
    buffer_load_dwordx4 v8, s[20:23], s57 offen  lds
    s_mov_b32 m0, 153600
    s_mov_b32 s57, 1310720
    buffer_load_dwordx4 v8, s[20:23], s57 offen  lds
    s_mov_b32 m0, 154624
    s_mov_b32 s57, 1441792
    buffer_load_dwordx4 v8, s[20:23], s57 offen  lds
    s_waitcnt vmcnt(40)
    ds_read_b64_tr_b16 a[192:193], v27 offset:32768
    ds_read_b64_tr_b16 a[194:195], v27 offset:33024
    ds_read_b64_tr_b16 a[196:197], v27 offset:34816
    ds_read_b64_tr_b16 a[198:199], v27 offset:35072
    ds_read_b64_tr_b16 a[200:201], v27 offset:32800
    ds_read_b64_tr_b16 a[202:203], v27 offset:33056
    ds_read_b64_tr_b16 a[204:205], v27 offset:34848
    ds_read_b64_tr_b16 a[206:207], v27 offset:35104
    s_waitcnt lgkmcnt(0)
    s_barrier
    s_mov_b32 m0, 69632
    s_mov_b32 s57, 1572864
    buffer_load_dwordx4 v8, s[20:23], s57 offen  lds
    s_mov_b32 m0, 70656
    s_mov_b32 s57, 1703936
    buffer_load_dwordx4 v8, s[20:23], s57 offen  lds
    s_mov_b32 m0, 71680
    s_mov_b32 s57, 1835008
    buffer_load_dwordx4 v8, s[20:23], s57 offen  lds
    s_mov_b32 m0, 72704
    s_mov_b32 s57, 1966080
    buffer_load_dwordx4 v8, s[20:23], s57 offen  lds
    s_waitcnt vmcnt(40)
    ds_read_b64_tr_b16 a[16:17], v27 offset:28672
    ds_read_b64_tr_b16 a[18:19], v27 offset:28928
    ds_read_b64_tr_b16 a[20:21], v27 offset:30720
    ds_read_b64_tr_b16 a[22:23], v27 offset:30976
    ds_read_b64_tr_b16 a[24:25], v27 offset:28704
    ds_read_b64_tr_b16 a[26:27], v27 offset:28960
    ds_read_b64_tr_b16 a[28:29], v27 offset:30752
    ds_read_b64_tr_b16 a[30:31], v27 offset:31008
    s_waitcnt lgkmcnt(0)
    s_barrier
    s_mov_b32 m0, 65536
    s_mov_b32 s57, 2097152
    buffer_load_dwordx4 v8, s[20:23], s57 offen  lds
    s_mov_b32 m0, 66560
    s_mov_b32 s57, 2228224
    buffer_load_dwordx4 v8, s[20:23], s57 offen  lds
    s_mov_b32 m0, 67584
    s_mov_b32 s57, 2359296
    buffer_load_dwordx4 v8, s[20:23], s57 offen  lds
    s_mov_b32 m0, 68608
    s_mov_b32 s57, 2490368
    buffer_load_dwordx4 v8, s[20:23], s57 offen  lds
    s_waitcnt vmcnt(8)
    ds_read_b64_tr_b16 a[112:113], v28 offset:0
    ds_read_b64_tr_b16 a[114:115], v28 offset:256
    ds_read_b64_tr_b16 a[116:117], v28 offset:2048
    ds_read_b64_tr_b16 a[118:119], v28 offset:2304
    ds_read_b64_tr_b16 a[120:121], v28 offset:32
    ds_read_b64_tr_b16 a[122:123], v28 offset:288
    ds_read_b64_tr_b16 a[124:125], v28 offset:2080
    ds_read_b64_tr_b16 a[126:127], v28 offset:2336
    s_waitcnt lgkmcnt(0)
    s_barrier
    s_mov_b32 m0, 151552
    s_mov_b32 s57, 2621440
    buffer_load_dwordx4 v8, s[20:23], s57 offen  lds
    s_mov_b32 m0, 152576
    s_mov_b32 s57, 2752512
    buffer_load_dwordx4 v8, s[20:23], s57 offen  lds
    s_mov_b32 m0, 153600
    s_mov_b32 s57, 2883584
    buffer_load_dwordx4 v8, s[20:23], s57 offen  lds
    s_mov_b32 m0, 154624
    s_mov_b32 s57, 3014656
    buffer_load_dwordx4 v8, s[20:23], s57 offen  lds
    s_waitcnt vmcnt(8)
    ds_read_b64_tr_b16 a[144:145], v27 offset:32768
    ds_read_b64_tr_b16 a[146:147], v27 offset:33024
    ds_read_b64_tr_b16 a[148:149], v27 offset:34816
    ds_read_b64_tr_b16 a[150:151], v27 offset:35072
    ds_read_b64_tr_b16 a[152:153], v27 offset:32800
    ds_read_b64_tr_b16 a[154:155], v27 offset:33056
    ds_read_b64_tr_b16 a[156:157], v27 offset:34848
    ds_read_b64_tr_b16 a[158:159], v27 offset:35104
    s_waitcnt lgkmcnt(0)
    s_barrier
    s_mov_b32 m0, 49152
    s_mov_b32 s57, 3145728
    buffer_load_dwordx4 v8, s[20:23], s57 offen  lds
    s_mov_b32 m0, 50176
    s_mov_b32 s57, 3276800
    buffer_load_dwordx4 v8, s[20:23], s57 offen  lds
    s_mov_b32 m0, 51200
    s_mov_b32 s57, 3407872
    buffer_load_dwordx4 v8, s[20:23], s57 offen  lds
    s_mov_b32 m0, 52224
    s_mov_b32 s57, 3538944
    buffer_load_dwordx4 v8, s[20:23], s57 offen  lds
    s_waitcnt vmcnt(8)
    ds_read_b64_tr_b16 v[128:129], v27 offset:28672
    ds_read_b64_tr_b16 v[130:131], v27 offset:28928
    ds_read_b64_tr_b16 v[132:133], v27 offset:30720
    ds_read_b64_tr_b16 v[134:135], v27 offset:30976
    ds_read_b64_tr_b16 v[136:137], v27 offset:28704
    ds_read_b64_tr_b16 v[138:139], v27 offset:28960
    ds_read_b64_tr_b16 v[140:141], v27 offset:30752
    ds_read_b64_tr_b16 v[142:143], v27 offset:31008
    s_waitcnt lgkmcnt(0)
    s_barrier
    s_mov_b32 m0, 69632
    s_mov_b32 s57, 3670016
    buffer_load_dwordx4 v8, s[20:23], s57 offen  lds
    s_mov_b32 m0, 70656
    s_mov_b32 s57, 3801088
    buffer_load_dwordx4 v8, s[20:23], s57 offen  lds
    s_mov_b32 m0, 71680
    s_mov_b32 s57, 3932160
    buffer_load_dwordx4 v8, s[20:23], s57 offen  lds
    s_mov_b32 m0, 72704
    s_mov_b32 s57, 4063232
    buffer_load_dwordx4 v8, s[20:23], s57 offen  lds
    v_perm_b32 v10, v32, v30, s54
    v_perm_b32 v18, v36, v34, s54
    v_perm_b32 v12, v40, v38, s54
    v_perm_b32 v20, v44, v42, s54
    v_perm_b32 v14, v48, v46, s54
    v_perm_b32 v22, v52, v50, s54
    v_perm_b32 v16, v56, v54, s54
    v_perm_b32 v24, v60, v58, s54
    v_perm_b32 v19, v32, v30, s55
    v_perm_b32 v11, v36, v34, s55
    v_perm_b32 v21, v40, v38, s55
    v_perm_b32 v13, v44, v42, s55
    v_perm_b32 v23, v48, v46, s55
    v_perm_b32 v15, v52, v50, s55
    v_perm_b32 v25, v56, v54, s55
    v_perm_b32 v17, v60, v58, s55
    ds_write_b128 v0, v[10:13] offset:0
    ds_write_b128 v0, v[14:17] offset:1024
    ds_write_b128 v0, v[18:21] offset:2048
    ds_write_b128 v0, v[22:25] offset:3072
    v_perm_b32 v160, v33, v31, s54
    v_perm_b32 v168, v37, v35, s54
    v_perm_b32 v162, v41, v39, s54
    v_perm_b32 v170, v45, v43, s54
    v_perm_b32 v164, v49, v47, s54
    v_perm_b32 v172, v53, v51, s54
    v_perm_b32 v166, v57, v55, s54
    v_perm_b32 v174, v61, v59, s54
    v_perm_b32 v169, v33, v31, s55
    v_perm_b32 v161, v37, v35, s55
    v_perm_b32 v171, v41, v39, s55
    v_perm_b32 v163, v45, v43, s55
    v_perm_b32 v173, v49, v47, s55
    v_perm_b32 v165, v53, v51, s55
    v_perm_b32 v175, v57, v55, s55
    v_perm_b32 v167, v61, v59, s55
    s_waitcnt vmcnt(8)
    ds_read_b64_tr_b16 a[64:65], v28 offset:0
    ds_read_b64_tr_b16 a[66:67], v28 offset:256
    ds_read_b64_tr_b16 a[68:69], v28 offset:2048
    ds_read_b64_tr_b16 a[70:71], v28 offset:2304
    ds_read_b64_tr_b16 a[72:73], v28 offset:32
    ds_read_b64_tr_b16 a[74:75], v28 offset:288
    ds_read_b64_tr_b16 a[76:77], v28 offset:2080
    ds_read_b64_tr_b16 a[78:79], v28 offset:2336
    s_waitcnt lgkmcnt(0)
    s_barrier
    s_mov_b32 m0, 53248
    s_mov_b32 s57, 4194304
    buffer_load_dwordx4 v8, s[20:23], s57 offen  lds
    s_mov_b32 m0, 54272
    s_mov_b32 s57, 4325376
    buffer_load_dwordx4 v8, s[20:23], s57 offen  lds
    s_mov_b32 m0, 55296
    s_mov_b32 s57, 4456448
    buffer_load_dwordx4 v8, s[20:23], s57 offen  lds
    s_mov_b32 m0, 56320
    s_mov_b32 s57, 4587520
    buffer_load_dwordx4 v8, s[20:23], s57 offen  lds
    s_mov_b32 s57, 73792
    buffer_load_dword v30, v9, s[24:27], s57 offen offset:0
    buffer_load_dword v31, v9, s[24:27], s57 offen offset:256
    s_mov_b32 s57, 92224
    buffer_load_dword v32, v9, s[24:27], s57 offen offset:0
    buffer_load_dword v33, v9, s[24:27], s57 offen offset:256
    s_mov_b32 s57, 78400
    buffer_load_dword v34, v9, s[24:27], s57 offen offset:0
    buffer_load_dword v35, v9, s[24:27], s57 offen offset:256
    s_mov_b32 s57, 96832
    buffer_load_dword v36, v9, s[24:27], s57 offen offset:0
    buffer_load_dword v37, v9, s[24:27], s57 offen offset:256
    s_mov_b32 s57, 74944
    buffer_load_dword v38, v9, s[24:27], s57 offen offset:0
    buffer_load_dword v39, v9, s[24:27], s57 offen offset:256
    s_mov_b32 s57, 93376
    buffer_load_dword v40, v9, s[24:27], s57 offen offset:0
    buffer_load_dword v41, v9, s[24:27], s57 offen offset:256
    s_mov_b32 s57, 79552
    buffer_load_dword v42, v9, s[24:27], s57 offen offset:0
    buffer_load_dword v43, v9, s[24:27], s57 offen offset:256
    s_mov_b32 s57, 97984
    buffer_load_dword v44, v9, s[24:27], s57 offen offset:0
    buffer_load_dword v45, v9, s[24:27], s57 offen offset:256
    s_mov_b32 s57, 110656
    buffer_load_dword v46, v9, s[24:27], s57 offen offset:0
    buffer_load_dword v47, v9, s[24:27], s57 offen offset:256
    s_mov_b32 s57, 129088
    buffer_load_dword v48, v9, s[24:27], s57 offen offset:0
    buffer_load_dword v49, v9, s[24:27], s57 offen offset:256
    s_mov_b32 s57, 115264
    buffer_load_dword v50, v9, s[24:27], s57 offen offset:0
    buffer_load_dword v51, v9, s[24:27], s57 offen offset:256
    s_mov_b32 s57, 133696
    buffer_load_dword v52, v9, s[24:27], s57 offen offset:0
    buffer_load_dword v53, v9, s[24:27], s57 offen offset:256
    s_mov_b32 s57, 111808
    buffer_load_dword v54, v9, s[24:27], s57 offen offset:0
    buffer_load_dword v55, v9, s[24:27], s57 offen offset:256
    s_mov_b32 s57, 130240
    buffer_load_dword v56, v9, s[24:27], s57 offen offset:0
    buffer_load_dword v57, v9, s[24:27], s57 offen offset:256
    s_mov_b32 s57, 116416
    buffer_load_dword v58, v9, s[24:27], s57 offen offset:0
    buffer_load_dword v59, v9, s[24:27], s57 offen offset:256
    s_mov_b32 s57, 134848
    buffer_load_dword v60, v9, s[24:27], s57 offen offset:0
    buffer_load_dword v61, v9, s[24:27], s57 offen offset:256
    s_waitcnt vmcnt(40)
    ds_read_b64_tr_b16 v[10:11], v27 offset:12288
    ds_read_b64_tr_b16 v[12:13], v27 offset:12544
    ds_read_b64_tr_b16 v[14:15], v27 offset:14336
    ds_read_b64_tr_b16 v[16:17], v27 offset:14592
    ds_read_b64_tr_b16 v[18:19], v27 offset:12320
    ds_read_b64_tr_b16 v[20:21], v27 offset:12576
    ds_read_b64_tr_b16 v[22:23], v27 offset:14368
    ds_read_b64_tr_b16 v[24:25], v27 offset:14624
    s_waitcnt lgkmcnt(0)
    ds_write_b128 v0, v[10:13] offset:12288
    ds_write_b128 v0, v[14:17] offset:13312
    ds_write_b128 v0, v[18:21] offset:14336
    ds_write_b128 v0, v[22:25] offset:15360
    s_barrier
    s_mov_b32 m0, 151552
    s_mov_b32 s57, 0
    buffer_load_dwordx4 v8, s[12:15], s57 offen  lds
    s_mov_b32 m0, 152576
    s_mov_b32 s57, 131072
    buffer_load_dwordx4 v8, s[12:15], s57 offen  lds
    s_mov_b32 m0, 153600
    s_mov_b32 s57, 262144
    buffer_load_dwordx4 v8, s[12:15], s57 offen  lds
    s_mov_b32 m0, 154624
    s_mov_b32 s57, 393216
    buffer_load_dwordx4 v8, s[12:15], s57 offen  lds
    s_waitcnt vmcnt(40)
    ds_read_b64_tr_b16 v[80:81], v27 offset:32768
    ds_read_b64_tr_b16 v[82:83], v27 offset:33024
    ds_read_b64_tr_b16 v[84:85], v27 offset:34816
    ds_read_b64_tr_b16 v[86:87], v27 offset:35072
    ds_read_b64_tr_b16 v[88:89], v27 offset:32800
    ds_read_b64_tr_b16 v[90:91], v27 offset:33056
    ds_read_b64_tr_b16 v[92:93], v27 offset:34848
    ds_read_b64_tr_b16 v[94:95], v27 offset:35104
    s_waitcnt lgkmcnt(0)
    s_barrier
    s_mov_b32 m0, 57344
    s_mov_b32 s57, 524288
    buffer_load_dwordx4 v8, s[12:15], s57 offen  lds
    s_mov_b32 m0, 58368
    s_mov_b32 s57, 655360
    buffer_load_dwordx4 v8, s[12:15], s57 offen  lds
    s_mov_b32 m0, 59392
    s_mov_b32 s57, 786432
    buffer_load_dwordx4 v8, s[12:15], s57 offen  lds
    s_mov_b32 m0, 60416
    s_mov_b32 s57, 917504
    buffer_load_dwordx4 v8, s[12:15], s57 offen  lds
    s_waitcnt vmcnt(40)
    ds_read_b64_tr_b16 v[10:11], v27 offset:16384
    ds_read_b64_tr_b16 v[12:13], v27 offset:16640
    ds_read_b64_tr_b16 v[14:15], v27 offset:18432
    ds_read_b64_tr_b16 v[16:17], v27 offset:18688
    ds_read_b64_tr_b16 v[18:19], v27 offset:16416
    ds_read_b64_tr_b16 v[20:21], v27 offset:16672
    ds_read_b64_tr_b16 v[22:23], v27 offset:18464
    ds_read_b64_tr_b16 v[24:25], v27 offset:18720
    s_waitcnt lgkmcnt(0)
    ds_write_b128 v0, v[10:13] offset:16384
    ds_write_b128 v0, v[14:17] offset:17408
    ds_write_b128 v0, v[18:21] offset:18432
    ds_write_b128 v0, v[22:25] offset:19456
    s_barrier
    s_mov_b32 m0, 69632
    s_mov_b32 s57, 1048576
    buffer_load_dwordx4 v8, s[12:15], s57 offen  lds
    s_mov_b32 m0, 70656
    s_mov_b32 s57, 1179648
    buffer_load_dwordx4 v8, s[12:15], s57 offen  lds
    s_mov_b32 m0, 71680
    s_mov_b32 s57, 1310720
    buffer_load_dwordx4 v8, s[12:15], s57 offen  lds
    s_mov_b32 m0, 72704
    s_mov_b32 s57, 1441792
    buffer_load_dwordx4 v8, s[12:15], s57 offen  lds
    s_waitcnt vmcnt(8)
    ds_read_b64_tr_b16 a[160:161], v28 offset:0
    ds_read_b64_tr_b16 a[162:163], v28 offset:256
    ds_read_b64_tr_b16 a[164:165], v28 offset:2048
    ds_read_b64_tr_b16 a[166:167], v28 offset:2304
    ds_read_b64_tr_b16 a[168:169], v28 offset:32
    ds_read_b64_tr_b16 a[170:171], v28 offset:288
    ds_read_b64_tr_b16 a[172:173], v28 offset:2080
    ds_read_b64_tr_b16 a[174:175], v28 offset:2336
    s_waitcnt lgkmcnt(0)
    s_barrier
    s_mov_b32 m0, 61440
    s_mov_b32 s57, 1572864
    buffer_load_dwordx4 v8, s[12:15], s57 offen  lds
    s_mov_b32 m0, 62464
    s_mov_b32 s57, 1703936
    buffer_load_dwordx4 v8, s[12:15], s57 offen  lds
    s_mov_b32 m0, 63488
    s_mov_b32 s57, 1835008
    buffer_load_dwordx4 v8, s[12:15], s57 offen  lds
    s_mov_b32 m0, 64512
    s_mov_b32 s57, 1966080
    buffer_load_dwordx4 v8, s[12:15], s57 offen  lds
    s_waitcnt vmcnt(8)
    ds_read_b64_tr_b16 v[10:11], v27 offset:20480
    ds_read_b64_tr_b16 v[12:13], v27 offset:20736
    ds_read_b64_tr_b16 v[14:15], v27 offset:22528
    ds_read_b64_tr_b16 v[16:17], v27 offset:22784
    ds_read_b64_tr_b16 v[18:19], v27 offset:20512
    ds_read_b64_tr_b16 v[20:21], v27 offset:20768
    ds_read_b64_tr_b16 v[22:23], v27 offset:22560
    ds_read_b64_tr_b16 v[24:25], v27 offset:22816
    s_waitcnt lgkmcnt(0)
    ds_write_b128 v0, v[10:13] offset:20480
    ds_write_b128 v0, v[14:17] offset:21504
    ds_write_b128 v0, v[18:21] offset:22528
    ds_write_b128 v0, v[22:25] offset:23552
    s_barrier
    s_mov_b32 m0, 151552
    s_mov_b32 s57, 2097152
    buffer_load_dwordx4 v8, s[12:15], s57 offen  lds
    s_mov_b32 m0, 152576
    s_mov_b32 s57, 2228224
    buffer_load_dwordx4 v8, s[12:15], s57 offen  lds
    s_mov_b32 m0, 153600
    s_mov_b32 s57, 2359296
    buffer_load_dwordx4 v8, s[12:15], s57 offen  lds
    s_mov_b32 m0, 154624
    s_mov_b32 s57, 2490368
    buffer_load_dwordx4 v8, s[12:15], s57 offen  lds
    s_waitcnt vmcnt(8)
    ds_read_b64_tr_b16 a[80:81], v27 offset:32768
    ds_read_b64_tr_b16 a[82:83], v27 offset:33024
    ds_read_b64_tr_b16 a[84:85], v27 offset:34816
    ds_read_b64_tr_b16 a[86:87], v27 offset:35072
    ds_read_b64_tr_b16 a[88:89], v27 offset:32800
    ds_read_b64_tr_b16 a[90:91], v27 offset:33056
    ds_read_b64_tr_b16 a[92:93], v27 offset:34848
    ds_read_b64_tr_b16 a[94:95], v27 offset:35104
    s_waitcnt lgkmcnt(0)
    s_barrier
    s_mov_b32 m0, 69632
    s_mov_b32 s57, 2621440
    buffer_load_dwordx4 v8, s[12:15], s57 offen  lds
    s_mov_b32 m0, 70656
    s_mov_b32 s57, 2752512
    buffer_load_dwordx4 v8, s[12:15], s57 offen  lds
    s_mov_b32 m0, 71680
    s_mov_b32 s57, 2883584
    buffer_load_dwordx4 v8, s[12:15], s57 offen  lds
    s_mov_b32 m0, 72704
    s_mov_b32 s57, 3014656
    buffer_load_dwordx4 v8, s[12:15], s57 offen  lds
    v_perm_b32 v208, v32, v30, s54
    v_perm_b32 v216, v36, v34, s54
    v_perm_b32 v210, v40, v38, s54
    v_perm_b32 v218, v44, v42, s54
    v_perm_b32 v212, v48, v46, s54
    v_perm_b32 v220, v52, v50, s54
    v_perm_b32 v214, v56, v54, s54
    v_perm_b32 v222, v60, v58, s54
    v_perm_b32 v217, v32, v30, s55
    v_perm_b32 v209, v36, v34, s55
    v_perm_b32 v219, v40, v38, s55
    v_perm_b32 v211, v44, v42, s55
    v_perm_b32 v221, v48, v46, s55
    v_perm_b32 v213, v52, v50, s55
    v_perm_b32 v223, v56, v54, s55
    v_perm_b32 v215, v60, v58, s55
    v_perm_b32 v10, v33, v31, s54
    v_perm_b32 v18, v37, v35, s54
    v_perm_b32 v12, v41, v39, s54
    v_perm_b32 v20, v45, v43, s54
    v_perm_b32 v14, v49, v47, s54
    v_perm_b32 v22, v53, v51, s54
    v_perm_b32 v16, v57, v55, s54
    v_perm_b32 v24, v61, v59, s54
    v_perm_b32 v19, v33, v31, s55
    v_perm_b32 v11, v37, v35, s55
    v_perm_b32 v21, v41, v39, s55
    v_perm_b32 v13, v45, v43, s55
    v_perm_b32 v23, v49, v47, s55
    v_perm_b32 v15, v53, v51, s55
    v_perm_b32 v25, v57, v55, s55
    v_perm_b32 v17, v61, v59, s55
    ds_write_b128 v0, v[10:13] offset:4096
    ds_write_b128 v0, v[14:17] offset:5120
    ds_write_b128 v0, v[18:21] offset:6144
    ds_write_b128 v0, v[22:25] offset:7168
    s_waitcnt vmcnt(8)
    ds_read_b64_tr_b16 v[10:11], v27 offset:24576
    ds_read_b64_tr_b16 v[12:13], v27 offset:24832
    ds_read_b64_tr_b16 v[14:15], v27 offset:26624
    ds_read_b64_tr_b16 v[16:17], v27 offset:26880
    ds_read_b64_tr_b16 v[18:19], v27 offset:24608
    ds_read_b64_tr_b16 v[20:21], v27 offset:24864
    ds_read_b64_tr_b16 v[22:23], v27 offset:26656
    ds_read_b64_tr_b16 v[24:25], v27 offset:26912
    s_waitcnt lgkmcnt(0)
    ds_write_b128 v0, v[10:13] offset:24576
    ds_write_b128 v0, v[14:17] offset:25600
    ds_write_b128 v0, v[18:21] offset:26624
    ds_write_b128 v0, v[22:25] offset:27648
    s_barrier
    s_mov_b32 m0, 65536
    s_mov_b32 s57, 3145728
    buffer_load_dwordx4 v8, s[12:15], s57 offen  lds
    s_mov_b32 m0, 66560
    s_mov_b32 s57, 3276800
    buffer_load_dwordx4 v8, s[12:15], s57 offen  lds
    s_mov_b32 m0, 67584
    s_mov_b32 s57, 3407872
    buffer_load_dwordx4 v8, s[12:15], s57 offen  lds
    s_mov_b32 m0, 68608
    s_mov_b32 s57, 3538944
    buffer_load_dwordx4 v8, s[12:15], s57 offen  lds
    s_mov_b32 s57, 576
    buffer_load_dword v30, v9, s[24:27], s57 offen offset:0
    buffer_load_dword v31, v9, s[24:27], s57 offen offset:256
    s_mov_b32 s57, 19008
    buffer_load_dword v32, v9, s[24:27], s57 offen offset:0
    buffer_load_dword v33, v9, s[24:27], s57 offen offset:256
    s_mov_b32 s57, 5184
    buffer_load_dword v34, v9, s[24:27], s57 offen offset:0
    buffer_load_dword v35, v9, s[24:27], s57 offen offset:256
    s_mov_b32 s57, 23616
    buffer_load_dword v36, v9, s[24:27], s57 offen offset:0
    buffer_load_dword v37, v9, s[24:27], s57 offen offset:256
    s_mov_b32 s57, 1728
    buffer_load_dword v38, v9, s[24:27], s57 offen offset:0
    buffer_load_dword v39, v9, s[24:27], s57 offen offset:256
    s_mov_b32 s57, 20160
    buffer_load_dword v40, v9, s[24:27], s57 offen offset:0
    buffer_load_dword v41, v9, s[24:27], s57 offen offset:256
    s_mov_b32 s57, 6336
    buffer_load_dword v42, v9, s[24:27], s57 offen offset:0
    buffer_load_dword v43, v9, s[24:27], s57 offen offset:256
    s_mov_b32 s57, 24768
    buffer_load_dword v44, v9, s[24:27], s57 offen offset:0
    buffer_load_dword v45, v9, s[24:27], s57 offen offset:256
    s_mov_b32 s57, 37440
    buffer_load_dword v46, v9, s[24:27], s57 offen offset:0
    buffer_load_dword v47, v9, s[24:27], s57 offen offset:256
    s_mov_b32 s57, 55872
    buffer_load_dword v48, v9, s[24:27], s57 offen offset:0
    buffer_load_dword v49, v9, s[24:27], s57 offen offset:256
    s_mov_b32 s57, 42048
    buffer_load_dword v50, v9, s[24:27], s57 offen offset:0
    buffer_load_dword v51, v9, s[24:27], s57 offen offset:256
    s_mov_b32 s57, 60480
    buffer_load_dword v52, v9, s[24:27], s57 offen offset:0
    buffer_load_dword v53, v9, s[24:27], s57 offen offset:256
    s_mov_b32 s57, 38592
    buffer_load_dword v54, v9, s[24:27], s57 offen offset:0
    buffer_load_dword v55, v9, s[24:27], s57 offen offset:256
    s_mov_b32 s57, 57024
    buffer_load_dword v56, v9, s[24:27], s57 offen offset:0
    buffer_load_dword v57, v9, s[24:27], s57 offen offset:256
    s_mov_b32 s57, 43200
    buffer_load_dword v58, v9, s[24:27], s57 offen offset:0
    buffer_load_dword v59, v9, s[24:27], s57 offen offset:256
    s_mov_b32 s57, 61632
    buffer_load_dword v60, v9, s[24:27], s57 offen offset:0
    buffer_load_dword v61, v9, s[24:27], s57 offen offset:256
    s_waitcnt vmcnt(40)
    ds_read_b64_tr_b16 v[96:97], v28 offset:0
    ds_read_b64_tr_b16 v[98:99], v28 offset:256
    ds_read_b64_tr_b16 v[100:101], v28 offset:2048
    ds_read_b64_tr_b16 v[102:103], v28 offset:2304
    ds_read_b64_tr_b16 v[104:105], v28 offset:32
    ds_read_b64_tr_b16 v[106:107], v28 offset:288
    ds_read_b64_tr_b16 v[108:109], v28 offset:2080
    ds_read_b64_tr_b16 v[110:111], v28 offset:2336
    s_waitcnt lgkmcnt(0)
    s_barrier
    s_mov_b32 m0, 151552
    s_mov_b32 s57, 3670016
    buffer_load_dwordx4 v8, s[12:15], s57 offen  lds
    s_mov_b32 m0, 152576
    s_mov_b32 s57, 3801088
    buffer_load_dwordx4 v8, s[12:15], s57 offen  lds
    s_mov_b32 m0, 153600
    s_mov_b32 s57, 3932160
    buffer_load_dwordx4 v8, s[12:15], s57 offen  lds
    s_mov_b32 m0, 154624
    s_mov_b32 s57, 4063232
    buffer_load_dwordx4 v8, s[12:15], s57 offen  lds
    s_waitcnt vmcnt(40)
    ds_read_b64_tr_b16 a[32:33], v27 offset:32768
    ds_read_b64_tr_b16 a[34:35], v27 offset:33024
    ds_read_b64_tr_b16 a[36:37], v27 offset:34816
    ds_read_b64_tr_b16 a[38:39], v27 offset:35072
    ds_read_b64_tr_b16 a[40:41], v27 offset:32800
    ds_read_b64_tr_b16 a[42:43], v27 offset:33056
    ds_read_b64_tr_b16 a[44:45], v27 offset:34848
    ds_read_b64_tr_b16 a[46:47], v27 offset:35104
    s_waitcnt lgkmcnt(0)
    s_barrier
    s_mov_b32 m0, 69632
    s_mov_b32 s57, 4194304
    buffer_load_dwordx4 v8, s[12:15], s57 offen  lds
    s_mov_b32 m0, 70656
    s_mov_b32 s57, 4325376
    buffer_load_dwordx4 v8, s[12:15], s57 offen  lds
    s_mov_b32 m0, 71680
    s_mov_b32 s57, 4456448
    buffer_load_dwordx4 v8, s[12:15], s57 offen  lds
    s_mov_b32 m0, 72704
    s_mov_b32 s57, 4587520
    buffer_load_dwordx4 v8, s[12:15], s57 offen  lds
    s_waitcnt vmcnt(40)
    ds_read_b64_tr_b16 v[10:11], v27 offset:28672
    ds_read_b64_tr_b16 v[12:13], v27 offset:28928
    ds_read_b64_tr_b16 v[14:15], v27 offset:30720
    ds_read_b64_tr_b16 v[16:17], v27 offset:30976
    ds_read_b64_tr_b16 v[18:19], v27 offset:28704
    ds_read_b64_tr_b16 v[20:21], v27 offset:28960
    ds_read_b64_tr_b16 v[22:23], v27 offset:30752
    ds_read_b64_tr_b16 v[24:25], v27 offset:31008
    s_waitcnt lgkmcnt(0)
    ds_write_b128 v0, v[10:13] offset:28672
    ds_write_b128 v0, v[14:17] offset:29696
    ds_write_b128 v0, v[18:21] offset:30720
    ds_write_b128 v0, v[22:25] offset:31744
    s_barrier
    s_waitcnt vmcnt(4)
    ds_read_b64_tr_b16 a[224:225], v28 offset:0
    ds_read_b64_tr_b16 a[226:227], v28 offset:256
    ds_read_b64_tr_b16 a[228:229], v28 offset:2048
    ds_read_b64_tr_b16 a[230:231], v28 offset:2304
    ds_read_b64_tr_b16 a[232:233], v28 offset:32
    ds_read_b64_tr_b16 a[234:235], v28 offset:288
    ds_read_b64_tr_b16 a[236:237], v28 offset:2080
    ds_read_b64_tr_b16 a[238:239], v28 offset:2336
    s_waitcnt lgkmcnt(0)
    s_barrier
    s_mov_b32 m0, 151552
    s_mov_b32 s57, 0
    buffer_load_dwordx4 v8, s[16:19], s57 offen  lds
    s_mov_b32 m0, 152576
    s_mov_b32 s57, 131072
    buffer_load_dwordx4 v8, s[16:19], s57 offen  lds
    s_mov_b32 m0, 153600
    s_mov_b32 s57, 262144
    buffer_load_dwordx4 v8, s[16:19], s57 offen  lds
    s_mov_b32 m0, 154624
    s_mov_b32 s57, 393216
    buffer_load_dwordx4 v8, s[16:19], s57 offen  lds
    s_waitcnt vmcnt(4)
    ds_read_b64_tr_b16 v[144:145], v27 offset:32768
    ds_read_b64_tr_b16 v[146:147], v27 offset:33024
    ds_read_b64_tr_b16 v[148:149], v27 offset:34816
    ds_read_b64_tr_b16 v[150:151], v27 offset:35072
    ds_read_b64_tr_b16 v[152:153], v27 offset:32800
    ds_read_b64_tr_b16 v[154:155], v27 offset:33056
    ds_read_b64_tr_b16 v[156:157], v27 offset:34848
    ds_read_b64_tr_b16 v[158:159], v27 offset:35104
    s_waitcnt lgkmcnt(0)
    s_barrier
    s_mov_b32 m0, 69632
    s_mov_b32 s57, 524288
    buffer_load_dwordx4 v8, s[16:19], s57 offen  lds
    s_mov_b32 m0, 70656
    s_mov_b32 s57, 655360
    buffer_load_dwordx4 v8, s[16:19], s57 offen  lds
    s_mov_b32 m0, 71680
    s_mov_b32 s57, 786432
    buffer_load_dwordx4 v8, s[16:19], s57 offen  lds
    s_mov_b32 m0, 72704
    s_mov_b32 s57, 917504
    buffer_load_dwordx4 v8, s[16:19], s57 offen  lds
    s_waitcnt vmcnt(4)
    ds_read_b64_tr_b16 a[176:177], v28 offset:0
    ds_read_b64_tr_b16 a[178:179], v28 offset:256
    ds_read_b64_tr_b16 a[180:181], v28 offset:2048
    ds_read_b64_tr_b16 a[182:183], v28 offset:2304
    ds_read_b64_tr_b16 a[184:185], v28 offset:32
    ds_read_b64_tr_b16 a[186:187], v28 offset:288
    ds_read_b64_tr_b16 a[188:189], v28 offset:2080
    ds_read_b64_tr_b16 a[190:191], v28 offset:2336
    s_waitcnt lgkmcnt(0)
    s_barrier
    s_mov_b32 m0, 151552
    s_mov_b32 s57, 1048576
    buffer_load_dwordx4 v8, s[16:19], s57 offen  lds
    s_mov_b32 m0, 152576
    s_mov_b32 s57, 1179648
    buffer_load_dwordx4 v8, s[16:19], s57 offen  lds
    s_mov_b32 m0, 153600
    s_mov_b32 s57, 1310720
    buffer_load_dwordx4 v8, s[16:19], s57 offen  lds
    s_mov_b32 m0, 154624
    s_mov_b32 s57, 1441792
    buffer_load_dwordx4 v8, s[16:19], s57 offen  lds
    v_perm_b32 v176, v32, v30, s54
    v_perm_b32 v184, v36, v34, s54
    v_perm_b32 v178, v40, v38, s54
    v_perm_b32 v186, v44, v42, s54
    v_perm_b32 v180, v48, v46, s54
    v_perm_b32 v188, v52, v50, s54
    v_perm_b32 v182, v56, v54, s54
    v_perm_b32 v190, v60, v58, s54
    v_perm_b32 v185, v32, v30, s55
    v_perm_b32 v177, v36, v34, s55
    v_perm_b32 v187, v40, v38, s55
    v_perm_b32 v179, v44, v42, s55
    v_perm_b32 v189, v48, v46, s55
    v_perm_b32 v181, v52, v50, s55
    v_perm_b32 v191, v56, v54, s55
    v_perm_b32 v183, v60, v58, s55
    v_perm_b32 v192, v33, v31, s54
    v_perm_b32 v200, v37, v35, s54
    v_perm_b32 v194, v41, v39, s54
    v_perm_b32 v202, v45, v43, s54
    v_perm_b32 v196, v49, v47, s54
    v_perm_b32 v204, v53, v51, s54
    v_perm_b32 v198, v57, v55, s54
    v_perm_b32 v206, v61, v59, s54
    v_perm_b32 v201, v33, v31, s55
    v_perm_b32 v193, v37, v35, s55
    v_perm_b32 v203, v41, v39, s55
    v_perm_b32 v195, v45, v43, s55
    v_perm_b32 v205, v49, v47, s55
    v_perm_b32 v197, v53, v51, s55
    v_perm_b32 v207, v57, v55, s55
    v_perm_b32 v199, v61, v59, s55
    s_waitcnt vmcnt(4)
    ds_read_b64_tr_b16 a[0:1], v27 offset:32768
    ds_read_b64_tr_b16 a[2:3], v27 offset:33024
    ds_read_b64_tr_b16 a[4:5], v27 offset:34816
    ds_read_b64_tr_b16 a[6:7], v27 offset:35072
    ds_read_b64_tr_b16 a[8:9], v27 offset:32800
    ds_read_b64_tr_b16 a[10:11], v27 offset:33056
    ds_read_b64_tr_b16 a[12:13], v27 offset:34848
    ds_read_b64_tr_b16 a[14:15], v27 offset:35104
    s_waitcnt lgkmcnt(0)
    s_barrier
    s_mov_b32 m0, 69632
    s_mov_b32 s57, 1572864
    buffer_load_dwordx4 v8, s[16:19], s57 offen  lds
    s_mov_b32 m0, 70656
    s_mov_b32 s57, 1703936
    buffer_load_dwordx4 v8, s[16:19], s57 offen  lds
    s_mov_b32 m0, 71680
    s_mov_b32 s57, 1835008
    buffer_load_dwordx4 v8, s[16:19], s57 offen  lds
    s_mov_b32 m0, 72704
    s_mov_b32 s57, 1966080
    buffer_load_dwordx4 v8, s[16:19], s57 offen  lds
    s_mov_b32 s57, 74304
    buffer_load_dword v30, v9, s[24:27], s57 offen offset:0
    buffer_load_dword v31, v9, s[24:27], s57 offen offset:256
    s_mov_b32 s57, 92736
    buffer_load_dword v32, v9, s[24:27], s57 offen offset:0
    buffer_load_dword v33, v9, s[24:27], s57 offen offset:256
    s_mov_b32 s57, 78912
    buffer_load_dword v34, v9, s[24:27], s57 offen offset:0
    buffer_load_dword v35, v9, s[24:27], s57 offen offset:256
    s_mov_b32 s57, 97344
    buffer_load_dword v36, v9, s[24:27], s57 offen offset:0
    buffer_load_dword v37, v9, s[24:27], s57 offen offset:256
    s_mov_b32 s57, 75456
    buffer_load_dword v38, v9, s[24:27], s57 offen offset:0
    buffer_load_dword v39, v9, s[24:27], s57 offen offset:256
    s_mov_b32 s57, 93888
    buffer_load_dword v40, v9, s[24:27], s57 offen offset:0
    buffer_load_dword v41, v9, s[24:27], s57 offen offset:256
    s_mov_b32 s57, 80064
    buffer_load_dword v42, v9, s[24:27], s57 offen offset:0
    buffer_load_dword v43, v9, s[24:27], s57 offen offset:256
    s_mov_b32 s57, 98496
    buffer_load_dword v44, v9, s[24:27], s57 offen offset:0
    buffer_load_dword v45, v9, s[24:27], s57 offen offset:256
    s_mov_b32 s57, 111168
    buffer_load_dword v46, v9, s[24:27], s57 offen offset:0
    buffer_load_dword v47, v9, s[24:27], s57 offen offset:256
    s_mov_b32 s57, 129600
    buffer_load_dword v48, v9, s[24:27], s57 offen offset:0
    buffer_load_dword v49, v9, s[24:27], s57 offen offset:256
    s_mov_b32 s57, 115776
    buffer_load_dword v50, v9, s[24:27], s57 offen offset:0
    buffer_load_dword v51, v9, s[24:27], s57 offen offset:256
    s_mov_b32 s57, 134208
    buffer_load_dword v52, v9, s[24:27], s57 offen offset:0
    buffer_load_dword v53, v9, s[24:27], s57 offen offset:256
    s_mov_b32 s57, 112320
    buffer_load_dword v54, v9, s[24:27], s57 offen offset:0
    buffer_load_dword v55, v9, s[24:27], s57 offen offset:256
    s_mov_b32 s57, 130752
    buffer_load_dword v56, v9, s[24:27], s57 offen offset:0
    buffer_load_dword v57, v9, s[24:27], s57 offen offset:256
    s_mov_b32 s57, 116928
    buffer_load_dword v58, v9, s[24:27], s57 offen offset:0
    buffer_load_dword v59, v9, s[24:27], s57 offen offset:256
    s_mov_b32 s57, 135360
    buffer_load_dword v60, v9, s[24:27], s57 offen offset:0
    buffer_load_dword v61, v9, s[24:27], s57 offen offset:256
    s_waitcnt vmcnt(36)
    ds_read_b64_tr_b16 a[96:97], v28 offset:0
    ds_read_b64_tr_b16 a[98:99], v28 offset:256
    ds_read_b64_tr_b16 a[100:101], v28 offset:2048
    ds_read_b64_tr_b16 a[102:103], v28 offset:2304
    ds_read_b64_tr_b16 a[104:105], v28 offset:32
    ds_read_b64_tr_b16 a[106:107], v28 offset:288
    ds_read_b64_tr_b16 a[108:109], v28 offset:2080
    ds_read_b64_tr_b16 a[110:111], v28 offset:2336
    s_waitcnt lgkmcnt(0)
    s_barrier
    s_mov_b32 m0, 151552
    s_mov_b32 s57, 2097152
    buffer_load_dwordx4 v8, s[16:19], s57 offen  lds
    s_mov_b32 m0, 152576
    s_mov_b32 s57, 2228224
    buffer_load_dwordx4 v8, s[16:19], s57 offen  lds
    s_mov_b32 m0, 153600
    s_mov_b32 s57, 2359296
    buffer_load_dwordx4 v8, s[16:19], s57 offen  lds
    s_mov_b32 m0, 154624
    s_mov_b32 s57, 2490368
    buffer_load_dwordx4 v8, s[16:19], s57 offen  lds
    buffer_load_dword v76, off, s[4:7], 0 offset:40 sc1
    v_lshlrev_b32 v75, 6, v2
    s_mov_b32 s57, 4096
    buffer_load_dword v75, v75, s[28:31], s57 offen
    s_waitcnt vmcnt(38)
    ds_read_b64_tr_b16 a[128:129], v27 offset:32768
    ds_read_b64_tr_b16 a[130:131], v27 offset:33024
    ds_read_b64_tr_b16 a[132:133], v27 offset:34816
    ds_read_b64_tr_b16 a[134:135], v27 offset:35072
    ds_read_b64_tr_b16 a[136:137], v27 offset:32800
    ds_read_b64_tr_b16 a[138:139], v27 offset:33056
    ds_read_b64_tr_b16 a[140:141], v27 offset:34848
    ds_read_b64_tr_b16 a[142:143], v27 offset:35104
    s_waitcnt lgkmcnt(0)
    s_barrier
    s_mov_b32 m0, 69632
    s_mov_b32 s57, 2621440
    buffer_load_dwordx4 v8, s[16:19], s57 offen  lds
    s_mov_b32 m0, 70656
    s_mov_b32 s57, 2752512
    buffer_load_dwordx4 v8, s[16:19], s57 offen  lds
    s_mov_b32 m0, 71680
    s_mov_b32 s57, 2883584
    buffer_load_dwordx4 v8, s[16:19], s57 offen  lds
    s_mov_b32 m0, 72704
    s_mov_b32 s57, 3014656
    buffer_load_dwordx4 v8, s[16:19], s57 offen  lds
    s_waitcnt vmcnt(6)
    ds_read_b64_tr_b16 v[112:113], v28 offset:0
    ds_read_b64_tr_b16 v[114:115], v28 offset:256
    ds_read_b64_tr_b16 v[116:117], v28 offset:2048
    ds_read_b64_tr_b16 v[118:119], v28 offset:2304
    ds_read_b64_tr_b16 v[120:121], v28 offset:32
    ds_read_b64_tr_b16 v[122:123], v28 offset:288
    ds_read_b64_tr_b16 v[124:125], v28 offset:2080
    ds_read_b64_tr_b16 v[126:127], v28 offset:2336
    s_waitcnt lgkmcnt(0)
    s_barrier
    s_mov_b32 m0, 151552
    s_mov_b32 s57, 3145728
    buffer_load_dwordx4 v8, s[16:19], s57 offen  lds
    s_mov_b32 m0, 152576
    s_mov_b32 s57, 3276800
    buffer_load_dwordx4 v8, s[16:19], s57 offen  lds
    s_mov_b32 m0, 153600
    s_mov_b32 s57, 3407872
    buffer_load_dwordx4 v8, s[16:19], s57 offen  lds
    s_mov_b32 m0, 154624
    s_mov_b32 s57, 3538944
    buffer_load_dwordx4 v8, s[16:19], s57 offen  lds
    s_waitcnt vmcnt(4)
    ds_read_b64_tr_b16 a[48:49], v27 offset:32768
    ds_read_b64_tr_b16 a[50:51], v27 offset:33024
    ds_read_b64_tr_b16 a[52:53], v27 offset:34816
    ds_read_b64_tr_b16 a[54:55], v27 offset:35072
    ds_read_b64_tr_b16 a[56:57], v27 offset:32800
    ds_read_b64_tr_b16 a[58:59], v27 offset:33056
    ds_read_b64_tr_b16 a[60:61], v27 offset:34848
    ds_read_b64_tr_b16 a[62:63], v27 offset:35104
    s_waitcnt lgkmcnt(0)
    s_barrier
    s_mov_b32 m0, 69632
    s_mov_b32 s57, 3670016
    buffer_load_dwordx4 v8, s[16:19], s57 offen  lds
    s_mov_b32 m0, 70656
    s_mov_b32 s57, 3801088
    buffer_load_dwordx4 v8, s[16:19], s57 offen  lds
    s_mov_b32 m0, 71680
    s_mov_b32 s57, 3932160
    buffer_load_dwordx4 v8, s[16:19], s57 offen  lds
    s_mov_b32 m0, 72704
    s_mov_b32 s57, 4063232
    buffer_load_dwordx4 v8, s[16:19], s57 offen  lds
    s_waitcnt vmcnt(4)
    ds_read_b64_tr_b16 a[208:209], v28 offset:0
    ds_read_b64_tr_b16 a[210:211], v28 offset:256
    ds_read_b64_tr_b16 a[212:213], v28 offset:2048
    ds_read_b64_tr_b16 a[214:215], v28 offset:2304
    ds_read_b64_tr_b16 a[216:217], v28 offset:32
    ds_read_b64_tr_b16 a[218:219], v28 offset:288
    ds_read_b64_tr_b16 a[220:221], v28 offset:2080
    ds_read_b64_tr_b16 a[222:223], v28 offset:2336
    s_waitcnt lgkmcnt(0)
    s_barrier
    s_waitcnt vmcnt(0)
    ds_read_b64_tr_b16 a[240:241], v27 offset:32768
    ds_read_b64_tr_b16 a[242:243], v27 offset:33024
    ds_read_b64_tr_b16 a[244:245], v27 offset:34816
    ds_read_b64_tr_b16 a[246:247], v27 offset:35072
    ds_read_b64_tr_b16 a[248:249], v27 offset:32800
    ds_read_b64_tr_b16 a[250:251], v27 offset:33056
    ds_read_b64_tr_b16 a[252:253], v27 offset:34848
    ds_read_b64_tr_b16 a[254:255], v27 offset:35104
    s_waitcnt lgkmcnt(0)
    s_barrier
    s_mov_b32 m0, 69632
    s_mov_b32 s57, 4194304
    buffer_load_dwordx4 v8, s[16:19], s57 offen  lds
    s_mov_b32 m0, 70656
    s_mov_b32 s57, 4325376
    buffer_load_dwordx4 v8, s[16:19], s57 offen  lds
    s_mov_b32 m0, 71680
    s_mov_b32 s57, 4456448
    buffer_load_dwordx4 v8, s[16:19], s57 offen  lds
    s_mov_b32 m0, 72704
    s_mov_b32 s57, 4587520
    buffer_load_dwordx4 v8, s[16:19], s57 offen  lds
    v_perm_b32 v224, v32, v30, s54
    v_perm_b32 v232, v36, v34, s54
    v_perm_b32 v226, v40, v38, s54
    v_perm_b32 v234, v44, v42, s54
    v_perm_b32 v228, v48, v46, s54
    v_perm_b32 v236, v52, v50, s54
    v_perm_b32 v230, v56, v54, s54
    v_perm_b32 v238, v60, v58, s54
    v_perm_b32 v233, v32, v30, s55
    v_perm_b32 v225, v36, v34, s55
    v_perm_b32 v235, v40, v38, s55
    v_perm_b32 v227, v44, v42, s55
    v_perm_b32 v237, v48, v46, s55
    v_perm_b32 v229, v52, v50, s55
    v_perm_b32 v239, v56, v54, s55
    v_perm_b32 v231, v60, v58, s55
    v_perm_b32 v10, v33, v31, s54
    v_perm_b32 v18, v37, v35, s54
    v_perm_b32 v12, v41, v39, s54
    v_perm_b32 v20, v45, v43, s54
    v_perm_b32 v14, v49, v47, s54
    v_perm_b32 v22, v53, v51, s54
    v_perm_b32 v16, v57, v55, s54
    v_perm_b32 v24, v61, v59, s54
    v_perm_b32 v19, v33, v31, s55
    v_perm_b32 v11, v37, v35, s55
    v_perm_b32 v21, v41, v39, s55
    v_perm_b32 v13, v45, v43, s55
    v_perm_b32 v23, v49, v47, s55
    v_perm_b32 v15, v53, v51, s55
    v_perm_b32 v25, v57, v55, s55
    v_perm_b32 v17, v61, v59, s55
    ds_write_b128 v0, v[10:13] offset:8192
    ds_write_b128 v0, v[14:17] offset:9216
    ds_write_b128 v0, v[18:21] offset:10240
    ds_write_b128 v0, v[22:25] offset:11264
    s_waitcnt vmcnt(0)
    ds_read_b64_tr_b16 v[10:11], v27 offset:32768
    ds_read_b64_tr_b16 v[12:13], v27 offset:33024
    ds_read_b64_tr_b16 v[14:15], v27 offset:34816
    ds_read_b64_tr_b16 v[16:17], v27 offset:35072
    ds_read_b64_tr_b16 v[18:19], v27 offset:32800
    ds_read_b64_tr_b16 v[20:21], v27 offset:33056
    ds_read_b64_tr_b16 v[22:23], v27 offset:34848
    ds_read_b64_tr_b16 v[24:25], v27 offset:35104
    s_waitcnt lgkmcnt(0)
    ds_write_b128 v0, v[10:13] offset:32768
    ds_write_b128 v0, v[14:17] offset:33792
    ds_write_b128 v0, v[18:21] offset:34816
    ds_write_b128 v0, v[22:25] offset:35840
    v_mov_b32 v60, v2
    v_mov_b32 v61, v3
    v_mov_b32 v62, v4
    v_and_b32 v63, 2, v60
    v_cmp_eq_u32 vcc, 0, v63
    v_mov_b32 v64, 0x5e5eeeee
    v_mov_b32 v65, 0x04044444
    v_cndmask_b32 v4, v64, v65, vcc
    s_lshl_b32 s54, s33, 6
    s_add_u32 s55, s54, 16384
    v_lshrrev_b32 v63, 3, v60
    v_lshlrev_b32 v63, 11, v63
    v_and_b32 v64, 7, v60
    v_lshlrev_b32 v64, 3, v64
    v_add3_u32 v5, v63, v64, s55
    v_lshrrev_b32 v63, 2, v61
    v_lshlrev_b32 v63, 8, v63
    v_lshl_add_u32 v63, v62, 6, v63
    v_and_b32 v64, 3, v61
    v_lshl_add_u32 v7, v64, 4, v63
    v_and_b32 v63, 2, v61
    v_lshlrev_b32 v63, 4, v63
    v_lshl_add_u32 v63, v62, 4, v63
    v_and_b32 v64, 1, v61
    v_lshl_add_u32 v63, v64, 3, v63
    v_and_b32 v64, 0x2c, v60
    v_cmp_eq_u32 vcc, 0, v64
    v_mov_b32 v64, 0x7ffff000
    s_nop 0
    v_cndmask_b32 v6, v64, v63, vcc
    s_bfe_u32 s54, s33, 0x20001
    s_lshl_b32 s54, s54, 8
    s_and_b32 s55, s33, 1
    s_lshr_b32 s56, s33, 3
    s_lshl_b32 s18, s56, 1
    s_add_u32 s18, s18, s55
    s_and_b32 s17, s18, 3
    s_lshl_b32 s18, s18, 5
    s_add_u32 s18, s18, s54
    s_add_u32 s18, s18, 8192
    s_lshl_b32 s17, s17, 6
    s_add_u32 s17, s17, s54
    s_lshr_b32 s56, s56, 1
    s_lshl_b32 s56, s56, 10
    s_add_u32 s17, s17, s56
    s_add_u32 s17, s17, 2048
    v_lshrrev_b32 v63, 3, v61
    v_lshlrev_b32 v63, 8, v63
    v_lshl_add_u32 v63, v62, 6, v63
    v_and_b32 v64, 4, v61
    v_lshl_add_u32 v63, v64, 3, v63
    v_and_b32 v64, 3, v61
    v_lshl_add_u32 v63, v64, 2, v63
    v_add_u32 v8, 162304, v63
    v_and_b32 v63, 1, v61
    v_lshlrev_b32 v63, 4, v63
    v_mov_b32 v64, 0x3f80
    v_lshlrev_b32 v63, v63, v64
    v_and_b32 v64, 14, v61
    v_lshlrev_b32 v65, 2, v62
    v_cmp_eq_u32 vcc, v64, v65
    s_nop 1
    v_cndmask_b32 v2, 0, v63, vcc
    v_bfe_u32 v65, v60, 4, 1
    v_lshlrev_b32 v65, 3, v65
    v_bfe_u32 v66, v60, 5, 1
    v_lshl_add_u32 v65, v66, 2, v65
    v_or_b32 v65, 2, v65
    v_cmp_eq_u32 vcc, v64, v65
    s_nop 1
    v_cndmask_b32 v3, 0, v63, vcc
    s_waitcnt vmcnt(0) lgkmcnt(0)
    s_waitcnt vmcnt(0) lgkmcnt(0)
    s_barrier
    v_mov_b32 v77, 163836
    s_cmp_lg_u32 s32, 0
    s_cbranch_scc1 T1_cm
    s_mov_b64 exec, 1
    ds_write_b32 v77, v79
    s_mov_b64 exec, -1
    s_waitcnt lgkmcnt(0)
T1_cm:
    s_barrier
    ds_read_b32 v77, v77
    s_waitcnt lgkmcnt(0)
    v_readfirstlane_b32 s94, v77
    s_barrier
    s_and_b32 s94, s94, s93
    s_cbranch_scc1 A_over
    v_cmp_gt_u32 vcc, 32, v76
    s_cbranch_vccz T1_iw_ok
    s_mov_b32 s94, 40
T1_iw:
    buffer_load_dword v76, off, s[4:7], s94 sc1
    s_sub_u32 s95, s95, 1
    s_cmp_eq_u32 s95, 0
    s_cbranch_scc1 L_end
    s_waitcnt vmcnt(0)
    v_cmp_gt_u32 vcc, 32, v76
    s_cbranch_vccz T1_iw_ok
    s_sleep 1
    s_branch T1_iw
T1_iw_ok:
T1_layer:
    v_bfe_u32 v63, v1, 6, 2
    v_bfe_u32 v64, v1, 4, 1
    v_lshl_add_u32 v63, v63, 1, v64
    v_mul_u32_u24 v63, 1152, v63
    v_bfe_u32 v64, v1, 8, 2
    v_lshl_add_u32 v63, v64, 5, v63
    v_bfe_u32 v64, v1, 5, 1
    v_lshl_add_u32 v63, v64, 4, v63
    buffer_load_dwordx4 v[28:31], v63, s[28:31], 0 offen offset:128
    buffer_load_dwordx4 v[72:75], v63, s[28:31], 0 offen offset:640
    buffer_load_dwordx4 v[68:71], v63, s[28:31], 0 offen offset:1024
    s_lshl_b32 s12, s33, 8
    s_add_u32 s12, s12, 3149824
    buffer_load_dwordx2 v[76:77], off, s[8:11], s12 sc1
    ds_read_b128 v[10:13], v0 offset:20480
    ds_read_b128 v[14:17], v0 offset:21504
    ds_read_b128 v[18:21], v0 offset:22528
    ds_read_b128 v[22:25], v0 offset:23552
    s_waitcnt vmcnt(2)
    v_mov_b64 v[60:61], v[72:73]
    v_mov_b64 v[62:63], v[74:75]
    v_mov_b64 v[32:33], 0
    v_mov_b64 v[34:35], 0
    v_mov_b64 v[36:37], 0
    v_mov_b64 v[38:39], 0
    v_mov_b64 v[40:41], 0
    v_mov_b64 v[42:43], 0
    v_mov_b64 v[44:45], 0
    v_mov_b64 v[46:47], 0
    v_mov_b64 v[48:49], 0
    v_mov_b64 v[50:51], 0
    v_mov_b64 v[52:53], 0
    v_mov_b64 v[54:55], 0
    s_mov_b32 s34, 0
    s_mov_b32 s35, 20000
    s_mov_b32 s36, 1
    s_mov_b32 s60, 0
    s_mov_b32 s61, 0
    s_mov_b32 s3, 0x5d800000
    s_mov_b32 s13, 0
    s_mov_b32 s14, 0x3f80
    s_mov_b32 s15, 3145728
    s_lshl_b32 s16, s33, 2
    s_add_u32 s16, s16, s15
    s_mov_b32 s37, 1343488
    s_mov_b32 s41, 2113536
    s_lshl_b32 s49, s33, 11
    s_add_u32 s49, s49, 4294885376
    s_lshl_b32 s19, s33, 10
    s_add_u32 s19, s19, 114688
    s_lshl_b32 s54, s33, 14
    s_add_u32 s44, s54, 33411072
    s_add_u32 s25, s44, 81920
    s_sub_u32 s45, s44, 442368
    s_mov_b32 s46, 16629760
    s_cmp_lt_u32 s33, 18
    s_cselect_b32 s47, 0, 18
    s_sub_u32 s47, s33, s47
    s_lshl_b32 s47, s47, 9
    s_add_u32 s47, s47, 73728
    s_mov_b32 s48, 0x3e0293ee
    s_mov_b32 s50, 0x33333333
    s_mov_b32 s51, 0x33333333
    s_mov_b32 s52, 0x3f803f80
    s_mov_b32 s53, 0x3f803f80
    s_mov_b32 s62, 0x11111111
    s_mov_b32 s63, 0x11111111
    s_mov_b32 m0, 156672
    v_lshlrev_b32 v78, 2, v1
    s_waitcnt lgkmcnt(0)
    s_waitcnt vmcnt(0)
    v_min_u32 v76, v76, v77
T1_kv:
    v_cmp_eq_u32 vcc, 0, v76
    s_cbranch_vccz T1_kv_ok
    buffer_load_dwordx2 v[76:77], off, s[8:11], s12 sc1
    s_sub_u32 s95, s95, 1
    s_cmp_eq_u32 s95, 0
    s_cbranch_scc1 L_end
    s_waitcnt vmcnt(0)
    v_min_u32 v76, v76, v77
    s_branch T1_kv
T1_kv_ok:
    buffer_load_dword v9, v78, s[8:11], s45 offen sc1
    s_add_u32 s12, s12, 8
    s_mul_i32 s54, s33, 18432
    s_add_u32 s54, s54, 462848
    buffer_load_dword v9, v78, s[8:11], s54 offen sc1
    s_and_b32 s54, s33, 7
    s_lshl_b32 s54, s54, 12
    s_add_u32 s54, s54, 1507328
    buffer_load_dword v9, v78, s[8:11], s54 offen sc1
    s_branch T1_head
T0_pro:
    v_and_b32 v2, 63, v0
    v_and_b32 v3, 15, v0
    v_lshrrev_b32 v4, 4, v2
    s_mul_i32 s54, s33, 147456
    v_bfe_u32 v5, v2, 5, 1
    v_lshlrev_b32 v5, 3, v5
    v_bfe_u32 v6, v2, 4, 1
    v_lshl_add_u32 v5, v6, 1, v5
    v_mul_u32_u24 v5, 1152, v5
    v_lshlrev_b32 v6, 2, v3
    v_add3_u32 v9, v5, v6, s54
    v_and_b32 v7, 3, v2
    v_lshlrev_b32 v7, 4, v7
    v_bfe_u32 v5, v2, 3, 1
    v_lshlrev_b32 v5, 3, v5
    v_lshl_add_u32 v5, v4, 1, v5
    v_bfe_u32 v6, v2, 2, 1
    v_add_u32 v5, v5, v6
    s_lshl_b32 s55, s33, 8
    s_add_u32 s55, s55, 0
    v_lshlrev_b32 v5, 13, v5
    v_add3_u32 v8, v5, v7, s55
    v_lshlrev_b32 v5, 4, v6
    v_bfe_u32 v6, v2, 3, 1
    v_lshl_add_u32 v5, v6, 2, v5
    v_add_u32 v5, v5, v4
    v_bfe_u32 v6, v2, 1, 1
    v_lshl_add_u32 v5, v6, 6, v5
    v_mul_u32_u24 v5, 1152, v5
    v_and_b32 v6, 16, v7
    v_add3_u32 v26, v5, v6, s54
    v_lshrrev_b32 v5, 2, v3
    v_lshl_add_u32 v5, v4, 3, v5
    v_lshlrev_b32 v5, 6, v5
    v_lshrrev_b32 v6, 1, v7
    v_add_u32 v5, v5, v6
    v_add_u32 v27, 0, v5
    v_add_u32 v28, 147456, v5
    v_lshlrev_b32 v5, 4, v2
    v_add_u32 v0, 0, v5
    v_add_u32 v1, 147456, v5
    s_mov_b32 s54, 0x05040100
    s_mov_b32 s55, 0x07060302
    s_barrier
    s_mov_b32 m0, 147456
    s_mov_b32 s57, 1024
    buffer_load_dwordx4 v26, s[24:27], s57 offen lds
    s_mov_b32 m0, 148480
    s_mov_b32 s57, 10240
    buffer_load_dwordx4 v26, s[24:27], s57 offen lds
    s_mov_b32 m0, 149504
    s_mov_b32 s57, 37888
    buffer_load_dwordx4 v26, s[24:27], s57 offen lds
    s_mov_b32 m0, 150528
    s_mov_b32 s57, 47104
    buffer_load_dwordx4 v26, s[24:27], s57 offen lds
    s_mov_b32 m0, 32768
    s_mov_b32 s57, 0
    buffer_load_dwordx4 v8, s[20:23], s57 offen  lds
    s_mov_b32 m0, 33792
    s_mov_b32 s57, 131072
    buffer_load_dwordx4 v8, s[20:23], s57 offen  lds
    s_mov_b32 m0, 34816
    s_mov_b32 s57, 262144
    buffer_load_dwordx4 v8, s[20:23], s57 offen  lds
    s_mov_b32 m0, 35840
    s_mov_b32 s57, 393216
    buffer_load_dwordx4 v8, s[20:23], s57 offen  lds
    s_mov_b32 m0, 28672
    s_mov_b32 s57, 524288
    buffer_load_dwordx4 v8, s[20:23], s57 offen  lds
    s_mov_b32 m0, 29696
    s_mov_b32 s57, 655360
    buffer_load_dwordx4 v8, s[20:23], s57 offen  lds
    s_mov_b32 m0, 30720
    s_mov_b32 s57, 786432
    buffer_load_dwordx4 v8, s[20:23], s57 offen  lds
    s_mov_b32 m0, 31744
    s_mov_b32 s57, 917504
    buffer_load_dwordx4 v8, s[20:23], s57 offen  lds
    s_mov_b32 s57, 0
    buffer_load_dword v30, v9, s[24:27], s57 offen offset:0
    buffer_load_dword v31, v9, s[24:27], s57 offen offset:256
    s_mov_b32 s57, 18432
    buffer_load_dword v32, v9, s[24:27], s57 offen offset:0
    buffer_load_dword v33, v9, s[24:27], s57 offen offset:256
    s_mov_b32 s57, 4608
    buffer_load_dword v34, v9, s[24:27], s57 offen offset:0
    buffer_load_dword v35, v9, s[24:27], s57 offen offset:256
    s_mov_b32 s57, 23040
    buffer_load_dword v36, v9, s[24:27], s57 offen offset:0
    buffer_load_dword v37, v9, s[24:27], s57 offen offset:256
    s_mov_b32 s57, 1152
    buffer_load_dword v38, v9, s[24:27], s57 offen offset:0
    buffer_load_dword v39, v9, s[24:27], s57 offen offset:256
    s_mov_b32 s57, 19584
    buffer_load_dword v40, v9, s[24:27], s57 offen offset:0
    buffer_load_dword v41, v9, s[24:27], s57 offen offset:256
    s_mov_b32 s57, 5760
    buffer_load_dword v42, v9, s[24:27], s57 offen offset:0
    buffer_load_dword v43, v9, s[24:27], s57 offen offset:256
    s_mov_b32 s57, 24192
    buffer_load_dword v44, v9, s[24:27], s57 offen offset:0
    buffer_load_dword v45, v9, s[24:27], s57 offen offset:256
    s_mov_b32 s57, 36864
    buffer_load_dword v46, v9, s[24:27], s57 offen offset:0
    buffer_load_dword v47, v9, s[24:27], s57 offen offset:256
    s_mov_b32 s57, 55296
    buffer_load_dword v48, v9, s[24:27], s57 offen offset:0
    buffer_load_dword v49, v9, s[24:27], s57 offen offset:256
    s_mov_b32 s57, 41472
    buffer_load_dword v50, v9, s[24:27], s57 offen offset:0
    buffer_load_dword v51, v9, s[24:27], s57 offen offset:256
    s_mov_b32 s57, 59904
    buffer_load_dword v52, v9, s[24:27], s57 offen offset:0
    buffer_load_dword v53, v9, s[24:27], s57 offen offset:256
    s_mov_b32 s57, 38016
    buffer_load_dword v54, v9, s[24:27], s57 offen offset:0
    buffer_load_dword v55, v9, s[24:27], s57 offen offset:256
    s_mov_b32 s57, 56448
    buffer_load_dword v56, v9, s[24:27], s57 offen offset:0
    buffer_load_dword v57, v9, s[24:27], s57 offen offset:256
    s_mov_b32 s57, 42624
    buffer_load_dword v58, v9, s[24:27], s57 offen offset:0
    buffer_load_dword v59, v9, s[24:27], s57 offen offset:256
    s_mov_b32 s57, 61056
    buffer_load_dword v60, v9, s[24:27], s57 offen offset:0
    buffer_load_dword v61, v9, s[24:27], s57 offen offset:256
    s_waitcnt vmcnt(40)
    ds_read_b64_tr_b16 v[240:241], v28 offset:0
    ds_read_b64_tr_b16 v[242:243], v28 offset:256
    ds_read_b64_tr_b16 v[244:245], v28 offset:2048
    ds_read_b64_tr_b16 v[246:247], v28 offset:2304
    ds_read_b64_tr_b16 v[248:249], v28 offset:32
    ds_read_b64_tr_b16 v[250:251], v28 offset:288
    ds_read_b64_tr_b16 v[252:253], v28 offset:2080
    ds_read_b64_tr_b16 v[254:255], v28 offset:2336
    s_waitcnt lgkmcnt(0)
    s_barrier
    s_mov_b32 m0, 147456
    s_mov_b32 s57, 1048576
    buffer_load_dwordx4 v8, s[20:23], s57 offen  lds
    s_mov_b32 m0, 148480
    s_mov_b32 s57, 1179648
    buffer_load_dwordx4 v8, s[20:23], s57 offen  lds
    s_mov_b32 m0, 149504
    s_mov_b32 s57, 1310720
    buffer_load_dwordx4 v8, s[20:23], s57 offen  lds
    s_mov_b32 m0, 150528
    s_mov_b32 s57, 1441792
    buffer_load_dwordx4 v8, s[20:23], s57 offen  lds
    s_waitcnt vmcnt(40)
    ds_read_b64_tr_b16 a[16:17], v27 offset:32768
    ds_read_b64_tr_b16 a[18:19], v27 offset:33024
    ds_read_b64_tr_b16 a[20:21], v27 offset:34816
    ds_read_b64_tr_b16 a[22:23], v27 offset:35072
    ds_read_b64_tr_b16 a[24:25], v27 offset:32800
    ds_read_b64_tr_b16 a[26:27], v27 offset:33056
    ds_read_b64_tr_b16 a[28:29], v27 offset:34848
    ds_read_b64_tr_b16 a[30:31], v27 offset:35104
    s_waitcnt lgkmcnt(0)
    s_barrier
    s_mov_b32 m0, 32768
    s_mov_b32 s57, 1572864
    buffer_load_dwordx4 v8, s[20:23], s57 offen  lds
    s_mov_b32 m0, 33792
    s_mov_b32 s57, 1703936
    buffer_load_dwordx4 v8, s[20:23], s57 offen  lds
    s_mov_b32 m0, 34816
    s_mov_b32 s57, 1835008
    buffer_load_dwordx4 v8, s[20:23], s57 offen  lds
    s_mov_b32 m0, 35840
    s_mov_b32 s57, 1966080
    buffer_load_dwordx4 v8, s[20:23], s57 offen  lds
    s_waitcnt vmcnt(40)
    ds_read_b64_tr_b16 a[112:113], v27 offset:28672
    ds_read_b64_tr_b16 a[114:115], v27 offset:28928
    ds_read_b64_tr_b16 a[116:117], v27 offset:30720
    ds_read_b64_tr_b16 a[118:119], v27 offset:30976
    ds_read_b64_tr_b16 a[120:121], v27 offset:28704
    ds_read_b64_tr_b16 a[122:123], v27 offset:28960
    ds_read_b64_tr_b16 a[124:125], v27 offset:30752
    ds_read_b64_tr_b16 a[126:127], v27 offset:31008
    s_waitcnt lgkmcnt(0)
    s_barrier
    s_mov_b32 m0, 28672
    s_mov_b32 s57, 2097152
    buffer_load_dwordx4 v8, s[20:23], s57 offen  lds
    s_mov_b32 m0, 29696
    s_mov_b32 s57, 2228224
    buffer_load_dwordx4 v8, s[20:23], s57 offen  lds
    s_mov_b32 m0, 30720
    s_mov_b32 s57, 2359296
    buffer_load_dwordx4 v8, s[20:23], s57 offen  lds
    s_mov_b32 m0, 31744
    s_mov_b32 s57, 2490368
    buffer_load_dwordx4 v8, s[20:23], s57 offen  lds
    s_waitcnt vmcnt(8)
    ds_read_b64_tr_b16 a[144:145], v28 offset:0
    ds_read_b64_tr_b16 a[146:147], v28 offset:256
    ds_read_b64_tr_b16 a[148:149], v28 offset:2048
    ds_read_b64_tr_b16 a[150:151], v28 offset:2304
    ds_read_b64_tr_b16 a[152:153], v28 offset:32
    ds_read_b64_tr_b16 a[154:155], v28 offset:288
    ds_read_b64_tr_b16 a[156:157], v28 offset:2080
    ds_read_b64_tr_b16 a[158:159], v28 offset:2336
    s_waitcnt lgkmcnt(0)
    s_barrier
    s_mov_b32 m0, 12288
    s_mov_b32 s57, 2621440
    buffer_load_dwordx4 v8, s[20:23], s57 offen  lds
    s_mov_b32 m0, 13312
    s_mov_b32 s57, 2752512
    buffer_load_dwordx4 v8, s[20:23], s57 offen  lds
    s_mov_b32 m0, 14336
    s_mov_b32 s57, 2883584
    buffer_load_dwordx4 v8, s[20:23], s57 offen  lds
    s_mov_b32 m0, 15360
    s_mov_b32 s57, 3014656
    buffer_load_dwordx4 v8, s[20:23], s57 offen  lds
    s_waitcnt vmcnt(8)
    ds_read_b64_tr_b16 a[192:193], v27 offset:32768
    ds_read_b64_tr_b16 a[194:195], v27 offset:33024
    ds_read_b64_tr_b16 a[196:197], v27 offset:34816
    ds_read_b64_tr_b16 a[198:199], v27 offset:35072
    ds_read_b64_tr_b16 a[200:201], v27 offset:32800
    ds_read_b64_tr_b16 a[202:203], v27 offset:33056
    ds_read_b64_tr_b16 a[204:205], v27 offset:34848
    ds_read_b64_tr_b16 a[206:207], v27 offset:35104
    s_waitcnt lgkmcnt(0)
    s_barrier
    s_mov_b32 m0, 147456
    s_mov_b32 s57, 3145728
    buffer_load_dwordx4 v8, s[20:23], s57 offen  lds
    s_mov_b32 m0, 148480
    s_mov_b32 s57, 3276800
    buffer_load_dwordx4 v8, s[20:23], s57 offen  lds
    s_mov_b32 m0, 149504
    s_mov_b32 s57, 3407872
    buffer_load_dwordx4 v8, s[20:23], s57 offen  lds
    s_mov_b32 m0, 150528
    s_mov_b32 s57, 3538944
    buffer_load_dwordx4 v8, s[20:23], s57 offen  lds
    s_waitcnt vmcnt(8)
    ds_read_b64_tr_b16 a[64:65], v27 offset:28672
    ds_read_b64_tr_b16 a[66:67], v27 offset:28928
    ds_read_b64_tr_b16 a[68:69], v27 offset:30720
    ds_read_b64_tr_b16 a[70:71], v27 offset:30976
    ds_read_b64_tr_b16 a[72:73], v27 offset:28704
    ds_read_b64_tr_b16 a[74:75], v27 offset:28960
    ds_read_b64_tr_b16 a[76:77], v27 offset:30752
    ds_read_b64_tr_b16 a[78:79], v27 offset:31008
    s_waitcnt lgkmcnt(0)
    s_barrier
    s_mov_b32 m0, 32768
    s_mov_b32 s57, 3670016
    buffer_load_dwordx4 v8, s[20:23], s57 offen  lds
    s_mov_b32 m0, 33792
    s_mov_b32 s57, 3801088
    buffer_load_dwordx4 v8, s[20:23], s57 offen  lds
    s_mov_b32 m0, 34816
    s_mov_b32 s57, 3932160
    buffer_load_dwordx4 v8, s[20:23], s57 offen  lds
    s_mov_b32 m0, 35840
    s_mov_b32 s57, 4063232
    buffer_load_dwordx4 v8, s[20:23], s57 offen  lds
    v_perm_b32 v10, v32, v30, s54
    v_perm_b32 v18, v36, v34, s54
    v_perm_b32 v12, v40, v38, s54
    v_perm_b32 v20, v44, v42, s54
    v_perm_b32 v14, v48, v46, s54
    v_perm_b32 v22, v52, v50, s54
    v_perm_b32 v16, v56, v54, s54
    v_perm_b32 v24, v60, v58, s54
    v_perm_b32 v19, v32, v30, s55
    v_perm_b32 v11, v36, v34, s55
    v_perm_b32 v21, v40, v38, s55
    v_perm_b32 v13, v44, v42, s55
    v_perm_b32 v23, v48, v46, s55
    v_perm_b32 v15, v52, v50, s55
    v_perm_b32 v25, v56, v54, s55
    v_perm_b32 v17, v60, v58, s55
    ds_write_b128 v0, v[10:13] offset:0
    ds_write_b128 v0, v[14:17] offset:1024
    ds_write_b128 v0, v[18:21] offset:2048
    ds_write_b128 v0, v[22:25] offset:3072
    v_perm_b32 v160, v33, v31, s54
    v_perm_b32 v168, v37, v35, s54
    v_perm_b32 v162, v41, v39, s54
    v_perm_b32 v170, v45, v43, s54
    v_perm_b32 v164, v49, v47, s54
    v_perm_b32 v172, v53, v51, s54
    v_perm_b32 v166, v57, v55, s54
    v_perm_b32 v174, v61, v59, s54
    v_perm_b32 v169, v33, v31, s55
    v_perm_b32 v161, v37, v35, s55
    v_perm_b32 v171, v41, v39, s55
    v_perm_b32 v163, v45, v43, s55
    v_perm_b32 v173, v49, v47, s55
    v_perm_b32 v165, v53, v51, s55
    v_perm_b32 v175, v57, v55, s55
    v_perm_b32 v167, v61, v59, s55
    s_waitcnt vmcnt(8)
    ds_read_b64_tr_b16 v[10:11], v27 offset:12288
    ds_read_b64_tr_b16 v[12:13], v27 offset:12544
    ds_read_b64_tr_b16 v[14:15], v27 offset:14336
    ds_read_b64_tr_b16 v[16:17], v27 offset:14592
    ds_read_b64_tr_b16 v[18:19], v27 offset:12320
    ds_read_b64_tr_b16 v[20:21], v27 offset:12576
    ds_read_b64_tr_b16 v[22:23], v27 offset:14368
    ds_read_b64_tr_b16 v[24:25], v27 offset:14624
    s_waitcnt lgkmcnt(0)
    ds_write_b128 v0, v[10:13] offset:12288
    ds_write_b128 v0, v[14:17] offset:13312
    ds_write_b128 v0, v[18:21] offset:14336
    ds_write_b128 v0, v[22:25] offset:15360
    s_barrier
    s_mov_b32 m0, 16384
    s_mov_b32 s57, 4194304
    buffer_load_dwordx4 v8, s[20:23], s57 offen  lds
    s_mov_b32 m0, 17408
    s_mov_b32 s57, 4325376
    buffer_load_dwordx4 v8, s[20:23], s57 offen  lds
    s_mov_b32 m0, 18432
    s_mov_b32 s57, 4456448
    buffer_load_dwordx4 v8, s[20:23], s57 offen  lds
    s_mov_b32 m0, 19456
    s_mov_b32 s57, 4587520
    buffer_load_dwordx4 v8, s[20:23], s57 offen  lds
    s_mov_b32 s57, 73728
    buffer_load_dword v30, v9, s[24:27], s57 offen offset:0
    buffer_load_dword v31, v9, s[24:27], s57 offen offset:256
    s_mov_b32 s57, 92160
    buffer_load_dword v32, v9, s[24:27], s57 offen offset:0
    buffer_load_dword v33, v9, s[24:27], s57 offen offset:256
    s_mov_b32 s57, 78336
    buffer_load_dword v34, v9, s[24:27], s57 offen offset:0
    buffer_load_dword v35, v9, s[24:27], s57 offen offset:256
    s_mov_b32 s57, 96768
    buffer_load_dword v36, v9, s[24:27], s57 offen offset:0
    buffer_load_dword v37, v9, s[24:27], s57 offen offset:256
    s_mov_b32 s57, 74880
    buffer_load_dword v38, v9, s[24:27], s57 offen offset:0
    buffer_load_dword v39, v9, s[24:27], s57 offen offset:256
    s_mov_b32 s57, 93312
    buffer_load_dword v40, v9, s[24:27], s57 offen offset:0
    buffer_load_dword v41, v9, s[24:27], s57 offen offset:256
    s_mov_b32 s57, 79488
    buffer_load_dword v42, v9, s[24:27], s57 offen offset:0
    buffer_load_dword v43, v9, s[24:27], s57 offen offset:256
    s_mov_b32 s57, 97920
    buffer_load_dword v44, v9, s[24:27], s57 offen offset:0
    buffer_load_dword v45, v9, s[24:27], s57 offen offset:256
    s_mov_b32 s57, 110592
    buffer_load_dword v46, v9, s[24:27], s57 offen offset:0
    buffer_load_dword v47, v9, s[24:27], s57 offen offset:256
    s_mov_b32 s57, 129024
    buffer_load_dword v48, v9, s[24:27], s57 offen offset:0
    buffer_load_dword v49, v9, s[24:27], s57 offen offset:256
    s_mov_b32 s57, 115200
    buffer_load_dword v50, v9, s[24:27], s57 offen offset:0
    buffer_load_dword v51, v9, s[24:27], s57 offen offset:256
    s_mov_b32 s57, 133632
    buffer_load_dword v52, v9, s[24:27], s57 offen offset:0
    buffer_load_dword v53, v9, s[24:27], s57 offen offset:256
    s_mov_b32 s57, 111744
    buffer_load_dword v54, v9, s[24:27], s57 offen offset:0
    buffer_load_dword v55, v9, s[24:27], s57 offen offset:256
    s_mov_b32 s57, 130176
    buffer_load_dword v56, v9, s[24:27], s57 offen offset:0
    buffer_load_dword v57, v9, s[24:27], s57 offen offset:256
    s_mov_b32 s57, 116352
    buffer_load_dword v58, v9, s[24:27], s57 offen offset:0
    buffer_load_dword v59, v9, s[24:27], s57 offen offset:256
    s_mov_b32 s57, 134784
    buffer_load_dword v60, v9, s[24:27], s57 offen offset:0
    buffer_load_dword v61, v9, s[24:27], s57 offen offset:256
    s_waitcnt vmcnt(40)
    ds_read_b64_tr_b16 v[80:81], v28 offset:0
    ds_read_b64_tr_b16 v[82:83], v28 offset:256
    ds_read_b64_tr_b16 v[84:85], v28 offset:2048
    ds_read_b64_tr_b16 v[86:87], v28 offset:2304
    ds_read_b64_tr_b16 v[88:89], v28 offset:32
    ds_read_b64_tr_b16 v[90:91], v28 offset:288
    ds_read_b64_tr_b16 v[92:93], v28 offset:2080
    ds_read_b64_tr_b16 v[94:95], v28 offset:2336
    s_waitcnt lgkmcnt(0)
    s_barrier
    s_mov_b32 m0, 20480
    s_mov_b32 s57, 0
    buffer_load_dwordx4 v8, s[12:15], s57 offen  lds
    s_mov_b32 m0, 21504
    s_mov_b32 s57, 131072
    buffer_load_dwordx4 v8, s[12:15], s57 offen  lds
    s_mov_b32 m0, 22528
    s_mov_b32 s57, 262144
    buffer_load_dwordx4 v8, s[12:15], s57 offen  lds
    s_mov_b32 m0, 23552
    s_mov_b32 s57, 393216
    buffer_load_dwordx4 v8, s[12:15], s57 offen  lds
    s_waitcnt vmcnt(40)
    ds_read_b64_tr_b16 v[128:129], v27 offset:32768
    ds_read_b64_tr_b16 v[130:131], v27 offset:33024
    ds_read_b64_tr_b16 v[132:133], v27 offset:34816
    ds_read_b64_tr_b16 v[134:135], v27 offset:35072
    ds_read_b64_tr_b16 v[136:137], v27 offset:32800
    ds_read_b64_tr_b16 v[138:139], v27 offset:33056
    ds_read_b64_tr_b16 v[140:141], v27 offset:34848
    ds_read_b64_tr_b16 v[142:143], v27 offset:35104
    s_waitcnt lgkmcnt(0)
    s_barrier
    s_mov_b32 m0, 147456
    s_mov_b32 s57, 524288
    buffer_load_dwordx4 v8, s[12:15], s57 offen  lds
    s_mov_b32 m0, 148480
    s_mov_b32 s57, 655360
    buffer_load_dwordx4 v8, s[12:15], s57 offen  lds
    s_mov_b32 m0, 149504
    s_mov_b32 s57, 786432
    buffer_load_dwordx4 v8, s[12:15], s57 offen  lds
    s_mov_b32 m0, 150528
    s_mov_b32 s57, 917504
    buffer_load_dwordx4 v8, s[12:15], s57 offen  lds
    s_waitcnt vmcnt(40)
    ds_read_b64_tr_b16 v[10:11], v27 offset:16384
    ds_read_b64_tr_b16 v[12:13], v27 offset:16640
    ds_read_b64_tr_b16 v[14:15], v27 offset:18432
    ds_read_b64_tr_b16 v[16:17], v27 offset:18688
    ds_read_b64_tr_b16 v[18:19], v27 offset:16416
    ds_read_b64_tr_b16 v[20:21], v27 offset:16672
    ds_read_b64_tr_b16 v[22:23], v27 offset:18464
    ds_read_b64_tr_b16 v[24:25], v27 offset:18720
    s_waitcnt lgkmcnt(0)
    ds_write_b128 v0, v[10:13] offset:16384
    ds_write_b128 v0, v[14:17] offset:17408
    ds_write_b128 v0, v[18:21] offset:18432
    ds_write_b128 v0, v[22:25] offset:19456
    s_barrier
    s_mov_b32 m0, 24576
    s_mov_b32 s57, 1048576
    buffer_load_dwordx4 v8, s[12:15], s57 offen  lds
    s_mov_b32 m0, 25600
    s_mov_b32 s57, 1179648
    buffer_load_dwordx4 v8, s[12:15], s57 offen  lds
    s_mov_b32 m0, 26624
    s_mov_b32 s57, 1310720
    buffer_load_dwordx4 v8, s[12:15], s57 offen  lds
    s_mov_b32 m0, 27648
    s_mov_b32 s57, 1441792
    buffer_load_dwordx4 v8, s[12:15], s57 offen  lds
    s_waitcnt vmcnt(8)
    ds_read_b64_tr_b16 v[10:11], v27 offset:20480
    ds_read_b64_tr_b16 v[12:13], v27 offset:20736
    ds_read_b64_tr_b16 v[14:15], v27 offset:22528
    ds_read_b64_tr_b16 v[16:17], v27 offset:22784
    ds_read_b64_tr_b16 v[18:19], v27 offset:20512
    ds_read_b64_tr_b16 v[20:21], v27 offset:20768
    ds_read_b64_tr_b16 v[22:23], v27 offset:22560
    ds_read_b64_tr_b16 v[24:25], v27 offset:22816
    s_waitcnt lgkmcnt(0)
    ds_write_b128 v0, v[10:13] offset:20480
    ds_write_b128 v0, v[14:17] offset:21504
    ds_write_b128 v0, v[18:21] offset:22528
    ds_write_b128 v0, v[22:25] offset:23552
    s_barrier
    s_mov_b32 m0, 32768
    s_mov_b32 s57, 1572864
    buffer_load_dwordx4 v8, s[12:15], s57 offen  lds
    s_mov_b32 m0, 33792
    s_mov_b32 s57, 1703936
    buffer_load_dwordx4 v8, s[12:15], s57 offen  lds
    s_mov_b32 m0, 34816
    s_mov_b32 s57, 1835008
    buffer_load_dwordx4 v8, s[12:15], s57 offen  lds
    s_mov_b32 m0, 35840
    s_mov_b32 s57, 1966080
    buffer_load_dwordx4 v8, s[12:15], s57 offen  lds
    s_waitcnt vmcnt(8)
    ds_read_b64_tr_b16 a[80:81], v28 offset:0
    ds_read_b64_tr_b16 a[82:83], v28 offset:256
    ds_read_b64_tr_b16 a[84:85], v28 offset:2048
    ds_read_b64_tr_b16 a[86:87], v28 offset:2304
    ds_read_b64_tr_b16 a[88:89], v28 offset:32
    ds_read_b64_tr_b16 a[90:91], v28 offset:288
    ds_read_b64_tr_b16 a[92:93], v28 offset:2080
    ds_read_b64_tr_b16 a[94:95], v28 offset:2336
    s_waitcnt lgkmcnt(0)
    s_barrier
    s_mov_b32 m0, 147456
    s_mov_b32 s57, 2097152
    buffer_load_dwordx4 v8, s[12:15], s57 offen  lds
    s_mov_b32 m0, 148480
    s_mov_b32 s57, 2228224
    buffer_load_dwordx4 v8, s[12:15], s57 offen  lds
    s_mov_b32 m0, 149504
    s_mov_b32 s57, 2359296
    buffer_load_dwordx4 v8, s[12:15], s57 offen  lds
    s_mov_b32 m0, 150528
    s_mov_b32 s57, 2490368
    buffer_load_dwordx4 v8, s[12:15], s57 offen  lds
    s_waitcnt vmcnt(8)
    ds_read_b64_tr_b16 v[10:11], v27 offset:24576
    ds_read_b64_tr_b16 v[12:13], v27 offset:24832
    ds_read_b64_tr_b16 v[14:15], v27 offset:26624
    ds_read_b64_tr_b16 v[16:17], v27 offset:26880
    ds_read_b64_tr_b16 v[18:19], v27 offset:24608
    ds_read_b64_tr_b16 v[20:21], v27 offset:24864
    ds_read_b64_tr_b16 v[22:23], v27 offset:26656
    ds_read_b64_tr_b16 v[24:25], v27 offset:26912
    s_waitcnt lgkmcnt(0)
    ds_write_b128 v0, v[10:13] offset:24576
    ds_write_b128 v0, v[14:17] offset:25600
    ds_write_b128 v0, v[18:21] offset:26624
    ds_write_b128 v0, v[22:25] offset:27648
    s_barrier
    s_mov_b32 m0, 28672
    s_mov_b32 s57, 2621440
    buffer_load_dwordx4 v8, s[12:15], s57 offen  lds
    s_mov_b32 m0, 29696
    s_mov_b32 s57, 2752512
    buffer_load_dwordx4 v8, s[12:15], s57 offen  lds
    s_mov_b32 m0, 30720
    s_mov_b32 s57, 2883584
    buffer_load_dwordx4 v8, s[12:15], s57 offen  lds
    s_mov_b32 m0, 31744
    s_mov_b32 s57, 3014656
    buffer_load_dwordx4 v8, s[12:15], s57 offen  lds
    v_perm_b32 v208, v32, v30, s54
    v_perm_b32 v216, v36, v34, s54
    v_perm_b32 v210, v40, v38, s54
    v_perm_b32 v218, v44, v42, s54
    v_perm_b32 v212, v48, v46, s54
    v_perm_b32 v220, v52, v50, s54
    v_perm_b32 v214, v56, v54, s54
    v_perm_b32 v222, v60, v58, s54
    v_perm_b32 v217, v32, v30, s55
    v_perm_b32 v209, v36, v34, s55
    v_perm_b32 v219, v40, v38, s55
    v_perm_b32 v211, v44, v42, s55
    v_perm_b32 v221, v48, v46, s55
    v_perm_b32 v213, v52, v50, s55
    v_perm_b32 v223, v56, v54, s55
    v_perm_b32 v215, v60, v58, s55
    v_perm_b32 v10, v33, v31, s54
    v_perm_b32 v18, v37, v35, s54
    v_perm_b32 v12, v41, v39, s54
    v_perm_b32 v20, v45, v43, s54
    v_perm_b32 v14, v49, v47, s54
    v_perm_b32 v22, v53, v51, s54
    v_perm_b32 v16, v57, v55, s54
    v_perm_b32 v24, v61, v59, s54
    v_perm_b32 v19, v33, v31, s55
    v_perm_b32 v11, v37, v35, s55
    v_perm_b32 v21, v41, v39, s55
    v_perm_b32 v13, v45, v43, s55
    v_perm_b32 v23, v49, v47, s55
    v_perm_b32 v15, v53, v51, s55
    v_perm_b32 v25, v57, v55, s55
    v_perm_b32 v17, v61, v59, s55
    ds_write_b128 v0, v[10:13] offset:4096
    ds_write_b128 v0, v[14:17] offset:5120
    ds_write_b128 v0, v[18:21] offset:6144
    ds_write_b128 v0, v[22:25] offset:7168
    s_waitcnt vmcnt(8)
    ds_read_b64_tr_b16 a[160:161], v27 offset:32768
    ds_read_b64_tr_b16 a[162:163], v27 offset:33024
    ds_read_b64_tr_b16 a[164:165], v27 offset:34816
    ds_read_b64_tr_b16 a[166:167], v27 offset:35072
    ds_read_b64_tr_b16 a[168:169], v27 offset:32800
    ds_read_b64_tr_b16 a[170:171], v27 offset:33056
    ds_read_b64_tr_b16 a[172:173], v27 offset:34848
    ds_read_b64_tr_b16 a[174:175], v27 offset:35104
    s_waitcnt lgkmcnt(0)
    s_barrier
    s_mov_b32 m0, 32768
    s_mov_b32 s57, 3145728
    buffer_load_dwordx4 v8, s[12:15], s57 offen  lds
    s_mov_b32 m0, 33792
    s_mov_b32 s57, 3276800
    buffer_load_dwordx4 v8, s[12:15], s57 offen  lds
    s_mov_b32 m0, 34816
    s_mov_b32 s57, 3407872
    buffer_load_dwordx4 v8, s[12:15], s57 offen  lds
    s_mov_b32 m0, 35840
    s_mov_b32 s57, 3538944
    buffer_load_dwordx4 v8, s[12:15], s57 offen  lds
    s_mov_b32 s57, 512
    buffer_load_dword v30, v9, s[24:27], s57 offen offset:0
    buffer_load_dword v31, v9, s[24:27], s57 offen offset:256
    s_mov_b32 s57, 18944
    buffer_load_dword v32, v9, s[24:27], s57 offen offset:0
    buffer_load_dword v33, v9, s[24:27], s57 offen offset:256
    s_mov_b32 s57, 5120
    buffer_load_dword v34, v9, s[24:27], s57 offen offset:0
    buffer_load_dword v35, v9, s[24:27], s57 offen offset:256
    s_mov_b32 s57, 23552
    buffer_load_dword v36, v9, s[24:27], s57 offen offset:0
    buffer_load_dword v37, v9, s[24:27], s57 offen offset:256
    s_mov_b32 s57, 1664
    buffer_load_dword v38, v9, s[24:27], s57 offen offset:0
    buffer_load_dword v39, v9, s[24:27], s57 offen offset:256
    s_mov_b32 s57, 20096
    buffer_load_dword v40, v9, s[24:27], s57 offen offset:0
    buffer_load_dword v41, v9, s[24:27], s57 offen offset:256
    s_mov_b32 s57, 6272
    buffer_load_dword v42, v9, s[24:27], s57 offen offset:0
    buffer_load_dword v43, v9, s[24:27], s57 offen offset:256
    s_mov_b32 s57, 24704
    buffer_load_dword v44, v9, s[24:27], s57 offen offset:0
    buffer_load_dword v45, v9, s[24:27], s57 offen offset:256
    s_mov_b32 s57, 37376
    buffer_load_dword v46, v9, s[24:27], s57 offen offset:0
    buffer_load_dword v47, v9, s[24:27], s57 offen offset:256
    s_mov_b32 s57, 55808
    buffer_load_dword v48, v9, s[24:27], s57 offen offset:0
    buffer_load_dword v49, v9, s[24:27], s57 offen offset:256
    s_mov_b32 s57, 41984
    buffer_load_dword v50, v9, s[24:27], s57 offen offset:0
    buffer_load_dword v51, v9, s[24:27], s57 offen offset:256
    s_mov_b32 s57, 60416
    buffer_load_dword v52, v9, s[24:27], s57 offen offset:0
    buffer_load_dword v53, v9, s[24:27], s57 offen offset:256
    s_mov_b32 s57, 38528
    buffer_load_dword v54, v9, s[24:27], s57 offen offset:0
    buffer_load_dword v55, v9, s[24:27], s57 offen offset:256
    s_mov_b32 s57, 56960
    buffer_load_dword v56, v9, s[24:27], s57 offen offset:0
    buffer_load_dword v57, v9, s[24:27], s57 offen offset:256
    s_mov_b32 s57, 43136
    buffer_load_dword v58, v9, s[24:27], s57 offen offset:0
    buffer_load_dword v59, v9, s[24:27], s57 offen offset:256
    s_mov_b32 s57, 61568
    buffer_load_dword v60, v9, s[24:27], s57 offen offset:0
    buffer_load_dword v61, v9, s[24:27], s57 offen offset:256
    s_waitcnt vmcnt(40)
    ds_read_b64_tr_b16 a[32:33], v28 offset:0
    ds_read_b64_tr_b16 a[34:35], v28 offset:256
    ds_read_b64_tr_b16 a[36:37], v28 offset:2048
    ds_read_b64_tr_b16 a[38:39], v28 offset:2304
    ds_read_b64_tr_b16 a[40:41], v28 offset:32
    ds_read_b64_tr_b16 a[42:43], v28 offset:288
    ds_read_b64_tr_b16 a[44:45], v28 offset:2080
    ds_read_b64_tr_b16 a[46:47], v28 offset:2336
    s_waitcnt lgkmcnt(0)
    s_barrier
    s_mov_b32 m0, 147456
    s_mov_b32 s57, 3670016
    buffer_load_dwordx4 v8, s[12:15], s57 offen  lds
    s_mov_b32 m0, 148480
    s_mov_b32 s57, 3801088
    buffer_load_dwordx4 v8, s[12:15], s57 offen  lds
    s_mov_b32 m0, 149504
    s_mov_b32 s57, 3932160
    buffer_load_dwordx4 v8, s[12:15], s57 offen  lds
    s_mov_b32 m0, 150528
    s_mov_b32 s57, 4063232
    buffer_load_dwordx4 v8, s[12:15], s57 offen  lds
    s_waitcnt vmcnt(40)
    ds_read_b64_tr_b16 v[10:11], v27 offset:28672
    ds_read_b64_tr_b16 v[12:13], v27 offset:28928
    ds_read_b64_tr_b16 v[14:15], v27 offset:30720
    ds_read_b64_tr_b16 v[16:17], v27 offset:30976
    ds_read_b64_tr_b16 v[18:19], v27 offset:28704
    ds_read_b64_tr_b16 v[20:21], v27 offset:28960
    ds_read_b64_tr_b16 v[22:23], v27 offset:30752
    ds_read_b64_tr_b16 v[24:25], v27 offset:31008
    s_waitcnt lgkmcnt(0)
    ds_write_b128 v0, v[10:13] offset:28672
    ds_write_b128 v0, v[14:17] offset:29696
    ds_write_b128 v0, v[18:21] offset:30720
    ds_write_b128 v0, v[22:25] offset:31744
    s_barrier
    s_waitcnt vmcnt(36)
    ds_read_b64_tr_b16 a[224:225], v27 offset:32768
    ds_read_b64_tr_b16 a[226:227], v27 offset:33024
    ds_read_b64_tr_b16 a[228:229], v27 offset:34816
    ds_read_b64_tr_b16 a[230:231], v27 offset:35072
    ds_read_b64_tr_b16 a[232:233], v27 offset:32800
    ds_read_b64_tr_b16 a[234:235], v27 offset:33056
    ds_read_b64_tr_b16 a[236:237], v27 offset:34848
    ds_read_b64_tr_b16 a[238:239], v27 offset:35104
    s_waitcnt lgkmcnt(0)
    s_barrier
    s_mov_b32 m0, 32768
    s_mov_b32 s57, 4194304
    buffer_load_dwordx4 v8, s[12:15], s57 offen  lds
    s_mov_b32 m0, 33792
    s_mov_b32 s57, 4325376
    buffer_load_dwordx4 v8, s[12:15], s57 offen  lds
    s_mov_b32 m0, 34816
    s_mov_b32 s57, 4456448
    buffer_load_dwordx4 v8, s[12:15], s57 offen  lds
    s_mov_b32 m0, 35840
    s_mov_b32 s57, 4587520
    buffer_load_dwordx4 v8, s[12:15], s57 offen  lds
    s_waitcnt vmcnt(4)
    ds_read_b64_tr_b16 v[96:97], v28 offset:0
    ds_read_b64_tr_b16 v[98:99], v28 offset:256
    ds_read_b64_tr_b16 v[100:101], v28 offset:2048
    ds_read_b64_tr_b16 v[102:103], v28 offset:2304
    ds_read_b64_tr_b16 v[104:105], v28 offset:32
    ds_read_b64_tr_b16 v[106:107], v28 offset:288
    ds_read_b64_tr_b16 v[108:109], v28 offset:2080
    ds_read_b64_tr_b16 v[110:111], v28 offset:2336
    s_waitcnt lgkmcnt(0)
    s_barrier
    s_mov_b32 m0, 147456
    s_mov_b32 s57, 0
    buffer_load_dwordx4 v8, s[16:19], s57 offen  lds
    s_mov_b32 m0, 148480
    s_mov_b32 s57, 131072
    buffer_load_dwordx4 v8, s[16:19], s57 offen  lds
    s_mov_b32 m0, 149504
    s_mov_b32 s57, 262144
    buffer_load_dwordx4 v8, s[16:19], s57 offen  lds
    s_mov_b32 m0, 150528
    s_mov_b32 s57, 393216
    buffer_load_dwordx4 v8, s[16:19], s57 offen  lds
    s_waitcnt vmcnt(4)
    ds_read_b64_tr_b16 v[144:145], v27 offset:32768
    ds_read_b64_tr_b16 v[146:147], v27 offset:33024
    ds_read_b64_tr_b16 v[148:149], v27 offset:34816
    ds_read_b64_tr_b16 v[150:151], v27 offset:35072
    ds_read_b64_tr_b16 v[152:153], v27 offset:32800
    ds_read_b64_tr_b16 v[154:155], v27 offset:33056
    ds_read_b64_tr_b16 v[156:157], v27 offset:34848
    ds_read_b64_tr_b16 v[158:159], v27 offset:35104
    s_waitcnt lgkmcnt(0)
    s_barrier
    s_mov_b32 m0, 32768
    s_mov_b32 s57, 524288
    buffer_load_dwordx4 v8, s[16:19], s57 offen  lds
    s_mov_b32 m0, 33792
    s_mov_b32 s57, 655360
    buffer_load_dwordx4 v8, s[16:19], s57 offen  lds
    s_mov_b32 m0, 34816
    s_mov_b32 s57, 786432
    buffer_load_dwordx4 v8, s[16:19], s57 offen  lds
    s_mov_b32 m0, 35840
    s_mov_b32 s57, 917504
    buffer_load_dwordx4 v8, s[16:19], s57 offen  lds
    s_waitcnt vmcnt(4)
    ds_read_b64_tr_b16 a[0:1], v28 offset:0
    ds_read_b64_tr_b16 a[2:3], v28 offset:256
    ds_read_b64_tr_b16 a[4:5], v28 offset:2048
    ds_read_b64_tr_b16 a[6:7], v28 offset:2304
    ds_read_b64_tr_b16 a[8:9], v28 offset:32
    ds_read_b64_tr_b16 a[10:11], v28 offset:288
    ds_read_b64_tr_b16 a[12:13], v28 offset:2080
    ds_read_b64_tr_b16 a[14:15], v28 offset:2336
    s_waitcnt lgkmcnt(0)
    s_barrier
    s_mov_b32 m0, 147456
    s_mov_b32 s57, 1048576
    buffer_load_dwordx4 v8, s[16:19], s57 offen  lds
    s_mov_b32 m0, 148480
    s_mov_b32 s57, 1179648
    buffer_load_dwordx4 v8, s[16:19], s57 offen  lds
    s_mov_b32 m0, 149504
    s_mov_b32 s57, 1310720
    buffer_load_dwordx4 v8, s[16:19], s57 offen  lds
    s_mov_b32 m0, 150528
    s_mov_b32 s57, 1441792
    buffer_load_dwordx4 v8, s[16:19], s57 offen  lds
    v_perm_b32 v176, v32, v30, s54
    v_perm_b32 v184, v36, v34, s54
    v_perm_b32 v178, v40, v38, s54
    v_perm_b32 v186, v44, v42, s54
    v_perm_b32 v180, v48, v46, s54
    v_perm_b32 v188, v52, v50, s54
    v_perm_b32 v182, v56, v54, s54
    v_perm_b32 v190, v60, v58, s54
    v_perm_b32 v185, v32, v30, s55
    v_perm_b32 v177, v36, v34, s55
    v_perm_b32 v187, v40, v38, s55
    v_perm_b32 v179, v44, v42, s55
    v_perm_b32 v189, v48, v46, s55
    v_perm_b32 v181, v52, v50, s55
    v_perm_b32 v191, v56, v54, s55
    v_perm_b32 v183, v60, v58, s55
    v_perm_b32 v192, v33, v31, s54
    v_perm_b32 v200, v37, v35, s54
    v_perm_b32 v194, v41, v39, s54
    v_perm_b32 v202, v45, v43, s54
    v_perm_b32 v196, v49, v47, s54
    v_perm_b32 v204, v53, v51, s54
    v_perm_b32 v198, v57, v55, s54
    v_perm_b32 v206, v61, v59, s54
    v_perm_b32 v201, v33, v31, s55
    v_perm_b32 v193, v37, v35, s55
    v_perm_b32 v203, v41, v39, s55
    v_perm_b32 v195, v45, v43, s55
    v_perm_b32 v205, v49, v47, s55
    v_perm_b32 v197, v53, v51, s55
    v_perm_b32 v207, v57, v55, s55
    v_perm_b32 v199, v61, v59, s55
    s_waitcnt vmcnt(4)
    ds_read_b64_tr_b16 a[96:97], v27 offset:32768
    ds_read_b64_tr_b16 a[98:99], v27 offset:33024
    ds_read_b64_tr_b16 a[100:101], v27 offset:34816
    ds_read_b64_tr_b16 a[102:103], v27 offset:35072
    ds_read_b64_tr_b16 a[104:105], v27 offset:32800
    ds_read_b64_tr_b16 a[106:107], v27 offset:33056
    ds_read_b64_tr_b16 a[108:109], v27 offset:34848
    ds_read_b64_tr_b16 a[110:111], v27 offset:35104
    s_waitcnt lgkmcnt(0)
    s_barrier
    s_mov_b32 m0, 32768
    s_mov_b32 s57, 1572864
    buffer_load_dwordx4 v8, s[16:19], s57 offen  lds
    s_mov_b32 m0, 33792
    s_mov_b32 s57, 1703936
    buffer_load_dwordx4 v8, s[16:19], s57 offen  lds
    s_mov_b32 m0, 34816
    s_mov_b32 s57, 1835008
    buffer_load_dwordx4 v8, s[16:19], s57 offen  lds
    s_mov_b32 m0, 35840
    s_mov_b32 s57, 1966080
    buffer_load_dwordx4 v8, s[16:19], s57 offen  lds
    s_mov_b32 s57, 74240
    buffer_load_dword v30, v9, s[24:27], s57 offen offset:0
    buffer_load_dword v31, v9, s[24:27], s57 offen offset:256
    s_mov_b32 s57, 92672
    buffer_load_dword v32, v9, s[24:27], s57 offen offset:0
    buffer_load_dword v33, v9, s[24:27], s57 offen offset:256
    s_mov_b32 s57, 78848
    buffer_load_dword v34, v9, s[24:27], s57 offen offset:0
    buffer_load_dword v35, v9, s[24:27], s57 offen offset:256
    s_mov_b32 s57, 97280
    buffer_load_dword v36, v9, s[24:27], s57 offen offset:0
    buffer_load_dword v37, v9, s[24:27], s57 offen offset:256
    s_mov_b32 s57, 75392
    buffer_load_dword v38, v9, s[24:27], s57 offen offset:0
    buffer_load_dword v39, v9, s[24:27], s57 offen offset:256
    s_mov_b32 s57, 93824
    buffer_load_dword v40, v9, s[24:27], s57 offen offset:0
    buffer_load_dword v41, v9, s[24:27], s57 offen offset:256
    s_mov_b32 s57, 80000
    buffer_load_dword v42, v9, s[24:27], s57 offen offset:0
    buffer_load_dword v43, v9, s[24:27], s57 offen offset:256
    s_mov_b32 s57, 98432
    buffer_load_dword v44, v9, s[24:27], s57 offen offset:0
    buffer_load_dword v45, v9, s[24:27], s57 offen offset:256
    s_mov_b32 s57, 111104
    buffer_load_dword v46, v9, s[24:27], s57 offen offset:0
    buffer_load_dword v47, v9, s[24:27], s57 offen offset:256
    s_mov_b32 s57, 129536
    buffer_load_dword v48, v9, s[24:27], s57 offen offset:0
    buffer_load_dword v49, v9, s[24:27], s57 offen offset:256
    s_mov_b32 s57, 115712
    buffer_load_dword v50, v9, s[24:27], s57 offen offset:0
    buffer_load_dword v51, v9, s[24:27], s57 offen offset:256
    s_mov_b32 s57, 134144
    buffer_load_dword v52, v9, s[24:27], s57 offen offset:0
    buffer_load_dword v53, v9, s[24:27], s57 offen offset:256
    s_mov_b32 s57, 112256
    buffer_load_dword v54, v9, s[24:27], s57 offen offset:0
    buffer_load_dword v55, v9, s[24:27], s57 offen offset:256
    s_mov_b32 s57, 130688
    buffer_load_dword v56, v9, s[24:27], s57 offen offset:0
    buffer_load_dword v57, v9, s[24:27], s57 offen offset:256
    s_mov_b32 s57, 116864
    buffer_load_dword v58, v9, s[24:27], s57 offen offset:0
    buffer_load_dword v59, v9, s[24:27], s57 offen offset:256
    s_mov_b32 s57, 135296
    buffer_load_dword v60, v9, s[24:27], s57 offen offset:0
    buffer_load_dword v61, v9, s[24:27], s57 offen offset:256
    s_waitcnt vmcnt(36)
    ds_read_b64_tr_b16 a[128:129], v28 offset:0
    ds_read_b64_tr_b16 a[130:131], v28 offset:256
    ds_read_b64_tr_b16 a[132:133], v28 offset:2048
    ds_read_b64_tr_b16 a[134:135], v28 offset:2304
    ds_read_b64_tr_b16 a[136:137], v28 offset:32
    ds_read_b64_tr_b16 a[138:139], v28 offset:288
    ds_read_b64_tr_b16 a[140:141], v28 offset:2080
    ds_read_b64_tr_b16 a[142:143], v28 offset:2336
    s_waitcnt lgkmcnt(0)
    s_barrier
    s_mov_b32 m0, 147456
    s_mov_b32 s57, 2097152
    buffer_load_dwordx4 v8, s[16:19], s57 offen  lds
    s_mov_b32 m0, 148480
    s_mov_b32 s57, 2228224
    buffer_load_dwordx4 v8, s[16:19], s57 offen  lds
    s_mov_b32 m0, 149504
    s_mov_b32 s57, 2359296
    buffer_load_dwordx4 v8, s[16:19], s57 offen  lds
    s_mov_b32 m0, 150528
    s_mov_b32 s57, 2490368
    buffer_load_dwordx4 v8, s[16:19], s57 offen  lds
    buffer_load_dword v76, off, s[4:7], 0 offset:40 sc1
    v_lshlrev_b32 v75, 6, v2
    s_mov_b32 s57, 0
    buffer_load_dword v75, v75, s[28:31], s57 offen
    s_waitcnt vmcnt(38)
    ds_read_b64_tr_b16 a[176:177], v27 offset:32768
    ds_read_b64_tr_b16 a[178:179], v27 offset:33024
    ds_read_b64_tr_b16 a[180:181], v27 offset:34816
    ds_read_b64_tr_b16 a[182:183], v27 offset:35072
    ds_read_b64_tr_b16 a[184:185], v27 offset:32800
    ds_read_b64_tr_b16 a[186:187], v27 offset:33056
    ds_read_b64_tr_b16 a[188:189], v27 offset:34848
    ds_read_b64_tr_b16 a[190:191], v27 offset:35104
    s_waitcnt lgkmcnt(0)
    s_barrier
    s_mov_b32 m0, 32768
    s_mov_b32 s57, 2621440
    buffer_load_dwordx4 v8, s[16:19], s57 offen  lds
    s_mov_b32 m0, 33792
    s_mov_b32 s57, 2752512
    buffer_load_dwordx4 v8, s[16:19], s57 offen  lds
    s_mov_b32 m0, 34816
    s_mov_b32 s57, 2883584
    buffer_load_dwordx4 v8, s[16:19], s57 offen  lds
    s_mov_b32 m0, 35840
    s_mov_b32 s57, 3014656
    buffer_load_dwordx4 v8, s[16:19], s57 offen  lds
    s_waitcnt vmcnt(6)
    ds_read_b64_tr_b16 a[48:49], v28 offset:0
    ds_read_b64_tr_b16 a[50:51], v28 offset:256
    ds_read_b64_tr_b16 a[52:53], v28 offset:2048
    ds_read_b64_tr_b16 a[54:55], v28 offset:2304
    ds_read_b64_tr_b16 a[56:57], v28 offset:32
    ds_read_b64_tr_b16 a[58:59], v28 offset:288
    ds_read_b64_tr_b16 a[60:61], v28 offset:2080
    ds_read_b64_tr_b16 a[62:63], v28 offset:2336
    s_waitcnt lgkmcnt(0)
    s_barrier
    s_mov_b32 m0, 147456
    s_mov_b32 s57, 3145728
    buffer_load_dwordx4 v8, s[16:19], s57 offen  lds
    s_mov_b32 m0, 148480
    s_mov_b32 s57, 3276800
    buffer_load_dwordx4 v8, s[16:19], s57 offen  lds
    s_mov_b32 m0, 149504
    s_mov_b32 s57, 3407872
    buffer_load_dwordx4 v8, s[16:19], s57 offen  lds
    s_mov_b32 m0, 150528
    s_mov_b32 s57, 3538944
    buffer_load_dwordx4 v8, s[16:19], s57 offen  lds
    s_waitcnt vmcnt(4)
    ds_read_b64_tr_b16 a[208:209], v27 offset:32768
    ds_read_b64_tr_b16 a[210:211], v27 offset:33024
    ds_read_b64_tr_b16 a[212:213], v27 offset:34816
    ds_read_b64_tr_b16 a[214:215], v27 offset:35072
    ds_read_b64_tr_b16 a[216:217], v27 offset:32800
    ds_read_b64_tr_b16 a[218:219], v27 offset:33056
    ds_read_b64_tr_b16 a[220:221], v27 offset:34848
    ds_read_b64_tr_b16 a[222:223], v27 offset:35104
    s_waitcnt lgkmcnt(0)
    s_barrier
    s_mov_b32 m0, 32768
    s_mov_b32 s57, 3670016
    buffer_load_dwordx4 v8, s[16:19], s57 offen  lds
    s_mov_b32 m0, 33792
    s_mov_b32 s57, 3801088
    buffer_load_dwordx4 v8, s[16:19], s57 offen  lds
    s_mov_b32 m0, 34816
    s_mov_b32 s57, 3932160
    buffer_load_dwordx4 v8, s[16:19], s57 offen  lds
    s_mov_b32 m0, 35840
    s_mov_b32 s57, 4063232
    buffer_load_dwordx4 v8, s[16:19], s57 offen  lds
    s_waitcnt vmcnt(4)
    ds_read_b64_tr_b16 a[240:241], v28 offset:0
    ds_read_b64_tr_b16 a[242:243], v28 offset:256
    ds_read_b64_tr_b16 a[244:245], v28 offset:2048
    ds_read_b64_tr_b16 a[246:247], v28 offset:2304
    ds_read_b64_tr_b16 a[248:249], v28 offset:32
    ds_read_b64_tr_b16 a[250:251], v28 offset:288
    ds_read_b64_tr_b16 a[252:253], v28 offset:2080
    ds_read_b64_tr_b16 a[254:255], v28 offset:2336
    s_waitcnt lgkmcnt(0)
    s_barrier
    s_waitcnt vmcnt(0)
    ds_read_b64_tr_b16 v[112:113], v27 offset:32768
    ds_read_b64_tr_b16 v[114:115], v27 offset:33024
    ds_read_b64_tr_b16 v[116:117], v27 offset:34816
    ds_read_b64_tr_b16 v[118:119], v27 offset:35072
    ds_read_b64_tr_b16 v[120:121], v27 offset:32800
    ds_read_b64_tr_b16 v[122:123], v27 offset:33056
    ds_read_b64_tr_b16 v[124:125], v27 offset:34848
    ds_read_b64_tr_b16 v[126:127], v27 offset:35104
    s_waitcnt lgkmcnt(0)
    s_barrier
    s_mov_b32 m0, 32768
    s_mov_b32 s57, 4194304
    buffer_load_dwordx4 v8, s[16:19], s57 offen  lds
    s_mov_b32 m0, 33792
    s_mov_b32 s57, 4325376
    buffer_load_dwordx4 v8, s[16:19], s57 offen  lds
    s_mov_b32 m0, 34816
    s_mov_b32 s57, 4456448
    buffer_load_dwordx4 v8, s[16:19], s57 offen  lds
    s_mov_b32 m0, 35840
    s_mov_b32 s57, 4587520
    buffer_load_dwordx4 v8, s[16:19], s57 offen  lds
    v_perm_b32 v224, v32, v30, s54
    v_perm_b32 v232, v36, v34, s54
    v_perm_b32 v226, v40, v38, s54
    v_perm_b32 v234, v44, v42, s54
    v_perm_b32 v228, v48, v46, s54
    v_perm_b32 v236, v52, v50, s54
    v_perm_b32 v230, v56, v54, s54
    v_perm_b32 v238, v60, v58, s54
    v_perm_b32 v233, v32, v30, s55
    v_perm_b32 v225, v36, v34, s55
    v_perm_b32 v235, v40, v38, s55
    v_perm_b32 v227, v44, v42, s55
    v_perm_b32 v237, v48, v46, s55
    v_perm_b32 v229, v52, v50, s55
    v_perm_b32 v239, v56, v54, s55
    v_perm_b32 v231, v60, v58, s55
    v_perm_b32 v10, v33, v31, s54
    v_perm_b32 v18, v37, v35, s54
    v_perm_b32 v12, v41, v39, s54
    v_perm_b32 v20, v45, v43, s54
    v_perm_b32 v14, v49, v47, s54
    v_perm_b32 v22, v53, v51, s54
    v_perm_b32 v16, v57, v55, s54
    v_perm_b32 v24, v61, v59, s54
    v_perm_b32 v19, v33, v31, s55
    v_perm_b32 v11, v37, v35, s55
    v_perm_b32 v21, v41, v39, s55
    v_perm_b32 v13, v45, v43, s55
    v_perm_b32 v23, v49, v47, s55
    v_perm_b32 v15, v53, v51, s55
    v_perm_b32 v25, v57, v55, s55
    v_perm_b32 v17, v61, v59, s55
    ds_write_b128 v0, v[10:13] offset:8192
    ds_write_b128 v0, v[14:17] offset:9216
    ds_write_b128 v0, v[18:21] offset:10240
    ds_write_b128 v0, v[22:25] offset:11264
    s_waitcnt vmcnt(0)
    ds_read_b64_tr_b16 v[10:11], v27 offset:32768
    ds_read_b64_tr_b16 v[12:13], v27 offset:33024
    ds_read_b64_tr_b16 v[14:15], v27 offset:34816
    ds_read_b64_tr_b16 v[16:17], v27 offset:35072
    ds_read_b64_tr_b16 v[18:19], v27 offset:32800
    ds_read_b64_tr_b16 v[20:21], v27 offset:33056
    ds_read_b64_tr_b16 v[22:23], v27 offset:34848
    ds_read_b64_tr_b16 v[24:25], v27 offset:35104
    s_waitcnt lgkmcnt(0)
    ds_write_b128 v0, v[10:13] offset:32768
    ds_write_b128 v0, v[14:17] offset:33792
    ds_write_b128 v0, v[18:21] offset:34816
    ds_write_b128 v0, v[22:25] offset:35840
    v_mov_b32 v60, v2
    v_mov_b32 v61, v3
    v_mov_b32 v62, v4
    v_and_b32 v63, 2, v60
    v_cmp_eq_u32 vcc, 0, v63
    v_mov_b32 v64, 0x5e5eeeee
    v_mov_b32 v65, 0x04044444
    v_cndmask_b32 v4, v64, v65, vcc
    s_lshl_b32 s54, s33, 6
    s_add_u32 s55, s54, 0
    v_lshrrev_b32 v63, 3, v60
    v_lshlrev_b32 v63, 11, v63
    v_and_b32 v64, 7, v60
    v_lshlrev_b32 v64, 3, v64
    v_add3_u32 v5, v63, v64, s55
    v_lshrrev_b32 v63, 2, v61
    v_lshlrev_b32 v63, 8, v63
    v_lshl_add_u32 v63, v62, 6, v63
    v_and_b32 v64, 3, v61
    v_lshl_add_u32 v7, v64, 4, v63
    v_and_b32 v63, 2, v61
    v_lshlrev_b32 v63, 4, v63
    v_lshl_add_u32 v63, v62, 4, v63
    v_and_b32 v64, 1, v61
    v_lshl_add_u32 v63, v64, 3, v63
    v_and_b32 v64, 0x2c, v60
    v_cmp_eq_u32 vcc, 0, v64
    v_mov_b32 v64, 0x7ffff000
    s_nop 0
    v_cndmask_b32 v6, v64, v63, vcc
    s_bfe_u32 s54, s33, 0x20001
    s_lshl_b32 s54, s54, 8
    s_and_b32 s55, s33, 1
    s_lshr_b32 s56, s33, 3
    s_lshl_b32 s18, s56, 1
    s_add_u32 s18, s18, s55
    s_and_b32 s17, s18, 3
    s_lshl_b32 s18, s18, 5
    s_add_u32 s18, s18, s54
    s_add_u32 s18, s18, 8192
    s_lshl_b32 s17, s17, 6
    s_add_u32 s17, s17, s54
    s_lshr_b32 s56, s56, 1
    s_lshl_b32 s56, s56, 10
    s_add_u32 s17, s17, s56
    s_add_u32 s17, s17, 0
    v_lshrrev_b32 v63, 3, v61
    v_lshlrev_b32 v63, 8, v63
    v_lshl_add_u32 v63, v62, 6, v63
    v_and_b32 v64, 4, v61
    v_lshl_add_u32 v63, v64, 3, v63
    v_and_b32 v64, 3, v61
    v_lshl_add_u32 v63, v64, 2, v63
    v_add_u32 v8, 161792, v63
    v_and_b32 v63, 1, v61
    v_lshlrev_b32 v63, 4, v63
    v_mov_b32 v64, 0x3f80
    v_lshlrev_b32 v63, v63, v64
    v_and_b32 v64, 14, v61
    v_lshlrev_b32 v65, 2, v62
    v_cmp_eq_u32 vcc, v64, v65
    s_nop 1
    v_cndmask_b32 v2, 0, v63, vcc
    v_bfe_u32 v65, v60, 4, 1
    v_lshlrev_b32 v65, 3, v65
    v_bfe_u32 v66, v60, 5, 1
    v_lshl_add_u32 v65, v66, 2, v65
    v_or_b32 v65, 2, v65
    v_cmp_eq_u32 vcc, v64, v65
    s_nop 1
    v_cndmask_b32 v3, 0, v63, vcc
    s_waitcnt vmcnt(0) lgkmcnt(0)
    s_waitcnt vmcnt(0) lgkmcnt(0)
    s_barrier
    v_mov_b32 v77, 163836
    s_cmp_lg_u32 s32, 0
    s_cbranch_scc1 T0_cm
    s_mov_b64 exec, 1
    ds_write_b32 v77, v79
    s_mov_b64 exec, -1
    s_waitcnt lgkmcnt(0)
T0_cm:
    s_barrier
    ds_read_b32 v77, v77
    s_waitcnt lgkmcnt(0)
    v_readfirstlane_b32 s94, v77
    s_barrier
    s_and_b32 s94, s94, s93
    s_cbranch_scc1 A_over
    v_cmp_gt_u32 vcc, 32, v76
    s_cbranch_vccz T0_iw_ok
    s_mov_b32 s94, 40
T0_iw:
    buffer_load_dword v76, off, s[4:7], s94 sc1
    s_sub_u32 s95, s95, 1
    s_cmp_eq_u32 s95, 0
    s_cbranch_scc1 L_end
    s_waitcnt vmcnt(0)
    v_cmp_gt_u32 vcc, 32, v76
    s_cbranch_vccz T0_iw_ok
    s_sleep 1
    s_branch T0_iw
T0_iw_ok:
T0_layer:
    v_bfe_u32 v63, v1, 6, 2
    v_bfe_u32 v64, v1, 4, 1
    v_lshl_add_u32 v63, v63, 1, v64
    v_mul_u32_u24 v63, 1152, v63
    v_bfe_u32 v64, v1, 8, 2
    v_lshl_add_u32 v63, v64, 5, v63
    v_bfe_u32 v64, v1, 5, 1
    v_lshl_add_u32 v63, v64, 4, v63
    buffer_load_dwordx4 v[28:31], v63, s[28:31], 0 offen offset:0
    buffer_load_dwordx4 v[72:75], v63, s[28:31], 0 offen offset:512
    buffer_load_dwordx4 v[68:71], v63, s[28:31], 0 offen offset:1024
    s_lshl_b32 s12, s33, 8
    s_add_u32 s12, s12, 3149824
    buffer_load_dwordx2 v[76:77], off, s[8:11], s12 sc1
    ds_read_b128 v[10:13], v0 offset:20480
    ds_read_b128 v[14:17], v0 offset:21504
    ds_read_b128 v[18:21], v0 offset:22528
    ds_read_b128 v[22:25], v0 offset:23552
    s_waitcnt vmcnt(2)
    v_mov_b64 v[60:61], v[72:73]
    v_mov_b64 v[62:63], v[74:75]
    v_mov_b64 v[32:33], 0
    v_mov_b64 v[34:35], 0
    v_mov_b64 v[36:37], 0
    v_mov_b64 v[38:39], 0
    v_mov_b64 v[40:41], 0
    v_mov_b64 v[42:43], 0
    v_mov_b64 v[44:45], 0
    v_mov_b64 v[46:47], 0
    v_mov_b64 v[48:49], 0
    v_mov_b64 v[50:51], 0
    v_mov_b64 v[52:53], 0
    v_mov_b64 v[54:55], 0
    s_mov_b32 s34, 0
    s_mov_b32 s35, 20000
    s_mov_b32 s36, 1
    s_mov_b32 s60, 0
    s_mov_b32 s61, 0
    s_mov_b32 s3, 0x5d800000
    s_mov_b32 s13, 0
    s_mov_b32 s14, 0x3f80
    s_mov_b32 s15, 3145728
    s_lshl_b32 s16, s33, 2
    s_add_u32 s16, s16, s15
    s_mov_b32 s37, 1343488
    s_mov_b32 s41, 2113536
    s_lshl_b32 s49, s33, 11
    s_add_u32 s49, s49, 4294819840
    s_lshl_b32 s19, s33, 10
    s_add_u32 s19, s19, 114688
    s_lshl_b32 s54, s33, 14
    s_add_u32 s44, s54, 33406976
    s_add_u32 s25, s44, 81920
    s_sub_u32 s45, s44, 442368
    s_mov_b32 s46, 16629760
    s_cmp_lt_u32 s33, 18
    s_cselect_b32 s47, 0, 18
    s_sub_u32 s47, s33, s47
    s_lshl_b32 s47, s47, 9
    s_add_u32 s47, s47, 73728
    s_mov_b32 s48, 0x3e0293ee
    s_mov_b32 s50, 0x33333333
    s_mov_b32 s51, 0x33333333
    s_mov_b32 s52, 0x3f803f80
    s_mov_b32 s53, 0x3f803f80
    s_mov_b32 s62, 0x11111111
    s_mov_b32 s63, 0x11111111
    s_mov_b32 m0, 155648
    v_lshlrev_b32 v78, 2, v1
    s_waitcnt lgkmcnt(0)
    s_waitcnt vmcnt(0)
    v_min_u32 v76, v76, v77
T0_kv:
    v_cmp_eq_u32 vcc, 0, v76
    s_cbranch_vccz T0_kv_ok
    buffer_load_dwordx2 v[76:77], off, s[8:11], s12 sc1
    s_sub_u32 s95, s95, 1
    s_cmp_eq_u32 s95, 0
    s_cbranch_scc1 L_end
    s_waitcnt vmcnt(0)
    v_min_u32 v76, v76, v77
    s_branch T0_kv
T0_kv_ok:
    buffer_load_dword v9, v78, s[8:11], s45 offen sc1
    s_add_u32 s12, s12, 8
    s_mul_i32 s54, s33, 18432
    s_add_u32 s54, s54, 458752
    buffer_load_dword v9, v78, s[8:11], s54 offen sc1
    s_add_u32 s54, s54, 14336
    buffer_load_dword v9, v78, s[8:11], s54 offen sc1
    s_branch T0_head
.p2align 6
T0_chk:
    s_waitcnt vmcnt(3)
    v_bitop3_b32 v76, v28, v30, s36 bitop3:0x7e
    v_and_b32 v76, 1, v76
    v_cmp_ne_u32 vcc, 0, v76
    s_cbranch_vccnz T0_br
T0_head:
    v_smfmac_f32_16x16x64_bf16 v[32:35], v[28:31], v[10:17], v4
    ds_write_b128 v1, v[28:31] offset:0
    v_smfmac_f32_16x16x64_bf16 v[40:43], v[28:31], v[18:25], v4
    ds_read_b128 v[10:13], v0 offset:24576
    v_smfmac_f32_16x16x64_bf16 v[36:39], v[28:31], a[0:7], v4
    ds_read_b128 v[14:17], v0 offset:25600
    v_smfmac_f32_16x16x64_bf16 v[44:47], v[28:31], a[8:15], v4
    s_waitcnt vmcnt(2)
    v_bitop3_b32 v76, v60, v62, s36 bitop3:0x7e
    v_smfmac_f32_16x16x64_bf16 v[48:51], v[28:31], a[16:23], v4
    s_waitcnt lgkmcnt(2)
    v_and_b32 v76, s61, v76
    v_cmp_ne_u32 vcc, 0, v76
    v_smfmac_f32_16x16x64_bf16 v[52:55], v[28:31], a[24:31], v4
    s_cbranch_vccnz T0_b1r
T0_b1c:
    s_barrier
    v_smfmac_f32_16x16x64_bf16 v[32:35], v[60:63], a[32:39], v4
    ds_read_b128 v[56:59], v1 offset:1024
    v_smfmac_f32_16x16x64_bf16 v[40:43], v[60:63], a[40:47], v4
    ds_write_b128 v1, v[60:63] offset:4096
    v_smfmac_f32_16x16x64_bf16 v[36:39], v[60:63], a[48:55], v4
    buffer_load_dwordx4 v[28:31], v1, s[8:11], s44 offen sc1
    v_smfmac_f32_16x16x64_bf16 v[44:47], v[60:63], a[56:63], v4
    ds_read_b128 v[18:21], v0 offset:26624
    s_waitcnt lgkmcnt(2)
    v_smfmac_f32_16x16x64_bf16 v[32:35], v[56:59], a[80:87], v4
    ds_read_b128 v[64:67], v1 offset:2048
    v_smfmac_f32_16x16x64_bf16 v[40:43], v[56:59], a[88:95], v4
    ds_read_b128 v[22:25], v0 offset:27648
    v_smfmac_f32_16x16x64_bf16 v[36:39], v[56:59], a[96:103], v4
    buffer_load_dwordx4 v1, s[8:11], s44 offen offset:1024 sc1 lds
    v_smfmac_f32_16x16x64_bf16 v[44:47], v[56:59], a[104:111], v4
    s_waitcnt lgkmcnt(2)
    s_barrier
    s_waitcnt lgkmcnt(1)
    v_smfmac_f32_16x16x64_bf16 v[32:35], v[64:67], v[10:17], v4
    ds_read_b128 v[56:59], v1 offset:3072
    s_waitcnt lgkmcnt(1)
    v_smfmac_f32_16x16x64_bf16 v[40:43], v[64:67], v[18:25], v4
    ds_read_b128 v[10:13], v0 offset:28672
    v_smfmac_f32_16x16x64_bf16 v[36:39], v[64:67], a[128:135], v4
    ds_read_b128 v[72:75], v1 offset:5120
    v_smfmac_f32_16x16x64_bf16 v[44:47], v[64:67], a[136:143], v4
    buffer_load_dwordx4 v[60:63], v1, s[8:11], s44 offen offset:2048 sc1
    s_waitcnt lgkmcnt(2)
    v_smfmac_f32_16x16x64_bf16 v[32:35], v[56:59], a[160:167], v4
    ds_read_b128 v[18:21], v0 offset:30720
    ds_read_b128 v[14:17], v0 offset:29696
    v_smfmac_f32_16x16x64_bf16 v[40:43], v[56:59], a[168:175], v4
    ds_read_b128 v[22:25], v0 offset:31744
    v_smfmac_f32_16x16x64_bf16 v[36:39], v[56:59], a[176:183], v4
    ds_read_b128 v[64:67], v1 offset:6144
    v_smfmac_f32_16x16x64_bf16 v[44:47], v[56:59], a[184:191], v4
    buffer_load_dwordx4 v[56:59], v1, s[8:11], s44 offen offset:3072 sc1
    s_waitcnt lgkmcnt(2)
    v_smfmac_f32_16x16x64_bf16 v[32:35], v[72:75], v[10:17], v4
    ds_read_b128 v[68:71], v1 offset:7168
    s_waitcnt lgkmcnt(2)
    v_smfmac_f32_16x16x64_bf16 v[40:43], v[72:75], v[18:25], v4
    ds_read_b128 v[10:13], v0 offset:32768
    v_smfmac_f32_16x16x64_bf16 v[36:39], v[72:75], a[208:215], v4
    ds_read_b128 v[14:17], v0 offset:33792
    v_smfmac_f32_16x16x64_bf16 v[44:47], v[72:75], a[216:223], v4
    s_barrier
    s_waitcnt lgkmcnt(3)
    v_smfmac_f32_16x16x64_bf16 v[32:35], v[64:67], a[224:231], v4
    ds_read_b128 v[72:75], v1 offset:8192
    s_waitcnt lgkmcnt(3)
    v_lshlrev_b32 v26, 2, v1
    v_smfmac_f32_16x16x64_bf16 v[32:35], v[68:71], v[96:103], v4
    buffer_load_dword v9, v26, s[8:11], s25 offen sc1
    v_smfmac_f32_16x16x64_bf16 v[36:39], v[64:67], a[240:247], v4
    ds_read_b128 v[18:21], v0 offset:34816
    v_smfmac_f32_16x16x64_bf16 v[36:39], v[68:71], v[112:119], v4
    ds_read_b128 v[22:25], v0 offset:35840
    s_waitcnt lgkmcnt(2)
    v_smfmac_f32_16x16x64_bf16 v[32:35], v[72:75], v[144:151], v4
    v_smfmac_f32_16x16x64_bf16 v[36:39], v[72:75], v[10:17], v4
    ds_read_b128 v[10:13], v0 offset:16384
    v_smfmac_f32_16x16x64_bf16 v[40:43], v[64:67], a[232:239], v4
    ds_read_b128 v[14:17], v0 offset:17408
    v_add_f32 v32, v32, v34
    v_smfmac_f32_16x16x64_bf16 v[40:43], v[68:71], v[104:111], v4
    v_add_f32 v33, v33, v35
    v_smfmac_f32_16x16x64_bf16 v[40:43], v[72:75], v[152:159], v4
    v_cvt_pk_bf16_f32 v26, v32, v33
    v_smfmac_f32_16x16x64_bf16 v[44:47], v[64:67], a[248:255], v4
    s_waitcnt vmcnt(3)
    ds_read_b128 v[32:35], v1 offset:9216
    v_add_f32 v36, v36, v38
    v_smfmac_f32_16x16x64_bf16 v[44:47], v[68:71], v[120:127], v4
    s_waitcnt lgkmcnt(1)
    v_add_f32 v37, v37, v39
    v_smfmac_f32_16x16x64_bf16 v[44:47], v[72:75], v[18:25], v4
    v_cvt_pk_bf16_f32 v27, v36, v37
    v_add_f32 v40, v40, v42
    v_add_f32 v41, v41, v43
    v_mfma_f32_16x16x16_bf16 v[36:39], v[26:27], v[2:3], 0
    v_cvt_pk_bf16_f32 v26, v40, v41
    s_cmp_eq_u32 s34, 63
    v_add_f32 v44, v44, v46
    v_add_f32 v45, v45, v47
    v_cvt_pk_bf16_f32 v27, v44, v45
    ds_read_b128 v[22:25], v0 offset:19456
    s_mov_b64 vcc, s[50:51]
    v_mfma_f32_16x16x16_bf16 v[40:43], v[26:27], v[2:3], 0
    v_cvt_pk_bf16_f32 v44, v36, v37
    v_cvt_pk_bf16_f32 v45, v38, v39
    v_smfmac_f32_16x16x64_bf16 v[48:51], v[64:67], v[80:87], v4
    ds_read_b128 v[18:21], v0 offset:18432
    v_smfmac_f32_16x16x64_bf16 v[52:55], v[64:67], v[88:95], v4
    ds_read_b128 v[36:39], v1 offset:4096
    v_cvt_pk_bf16_f32 v46, v40, v41
    v_cvt_pk_bf16_f32 v47, v42, v43
    s_nop 1
    v_mfma_f32_16x16x32_bf16 v[40:43], v[44:47], v[44:47], 0
    v_mfma_f32_16x16x32_bf16 v[76:79], v[28:31], v[44:47], 0
    s_waitcnt vmcnt(1)
    s_waitcnt lgkmcnt(2)
    v_mov_b64 v[66:67], v[58:59]
    v_mfma_f32_16x16x32_bf16 v[28:31], v[32:35], v[44:47], 0
    s_cbranch_scc1 L_team_done
    v_cndmask_b32_dpp v26, v43, v42, vcc quad_perm:[0,1,0,1] row_mask:0xf bank_mask:0xf
    v_mul_f32 v26, s48, v26
    v_smfmac_f32_16x16x64_bf16 v[48:51], v[68:71], v[128:135], v4
    ds_write_b32 v1, v26 offset:13312
    v_smfmac_f32_16x16x64_bf16 v[52:55], v[68:71], v[136:143], v4
    ds_read_b128 v[32:35], v1 offset:1024
    v_cndmask_b32_dpp v76, v28, v76, vcc quad_perm:[0,1,0,1] row_mask:0xf bank_mask:0xf
    v_cndmask_b32_dpp v77, v29, v77, vcc quad_perm:[0,1,0,1] row_mask:0xf bank_mask:0xf
    v_cndmask_b32_dpp v78, v30, v78, vcc quad_perm:[0,1,0,1] row_mask:0xf bank_mask:0xf
    v_cndmask_b32_dpp v79, v31, v79, vcc quad_perm:[0,1,0,1] row_mask:0xf bank_mask:0xf
    ds_write_b128 v1, v[76:79] offset:9216
    v_smfmac_f32_16x16x64_bf16 v[48:51], v[72:75], v[10:17], v4
    ds_read_b128 v[28:31], v1 offset:2048
    s_waitcnt lgkmcnt(4)
    v_smfmac_f32_16x16x64_bf16 v[52:55], v[72:75], v[18:25], v4
    ds_read_b128 v[10:13], v0 offset:12288
    v_mov_b64 v[26:27], 0
    v_smfmac_f32_16x16x64_bf16 v[48:51], v[36:39], a[64:71], v4
    s_waitcnt lgkmcnt(2)
    s_barrier
    ds_read_b128 v[40:43], v1 offset:13312
    v_smfmac_f32_16x16x64_bf16 v[52:55], v[36:39], a[72:79], v4
    ds_read_b128 v[68:71], v1 offset:10240
    ds_read_b128 v[72:75], v1 offset:11264
    v_smfmac_f32_16x16x64_bf16 v[48:51], v[32:35], a[112:119], v4
    ds_read_b128 v[36:39], v1 offset:12288
    ds_read_b128 v[44:47], v1 offset:3072
    v_smfmac_f32_16x16x64_bf16 v[52:55], v[32:35], a[120:127], v4
    ds_read_b128 v[32:35], v1 offset:5120
    s_waitcnt lgkmcnt(6)
    v_smfmac_f32_16x16x64_bf16 v[48:51], v[28:31], a[144:151], v4
    ds_read_b128 v[14:17], v0 offset:13312
    s_waitcnt lgkmcnt(6)
    v_add_f32 v40, v40, v41
    v_smfmac_f32_16x16x64_bf16 v[52:55], v[28:31], a[152:159], v4
    ds_read_b128 v[18:21], v0 offset:14336
    v_add_f32 v42, v42, v43
    s_waitcnt lgkmcnt(5)
    v_add_f32 v76, v76, v68
    v_add_f32 v77, v77, v69
    s_waitcnt lgkmcnt(3)
    v_smfmac_f32_16x16x64_bf16 v[48:51], v[44:47], a[192:199], v4
    ds_read_b128 v[22:25], v0 offset:15360
    v_add_f32 v78, v78, v70
    v_add_f32 v79, v79, v71
    v_smfmac_f32_16x16x64_bf16 v[52:55], v[44:47], a[200:207], v4
    v_add_f32 v45, v40, v42
    v_add_f32 v72, v72, v36
    s_waitcnt lgkmcnt(2)
    v_smfmac_f32_16x16x64_bf16 v[48:51], v[32:35], v[10:17], v4
    ds_read_b128 v[10:13], v0 offset:0
    v_add_f32 v73, v73, v37
    v_add_f32 v74, v74, v38
    s_waitcnt lgkmcnt(1)
    v_smfmac_f32_16x16x64_bf16 v[52:55], v[32:35], v[18:25], v4
    ds_read_b128 v[14:17], v0 offset:1024
    v_add_f32 v75, v75, v39
    v_exp_f32 v28, v45
    v_mov_b32 v43, 0
    v_pk_add_f32 v[76:77], v[76:77], v[72:73]
    v_pk_add_f32 v[78:79], v[78:79], v[74:75]
    v_cvt_pk_bf16_f32 v41, v28, 0
    v_pk_add_f32 v[48:49], v[48:49], v[50:51]
    v_pk_add_f32 v[52:53], v[52:53], v[54:55]
    v_mfma_f32_16x16x16_bf16 v[28:31], v[26:27], v[26:27], 0
    v_exp_f32 v36, v76
    v_exp_f32 v37, v77
    v_mfma_f32_16x16x16_bf16 v[32:35], v[26:27], v[26:27], 0
    v_permlane32_swap_b32 v41, v43
    v_exp_f32 v38, v78
    v_exp_f32 v39, v79
    v_mov_b64 v[68:69], s[52:53]
    v_mov_b64 v[70:71], s[52:53]
    v_cvt_pk_bf16_f32 v40, v36, v37
    v_cvt_pk_bf16_f32 v42, v38, v39
    v_cvt_pk_bf16_f32 v58, v48, v49
    v_cvt_pk_bf16_f32 v64, v52, v53
    v_mfma_f32_16x16x32_bf16 v[36:39], v[40:43], v[68:71], 0
    ds_read_b128 v[18:21], v0 offset:2048
    v_smfmac_f32_16x16x64_bf16 v[28:31], v[40:43], v[56:63], v4 abid:1
    ds_read_b128 v[22:25], v0 offset:3072
    v_smfmac_f32_16x16x64_bf16 v[32:35], v[40:43], v[62:69], v4 abid:1
    v_add_f32 v36, v36, v38
    v_add_f32 v37, v37, v39
    v_rcp_f32 v38, v36
    v_rcp_f32 v39, v37
    v_pk_add_f32 v[28:29], v[28:29], v[30:31]
    v_pk_add_f32 v[32:33], v[32:33], v[34:35]
    v_pk_mul_f32 v[28:29], v[28:29], v[38:39]
    v_pk_mul_f32 v[32:33], v[32:33], v[38:39]
    v_cvt_pk_bf16_f32 v30, v28, v32
    v_cvt_pk_bf16_f32 v31, v29, v33
    ds_write2_b32 v8, v30, v31 offset0:0 offset1:4
    v_mfma_f32_16x16x16_bf16 v[72:75], v[26:27], v[26:27], 0
    v_max3_f32 v44, v36, v37, v38
    v_max_f32 v44, v44, v39
    v_cmp_nle_f32 vcc, v44, s3
    v_mfma_f32_16x16x16_bf16 v[52:55], v[26:27], v[26:27], 0
    v_xor_b32 v44, 32, v1
    s_xor_b32 s37, s37, 294912
    s_bfe_u32 s36, s34, 0x10001
    v_mfma_f32_16x16x16_bf16 v[48:51], v[26:27], v[26:27], 0
    s_xor_b32 s36, s36, 1
    s_cbranch_vccnz T0_sr
T0_sc:
    s_waitcnt lgkmcnt(0)
    s_barrier
    ds_read_b128 v[56:59], v1 offset:14336
    ds_read_b128 v[32:35], v1 offset:15360
    v_mfma_f32_16x16x16_bf16 v[40:43], v[26:27], v[26:27], 0
    ds_read_b128 v[36:39], v44 offset:14336
    ds_read_b128 v[28:31], v44 offset:15360
    v_mfma_f32_16x16x16_bf16 v[44:47], v[26:27], v[26:27], 0
    v_lshrrev_b32 v60, 1, v5
    s_add_u32 s21, s37, 0x40000
    s_waitcnt lgkmcnt(3)
    v_smfmac_f32_16x16x64_bf16 v[52:55], v[56:59], v[240:247], v4
    s_add_u32 s38, s37, 0x10000
    s_add_u32 s39, s37, 0x20000
    s_add_u32 s20, s37, 0x30000
    s_waitcnt lgkmcnt(2)
    v_smfmac_f32_16x16x64_bf16 v[52:55], v[32:35], v[248:255], v4
    s_add_u32 s40, s37, s49
    s_add_u32 s22, s37, s19
    v_smfmac_f32_16x16x64_bf16 v[72:75], v[56:59], v[10:17], v4
    ds_read_b128 v[10:13], v0 offset:4096
    v_smfmac_f32_16x16x64_bf16 v[72:75], v[32:35], v[208:215], v4
    ds_read_b128 v[14:17], v0 offset:5120
    v_add_f32 v52, v52, v54
    v_add_f32 v53, v53, v55
    s_waitcnt lgkmcnt(2)
    v_smfmac_f32_16x16x64_bf16 v[72:75], v[36:39], v[18:25], v4
    ds_read_b128 v[18:21], v0 offset:6144
    v_cvt_pk_bf16_f32 v52, v52, v53
    v_smfmac_f32_16x16x64_bf16 v[72:75], v[28:31], v[216:223], v4
    ds_read_b128 v[22:25], v0 offset:7168
    v_bfi_b32 v52, 1, s36, v52
    v_smfmac_f32_16x16x64_bf16 v[48:51], v[56:59], v[160:167], v4
    buffer_store_dword v52, v60, s[8:11], s21 offen
    s_waitcnt lgkmcnt(2)
    v_smfmac_f32_16x16x64_bf16 v[48:51], v[32:35], v[10:17], v4
    ds_read_b128 v[10:13], v0 offset:8192
    v_cvt_pk_bf16_f32 v52, v72, v73
    v_smfmac_f32_16x16x64_bf16 v[48:51], v[36:39], v[168:175], v4
    ds_read_b128 v[14:17], v0 offset:9216
    s_waitcnt lgkmcnt(2)
    v_cvt_pk_bf16_f32 v53, v74, v75
    v_smfmac_f32_16x16x64_bf16 v[48:51], v[28:31], v[18:25], v4
    ds_read_b128 v[18:21], v0 offset:10240
    v_bfi_b32 v52, 1, s36, v52
    v_smfmac_f32_16x16x64_bf16 v[40:43], v[56:59], v[176:183], v4
    buffer_store_dwordx2 v[52:53], v5, s[8:11], s37 offen
    v_smfmac_f32_16x16x64_bf16 v[40:43], v[32:35], v[224:231], v4
    ds_read_b128 v[22:25], v0 offset:11264
    v_cvt_pk_bf16_f32 v48, v48, v49
    v_smfmac_f32_16x16x64_bf16 v[40:43], v[36:39], v[184:191], v4
    v_cvt_pk_bf16_f32 v49, v50, v51
    v_smfmac_f32_16x16x64_bf16 v[40:43], v[28:31], v[232:239], v4
    v_bfi_b32 v48, 1, s36, v48
    v_smfmac_f32_16x16x64_bf16 v[44:47], v[56:59], v[192:199], v4
    buffer_store_dwordx2 v[48:49], v5, s[8:11], s38 offen
    s_waitcnt lgkmcnt(1)
    v_smfmac_f32_16x16x64_bf16 v[44:47], v[32:35], v[10:17], v4
    v_cvt_pk_bf16_f32 v32, v40, v41
    v_smfmac_f32_16x16x64_bf16 v[44:47], v[36:39], v[200:207], v4
    s_waitcnt lgkmcnt(0)
    v_cvt_pk_bf16_f32 v33, v42, v43
    v_smfmac_f32_16x16x64_bf16 v[44:47], v[28:31], v[18:25], v4
    v_bfi_b32 v32, 1, s36, v32
    buffer_store_dwordx2 v[32:33], v5, s[8:11], s39 offen
    s_nop 3
    v_cvt_pk_bf16_f32 v28, v44, v45
    v_cvt_pk_bf16_f32 v29, v46, v47
    v_bfi_b32 v28, 1, s36, v28
    buffer_store_dwordx2 v[28:29], v5, s[8:11], s20 offen
    s_xor_b32 s41, s41, 16384
    s_add_u32 s23, s41, s17
    s_nop 1
    s_add_u32 s24, s41, s18
    s_add_u32 s42, s41, 4096
    s_nop 1
    s_add_u32 s43, s41, 8192
    s_mov_b32 s61, 1
    s_nop 1
    s_mov_b32 s13, 0
    s_add_u32 s44, s25, 442368
    s_nop 1
    s_add_u32 s25, s34, 2
    s_and_b32 s25, s25, 15
    s_nop 1
    s_lshl_b32 s25, s25, 19
    s_add_u32 s25, s25, s45
    s_nop 1
    s_add_u32 s46, s46, 9216
    s_add_u32 s34, s34, 1
    s_nop 1
    s_nop 3
    s_nop 3
    buffer_load_dwordx4 v[28:31], v1, s[8:11], s22 offen sc1
    buffer_load_dwordx4 v[64:67], v1, s[8:11], s40 offen offset:0 sc1
    buffer_load_dwordx4 v[72:75], v1, s[8:11], s40 offen offset:1024 sc1
    v_bfe_u32 v35, v1, 6, 1
    v_lshlrev_b32 v35, 4, v35
    s_nop 1
    v_lshlrev_b32 v35, v35, s14
    s_lshl_b64 s[54:55], s[62:63], 0
    s_nop 1
    v_cndmask_b32 v32, 0, v35, s[54:55]
    s_lshl_b64 s[54:55], s[62:63], 1
    s_nop 1
    v_cndmask_b32 v33, 0, v35, s[54:55]
    s_lshl_b64 s[54:55], s[62:63], 2
    s_nop 1
    v_cndmask_b32 v34, 0, v35, s[54:55]
    s_lshl_b64 s[54:55], s[62:63], 3
    s_nop 1
    v_cndmask_b32 v35, 0, v35, s[54:55]
    v_and_b32 v46, 32, v6
    s_nop 1
    v_lshl_or_b32 v46, v46, 25, v6
    s_nop 2
    s_nop 3
    s_nop 3
    buffer_load_dwordx4 v[68:71], v1, s[8:11], s40 offen offset:0 sc1
    buffer_load_dwordx4 v[56:59], v1, s[8:11], s40 offen offset:1024 sc1
    ds_read_b128 v[10:13], v0 offset:20480
    ds_read_b128 v[14:17], v0 offset:21504
    ds_read_b128 v[18:21], v0 offset:22528
    ds_read_b128 v[22:25], v0 offset:23552
T0_ac:
    s_waitcnt vmcnt(3)
    v_mfma_f32_16x16x32_bf16 v[40:43], v[32:35], v[64:67], 0
    s_waitcnt vmcnt(2)
    v_bitop3_b32 v76, v64, v66, s36 bitop3:0x7e
    v_mfma_f32_16x16x32_bf16 v[40:43], v[32:35], v[72:75], v[40:43]
    v_bitop3_b32 v44, v72, v74, s36 bitop3:0x7e
    v_bitop3_b32 v76, v76, v44, 1 bitop3:0xa8
    v_cmp_ne_u32 vcc, 0, v76
    v_mfma_f32_16x16x32_bf16 v[36:39], v[32:35], v[28:31], 0
    v_bitop3_b32 v45, v28, v29, s36 bitop3:0x7e
    v_bitop3_b32 v44, v30, v31, s36 bitop3:0x7e
    v_bitop3_b32 v45, v45, v44, 1 bitop3:0xa8
    v_cmp_ne_u32 s[58:59], 0, v45
    s_cbranch_vccnz T0_ar
T0_ad:
    v_add_f32_dpp v40, v40, v40 row_ror:8 row_mask:0xf bank_mask:0xf
    v_add_f32_dpp v41, v41, v41 row_ror:8 row_mask:0xf bank_mask:0xf
    v_add_f32_dpp v42, v42, v42 row_ror:8 row_mask:0xf bank_mask:0xf
    v_add_f32_dpp v43, v43, v43 row_ror:8 row_mask:0xf bank_mask:0xf
    v_add_f32_dpp v40, v40, v40 row_ror:4 row_mask:0xf bank_mask:0xf
    v_add_f32_dpp v41, v41, v41 row_ror:4 row_mask:0xf bank_mask:0xf
    v_add_f32_dpp v42, v42, v42 row_ror:4 row_mask:0xf bank_mask:0xf
    v_add_f32_dpp v43, v43, v43 row_ror:4 row_mask:0xf bank_mask:0xf
    v_cvt_pk_bf16_f32 v40, v40, v41
    v_cvt_pk_bf16_f32 v41, v42, v43
    v_bfi_b32 v40, 1, s36, v40
    buffer_store_dwordx2 v[40:41], v6, s[8:11], s23 offen
    s_cmp_eq_u32 s34, 63
    s_cbranch_scc1 T0_al
T0_am:
    s_cmp_lg_u64 s[58:59], 0
    s_cbranch_scc1 T0_a8r
T0_a8d:
    v_add_f32_dpp v36, v36, v36 row_ror:8 row_mask:0xf bank_mask:0xf
    v_add_f32_dpp v37, v37, v37 row_ror:8 row_mask:0xf bank_mask:0xf
    v_add_f32_dpp v38, v38, v38 row_ror:8 row_mask:0xf bank_mask:0xf
    v_add_f32_dpp v39, v39, v39 row_ror:8 row_mask:0xf bank_mask:0xf
    v_add_f32_dpp v36, v36, v36 row_ror:4 row_mask:0xf bank_mask:0xf
    v_add_f32_dpp v37, v37, v37 row_ror:4 row_mask:0xf bank_mask:0xf
    v_add_f32_dpp v38, v38, v38 row_ror:4 row_mask:0xf bank_mask:0xf
    v_add_f32_dpp v39, v39, v39 row_ror:4 row_mask:0xf bank_mask:0xf
    v_add_f32_dpp v36, v36, v36 row_ror:2 row_mask:0xf bank_mask:0xf
    v_add_f32_dpp v37, v37, v37 row_ror:2 row_mask:0xf bank_mask:0xf
    v_add_f32_dpp v38, v38, v38 row_ror:2 row_mask:0xf bank_mask:0xf
    v_add_f32_dpp v39, v39, v39 row_ror:2 row_mask:0xf bank_mask:0xf
    v_cvt_pk_bf16_f32 v36, v36, v37
    v_cvt_pk_bf16_f32 v37, v38, v39
    v_bfi_b32 v36, 1, s36, v36
    buffer_store_dwordx2 v[36:37], v46, s[8:11], s24 offen
    s_cmp_eq_u32 s34, 63
    s_cbranch_scc1 T0_a8l
T0_a8m:
    s_barrier
    v_mfma_f32_16x16x16_bf16 v[48:51], v[26:27], v[26:27], 0
    v_mfma_f32_16x16x16_bf16 v[52:55], v[26:27], v[26:27], 0
    v_mfma_f32_16x16x16_bf16 v[32:35], v[26:27], v[26:27], 0
    buffer_load_dwordx4 v[28:31], v7, s[8:11], s41 offen offset:0 sc1
    v_mfma_f32_16x16x16_bf16 v[36:39], v[26:27], v[26:27], 0
    v_mfma_f32_16x16x16_bf16 v[40:43], v[26:27], v[26:27], 0
    buffer_load_dwordx4 v[60:63], v7, s[8:11], s42 offen offset:0 sc1
    v_mfma_f32_16x16x16_bf16 v[44:47], v[26:27], v[26:27], 0
    s_nop 3
    s_nop 3
    s_nop 3
    buffer_load_dwordx4 v[28:31], v7, s[8:11], s41 offen offset:0 sc1
    s_nop 3
    s_nop 3
    buffer_load_dwordx4 v[60:63], v7, s[8:11], s42 offen offset:0 sc1
    s_waitcnt lgkmcnt(0)
    s_branch T0_chk
T0_br:
    buffer_load_dwordx4 v[28:31], v7, s[8:11], s41 offen offset:0 sc1
    buffer_load_dwordx4 v[60:63], v7, s[8:11], s42 offen offset:0 sc1
T0_brq:
    s_add_u32 s13, s13, 1
    s_and_b32 s56, s13, 63
    s_cbranch_scc1 T0_brq_nw
    s_sub_u32 s35, s35, 1
    s_cmp_eq_u32 s35, 0
    s_cbranch_scc1 L_end
    buffer_wbl2 sc1
    s_waitcnt vmcnt(0)
    buffer_inv sc1
T0_brq_nw:
    s_branch T0_chk
T0_b1r:
    buffer_load_dwordx4 v[60:63], v7, s[8:11], s42 offen offset:0 sc1
T0_b1q:
    s_add_u32 s13, s13, 1
    s_and_b32 s56, s13, 127
    s_cbranch_scc1 T0_b1q_nw
    s_sub_u32 s35, s35, 1
    s_cmp_eq_u32 s35, 0
    s_cbranch_scc1 L_end
    buffer_wbl2 sc1
    s_waitcnt vmcnt(0)
    buffer_inv sc1
T0_b1q_nw:
    s_waitcnt vmcnt(1)
    v_bitop3_b32 v76, v60, v62, s36 bitop3:0x7e
    v_and_b32 v76, s61, v76
    v_cmp_ne_u32 vcc, 0, v76
    s_cbranch_vccnz T0_b1r
    s_branch T0_b1c
T0_al:
    buffer_store_dwordx2 v[40:41], v6, s[8:11], s23 offen sc1
    s_branch T0_am
T0_a8l:
    buffer_store_dwordx2 v[36:37], v46, s[8:11], s24 offen sc1
    s_branch T0_a8m
T0_sr:
    s_nop 7
    v_max3_f32 v36, v76, v77, v78
    v_max3_f32 v36, v36, v79, v45
    s_nop 1
    v_max_f32_dpp v36, v36, v36 quad_perm:[2,3,0,1] row_mask:0xf bank_mask:0xf
    v_mov_b32 v37, v36
    s_nop 1
    v_permlane16_swap_b32 v36, v37
    v_max_f32 v36, v36, v37
    v_mov_b32 v37, v36
    s_nop 1
    v_permlane32_swap_b32 v36, v37
    v_max_f32 v36, v36, v37
    v_sub_f32 v76, v76, v36
    v_sub_f32 v77, v77, v36
    v_sub_f32 v78, v78, v36
    v_sub_f32 v79, v79, v36
    v_sub_f32 v45, v45, v36
    v_exp_f32 v76, v76
    v_exp_f32 v77, v77
    v_exp_f32 v78, v78
    v_exp_f32 v79, v79
    v_exp_f32 v45, v45
    v_cvt_pk_bf16_f32 v40, v76, v77
    v_cvt_pk_bf16_f32 v42, v78, v79
    v_cvt_pk_bf16_f32 v41, v45, 0
    v_mov_b32 v43, 0
    s_nop 1
    v_permlane32_swap_b32 v41, v43
    v_mov_b64 v[28:29], 0
    v_mov_b64 v[30:31], 0
    v_mov_b64 v[32:33], 0
    v_mov_b64 v[34:35], 0
    v_mfma_f32_16x16x32_bf16 v[36:39], v[40:43], v[68:71], 0
    v_smfmac_f32_16x16x64_bf16 v[28:31], v[40:43], v[56:63], v4 abid:1
    v_smfmac_f32_16x16x64_bf16 v[32:35], v[40:43], v[62:69], v4 abid:1
    s_nop 5
    v_add_f32 v36, v36, v38
    v_add_f32 v37, v37, v39
    v_rcp_f32 v38, v36
    v_rcp_f32 v39, v37
    v_pk_add_f32 v[28:29], v[28:29], v[30:31]
    v_pk_add_f32 v[32:33], v[32:33], v[34:35]
    v_pk_mul_f32 v[28:29], v[28:29], v[38:39]
    v_pk_mul_f32 v[32:33], v[32:33], v[38:39]
    v_cvt_pk_bf16_f32 v30, v28, v32
    v_cvt_pk_bf16_f32 v31, v29, v33
    ds_write2_b32 v8, v30, v31 offset0:0 offset1:4
    s_waitcnt lgkmcnt(0)
    s_branch T0_sc
T0_a8r:
    s_waitcnt vmcnt(1)
    v_mfma_f32_16x16x32_bf16 v[36:39], v[32:35], v[28:31], 0
    v_bitop3_b32 v45, v28, v29, s36 bitop3:0x7e
    v_bitop3_b32 v44, v30, v31, s36 bitop3:0x7e
    v_bitop3_b32 v45, v45, v44, 1 bitop3:0xa8
    v_cmp_ne_u32 s[58:59], 0, v45
    s_nop 3
    s_cmp_lg_u64 s[58:59], 0
    s_cbranch_scc0 T0_a8d
T0_a8q:
    s_add_u32 s13, s13, 1
    s_and_b32 s56, s13, 31
    s_cbranch_scc1 T0_a8q_nw
    s_sub_u32 s35, s35, 1
    s_cmp_eq_u32 s35, 0
    s_cbranch_scc1 L_end
    buffer_wbl2 sc1
    s_waitcnt vmcnt(0)
    buffer_inv sc1
T0_a8q_nw:
    buffer_load_dwordx4 v[28:31], v1, s[8:11], s22 offen sc1
    s_waitcnt vmcnt(0)
    s_branch T0_a8r
T0_ar:
    buffer_load_dwordx4 v[28:31], v1, s[8:11], s22 offen sc1
    buffer_load_dwordx4 v[64:67], v1, s[8:11], s40 offen offset:0 sc1
    buffer_load_dwordx4 v[72:75], v1, s[8:11], s40 offen offset:1024 sc1
    s_waitcnt vmcnt(3)
    v_mfma_f32_16x16x32_bf16 v[40:43], v[32:35], v[68:71], 0
    v_bitop3_b32 v76, v68, v70, s36 bitop3:0x7e
    v_mfma_f32_16x16x32_bf16 v[40:43], v[32:35], v[56:59], v[40:43]
    v_bitop3_b32 v44, v56, v58, s36 bitop3:0x7e
    v_bitop3_b32 v76, v76, v44, 1 bitop3:0xa8
    v_cmp_ne_u32 vcc, 0, v76
    s_nop 3
    s_cbranch_vccz T0_ad
    buffer_load_dwordx4 v[68:71], v1, s[8:11], s40 offen offset:0 sc1
    buffer_load_dwordx4 v[56:59], v1, s[8:11], s40 offen offset:1024 sc1
T0_aq:
    s_add_u32 s13, s13, 1
    s_and_b32 s56, s13, 31
    s_cbranch_scc1 T0_aq_nw
    s_sub_u32 s35, s35, 1
    s_cmp_eq_u32 s35, 0
    s_cbranch_scc1 L_end
    buffer_wbl2 sc1
    s_waitcnt vmcnt(0)
    buffer_inv sc1
T0_aq_nw:
    s_waitcnt vmcnt(2)
    s_branch T0_ac
.p2align 6
T1_chk:
    s_waitcnt vmcnt(3)
    v_bitop3_b32 v76, v28, v30, s36 bitop3:0x7e
    v_and_b32 v76, 1, v76
    v_cmp_ne_u32 vcc, 0, v76
    s_cbranch_vccnz T1_br
T1_head:
    v_smfmac_f32_16x16x64_bf16 v[32:35], v[28:31], v[10:17], v4
    ds_write_b128 v1, v[28:31] offset:1024
    v_smfmac_f32_16x16x64_bf16 v[40:43], v[28:31], v[18:25], v4
    ds_read_b128 v[10:13], v0 offset:24576
    v_smfmac_f32_16x16x64_bf16 v[36:39], v[28:31], a[0:7], v4
    ds_read_b128 v[14:17], v0 offset:25600
    v_smfmac_f32_16x16x64_bf16 v[44:47], v[28:31], a[8:15], v4
    s_waitcnt vmcnt(2)
    v_bitop3_b32 v76, v60, v62, s36 bitop3:0x7e
    v_smfmac_f32_16x16x64_bf16 v[48:51], v[28:31], a[16:23], v4
    s_waitcnt lgkmcnt(2)
    v_and_b32 v76, s61, v76
    v_cmp_ne_u32 vcc, 0, v76
    v_smfmac_f32_16x16x64_bf16 v[52:55], v[28:31], a[24:31], v4
    s_cbranch_vccnz T1_b1r
T1_b1c:
    s_barrier
    v_smfmac_f32_16x16x64_bf16 v[32:35], v[60:63], a[32:39], v4
    ds_read_b128 v[68:71], v1 offset:2048
    v_smfmac_f32_16x16x64_bf16 v[40:43], v[60:63], a[40:47], v4
    ds_write_b128 v1, v[60:63] offset:5120
    v_smfmac_f32_16x16x64_bf16 v[36:39], v[60:63], a[48:55], v4
    ds_read_b128 v[18:21], v0 offset:26624
    v_smfmac_f32_16x16x64_bf16 v[44:47], v[60:63], a[56:63], v4
    buffer_load_dwordx4 v[28:31], v1, s[8:11], s44 offen sc1
    s_waitcnt lgkmcnt(2)
    v_smfmac_f32_16x16x64_bf16 v[32:35], v[68:71], a[80:87], v4
    ds_read_b128 v[64:67], v1 offset:3072
    v_smfmac_f32_16x16x64_bf16 v[40:43], v[68:71], a[88:95], v4
    ds_read_b128 v[22:25], v0 offset:27648
    v_smfmac_f32_16x16x64_bf16 v[36:39], v[68:71], a[96:103], v4
    ds_read_b128 v[56:59], v1 offset:0
    v_smfmac_f32_16x16x64_bf16 v[44:47], v[68:71], a[104:111], v4
    s_waitcnt lgkmcnt(3)
    s_barrier
    s_waitcnt lgkmcnt(2)
    v_smfmac_f32_16x16x64_bf16 v[32:35], v[64:67], v[10:17], v4
    buffer_load_dwordx4 v1, s[8:11], s44 offen offset:1024 sc1 lds
    s_waitcnt lgkmcnt(1)
    v_smfmac_f32_16x16x64_bf16 v[40:43], v[64:67], v[18:25], v4
    ds_read_b128 v[10:13], v0 offset:28672
    v_smfmac_f32_16x16x64_bf16 v[36:39], v[64:67], a[128:135], v4
    ds_read_b128 v[68:71], v1 offset:6144
    v_smfmac_f32_16x16x64_bf16 v[44:47], v[64:67], a[136:143], v4
    ds_read_b128 v[14:17], v0 offset:29696
    s_waitcnt lgkmcnt(3)
    v_smfmac_f32_16x16x64_bf16 v[32:35], v[56:59], a[160:167], v4
    ds_read_b128 v[18:21], v0 offset:30720
    buffer_load_dwordx4 v[60:63], v1, s[8:11], s44 offen offset:2048 sc1
    v_smfmac_f32_16x16x64_bf16 v[40:43], v[56:59], a[168:175], v4
    ds_read_b128 v[22:25], v0 offset:31744
    v_smfmac_f32_16x16x64_bf16 v[36:39], v[56:59], a[176:183], v4
    ds_read_b128 v[64:67], v1 offset:7168
    v_smfmac_f32_16x16x64_bf16 v[44:47], v[56:59], a[184:191], v4
    s_waitcnt lgkmcnt(3)
    v_smfmac_f32_16x16x64_bf16 v[32:35], v[68:71], v[10:17], v4
    buffer_load_dwordx4 v[56:59], v1, s[8:11], s44 offen offset:3072 sc1
    s_waitcnt lgkmcnt(1)
    v_smfmac_f32_16x16x64_bf16 v[40:43], v[68:71], v[18:25], v4
    ds_read_b128 v[72:75], v1 offset:4096
    v_smfmac_f32_16x16x64_bf16 v[36:39], v[68:71], a[208:215], v4
    ds_read_b128 v[10:13], v0 offset:32768
    v_smfmac_f32_16x16x64_bf16 v[44:47], v[68:71], a[216:223], v4
    s_barrier
    s_waitcnt lgkmcnt(2)
    v_smfmac_f32_16x16x64_bf16 v[32:35], v[64:67], a[224:231], v4
    ds_read_b128 v[68:71], v1 offset:8192
    s_waitcnt lgkmcnt(2)
    v_lshlrev_b32 v26, 2, v1
    v_smfmac_f32_16x16x64_bf16 v[32:35], v[72:75], v[96:103], v4
    ds_read_b128 v[14:17], v0 offset:33792
    v_smfmac_f32_16x16x64_bf16 v[36:39], v[64:67], a[240:247], v4
    buffer_load_dword v9, v26, s[8:11], s25 offen sc1
    v_smfmac_f32_16x16x64_bf16 v[36:39], v[72:75], v[112:119], v4
    ds_read_b128 v[18:21], v0 offset:34816
    s_waitcnt lgkmcnt(2)
    v_smfmac_f32_16x16x64_bf16 v[32:35], v[68:71], v[144:151], v4
    ds_read_b128 v[22:25], v0 offset:35840
    s_waitcnt lgkmcnt(2)
    v_smfmac_f32_16x16x64_bf16 v[36:39], v[68:71], v[10:17], v4
    buffer_load_dword v9, off, s[8:11], s12 sc1
    v_smfmac_f32_16x16x64_bf16 v[40:43], v[64:67], a[232:239], v4
    ds_read_b128 v[10:13], v0 offset:16384
    v_add_f32 v32, v32, v34
    v_smfmac_f32_16x16x64_bf16 v[40:43], v[72:75], v[104:111], v4
    ds_read_b128 v[14:17], v0 offset:17408
    v_add_f32 v33, v33, v35
    v_smfmac_f32_16x16x64_bf16 v[40:43], v[68:71], v[152:159], v4
    v_cvt_pk_bf16_f32 v26, v32, v33
    v_smfmac_f32_16x16x64_bf16 v[44:47], v[64:67], a[248:255], v4
    s_waitcnt vmcnt(4)
    ds_read_b128 v[32:35], v1 offset:10240
    v_add_f32 v36, v36, v38
    v_smfmac_f32_16x16x64_bf16 v[44:47], v[72:75], v[120:127], v4
    s_waitcnt lgkmcnt(2)
    v_add_f32 v37, v37, v39
    v_smfmac_f32_16x16x64_bf16 v[44:47], v[68:71], v[18:25], v4
    v_cvt_pk_bf16_f32 v27, v36, v37
    v_add_f32 v40, v40, v42
    v_add_f32 v41, v41, v43
    v_mfma_f32_16x16x16_bf16 v[36:39], v[26:27], v[2:3], 0
    v_cvt_pk_bf16_f32 v26, v40, v41
    s_cmp_eq_u32 s34, 63
    v_add_f32 v44, v44, v46
    v_add_f32 v45, v45, v47
    v_cvt_pk_bf16_f32 v27, v44, v45
    ds_read_b128 v[22:25], v0 offset:19456
    s_mov_b64 vcc, s[50:51]
    v_mfma_f32_16x16x16_bf16 v[40:43], v[26:27], v[2:3], 0
    v_cvt_pk_bf16_f32 v44, v36, v37
    v_cvt_pk_bf16_f32 v45, v38, v39
    v_smfmac_f32_16x16x64_bf16 v[48:51], v[64:67], v[80:87], v4
    ds_read_b128 v[18:21], v0 offset:18432
    v_smfmac_f32_16x16x64_bf16 v[52:55], v[64:67], v[88:95], v4
    ds_read_b128 v[36:39], v1 offset:5120
    v_cvt_pk_bf16_f32 v46, v40, v41
    v_cvt_pk_bf16_f32 v47, v42, v43
    s_nop 1
    v_mfma_f32_16x16x32_bf16 v[40:43], v[44:47], v[44:47], 0
    v_mfma_f32_16x16x32_bf16 v[76:79], v[28:31], v[44:47], 0
    s_waitcnt vmcnt(2)
    s_waitcnt lgkmcnt(2)
    v_mov_b64 v[66:67], v[58:59]
    v_mfma_f32_16x16x32_bf16 v[28:31], v[32:35], v[44:47], 0
    s_cbranch_scc1 L_team_done
    v_cndmask_b32_dpp v26, v43, v42, vcc quad_perm:[0,1,0,1] row_mask:0xf bank_mask:0xf
    v_mul_f32 v26, s48, v26
    v_smfmac_f32_16x16x64_bf16 v[48:51], v[72:75], v[128:135], v4
    ds_write_b32 v1, v26 offset:13316
    v_smfmac_f32_16x16x64_bf16 v[52:55], v[72:75], v[136:143], v4
    ds_read_b128 v[32:35], v1 offset:2048
    v_cndmask_b32_dpp v76, v28, v76, vcc quad_perm:[0,1,0,1] row_mask:0xf bank_mask:0xf
    v_cndmask_b32_dpp v77, v29, v77, vcc quad_perm:[0,1,0,1] row_mask:0xf bank_mask:0xf
    v_cndmask_b32_dpp v78, v30, v78, vcc quad_perm:[0,1,0,1] row_mask:0xf bank_mask:0xf
    v_cndmask_b32_dpp v79, v31, v79, vcc quad_perm:[0,1,0,1] row_mask:0xf bank_mask:0xf
    ds_write_b128 v1, v[76:79] offset:10240
    v_smfmac_f32_16x16x64_bf16 v[48:51], v[68:71], v[10:17], v4
    ds_read_b128 v[28:31], v1 offset:3072
    s_waitcnt lgkmcnt(4)
    v_smfmac_f32_16x16x64_bf16 v[52:55], v[68:71], v[18:25], v4
    ds_read_b128 v[10:13], v0 offset:12288
    v_mov_b64 v[26:27], 0
    v_smfmac_f32_16x16x64_bf16 v[48:51], v[36:39], a[64:71], v4
    s_waitcnt lgkmcnt(2)
    s_barrier
    ds_read_b128 v[40:43], v1 offset:13312
    v_smfmac_f32_16x16x64_bf16 v[52:55], v[36:39], a[72:79], v4
    ds_read_b128 v[68:71], v1 offset:11264
    ds_read_b128 v[72:75], v1 offset:12288
    v_smfmac_f32_16x16x64_bf16 v[48:51], v[32:35], a[112:119], v4
    ds_read_b128 v[36:39], v1 offset:9216
    ds_read_b128 v[44:47], v1 offset:0
    v_smfmac_f32_16x16x64_bf16 v[52:55], v[32:35], a[120:127], v4
    ds_read_b128 v[32:35], v1 offset:6144
    s_waitcnt lgkmcnt(6)
    v_smfmac_f32_16x16x64_bf16 v[48:51], v[28:31], a[144:151], v4
    ds_read_b128 v[14:17], v0 offset:13312
    s_waitcnt lgkmcnt(6)
    v_add_f32 v40, v40, v41
    v_smfmac_f32_16x16x64_bf16 v[52:55], v[28:31], a[152:159], v4
    ds_read_b128 v[18:21], v0 offset:14336
    v_add_f32 v42, v42, v43
    s_waitcnt lgkmcnt(5)
    v_add_f32 v76, v76, v68
    v_add_f32 v77, v77, v69
    s_waitcnt lgkmcnt(3)
    v_smfmac_f32_16x16x64_bf16 v[48:51], v[44:47], a[192:199], v4
    ds_read_b128 v[22:25], v0 offset:15360
    v_add_f32 v78, v78, v70
    v_add_f32 v79, v79, v71
    v_smfmac_f32_16x16x64_bf16 v[52:55], v[44:47], a[200:207], v4
    v_add_f32 v44, v40, v42
    v_add_f32 v72, v72, v36
    s_waitcnt lgkmcnt(2)
    v_smfmac_f32_16x16x64_bf16 v[48:51], v[32:35], v[10:17], v4
    ds_read_b128 v[10:13], v0 offset:0
    v_add_f32 v73, v73, v37
    v_add_f32 v74, v74, v38
    s_waitcnt lgkmcnt(1)
    v_smfmac_f32_16x16x64_bf16 v[52:55], v[32:35], v[18:25], v4
    ds_read_b128 v[14:17], v0 offset:1024
    v_add_f32 v75, v75, v39
    v_exp_f32 v28, v44
    v_mov_b32 v43, 0
    v_pk_add_f32 v[76:77], v[76:77], v[72:73]
    v_pk_add_f32 v[78:79], v[78:79], v[74:75]
    v_cvt_pk_bf16_f32 v41, v28, 0
    v_pk_add_f32 v[48:49], v[48:49], v[50:51]
    v_pk_add_f32 v[52:53], v[52:53], v[54:55]
    v_mfma_f32_16x16x16_bf16 v[28:31], v[26:27], v[26:27], 0
    v_exp_f32 v36, v76
    v_exp_f32 v37, v77
    v_mfma_f32_16x16x16_bf16 v[32:35], v[26:27], v[26:27], 0
    v_permlane32_swap_b32 v41, v43
    v_exp_f32 v38, v78
    v_exp_f32 v39, v79
    v_mov_b64 v[68:69], s[52:53]
    v_mov_b64 v[70:71], s[52:53]
    v_cvt_pk_bf16_f32 v40, v36, v37
    v_cvt_pk_bf16_f32 v42, v38, v39
    v_cvt_pk_bf16_f32 v58, v48, v49
    v_cvt_pk_bf16_f32 v64, v52, v53
    v_mfma_f32_16x16x32_bf16 v[36:39], v[40:43], v[68:71], 0
    ds_read_b128 v[18:21], v0 offset:2048
    v_smfmac_f32_16x16x64_bf16 v[28:31], v[40:43], v[56:63], v4 abid:1
    ds_read_b128 v[22:25], v0 offset:3072
    v_smfmac_f32_16x16x64_bf16 v[32:35], v[40:43], v[62:69], v4 abid:1
    v_add_f32 v36, v36, v38
    v_add_f32 v37, v37, v39
    v_rcp_f32 v38, v36
    v_rcp_f32 v39, v37
    v_pk_add_f32 v[28:29], v[28:29], v[30:31]
    v_pk_add_f32 v[32:33], v[32:33], v[34:35]
    v_pk_mul_f32 v[28:29], v[28:29], v[38:39]
    v_pk_mul_f32 v[32:33], v[32:33], v[38:39]
    v_cvt_pk_bf16_f32 v30, v28, v32
    v_cvt_pk_bf16_f32 v31, v29, v33
    ds_write2_b32 v8, v30, v31 offset0:0 offset1:4
    v_mfma_f32_16x16x16_bf16 v[72:75], v[26:27], v[26:27], 0
    v_max3_f32 v45, v36, v37, v38
    v_max_f32 v45, v45, v39
    v_cmp_nle_f32 vcc, v45, s3
    v_mfma_f32_16x16x16_bf16 v[52:55], v[26:27], v[26:27], 0
    v_xor_b32 v45, 32, v1
    s_xor_b32 s37, s37, 294912
    s_bfe_u32 s36, s34, 0x10001
    v_mfma_f32_16x16x16_bf16 v[48:51], v[26:27], v[26:27], 0
    s_xor_b32 s36, s36, 1
    s_cbranch_vccnz T1_sr
T1_sc:
    s_waitcnt lgkmcnt(0)
    s_barrier
    ds_read_b128 v[56:59], v1 offset:14336
    ds_read_b128 v[32:35], v1 offset:15360
    v_mfma_f32_16x16x16_bf16 v[40:43], v[26:27], v[26:27], 0
    ds_read_b128 v[36:39], v45 offset:14336
    ds_read_b128 v[28:31], v45 offset:15360
    v_mfma_f32_16x16x16_bf16 v[44:47], v[26:27], v[26:27], 0
    v_lshrrev_b32 v60, 1, v5
    s_add_u32 s21, s37, 0x40000
    s_waitcnt lgkmcnt(3)
    v_smfmac_f32_16x16x64_bf16 v[52:55], v[56:59], v[240:247], v4
    s_add_u32 s38, s37, 0x10000
    s_add_u32 s39, s37, 0x20000
    s_add_u32 s20, s37, 0x30000
    s_waitcnt lgkmcnt(2)
    v_smfmac_f32_16x16x64_bf16 v[52:55], v[32:35], v[248:255], v4
    s_add_u32 s40, s37, s49
    s_add_u32 s22, s37, s19
    v_smfmac_f32_16x16x64_bf16 v[72:75], v[56:59], v[10:17], v4
    ds_read_b128 v[10:13], v0 offset:4096
    v_smfmac_f32_16x16x64_bf16 v[72:75], v[32:35], v[208:215], v4
    ds_read_b128 v[14:17], v0 offset:5120
    v_add_f32 v52, v52, v54
    v_add_f32 v53, v53, v55
    s_waitcnt lgkmcnt(2)
    v_smfmac_f32_16x16x64_bf16 v[72:75], v[36:39], v[18:25], v4
    ds_read_b128 v[18:21], v0 offset:6144
    v_cvt_pk_bf16_f32 v52, v52, v53
    v_smfmac_f32_16x16x64_bf16 v[72:75], v[28:31], v[216:223], v4
    ds_read_b128 v[22:25], v0 offset:7168
    v_bfi_b32 v52, 1, s36, v52
    v_smfmac_f32_16x16x64_bf16 v[48:51], v[56:59], v[160:167], v4
    buffer_store_dword v52, v60, s[8:11], s21 offen
    s_waitcnt lgkmcnt(2)
    v_smfmac_f32_16x16x64_bf16 v[48:51], v[32:35], v[10:17], v4
    ds_read_b128 v[10:13], v0 offset:8192
    v_cvt_pk_bf16_f32 v52, v72, v73
    v_smfmac_f32_16x16x64_bf16 v[48:51], v[36:39], v[168:175], v4
    ds_read_b128 v[14:17], v0 offset:9216
    s_waitcnt lgkmcnt(2)
    v_cvt_pk_bf16_f32 v53, v74, v75
    v_smfmac_f32_16x16x64_bf16 v[48:51], v[28:31], v[18:25], v4
    ds_read_b128 v[18:21], v0 offset:10240
    v_bfi_b32 v52, 1, s36, v52
    v_smfmac_f32_16x16x64_bf16 v[40:43], v[56:59], v[176:183], v4
    buffer_store_dwordx2 v[52:53], v5, s[8:11], s37 offen
    v_smfmac_f32_16x16x64_bf16 v[40:43], v[32:35], v[224:231], v4
    ds_read_b128 v[22:25], v0 offset:11264
    v_cvt_pk_bf16_f32 v48, v48, v49
    v_smfmac_f32_16x16x64_bf16 v[40:43], v[36:39], v[184:191], v4
    v_cvt_pk_bf16_f32 v49, v50, v51
    v_smfmac_f32_16x16x64_bf16 v[40:43], v[28:31], v[232:239], v4
    v_bfi_b32 v48, 1, s36, v48
    v_smfmac_f32_16x16x64_bf16 v[44:47], v[56:59], v[192:199], v4
    buffer_store_dwordx2 v[48:49], v5, s[8:11], s38 offen
    s_waitcnt lgkmcnt(1)
    v_smfmac_f32_16x16x64_bf16 v[44:47], v[32:35], v[10:17], v4
    v_cvt_pk_bf16_f32 v32, v40, v41
    v_smfmac_f32_16x16x64_bf16 v[44:47], v[36:39], v[200:207], v4
    s_waitcnt lgkmcnt(0)
    v_cvt_pk_bf16_f32 v33, v42, v43
    v_smfmac_f32_16x16x64_bf16 v[44:47], v[28:31], v[18:25], v4
    v_bfi_b32 v32, 1, s36, v32
    buffer_store_dwordx2 v[32:33], v5, s[8:11], s39 offen
    s_nop 3
    v_cvt_pk_bf16_f32 v28, v44, v45
    v_cvt_pk_bf16_f32 v29, v46, v47
    v_bfi_b32 v28, 1, s36, v28
    buffer_store_dwordx2 v[28:29], v5, s[8:11], s20 offen
    s_xor_b32 s41, s41, 16384
    s_add_u32 s23, s41, s17
    s_nop 1
    s_add_u32 s24, s41, s18
    s_add_u32 s42, s41, 4096
    s_nop 1
    s_add_u32 s43, s41, 8192
    s_mov_b32 s61, 1
    s_nop 1
    s_mov_b32 s13, 0
    s_add_u32 s44, s25, 442368
    s_nop 1
    s_add_u32 s25, s34, 2
    s_and_b32 s25, s25, 15
    s_nop 1
    s_lshl_b32 s25, s25, 19
    s_add_u32 s25, s25, s45
    s_nop 1
    s_add_u32 s46, s46, 9216
    s_add_u32 s34, s34, 1
    s_nop 1
    s_nop 3
    s_nop 3
    s_nop 3
    s_nop 3
    s_nop 3
    buffer_load_dwordx4 v[72:75], v1, s[8:11], s40 offen offset:0 sc1
    buffer_load_dwordx4 v[56:59], v1, s[8:11], s40 offen offset:1024 sc1
    v_bfe_u32 v28, v1, 6, 1
    v_lshlrev_b32 v28, 4, v28
    s_nop 1
    v_lshlrev_b32 v28, v28, s14
    s_lshl_b64 s[54:55], s[62:63], 0
    s_nop 1
    v_cndmask_b32 v32, 0, v28, s[54:55]
    s_lshl_b64 s[54:55], s[62:63], 1
    s_nop 1
    v_cndmask_b32 v33, 0, v28, s[54:55]
    s_lshl_b64 s[54:55], s[62:63], 2
    s_nop 1
    v_cndmask_b32 v34, 0, v28, s[54:55]
    s_lshl_b64 s[54:55], s[62:63], 3
    s_nop 1
    v_cndmask_b32 v35, 0, v28, s[54:55]
    s_nop 2
    s_nop 3
    buffer_load_dwordx4 v[68:71], v1, s[8:11], s40 offen offset:0 sc1
    buffer_load_dwordx4 v[64:67], v1, s[8:11], s40 offen offset:1024 sc1
    s_waitcnt vmcnt(9)
    v_cmp_eq_u32 vcc, 0, v9
    ds_read_b128 v[10:13], v0 offset:20480
    ds_read_b128 v[14:17], v0 offset:21504
    ds_read_b128 v[18:21], v0 offset:22528
    ds_read_b128 v[22:25], v0 offset:23552
    s_cbranch_vccnz T1_kr
T1_kc:
    s_add_u32 s12, s12, 4
T1_ac:
    s_waitcnt vmcnt(3)
    v_mfma_f32_16x16x32_bf16 v[28:31], v[32:35], v[72:75], 0
    s_waitcnt vmcnt(2)
    v_bitop3_b32 v76, v72, v74, s36 bitop3:0x7e
    v_mfma_f32_16x16x32_bf16 v[28:31], v[32:35], v[56:59], v[28:31]
    v_bitop3_b32 v36, v56, v58, s36 bitop3:0x7e
    v_bitop3_b32 v76, v76, v36, 1 bitop3:0xa8
    v_cmp_ne_u32 vcc, 0, v76
    s_nop 2
    s_cbranch_vccnz T1_ar
T1_ad:
    v_add_f32_dpp v28, v28, v28 row_ror:8 row_mask:0xf bank_mask:0xf
    v_add_f32_dpp v29, v29, v29 row_ror:8 row_mask:0xf bank_mask:0xf
    v_add_f32_dpp v30, v30, v30 row_ror:8 row_mask:0xf bank_mask:0xf
    v_add_f32_dpp v31, v31, v31 row_ror:8 row_mask:0xf bank_mask:0xf
    v_add_f32_dpp v28, v28, v28 row_ror:4 row_mask:0xf bank_mask:0xf
    v_add_f32_dpp v29, v29, v29 row_ror:4 row_mask:0xf bank_mask:0xf
    v_add_f32_dpp v30, v30, v30 row_ror:4 row_mask:0xf bank_mask:0xf
    v_add_f32_dpp v31, v31, v31 row_ror:4 row_mask:0xf bank_mask:0xf
    v_cvt_pk_bf16_f32 v28, v28, v29
    v_cvt_pk_bf16_f32 v29, v30, v31
    v_bfi_b32 v28, 1, s36, v28
    buffer_store_dwordx2 v[28:29], v6, s[8:11], s23 offen
    s_cmp_eq_u32 s34, 63
    s_cbranch_scc1 T1_al
T1_am:
    s_barrier
    v_mfma_f32_16x16x16_bf16 v[48:51], v[26:27], v[26:27], 0
    v_mfma_f32_16x16x16_bf16 v[52:55], v[26:27], v[26:27], 0
    v_mfma_f32_16x16x16_bf16 v[32:35], v[26:27], v[26:27], 0
    buffer_load_dwordx4 v[28:31], v7, s[8:11], s41 offen offset:1024 sc1
    v_mfma_f32_16x16x16_bf16 v[36:39], v[26:27], v[26:27], 0
    v_mfma_f32_16x16x16_bf16 v[40:43], v[26:27], v[26:27], 0
    buffer_load_dwordx4 v[60:63], v7, s[8:11], s42 offen offset:1024 sc1
    v_mfma_f32_16x16x16_bf16 v[44:47], v[26:27], v[26:27], 0
    s_nop 3
    s_nop 3
    s_nop 3
    buffer_load_dwordx4 v[28:31], v7, s[8:11], s41 offen offset:1024 sc1
    s_nop 3
    s_nop 3
    buffer_load_dwordx4 v[60:63], v7, s[8:11], s42 offen offset:1024 sc1
    s_waitcnt lgkmcnt(0)
    s_branch T1_chk
T1_br:
    buffer_load_dwordx4 v[28:31], v7, s[8:11], s41 offen offset:1024 sc1
    buffer_load_dwordx4 v[60:63], v7, s[8:11], s42 offen offset:1024 sc1
T1_brq:
    s_add_u32 s13, s13, 1
    s_and_b32 s56, s13, 63
    s_cbranch_scc1 T1_brq_nw
    s_sub_u32 s35, s35, 1
    s_cmp_eq_u32 s35, 0
    s_cbranch_scc1 L_end
    buffer_wbl2 sc1
    s_waitcnt vmcnt(0)
    buffer_inv sc1
T1_brq_nw:
    s_branch T1_chk
T1_b1r:
    buffer_load_dwordx4 v[60:63], v7, s[8:11], s42 offen offset:1024 sc1
T1_b1q:
    s_add_u32 s13, s13, 1
    s_and_b32 s56, s13, 127
    s_cbranch_scc1 T1_b1q_nw
    s_sub_u32 s35, s35, 1
    s_cmp_eq_u32 s35, 0
    s_cbranch_scc1 L_end
    buffer_wbl2 sc1
    s_waitcnt vmcnt(0)
    buffer_inv sc1
T1_b1q_nw:
    s_waitcnt vmcnt(1)
    v_bitop3_b32 v76, v60, v62, s36 bitop3:0x7e
    v_and_b32 v76, s61, v76
    v_cmp_ne_u32 vcc, 0, v76
    s_cbranch_vccnz T1_b1r
    s_branch T1_b1c
T1_al:
    buffer_store_dwordx2 v[28:29], v6, s[8:11], s23 offen sc1
    s_branch T1_am
T1_kr:
    s_cmp_ge_u32 s34, 62
    s_cbranch_scc1 T1_kc
    buffer_load_dword v9, off, s[8:11], s12 sc1
    s_sub_u32 s35, s35, 1
    s_cmp_eq_u32 s35, 0
    s_cbranch_scc1 L_end
    s_waitcnt vmcnt(0)
    v_cmp_ne_u32 vcc, 0, v9
    s_cbranch_vccnz T1_kc
    s_branch T1_kr
T1_sr:
    s_nop 7
    v_max3_f32 v36, v76, v77, v78
    v_max3_f32 v36, v36, v79, v44
    s_nop 1
    v_max_f32_dpp v36, v36, v36 quad_perm:[2,3,0,1] row_mask:0xf bank_mask:0xf
    v_mov_b32 v37, v36
    s_nop 1
    v_permlane16_swap_b32 v36, v37
    v_max_f32 v36, v36, v37
    v_mov_b32 v37, v36
    s_nop 1
    v_permlane32_swap_b32 v36, v37
    v_max_f32 v36, v36, v37
    v_sub_f32 v76, v76, v36
    v_sub_f32 v77, v77, v36
    v_sub_f32 v78, v78, v36
    v_sub_f32 v79, v79, v36
    v_sub_f32 v44, v44, v36
    v_exp_f32 v76, v76
    v_exp_f32 v77, v77
    v_exp_f32 v78, v78
    v_exp_f32 v79, v79
    v_exp_f32 v44, v44
    v_cvt_pk_bf16_f32 v40, v76, v77
    v_cvt_pk_bf16_f32 v42, v78, v79
    v_cvt_pk_bf16_f32 v41, v44, 0
    v_mov_b32 v43, 0
    s_nop 1
    v_permlane32_swap_b32 v41, v43
    v_mov_b64 v[28:29], 0
    v_mov_b64 v[30:31], 0
    v_mov_b64 v[32:33], 0
    v_mov_b64 v[34:35], 0
    v_mfma_f32_16x16x32_bf16 v[36:39], v[40:43], v[68:71], 0
    v_smfmac_f32_16x16x64_bf16 v[28:31], v[40:43], v[56:63], v4 abid:1
    v_smfmac_f32_16x16x64_bf16 v[32:35], v[40:43], v[62:69], v4 abid:1
    s_nop 5
    v_add_f32 v36, v36, v38
    v_add_f32 v37, v37, v39
    v_rcp_f32 v38, v36
    v_rcp_f32 v39, v37
    v_pk_add_f32 v[28:29], v[28:29], v[30:31]
    v_pk_add_f32 v[32:33], v[32:33], v[34:35]
    v_pk_mul_f32 v[28:29], v[28:29], v[38:39]
    v_pk_mul_f32 v[32:33], v[32:33], v[38:39]
    v_cvt_pk_bf16_f32 v30, v28, v32
    v_cvt_pk_bf16_f32 v31, v29, v33
    ds_write2_b32 v8, v30, v31 offset0:0 offset1:4
    s_waitcnt lgkmcnt(0)
    s_branch T1_sc
T1_ar:
    buffer_load_dwordx4 v[72:75], v1, s[8:11], s40 offen offset:0 sc1
    buffer_load_dwordx4 v[56:59], v1, s[8:11], s40 offen offset:1024 sc1
    s_waitcnt vmcnt(2)
    v_mfma_f32_16x16x32_bf16 v[28:31], v[32:35], v[68:71], 0
    v_bitop3_b32 v76, v68, v70, s36 bitop3:0x7e
    v_mfma_f32_16x16x32_bf16 v[28:31], v[32:35], v[64:67], v[28:31]
    v_bitop3_b32 v36, v64, v66, s36 bitop3:0x7e
    v_bitop3_b32 v76, v76, v36, 1 bitop3:0xa8
    v_cmp_ne_u32 vcc, 0, v76
    s_nop 3
    s_cbranch_vccz T1_ad
    buffer_load_dwordx4 v[68:71], v1, s[8:11], s40 offen offset:0 sc1
    buffer_load_dwordx4 v[64:67], v1, s[8:11], s40 offen offset:1024 sc1
T1_aq:
    s_add_u32 s13, s13, 1
    s_and_b32 s56, s13, 31
    s_cbranch_scc1 T1_aq_nw
    s_sub_u32 s35, s35, 1
    s_cmp_eq_u32 s35, 0
    s_cbranch_scc1 L_end
    buffer_wbl2 sc1
    s_waitcnt vmcnt(0)
    buffer_inv sc1
T1_aq_nw:
    s_waitcnt vmcnt(2)
    s_branch T1_ac
.p2align 6
T2_chk:
    s_waitcnt vmcnt(3)
    v_bitop3_b32 v76, v28, v30, s36 bitop3:0x7e
    v_and_b32 v76, 1, v76
    v_cmp_ne_u32 vcc, 0, v76
    s_cbranch_vccnz T2_br
T2_head:
    v_smfmac_f32_16x16x64_bf16 v[32:35], v[28:31], v[10:17], v4
    ds_write_b128 v1, v[28:31] offset:2048
    v_smfmac_f32_16x16x64_bf16 v[40:43], v[28:31], v[18:25], v4
    ds_read_b128 v[10:13], v0 offset:20480
    v_smfmac_f32_16x16x64_bf16 v[36:39], v[28:31], a[0:7], v4
    ds_read_b128 v[14:17], v0 offset:21504
    v_smfmac_f32_16x16x64_bf16 v[44:47], v[28:31], a[8:15], v4
    s_waitcnt vmcnt(2)
    v_bitop3_b32 v76, v60, v62, s36 bitop3:0x7e
    v_smfmac_f32_16x16x64_bf16 v[48:51], v[28:31], a[16:23], v4
    s_waitcnt lgkmcnt(2)
    v_and_b32 v76, s61, v76
    v_cmp_ne_u32 vcc, 0, v76
    v_smfmac_f32_16x16x64_bf16 v[52:55], v[28:31], a[24:31], v4
    s_cbranch_vccnz T2_b1r
T2_b1c:
    s_barrier
    v_smfmac_f32_16x16x64_bf16 v[32:35], v[60:63], a[32:39], v4
    ds_read_b128 v[68:71], v1 offset:3072
    v_smfmac_f32_16x16x64_bf16 v[40:43], v[60:63], a[40:47], v4
    ds_write_b128 v1, v[60:63] offset:6144
    v_smfmac_f32_16x16x64_bf16 v[36:39], v[60:63], a[48:55], v4
    ds_read_b128 v[18:21], v0 offset:22528
    v_smfmac_f32_16x16x64_bf16 v[44:47], v[60:63], a[56:63], v4
    ds_read_b128 v[64:67], v1 offset:0
    s_waitcnt lgkmcnt(3)
    v_smfmac_f32_16x16x64_bf16 v[32:35], v[68:71], a[80:87], v4
    buffer_load_dwordx4 v[28:31], v1, s[8:11], s44 offen sc1
    v_smfmac_f32_16x16x64_bf16 v[40:43], v[68:71], a[88:95], v4
    ds_read_b128 v[22:25], v0 offset:23552
    v_smfmac_f32_16x16x64_bf16 v[36:39], v[68:71], a[96:103], v4
    ds_read_b128 v[56:59], v1 offset:1024
    v_smfmac_f32_16x16x64_bf16 v[44:47], v[68:71], a[104:111], v4
    s_waitcnt lgkmcnt(2)
    s_barrier
    v_smfmac_f32_16x16x64_bf16 v[32:35], v[64:67], v[10:17], v4
    ds_read_b128 v[10:13], v0 offset:28672
    s_waitcnt lgkmcnt(2)
    v_smfmac_f32_16x16x64_bf16 v[40:43], v[64:67], v[18:25], v4
    buffer_load_dwordx4 v1, s[8:11], s44 offen offset:1024 sc1 lds
    v_smfmac_f32_16x16x64_bf16 v[36:39], v[64:67], a[128:135], v4
    ds_read_b128 v[68:71], v1 offset:7168
    v_smfmac_f32_16x16x64_bf16 v[44:47], v[64:67], a[136:143], v4
    ds_read_b128 v[14:17], v0 offset:29696
    s_waitcnt lgkmcnt(3)
    v_smfmac_f32_16x16x64_bf16 v[32:35], v[56:59], a[160:167], v4
    ds_read_b128 v[18:21], v0 offset:30720
    v_smfmac_f32_16x16x64_bf16 v[40:43], v[56:59], a[168:175], v4
    ds_read_b128 v[22:25], v0 offset:31744
    buffer_load_dwordx4 v[60:63], v1, s[8:11], s44 offen offset:2048 sc1
    v_smfmac_f32_16x16x64_bf16 v[36:39], v[56:59], a[176:183], v4
    ds_read_b128 v[64:67], v1 offset:4096
    v_smfmac_f32_16x16x64_bf16 v[44:47], v[56:59], a[184:191], v4
    s_waitcnt lgkmcnt(3)
    v_smfmac_f32_16x16x64_bf16 v[32:35], v[68:71], v[10:17], v4
    ds_read_b128 v[72:75], v1 offset:5120
    s_waitcnt lgkmcnt(2)
    v_lshrrev_b32 v77, 1, v1
    v_smfmac_f32_16x16x64_bf16 v[40:43], v[68:71], v[18:25], v4
    buffer_load_dwordx4 v[56:59], v1, s[8:11], s44 offen offset:3072 sc1
    v_smfmac_f32_16x16x64_bf16 v[36:39], v[68:71], a[208:215], v4
    ds_read_b128 v[10:13], v0 offset:32768
    v_add_u32 v77, s47, v77
    v_smfmac_f32_16x16x64_bf16 v[44:47], v[68:71], a[216:223], v4
    s_barrier
    s_waitcnt lgkmcnt(2)
    v_smfmac_f32_16x16x64_bf16 v[32:35], v[64:67], a[224:231], v4
    ds_read_b128 v[68:71], v1 offset:8192
    s_waitcnt lgkmcnt(2)
    v_lshlrev_b32 v76, 2, v1
    v_smfmac_f32_16x16x64_bf16 v[32:35], v[72:75], v[96:103], v4
    ds_read_b64 v[26:27], v77
    ds_read_b128 v[14:17], v0 offset:33792
    v_smfmac_f32_16x16x64_bf16 v[36:39], v[64:67], a[240:247], v4
    ds_read_b128 v[18:21], v0 offset:34816
    v_smfmac_f32_16x16x64_bf16 v[36:39], v[72:75], v[112:119], v4
    buffer_load_dword v9, v76, s[8:11], s25 offen sc1
    s_waitcnt lgkmcnt(3)
    v_smfmac_f32_16x16x64_bf16 v[32:35], v[68:71], v[144:151], v4
    ds_read_b128 v[22:25], v0 offset:35840
    s_waitcnt lgkmcnt(2)
    v_smfmac_f32_16x16x64_bf16 v[36:39], v[68:71], v[10:17], v4
    buffer_store_dwordx2 v[26:27], v77, s[8:11], s46 offen sc1
    v_smfmac_f32_16x16x64_bf16 v[40:43], v[64:67], a[232:239], v4
    ds_read_b128 v[10:13], v0 offset:16384
    v_add_f32 v32, v32, v34
    v_smfmac_f32_16x16x64_bf16 v[40:43], v[72:75], v[104:111], v4
    ds_read_b128 v[14:17], v0 offset:17408
    v_add_f32 v33, v33, v35
    v_smfmac_f32_16x16x64_bf16 v[40:43], v[68:71], v[152:159], v4
    v_cvt_pk_bf16_f32 v26, v32, v33
    v_smfmac_f32_16x16x64_bf16 v[44:47], v[64:67], a[248:255], v4
    s_waitcnt vmcnt(4)
    ds_read_b128 v[32:35], v1 offset:11264
    v_add_f32 v36, v36, v38
    v_smfmac_f32_16x16x64_bf16 v[44:47], v[72:75], v[120:127], v4
    s_waitcnt lgkmcnt(2)
    v_add_f32 v37, v37, v39
    v_smfmac_f32_16x16x64_bf16 v[44:47], v[68:71], v[18:25], v4
    v_cvt_pk_bf16_f32 v27, v36, v37
    v_add_f32 v40, v40, v42
    v_add_f32 v41, v41, v43
    v_mfma_f32_16x16x16_bf16 v[36:39], v[26:27], v[2:3], 0
    v_cvt_pk_bf16_f32 v26, v40, v41
    s_cmp_eq_u32 s34, 63
    v_add_f32 v44, v44, v46
    v_add_f32 v45, v45, v47
    v_cvt_pk_bf16_f32 v27, v44, v45
    ds_read_b128 v[22:25], v0 offset:19456
    s_mov_b64 vcc, s[50:51]
    v_mfma_f32_16x16x16_bf16 v[40:43], v[26:27], v[2:3], 0
    v_cvt_pk_bf16_f32 v44, v36, v37
    v_cvt_pk_bf16_f32 v45, v38, v39
    v_smfmac_f32_16x16x64_bf16 v[48:51], v[64:67], v[80:87], v4
    ds_read_b128 v[18:21], v0 offset:18432
    v_smfmac_f32_16x16x64_bf16 v[52:55], v[64:67], v[88:95], v4
    ds_read_b128 v[36:39], v1 offset:6144
    v_cvt_pk_bf16_f32 v46, v40, v41
    v_cvt_pk_bf16_f32 v47, v42, v43
    s_nop 1
    v_mfma_f32_16x16x32_bf16 v[40:43], v[44:47], v[44:47], 0
    v_mfma_f32_16x16x32_bf16 v[76:79], v[28:31], v[44:47], 0
    s_waitcnt vmcnt(2)
    s_waitcnt lgkmcnt(2)
    v_mov_b64 v[66:67], v[58:59]
    v_mfma_f32_16x16x32_bf16 v[28:31], v[32:35], v[44:47], 0
    s_cbranch_scc1 L_team_done
    v_cndmask_b32_dpp v26, v43, v42, vcc quad_perm:[0,1,0,1] row_mask:0xf bank_mask:0xf
    v_mul_f32 v26, s48, v26
    v_smfmac_f32_16x16x64_bf16 v[48:51], v[72:75], v[128:135], v4
    ds_write_b32 v1, v26 offset:13320
    v_smfmac_f32_16x16x64_bf16 v[52:55], v[72:75], v[136:143], v4
    ds_read_b128 v[32:35], v1 offset:3072
    v_cndmask_b32_dpp v76, v28, v76, vcc quad_perm:[0,1,0,1] row_mask:0xf bank_mask:0xf
    v_cndmask_b32_dpp v77, v29, v77, vcc quad_perm:[0,1,0,1] row_mask:0xf bank_mask:0xf
    v_cndmask_b32_dpp v78, v30, v78, vcc quad_perm:[0,1,0,1] row_mask:0xf bank_mask:0xf
    v_cndmask_b32_dpp v79, v31, v79, vcc quad_perm:[0,1,0,1] row_mask:0xf bank_mask:0xf
    ds_write_b128 v1, v[76:79] offset:11264
    v_smfmac_f32_16x16x64_bf16 v[48:51], v[68:71], v[10:17], v4
    ds_read_b128 v[28:31], v1 offset:0
    s_waitcnt lgkmcnt(4)
    v_smfmac_f32_16x16x64_bf16 v[52:55], v[68:71], v[18:25], v4
    ds_read_b128 v[10:13], v0 offset:12288
    v_mov_b64 v[26:27], 0
    v_smfmac_f32_16x16x64_bf16 v[48:51], v[36:39], a[64:71], v4
    s_waitcnt lgkmcnt(2)
    s_barrier
    ds_read_b128 v[40:43], v1 offset:13312
    v_smfmac_f32_16x16x64_bf16 v[52:55], v[36:39], a[72:79], v4
    ds_read_b128 v[68:71], v1 offset:12288
    ds_read_b128 v[72:75], v1 offset:9216
    v_smfmac_f32_16x16x64_bf16 v[48:51], v[32:35], a[112:119], v4
    ds_read_b128 v[36:39], v1 offset:10240
    ds_read_b128 v[44:47], v1 offset:1024
    v_smfmac_f32_16x16x64_bf16 v[52:55], v[32:35], a[120:127], v4
    ds_read_b128 v[32:35], v1 offset:7168
    s_waitcnt lgkmcnt(6)
    v_smfmac_f32_16x16x64_bf16 v[48:51], v[28:31], a[144:151], v4
    ds_read_b128 v[14:17], v0 offset:13312
    s_waitcnt lgkmcnt(6)
    v_add_f32 v40, v40, v41
    v_smfmac_f32_16x16x64_bf16 v[52:55], v[28:31], a[152:159], v4
    ds_read_b128 v[18:21], v0 offset:14336
    v_add_f32 v42, v42, v43
    s_waitcnt lgkmcnt(5)
    v_add_f32 v76, v76, v68
    v_add_f32 v77, v77, v69
    s_waitcnt lgkmcnt(3)
    v_smfmac_f32_16x16x64_bf16 v[48:51], v[44:47], a[192:199], v4
    ds_read_b128 v[22:25], v0 offset:15360
    v_add_f32 v78, v78, v70
    v_add_f32 v79, v79, v71
    v_smfmac_f32_16x16x64_bf16 v[52:55], v[44:47], a[200:207], v4
    v_add_f32 v45, v40, v42
    v_add_f32 v72, v72, v36
    s_waitcnt lgkmcnt(2)
    v_smfmac_f32_16x16x64_bf16 v[48:51], v[32:35], v[10:17], v4
    ds_read_b128 v[10:13], v0 offset:0
    v_add_f32 v73, v73, v37
    v_add_f32 v74, v74, v38
    s_waitcnt lgkmcnt(1)
    v_smfmac_f32_16x16x64_bf16 v[52:55], v[32:35], v[18:25], v4
    ds_read_b128 v[14:17], v0 offset:1024
    v_add_f32 v75, v75, v39
    v_exp_f32 v28, v45
    v_mov_b32 v43, 0
    v_pk_add_f32 v[76:77], v[76:77], v[72:73]
    v_pk_add_f32 v[78:79], v[78:79], v[74:75]
    v_cvt_pk_bf16_f32 v41, v28, 0
    v_pk_add_f32 v[48:49], v[48:49], v[50:51]
    v_pk_add_f32 v[52:53], v[52:53], v[54:55]
    v_mfma_f32_16x16x16_bf16 v[28:31], v[26:27], v[26:27], 0
    v_exp_f32 v36, v76
    v_exp_f32 v37, v77
    v_mfma_f32_16x16x16_bf16 v[32:35], v[26:27], v[26:27], 0
    v_permlane32_swap_b32 v41, v43
    v_exp_f32 v38, v78
    v_exp_f32 v39, v79
    v_mov_b64 v[68:69], s[52:53]
    v_mov_b64 v[70:71], s[52:53]
    v_cvt_pk_bf16_f32 v40, v36, v37
    v_cvt_pk_bf16_f32 v42, v38, v39
    v_cvt_pk_bf16_f32 v58, v48, v49
    v_cvt_pk_bf16_f32 v64, v52, v53
    v_mfma_f32_16x16x32_bf16 v[36:39], v[40:43], v[68:71], 0
    ds_read_b128 v[18:21], v0 offset:2048
    v_smfmac_f32_16x16x64_bf16 v[28:31], v[40:43], v[56:63], v4 abid:1
    ds_read_b128 v[22:25], v0 offset:3072
    v_smfmac_f32_16x16x64_bf16 v[32:35], v[40:43], v[62:69], v4 abid:1
    v_add_f32 v36, v36, v38
    v_add_f32 v37, v37, v39
    v_rcp_f32 v38, v36
    v_rcp_f32 v39, v37
    v_pk_add_f32 v[28:29], v[28:29], v[30:31]
    v_pk_add_f32 v[32:33], v[32:33], v[34:35]
    v_pk_mul_f32 v[28:29], v[28:29], v[38:39]
    v_pk_mul_f32 v[32:33], v[32:33], v[38:39]
    v_cvt_pk_bf16_f32 v30, v28, v32
    v_cvt_pk_bf16_f32 v31, v29, v33
    ds_write2_b32 v8, v30, v31 offset0:0 offset1:4
    v_mfma_f32_16x16x16_bf16 v[72:75], v[26:27], v[26:27], 0
    v_max3_f32 v44, v36, v37, v38
    v_max_f32 v44, v44, v39
    v_cmp_nle_f32 vcc, v44, s3
    v_mfma_f32_16x16x16_bf16 v[52:55], v[26:27], v[26:27], 0
    v_xor_b32 v44, 32, v1
    s_xor_b32 s37, s37, 294912
    s_bfe_u32 s36, s34, 0x10001
    v_mfma_f32_16x16x16_bf16 v[48:51], v[26:27], v[26:27], 0
    s_xor_b32 s36, s36, 1
    s_cbranch_vccnz T2_sr
T2_sc:
    s_waitcnt lgkmcnt(0)
    s_barrier
    ds_read_b128 v[56:59], v1 offset:14336
    ds_read_b128 v[32:35], v1 offset:15360
    v_mfma_f32_16x16x16_bf16 v[40:43], v[26:27], v[26:27], 0
    ds_read_b128 v[36:39], v44 offset:14336
    ds_read_b128 v[28:31], v44 offset:15360
    v_mfma_f32_16x16x16_bf16 v[44:47], v[26:27], v[26:27], 0
    v_lshrrev_b32 v60, 1, v5
    s_add_u32 s21, s37, 0x40000
    s_waitcnt lgkmcnt(3)
    v_smfmac_f32_16x16x64_bf16 v[52:55], v[56:59], v[240:247], v4
    s_add_u32 s38, s37, 0x10000
    s_add_u32 s39, s37, 0x20000
    s_add_u32 s20, s37, 0x30000
    s_waitcnt lgkmcnt(2)
    v_smfmac_f32_16x16x64_bf16 v[52:55], v[32:35], v[248:255], v4
    s_add_u32 s40, s37, s49
    s_add_u32 s22, s37, s19
    v_smfmac_f32_16x16x64_bf16 v[72:75], v[56:59], v[10:17], v4
    ds_read_b128 v[10:13], v0 offset:4096
    v_smfmac_f32_16x16x64_bf16 v[72:75], v[32:35], v[208:215], v4
    ds_read_b128 v[14:17], v0 offset:5120
    v_add_f32 v52, v52, v54
    v_add_f32 v53, v53, v55
    s_waitcnt lgkmcnt(2)
    v_smfmac_f32_16x16x64_bf16 v[72:75], v[36:39], v[18:25], v4
    ds_read_b128 v[18:21], v0 offset:6144
    v_cvt_pk_bf16_f32 v52, v52, v53
    v_smfmac_f32_16x16x64_bf16 v[72:75], v[28:31], v[216:223], v4
    ds_read_b128 v[22:25], v0 offset:7168
    v_bfi_b32 v52, 1, s36, v52
    v_smfmac_f32_16x16x64_bf16 v[48:51], v[56:59], v[160:167], v4
    buffer_store_dword v52, v60, s[8:11], s21 offen
    s_waitcnt lgkmcnt(2)
    v_smfmac_f32_16x16x64_bf16 v[48:51], v[32:35], v[10:17], v4
    ds_read_b128 v[10:13], v0 offset:8192
    v_cvt_pk_bf16_f32 v52, v72, v73
    v_smfmac_f32_16x16x64_bf16 v[48:51], v[36:39], v[168:175], v4
    ds_read_b128 v[14:17], v0 offset:9216
    s_waitcnt lgkmcnt(2)
    v_cvt_pk_bf16_f32 v53, v74, v75
    v_smfmac_f32_16x16x64_bf16 v[48:51], v[28:31], v[18:25], v4
    ds_read_b128 v[18:21], v0 offset:10240
    v_bfi_b32 v52, 1, s36, v52
    v_smfmac_f32_16x16x64_bf16 v[40:43], v[56:59], v[176:183], v4
    buffer_store_dwordx2 v[52:53], v5, s[8:11], s37 offen
    v_smfmac_f32_16x16x64_bf16 v[40:43], v[32:35], v[224:231], v4
    ds_read_b128 v[22:25], v0 offset:11264
    v_cvt_pk_bf16_f32 v48, v48, v49
    v_smfmac_f32_16x16x64_bf16 v[40:43], v[36:39], v[184:191], v4
    v_cvt_pk_bf16_f32 v49, v50, v51
    v_smfmac_f32_16x16x64_bf16 v[40:43], v[28:31], v[232:239], v4
    v_bfi_b32 v48, 1, s36, v48
    v_smfmac_f32_16x16x64_bf16 v[44:47], v[56:59], v[192:199], v4
    buffer_store_dwordx2 v[48:49], v5, s[8:11], s38 offen
    s_waitcnt lgkmcnt(1)
    v_smfmac_f32_16x16x64_bf16 v[44:47], v[32:35], v[10:17], v4
    v_cvt_pk_bf16_f32 v32, v40, v41
    v_smfmac_f32_16x16x64_bf16 v[44:47], v[36:39], v[200:207], v4
    s_waitcnt lgkmcnt(0)
    v_cvt_pk_bf16_f32 v33, v42, v43
    v_smfmac_f32_16x16x64_bf16 v[44:47], v[28:31], v[18:25], v4
    v_bfi_b32 v32, 1, s36, v32
    buffer_store_dwordx2 v[32:33], v5, s[8:11], s39 offen
    s_nop 3
    v_cvt_pk_bf16_f32 v28, v44, v45
    v_cvt_pk_bf16_f32 v29, v46, v47
    v_bfi_b32 v28, 1, s36, v28
    buffer_store_dwordx2 v[28:29], v5, s[8:11], s20 offen
    s_xor_b32 s41, s41, 16384
    s_add_u32 s23, s41, s17
    s_nop 1
    s_add_u32 s24, s41, s18
    s_add_u32 s42, s41, 4096
    s_nop 1
    s_add_u32 s43, s41, 8192
    s_mov_b32 s61, 1
    s_nop 1
    s_mov_b32 s13, 0
    s_add_u32 s44, s25, 442368
    s_nop 1
    s_add_u32 s25, s34, 2
    s_and_b32 s25, s25, 15
    s_nop 1
    s_lshl_b32 s25, s25, 19
    s_add_u32 s25, s25, s45
    s_nop 1
    s_add_u32 s46, s46, 9216
    s_add_u32 s34, s34, 1
    s_nop 1
    s_nop 3
    s_nop 3
    s_nop 3
    s_nop 3
    s_nop 3
    s_nop 3
    s_nop 3
    buffer_load_dwordx4 v[72:75], v1, s[8:11], s40 offen offset:0 sc1
    buffer_load_dwordx4 v[56:59], v1, s[8:11], s40 offen offset:1024 sc1
    v_bfe_u32 v31, v1, 6, 1
    v_lshlrev_b32 v31, 4, v31
    s_nop 1
    v_lshlrev_b32 v31, v31, s14
    s_lshl_b64 s[54:55], s[62:63], 0
    s_nop 1
    v_cndmask_b32 v28, 0, v31, s[54:55]
    s_lshl_b64 s[54:55], s[62:63], 1
    s_nop 1
    v_cndmask_b32 v29, 0, v31, s[54:55]
    s_lshl_b64 s[54:55], s[62:63], 2
    s_nop 1
    v_cndmask_b32 v30, 0, v31, s[54:55]
    s_lshl_b64 s[54:55], s[62:63], 3
    s_nop 1
    v_cndmask_b32 v31, 0, v31, s[54:55]
    buffer_load_dwordx4 v[68:71], v1, s[8:11], s40 offen offset:0 sc1
    buffer_load_dwordx4 v[64:67], v1, s[8:11], s40 offen offset:1024 sc1
    ds_read_b128 v[10:13], v0 offset:24576
    ds_read_b128 v[14:17], v0 offset:25600
    ds_read_b128 v[18:21], v0 offset:26624
    ds_read_b128 v[22:25], v0 offset:27648
T2_ac:
    s_waitcnt vmcnt(3)
    v_mfma_f32_16x16x32_bf16 v[32:35], v[28:31], v[72:75], 0
    s_waitcnt vmcnt(2)
    v_bitop3_b32 v76, v72, v74, s36 bitop3:0x7e
    v_mfma_f32_16x16x32_bf16 v[32:35], v[28:31], v[56:59], v[32:35]
    v_bitop3_b32 v36, v56, v58, s36 bitop3:0x7e
    v_bitop3_b32 v76, v76, v36, 1 bitop3:0xa8
    v_cmp_ne_u32 vcc, 0, v76
    s_nop 2
    s_cbranch_vccnz T2_ar
T2_ad:
    v_add_f32_dpp v32, v32, v32 row_ror:8 row_mask:0xf bank_mask:0xf
    v_add_f32_dpp v33, v33, v33 row_ror:8 row_mask:0xf bank_mask:0xf
    v_add_f32_dpp v34, v34, v34 row_ror:8 row_mask:0xf bank_mask:0xf
    v_add_f32_dpp v35, v35, v35 row_ror:8 row_mask:0xf bank_mask:0xf
    v_add_f32_dpp v32, v32, v32 row_ror:4 row_mask:0xf bank_mask:0xf
    v_add_f32_dpp v33, v33, v33 row_ror:4 row_mask:0xf bank_mask:0xf
    v_add_f32_dpp v34, v34, v34 row_ror:4 row_mask:0xf bank_mask:0xf
    v_add_f32_dpp v35, v35, v35 row_ror:4 row_mask:0xf bank_mask:0xf
    v_cvt_pk_bf16_f32 v32, v32, v33
    v_cvt_pk_bf16_f32 v33, v34, v35
    v_bfi_b32 v32, 1, s36, v32
    buffer_store_dwordx2 v[32:33], v6, s[8:11], s23 offen
    s_cmp_eq_u32 s34, 63
    s_cbranch_scc1 T2_al
T2_am:
    s_barrier
    v_mfma_f32_16x16x16_bf16 v[48:51], v[26:27], v[26:27], 0
    v_mfma_f32_16x16x16_bf16 v[52:55], v[26:27], v[26:27], 0
    v_mfma_f32_16x16x16_bf16 v[32:35], v[26:27], v[26:27], 0
    buffer_load_dwordx4 v[28:31], v7, s[8:11], s41 offen offset:2048 sc1
    v_mfma_f32_16x16x16_bf16 v[36:39], v[26:27], v[26:27], 0
    v_mfma_f32_16x16x16_bf16 v[40:43], v[26:27], v[26:27], 0
    buffer_load_dwordx4 v[60:63], v7, s[8:11], s42 offen offset:2048 sc1
    v_mfma_f32_16x16x16_bf16 v[44:47], v[26:27], v[26:27], 0
    s_nop 3
    s_nop 3
    s_nop 3
    buffer_load_dwordx4 v[28:31], v7, s[8:11], s41 offen offset:2048 sc1
    s_nop 3
    s_nop 3
    buffer_load_dwordx4 v[60:63], v7, s[8:11], s42 offen offset:2048 sc1
    s_waitcnt lgkmcnt(0)
    s_branch T2_chk
T2_br:
    buffer_load_dwordx4 v[28:31], v7, s[8:11], s41 offen offset:2048 sc1
    buffer_load_dwordx4 v[60:63], v7, s[8:11], s42 offen offset:2048 sc1
T2_brq:
    s_add_u32 s13, s13, 1
    s_and_b32 s56, s13, 63
    s_cbranch_scc1 T2_brq_nw
    s_sub_u32 s35, s35, 1
    s_cmp_eq_u32 s35, 0
    s_cbranch_scc1 L_end
    buffer_wbl2 sc1
    s_waitcnt vmcnt(0)
    buffer_inv sc1
T2_brq_nw:
    s_branch T2_chk
T2_b1r:
    buffer_load_dwordx4 v[60:63], v7, s[8:11], s42 offen offset:2048 sc1
T2_b1q:
    s_add_u32 s13, s13, 1
    s_and_b32 s56, s13, 127
    s_cbranch_scc1 T2_b1q_nw
    s_sub_u32 s35, s35, 1
    s_cmp_eq_u32 s35, 0
    s_cbranch_scc1 L_end
    buffer_wbl2 sc1
    s_waitcnt vmcnt(0)
    buffer_inv sc1
T2_b1q_nw:
    s_waitcnt vmcnt(1)
    v_bitop3_b32 v76, v60, v62, s36 bitop3:0x7e
    v_and_b32 v76, s61, v76
    v_cmp_ne_u32 vcc, 0, v76
    s_cbranch_vccnz T2_b1r
    s_branch T2_b1c
T2_al:
    buffer_store_dwordx2 v[32:33], v6, s[8:11], s23 offen sc1
    s_branch T2_am
T2_sr:
    s_nop 7
    v_max3_f32 v36, v76, v77, v78
    v_max3_f32 v36, v36, v79, v45
    s_nop 1
    v_max_f32_dpp v36, v36, v36 quad_perm:[2,3,0,1] row_mask:0xf bank_mask:0xf
    v_mov_b32 v37, v36
    s_nop 1
    v_permlane16_swap_b32 v36, v37
    v_max_f32 v36, v36, v37
    v_mov_b32 v37, v36
    s_nop 1
    v_permlane32_swap_b32 v36, v37
    v_max_f32 v36, v36, v37
    v_sub_f32 v76, v76, v36
    v_sub_f32 v77, v77, v36
    v_sub_f32 v78, v78, v36
    v_sub_f32 v79, v79, v36
    v_sub_f32 v45, v45, v36
    v_exp_f32 v76, v76
    v_exp_f32 v77, v77
    v_exp_f32 v78, v78
    v_exp_f32 v79, v79
    v_exp_f32 v45, v45
    v_cvt_pk_bf16_f32 v40, v76, v77
    v_cvt_pk_bf16_f32 v42, v78, v79
    v_cvt_pk_bf16_f32 v41, v45, 0
    v_mov_b32 v43, 0
    s_nop 1
    v_permlane32_swap_b32 v41, v43
    v_mov_b64 v[28:29], 0
    v_mov_b64 v[30:31], 0
    v_mov_b64 v[32:33], 0
    v_mov_b64 v[34:35], 0
    v_mfma_f32_16x16x32_bf16 v[36:39], v[40:43], v[68:71], 0
    v_smfmac_f32_16x16x64_bf16 v[28:31], v[40:43], v[56:63], v4 abid:1
    v_smfmac_f32_16x16x64_bf16 v[32:35], v[40:43], v[62:69], v4 abid:1
    s_nop 5
    v_add_f32 v36, v36, v38
    v_add_f32 v37, v37, v39
    v_rcp_f32 v38, v36
    v_rcp_f32 v39, v37
    v_pk_add_f32 v[28:29], v[28:29], v[30:31]
    v_pk_add_f32 v[32:33], v[32:33], v[34:35]
    v_pk_mul_f32 v[28:29], v[28:29], v[38:39]
    v_pk_mul_f32 v[32:33], v[32:33], v[38:39]
    v_cvt_pk_bf16_f32 v30, v28, v32
    v_cvt_pk_bf16_f32 v31, v29, v33
    ds_write2_b32 v8, v30, v31 offset0:0 offset1:4
    s_waitcnt lgkmcnt(0)
    s_branch T2_sc
T2_ar:
    buffer_load_dwordx4 v[72:75], v1, s[8:11], s40 offen offset:0 sc1
    buffer_load_dwordx4 v[56:59], v1, s[8:11], s40 offen offset:1024 sc1
    s_waitcnt vmcnt(2)
    v_mfma_f32_16x16x32_bf16 v[32:35], v[28:31], v[68:71], 0
    v_bitop3_b32 v76, v68, v70, s36 bitop3:0x7e
    v_mfma_f32_16x16x32_bf16 v[32:35], v[28:31], v[64:67], v[32:35]
    v_bitop3_b32 v36, v64, v66, s36 bitop3:0x7e
    v_bitop3_b32 v76, v76, v36, 1 bitop3:0xa8
    v_cmp_ne_u32 vcc, 0, v76
    s_nop 3
    s_cbranch_vccz T2_ad
    buffer_load_dwordx4 v[68:71], v1, s[8:11], s40 offen offset:0 sc1
    buffer_load_dwordx4 v[64:67], v1, s[8:11], s40 offen offset:1024 sc1
T2_aq:
    s_add_u32 s13, s13, 1
    s_and_b32 s56, s13, 31
    s_cbranch_scc1 T2_aq_nw
    s_sub_u32 s35, s35, 1
    s_cmp_eq_u32 s35, 0
    s_cbranch_scc1 L_end
    buffer_wbl2 sc1
    s_waitcnt vmcnt(0)
    buffer_inv sc1
T2_aq_nw:
    s_waitcnt vmcnt(2)
    s_branch T2_ac
.p2align 6
T3_chk:
    s_waitcnt vmcnt(3)
    v_bitop3_b32 v76, v28, v30, s36 bitop3:0x7e
    v_and_b32 v76, 1, v76
    v_cmp_ne_u32 vcc, 0, v76
    s_cbranch_vccnz T3_br
T3_head:
    v_smfmac_f32_16x16x64_bf16 v[32:35], v[28:31], v[10:17], v4
    ds_write_b128 v1, v[28:31] offset:3072
    v_smfmac_f32_16x16x64_bf16 v[40:43], v[28:31], v[18:25], v4
    ds_read_b128 v[10:13], v0 offset:20480
    v_smfmac_f32_16x16x64_bf16 v[36:39], v[28:31], a[0:7], v4
    ds_read_b128 v[14:17], v0 offset:21504
    v_smfmac_f32_16x16x64_bf16 v[44:47], v[28:31], a[8:15], v4
    s_waitcnt vmcnt(2)
    v_bitop3_b32 v76, v60, v62, s36 bitop3:0x7e
    v_smfmac_f32_16x16x64_bf16 v[48:51], v[28:31], a[16:23], v4
    s_waitcnt lgkmcnt(2)
    v_and_b32 v76, s61, v76
    v_cmp_ne_u32 vcc, 0, v76
    v_smfmac_f32_16x16x64_bf16 v[52:55], v[28:31], a[24:31], v4
    s_cbranch_vccnz T3_b1r
T3_b1c:
    s_barrier
    v_smfmac_f32_16x16x64_bf16 v[32:35], v[60:63], a[32:39], v4
    ds_read_b128 v[64:67], v1 offset:0
    buffer_load_dwordx4 v[68:71], v7, s[8:11], s43 offen sc1
    v_smfmac_f32_16x16x64_bf16 v[40:43], v[60:63], a[40:47], v4
    ds_write_b128 v1, v[60:63] offset:7168
    v_smfmac_f32_16x16x64_bf16 v[36:39], v[60:63], a[48:55], v4
    ds_read_b128 v[18:21], v0 offset:22528
    v_smfmac_f32_16x16x64_bf16 v[44:47], v[60:63], a[56:63], v4
    ds_read_b128 v[56:59], v1 offset:1024
    s_waitcnt lgkmcnt(3)
    v_smfmac_f32_16x16x64_bf16 v[32:35], v[64:67], a[80:87], v4
    ds_read_b128 v[22:25], v0 offset:23552
    v_smfmac_f32_16x16x64_bf16 v[40:43], v[64:67], a[88:95], v4
    buffer_load_dwordx4 v[28:31], v1, s[8:11], s44 offen sc1
    v_smfmac_f32_16x16x64_bf16 v[36:39], v[64:67], a[96:103], v4
    ds_read_b128 v[72:75], v1 offset:2048
    v_smfmac_f32_16x16x64_bf16 v[44:47], v[64:67], a[104:111], v4
    s_waitcnt lgkmcnt(2)
    s_barrier
    v_smfmac_f32_16x16x64_bf16 v[32:35], v[56:59], v[10:17], v4
    ds_read_b128 v[10:13], v0 offset:28672
    s_waitcnt lgkmcnt(2)
    v_smfmac_f32_16x16x64_bf16 v[40:43], v[56:59], v[18:25], v4
    ds_read_b128 v[64:67], v1 offset:4096
    v_smfmac_f32_16x16x64_bf16 v[36:39], v[56:59], a[128:135], v4
    buffer_load_dwordx4 v1, s[8:11], s44 offen offset:1024 sc1 lds
    v_smfmac_f32_16x16x64_bf16 v[44:47], v[56:59], a[136:143], v4
    ds_read_b128 v[14:17], v0 offset:29696
    s_waitcnt lgkmcnt(3)
    v_smfmac_f32_16x16x64_bf16 v[32:35], v[72:75], a[160:167], v4
    ds_read_b128 v[18:21], v0 offset:30720
    s_waitcnt vmcnt(2)
    v_bitop3_b32 v76, v68, v70, s36 bitop3:0x7e
    v_smfmac_f32_16x16x64_bf16 v[40:43], v[72:75], a[168:175], v4
    ds_read_b128 v[22:25], v0 offset:31744
    v_and_b32 v76, s61, v76
    v_cmp_ne_u32 vcc, 0, v76
    v_smfmac_f32_16x16x64_bf16 v[36:39], v[72:75], a[176:183], v4
    buffer_load_dwordx4 v[60:63], v1, s[8:11], s44 offen offset:2048 sc1
    v_smfmac_f32_16x16x64_bf16 v[44:47], v[72:75], a[184:191], v4
    s_cbranch_vccnz T3_b8r
T3_b8c:
    ds_write_b128 v1, v[68:71] offset:8192
    s_waitcnt lgkmcnt(3)
    v_smfmac_f32_16x16x64_bf16 v[32:35], v[64:67], v[10:17], v4
    ds_read_b128 v[72:75], v1 offset:5120
    s_waitcnt lgkmcnt(2)
    v_smfmac_f32_16x16x64_bf16 v[40:43], v[64:67], v[18:25], v4
    ds_read_b128 v[76:79], v1 offset:6144
    v_smfmac_f32_16x16x64_bf16 v[36:39], v[64:67], a[208:215], v4
    buffer_load_dwordx4 v[56:59], v1, s[8:11], s44 offen offset:3072 sc1
    v_smfmac_f32_16x16x64_bf16 v[44:47], v[64:67], a[216:223], v4
    s_waitcnt lgkmcnt(2)
    s_barrier
    s_waitcnt lgkmcnt(1)
    v_smfmac_f32_16x16x64_bf16 v[32:35], v[72:75], a[224:231], v4
    ds_read_b128 v[10:13], v0 offset:32768
    ds_read_b128 v[68:71], v1 offset:8192
    s_waitcnt lgkmcnt(2)
    v_lshlrev_b32 v26, 2, v1
    v_smfmac_f32_16x16x64_bf16 v[32:35], v[76:79], v[96:103], v4
    ds_read_b128 v[14:17], v0 offset:33792
    v_smfmac_f32_16x16x64_bf16 v[36:39], v[72:75], a[240:247], v4
    ds_read_b128 v[18:21], v0 offset:34816
    v_smfmac_f32_16x16x64_bf16 v[36:39], v[76:79], v[112:119], v4
    ds_read_b128 v[22:25], v0 offset:35840
    s_waitcnt lgkmcnt(3)
    v_smfmac_f32_16x16x64_bf16 v[32:35], v[68:71], v[144:151], v4
    buffer_load_dword v9, v26, s[8:11], s25 offen sc1
    s_waitcnt lgkmcnt(2)
    v_smfmac_f32_16x16x64_bf16 v[36:39], v[68:71], v[10:17], v4
    ds_read_b128 v[10:13], v0 offset:16384
    v_smfmac_f32_16x16x64_bf16 v[40:43], v[72:75], a[232:239], v4
    ds_read_b128 v[14:17], v0 offset:17408
    v_add_f32 v32, v32, v34
    v_smfmac_f32_16x16x64_bf16 v[40:43], v[76:79], v[104:111], v4
    v_add_f32 v33, v33, v35
    v_smfmac_f32_16x16x64_bf16 v[40:43], v[68:71], v[152:159], v4
    v_cvt_pk_bf16_f32 v26, v32, v33
    v_smfmac_f32_16x16x64_bf16 v[44:47], v[72:75], a[248:255], v4
    s_waitcnt vmcnt(3)
    ds_read_b128 v[32:35], v1 offset:12288
    v_add_f32 v36, v36, v38
    v_smfmac_f32_16x16x64_bf16 v[44:47], v[76:79], v[120:127], v4
    s_waitcnt lgkmcnt(1)
    v_add_f32 v37, v37, v39
    v_smfmac_f32_16x16x64_bf16 v[44:47], v[68:71], v[18:25], v4
    v_cvt_pk_bf16_f32 v27, v36, v37
    v_add_f32 v40, v40, v42
    v_add_f32 v41, v41, v43
    v_mfma_f32_16x16x16_bf16 v[36:39], v[26:27], v[2:3], 0
    v_cvt_pk_bf16_f32 v26, v40, v41
    s_cmp_eq_u32 s34, 63
    v_add_f32 v44, v44, v46
    v_add_f32 v45, v45, v47
    v_cvt_pk_bf16_f32 v27, v44, v45
    ds_read_b128 v[22:25], v0 offset:19456
    s_mov_b64 vcc, s[50:51]
    v_mfma_f32_16x16x16_bf16 v[40:43], v[26:27], v[2:3], 0
    v_cvt_pk_bf16_f32 v36, v36, v37
    v_cvt_pk_bf16_f32 v37, v38, v39
    v_smfmac_f32_16x16x64_bf16 v[48:51], v[72:75], v[80:87], v4
    ds_read_b128 v[18:21], v0 offset:18432
    v_smfmac_f32_16x16x64_bf16 v[52:55], v[72:75], v[88:95], v4
    ds_read_b128 v[44:47], v1 offset:7168
    v_cvt_pk_bf16_f32 v38, v40, v41
    v_cvt_pk_bf16_f32 v39, v42, v43
    s_nop 1
    v_mfma_f32_16x16x32_bf16 v[40:43], v[36:39], v[36:39], 0
    v_mfma_f32_16x16x32_bf16 v[72:75], v[28:31], v[36:39], 0
    s_waitcnt vmcnt(1)
    s_waitcnt lgkmcnt(2)
    v_mov_b64 v[66:67], v[58:59]
    v_mfma_f32_16x16x32_bf16 v[28:31], v[32:35], v[36:39], 0
    s_cbranch_scc1 L_team_done
    v_cndmask_b32_dpp v26, v43, v42, vcc quad_perm:[0,1,0,1] row_mask:0xf bank_mask:0xf
    v_mul_f32 v26, s48, v26
    v_smfmac_f32_16x16x64_bf16 v[48:51], v[76:79], v[128:135], v4
    ds_write_b32 v1, v26 offset:13324
    v_smfmac_f32_16x16x64_bf16 v[52:55], v[76:79], v[136:143], v4
    ds_read_b128 v[32:35], v1 offset:0
    v_cndmask_b32_dpp v72, v28, v72, vcc quad_perm:[0,1,0,1] row_mask:0xf bank_mask:0xf
    v_cndmask_b32_dpp v73, v29, v73, vcc quad_perm:[0,1,0,1] row_mask:0xf bank_mask:0xf
    v_cndmask_b32_dpp v74, v30, v74, vcc quad_perm:[0,1,0,1] row_mask:0xf bank_mask:0xf
    v_cndmask_b32_dpp v75, v31, v75, vcc quad_perm:[0,1,0,1] row_mask:0xf bank_mask:0xf
    ds_write_b128 v1, v[72:75] offset:12288
    v_smfmac_f32_16x16x64_bf16 v[48:51], v[68:71], v[10:17], v4
    ds_read_b128 v[28:31], v1 offset:1024
    s_waitcnt lgkmcnt(4)
    v_smfmac_f32_16x16x64_bf16 v[52:55], v[68:71], v[18:25], v4
    ds_read_b128 v[10:13], v0 offset:12288
    v_mov_b64 v[26:27], 0
    v_smfmac_f32_16x16x64_bf16 v[48:51], v[44:47], a[64:71], v4
    s_waitcnt lgkmcnt(2)
    s_barrier
    ds_read_b128 v[36:39], v1 offset:13312
    v_smfmac_f32_16x16x64_bf16 v[52:55], v[44:47], a[72:79], v4
    ds_read_b128 v[68:71], v1 offset:9216
    ds_read_b128 v[76:79], v1 offset:10240
    v_smfmac_f32_16x16x64_bf16 v[48:51], v[32:35], a[112:119], v4
    ds_read_b128 v[40:43], v1 offset:11264
    ds_read_b128 v[44:47], v1 offset:2048
    v_smfmac_f32_16x16x64_bf16 v[52:55], v[32:35], a[120:127], v4
    ds_read_b128 v[32:35], v1 offset:4096
    s_waitcnt lgkmcnt(6)
    v_smfmac_f32_16x16x64_bf16 v[48:51], v[28:31], a[144:151], v4
    ds_read_b128 v[14:17], v0 offset:13312
    s_waitcnt lgkmcnt(6)
    v_add_f32 v36, v36, v37
    v_smfmac_f32_16x16x64_bf16 v[52:55], v[28:31], a[152:159], v4
    ds_read_b128 v[18:21], v0 offset:14336
    v_add_f32 v38, v38, v39
    s_waitcnt lgkmcnt(5)
    v_add_f32 v72, v72, v68
    v_add_f32 v73, v73, v69
    s_waitcnt lgkmcnt(3)
    v_smfmac_f32_16x16x64_bf16 v[48:51], v[44:47], a[192:199], v4
    ds_read_b128 v[22:25], v0 offset:15360
    v_add_f32 v74, v74, v70
    v_add_f32 v75, v75, v71
    v_smfmac_f32_16x16x64_bf16 v[52:55], v[44:47], a[200:207], v4
    v_add_f32 v44, v36, v38
    v_add_f32 v76, v76, v40
    s_waitcnt lgkmcnt(2)
    v_smfmac_f32_16x16x64_bf16 v[48:51], v[32:35], v[10:17], v4
    ds_read_b128 v[10:13], v0 offset:0
    v_add_f32 v77, v77, v41
    v_add_f32 v78, v78, v42
    s_waitcnt lgkmcnt(1)
    v_smfmac_f32_16x16x64_bf16 v[52:55], v[32:35], v[18:25], v4
    ds_read_b128 v[14:17], v0 offset:1024
    v_add_f32 v79, v79, v43
    v_exp_f32 v28, v44
    v_mov_b32 v39, 0
    v_pk_add_f32 v[72:73], v[72:73], v[76:77]
    v_pk_add_f32 v[74:75], v[74:75], v[78:79]
    v_cvt_pk_bf16_f32 v37, v28, 0
    v_pk_add_f32 v[48:49], v[48:49], v[50:51]
    v_pk_add_f32 v[52:53], v[52:53], v[54:55]
    v_mfma_f32_16x16x16_bf16 v[28:31], v[26:27], v[26:27], 0
    v_exp_f32 v40, v72
    v_exp_f32 v41, v73
    v_mfma_f32_16x16x16_bf16 v[32:35], v[26:27], v[26:27], 0
    v_permlane32_swap_b32 v37, v39
    v_exp_f32 v42, v74
    v_exp_f32 v43, v75
    v_mov_b64 v[68:69], s[52:53]
    v_mov_b64 v[70:71], s[52:53]
    v_cvt_pk_bf16_f32 v36, v40, v41
    v_cvt_pk_bf16_f32 v38, v42, v43
    v_cvt_pk_bf16_f32 v58, v48, v49
    v_cvt_pk_bf16_f32 v64, v52, v53
    v_mfma_f32_16x16x32_bf16 v[40:43], v[36:39], v[68:71], 0
    ds_read_b128 v[18:21], v0 offset:2048
    v_smfmac_f32_16x16x64_bf16 v[28:31], v[36:39], v[56:63], v4 abid:1
    ds_read_b128 v[22:25], v0 offset:3072
    v_smfmac_f32_16x16x64_bf16 v[32:35], v[36:39], v[62:69], v4 abid:1
    v_add_f32 v40, v40, v42
    v_add_f32 v41, v41, v43
    v_rcp_f32 v42, v40
    v_rcp_f32 v43, v41
    v_pk_add_f32 v[28:29], v[28:29], v[30:31]
    v_pk_add_f32 v[32:33], v[32:33], v[34:35]
    v_pk_mul_f32 v[28:29], v[28:29], v[42:43]
    v_pk_mul_f32 v[32:33], v[32:33], v[42:43]
    v_cvt_pk_bf16_f32 v30, v28, v32
    v_cvt_pk_bf16_f32 v31, v29, v33
    ds_write2_b32 v8, v30, v31 offset0:0 offset1:4
    v_mfma_f32_16x16x16_bf16 v[76:79], v[26:27], v[26:27], 0
    v_max3_f32 v45, v40, v41, v42
    v_max_f32 v45, v45, v43
    v_cmp_nle_f32 vcc, v45, s3
    v_mfma_f32_16x16x16_bf16 v[52:55], v[26:27], v[26:27], 0
    v_xor_b32 v45, 32, v1
    s_xor_b32 s37, s37, 294912
    s_bfe_u32 s36, s34, 0x10001
    v_mfma_f32_16x16x16_bf16 v[48:51], v[26:27], v[26:27], 0
    s_xor_b32 s36, s36, 1
    s_cbranch_vccnz T3_sr
T3_sc:
    s_waitcnt lgkmcnt(0)
    s_barrier
    ds_read_b128 v[56:59], v1 offset:14336
    ds_read_b128 v[32:35], v1 offset:15360
    v_mfma_f32_16x16x16_bf16 v[40:43], v[26:27], v[26:27], 0
    ds_read_b128 v[36:39], v45 offset:14336
    ds_read_b128 v[28:31], v45 offset:15360
    v_mfma_f32_16x16x16_bf16 v[44:47], v[26:27], v[26:27], 0
    v_lshrrev_b32 v60, 1, v5
    s_add_u32 s21, s37, 0x40000
    s_waitcnt lgkmcnt(3)
    v_smfmac_f32_16x16x64_bf16 v[52:55], v[56:59], v[240:247], v4
    s_add_u32 s38, s37, 0x10000
    s_add_u32 s39, s37, 0x20000
    s_add_u32 s20, s37, 0x30000
    s_waitcnt lgkmcnt(2)
    v_smfmac_f32_16x16x64_bf16 v[52:55], v[32:35], v[248:255], v4
    s_add_u32 s40, s37, s49
    s_add_u32 s22, s37, s19
    v_smfmac_f32_16x16x64_bf16 v[76:79], v[56:59], v[10:17], v4
    ds_read_b128 v[10:13], v0 offset:4096
    v_smfmac_f32_16x16x64_bf16 v[76:79], v[32:35], v[208:215], v4
    ds_read_b128 v[14:17], v0 offset:5120
    v_add_f32 v52, v52, v54
    v_add_f32 v53, v53, v55
    s_waitcnt lgkmcnt(2)
    v_smfmac_f32_16x16x64_bf16 v[76:79], v[36:39], v[18:25], v4
    ds_read_b128 v[18:21], v0 offset:6144
    v_cvt_pk_bf16_f32 v52, v52, v53
    v_smfmac_f32_16x16x64_bf16 v[76:79], v[28:31], v[216:223], v4
    ds_read_b128 v[22:25], v0 offset:7168
    v_bfi_b32 v52, 1, s36, v52
    v_smfmac_f32_16x16x64_bf16 v[48:51], v[56:59], v[160:167], v4
    buffer_store_dword v52, v60, s[8:11], s21 offen
    s_waitcnt lgkmcnt(2)
    v_smfmac_f32_16x16x64_bf16 v[48:51], v[32:35], v[10:17], v4
    ds_read_b128 v[10:13], v0 offset:8192
    v_cvt_pk_bf16_f32 v52, v76, v77
    v_smfmac_f32_16x16x64_bf16 v[48:51], v[36:39], v[168:175], v4
    ds_read_b128 v[14:17], v0 offset:9216
    s_waitcnt lgkmcnt(2)
    v_cvt_pk_bf16_f32 v53, v78, v79
    v_smfmac_f32_16x16x64_bf16 v[48:51], v[28:31], v[18:25], v4
    ds_read_b128 v[18:21], v0 offset:10240
    v_bfi_b32 v52, 1, s36, v52
    v_smfmac_f32_16x16x64_bf16 v[40:43], v[56:59], v[176:183], v4
    buffer_store_dwordx2 v[52:53], v5, s[8:11], s37 offen
    v_smfmac_f32_16x16x64_bf16 v[40:43], v[32:35], v[224:231], v4
    ds_read_b128 v[22:25], v0 offset:11264
    v_cvt_pk_bf16_f32 v48, v48, v49
    v_smfmac_f32_16x16x64_bf16 v[40:43], v[36:39], v[184:191], v4
    v_cvt_pk_bf16_f32 v49, v50, v51
    v_smfmac_f32_16x16x64_bf16 v[40:43], v[28:31], v[232:239], v4
    v_bfi_b32 v48, 1, s36, v48
    v_smfmac_f32_16x16x64_bf16 v[44:47], v[56:59], v[192:199], v4
    buffer_store_dwordx2 v[48:49], v5, s[8:11], s38 offen
    s_waitcnt lgkmcnt(1)
    v_smfmac_f32_16x16x64_bf16 v[44:47], v[32:35], v[10:17], v4
    v_cvt_pk_bf16_f32 v32, v40, v41
    v_smfmac_f32_16x16x64_bf16 v[44:47], v[36:39], v[200:207], v4
    s_waitcnt lgkmcnt(0)
    v_cvt_pk_bf16_f32 v33, v42, v43
    v_smfmac_f32_16x16x64_bf16 v[44:47], v[28:31], v[18:25], v4
    v_bfi_b32 v32, 1, s36, v32
    buffer_store_dwordx2 v[32:33], v5, s[8:11], s39 offen
    s_nop 3
    v_cvt_pk_bf16_f32 v28, v44, v45
    v_cvt_pk_bf16_f32 v29, v46, v47
    v_bfi_b32 v28, 1, s36, v28
    buffer_store_dwordx2 v[28:29], v5, s[8:11], s20 offen
    v_mfma_f32_16x16x16_bf16 v[32:35], v[26:27], v[26:27], v[32:35]
    s_xor_b32 s41, s41, 16384
    s_add_u32 s23, s41, s17
    v_mfma_f32_16x16x16_bf16 v[32:35], v[26:27], v[26:27], v[32:35]
    s_add_u32 s24, s41, s18
    s_add_u32 s42, s41, 4096
    v_mfma_f32_16x16x16_bf16 v[32:35], v[26:27], v[26:27], v[32:35]
    s_add_u32 s43, s41, 8192
    s_mov_b32 s61, 1
    v_mfma_f32_16x16x16_bf16 v[32:35], v[26:27], v[26:27], v[32:35]
    s_mov_b32 s13, 0
    s_add_u32 s44, s25, 442368
    v_mfma_f32_16x16x16_bf16 v[32:35], v[26:27], v[26:27], v[32:35]
    s_add_u32 s25, s34, 2
    s_and_b32 s25, s25, 15
    v_mfma_f32_16x16x16_bf16 v[32:35], v[26:27], v[26:27], v[32:35]
    s_lshl_b32 s25, s25, 19
    s_add_u32 s25, s25, s45
    v_mfma_f32_16x16x16_bf16 v[32:35], v[26:27], v[26:27], v[32:35]
    s_add_u32 s46, s46, 9216
    s_add_u32 s34, s34, 1
    v_mfma_f32_16x16x16_bf16 v[32:35], v[26:27], v[26:27], v[32:35]
    v_mfma_f32_16x16x16_bf16 v[32:35], v[26:27], v[26:27], v[32:35]
    v_mfma_f32_16x16x16_bf16 v[32:35], v[26:27], v[26:27], v[32:35]
    v_mfma_f32_16x16x16_bf16 v[32:35], v[26:27], v[26:27], v[32:35]
    v_mfma_f32_16x16x16_bf16 v[32:35], v[26:27], v[26:27], v[32:35]
    v_mfma_f32_16x16x16_bf16 v[32:35], v[26:27], v[26:27], v[32:35]
    v_mfma_f32_16x16x16_bf16 v[32:35], v[26:27], v[26:27], v[32:35]
    v_mfma_f32_16x16x16_bf16 v[32:35], v[26:27], v[26:27], v[32:35]
    v_mfma_f32_16x16x16_bf16 v[32:35], v[26:27], v[26:27], v[32:35]
    buffer_load_dwordx4 v[72:75], v1, s[8:11], s40 offen offset:0 sc1
    buffer_load_dwordx4 v[56:59], v1, s[8:11], s40 offen offset:1024 sc1
    v_mfma_f32_16x16x16_bf16 v[32:35], v[26:27], v[26:27], v[32:35]
    v_bfe_u32 v31, v1, 6, 1
    v_lshlrev_b32 v31, 4, v31
    v_mfma_f32_16x16x16_bf16 v[32:35], v[26:27], v[26:27], v[32:35]
    v_lshlrev_b32 v31, v31, s14
    s_lshl_b64 s[54:55], s[62:63], 0
    v_mfma_f32_16x16x16_bf16 v[32:35], v[26:27], v[26:27], v[32:35]
    v_cndmask_b32 v28, 0, v31, s[54:55]
    s_lshl_b64 s[54:55], s[62:63], 1
    v_cndmask_b32 v29, 0, v31, s[54:55]
    s_lshl_b64 s[54:55], s[62:63], 2
    v_cndmask_b32 v30, 0, v31, s[54:55]
    s_lshl_b64 s[54:55], s[62:63], 3
    v_cndmask_b32 v31, 0, v31, s[54:55]
    buffer_load_dwordx4 v[68:71], v1, s[8:11], s40 offen offset:0 sc1
    buffer_load_dwordx4 v[64:67], v1, s[8:11], s40 offen offset:1024 sc1
    v_mfma_f32_16x16x16_bf16 v[32:35], v[26:27], v[26:27], v[32:35]
    ds_read_b128 v[10:13], v0 offset:24576
    ds_read_b128 v[14:17], v0 offset:25600
    v_mfma_f32_16x16x16_bf16 v[32:35], v[26:27], v[26:27], v[32:35]
    ds_read_b128 v[18:21], v0 offset:26624
    ds_read_b128 v[22:25], v0 offset:27648
    v_mfma_f32_16x16x16_bf16 v[32:35], v[26:27], v[26:27], v[32:35]
    v_mfma_f32_16x16x16_bf16 v[32:35], v[26:27], v[26:27], v[32:35]
    v_mfma_f32_16x16x16_bf16 v[32:35], v[26:27], v[26:27], v[32:35]
    v_mfma_f32_16x16x16_bf16 v[32:35], v[26:27], v[26:27], v[32:35]
    v_mfma_f32_16x16x16_bf16 v[32:35], v[26:27], v[26:27], v[32:35]
T3_ac:
    s_waitcnt vmcnt(3)
    v_mfma_f32_16x16x32_bf16 v[32:35], v[28:31], v[72:75], 0
    s_waitcnt vmcnt(2)
    v_bitop3_b32 v76, v72, v74, s36 bitop3:0x7e
    v_mfma_f32_16x16x32_bf16 v[32:35], v[28:31], v[56:59], v[32:35]
    v_bitop3_b32 v36, v56, v58, s36 bitop3:0x7e
    v_bitop3_b32 v76, v76, v36, 1 bitop3:0xa8
    v_cmp_ne_u32 vcc, 0, v76
    s_nop 2
    s_cbranch_vccnz T3_ar
T3_ad:
    v_add_f32_dpp v32, v32, v32 row_ror:8 row_mask:0xf bank_mask:0xf
    v_add_f32_dpp v33, v33, v33 row_ror:8 row_mask:0xf bank_mask:0xf
    v_add_f32_dpp v34, v34, v34 row_ror:8 row_mask:0xf bank_mask:0xf
    v_add_f32_dpp v35, v35, v35 row_ror:8 row_mask:0xf bank_mask:0xf
    v_add_f32_dpp v32, v32, v32 row_ror:4 row_mask:0xf bank_mask:0xf
    v_add_f32_dpp v33, v33, v33 row_ror:4 row_mask:0xf bank_mask:0xf
    v_add_f32_dpp v34, v34, v34 row_ror:4 row_mask:0xf bank_mask:0xf
    v_add_f32_dpp v35, v35, v35 row_ror:4 row_mask:0xf bank_mask:0xf
    v_cvt_pk_bf16_f32 v32, v32, v33
    v_cvt_pk_bf16_f32 v33, v34, v35
    v_bfi_b32 v32, 1, s36, v32
    buffer_store_dwordx2 v[32:33], v6, s[8:11], s23 offen
    s_cmp_eq_u32 s34, 63
    s_cbranch_scc1 T3_al
T3_am:
    s_barrier
    v_mfma_f32_16x16x16_bf16 v[48:51], v[26:27], v[26:27], 0
    v_mfma_f32_16x16x16_bf16 v[52:55], v[26:27], v[26:27], 0
    v_mfma_f32_16x16x16_bf16 v[32:35], v[26:27], v[26:27], 0
    buffer_load_dwordx4 v[28:31], v7, s[8:11], s41 offen offset:3072 sc1
    v_mfma_f32_16x16x16_bf16 v[36:39], v[26:27], v[26:27], 0
    v_mfma_f32_16x16x16_bf16 v[40:43], v[26:27], v[26:27], 0
    buffer_load_dwordx4 v[60:63], v7, s[8:11], s42 offen offset:3072 sc1
    v_mfma_f32_16x16x16_bf16 v[44:47], v[26:27], v[26:27], 0
    v_mfma_f32_16x16x16_bf16 v[32:35], v[26:27], v[26:27], 0
    v_mfma_f32_16x16x16_bf16 v[36:39], v[26:27], v[26:27], 0
    v_mfma_f32_16x16x16_bf16 v[40:43], v[26:27], v[26:27], 0
    buffer_load_dwordx4 v[28:31], v7, s[8:11], s41 offen offset:3072 sc1
    v_mfma_f32_16x16x16_bf16 v[44:47], v[26:27], v[26:27], 0
    v_mfma_f32_16x16x16_bf16 v[32:35], v[26:27], v[26:27], 0
    buffer_load_dwordx4 v[60:63], v7, s[8:11], s42 offen offset:3072 sc1
    v_mfma_f32_16x16x16_bf16 v[36:39], v[26:27], v[26:27], 0
    v_mfma_f32_16x16x16_bf16 v[40:43], v[26:27], v[26:27], 0
    v_mfma_f32_16x16x16_bf16 v[44:47], v[26:27], v[26:27], 0
    v_mfma_f32_16x16x16_bf16 v[32:35], v[26:27], v[26:27], 0
    s_waitcnt lgkmcnt(0)
    s_branch T3_chk
T3_br:
    buffer_load_dwordx4 v[28:31], v7, s[8:11], s41 offen offset:3072 sc1
    buffer_load_dwordx4 v[60:63], v7, s[8:11], s42 offen offset:3072 sc1
T3_brq:
    s_add_u32 s13, s13, 1
    s_and_b32 s56, s13, 63
    s_cbranch_scc1 T3_brq_nw
    s_sub_u32 s35, s35, 1
    s_cmp_eq_u32 s35, 0
    s_cbranch_scc1 L_end
    buffer_wbl2 sc1
    s_waitcnt vmcnt(0)
    buffer_inv sc1
T3_brq_nw:
    s_branch T3_chk
T3_b1r:
    buffer_load_dwordx4 v[60:63], v7, s[8:11], s42 offen offset:3072 sc1
T3_b1q:
    s_add_u32 s13, s13, 1
    s_and_b32 s56, s13, 127
    s_cbranch_scc1 T3_b1q_nw
    s_sub_u32 s35, s35, 1
    s_cmp_eq_u32 s35, 0
    s_cbranch_scc1 L_end
    buffer_wbl2 sc1
    s_waitcnt vmcnt(0)
    buffer_inv sc1
T3_b1q_nw:
    s_waitcnt vmcnt(1)
    v_bitop3_b32 v76, v60, v62, s36 bitop3:0x7e
    v_and_b32 v76, s61, v76
    v_cmp_ne_u32 vcc, 0, v76
    s_cbranch_vccnz T3_b1r
    s_branch T3_b1c
T3_b8r:
    s_add_u32 s13, s13, 1
    s_and_b32 s56, s13, 31
    s_cbranch_scc1 T3_b8r_nw
    s_sub_u32 s35, s35, 1
    s_cmp_eq_u32 s35, 0
    s_cbranch_scc1 L_end
    buffer_wbl2 sc1
    s_waitcnt vmcnt(0)
    buffer_inv sc1
T3_b8r_nw:
    buffer_load_dwordx4 v[68:71], v7, s[8:11], s43 offen sc1
    s_waitcnt vmcnt(0)
    v_bitop3_b32 v76, v68, v70, s36 bitop3:0x7e
    v_and_b32 v76, s61, v76
    v_cmp_ne_u32 vcc, 0, v76
    s_cbranch_vccnz T3_b8r
    s_branch T3_b8c
T3_al:
    buffer_store_dwordx2 v[32:33], v6, s[8:11], s23 offen sc1
    s_branch T3_am
T3_sr:
    s_nop 7
    v_max3_f32 v40, v72, v73, v74
    v_max3_f32 v40, v40, v75, v44
    s_nop 1
    v_max_f32_dpp v40, v40, v40 quad_perm:[2,3,0,1] row_mask:0xf bank_mask:0xf
    v_mov_b32 v41, v40
    s_nop 1
    v_permlane16_swap_b32 v40, v41
    v_max_f32 v40, v40, v41
    v_mov_b32 v41, v40
    s_nop 1
    v_permlane32_swap_b32 v40, v41
    v_max_f32 v40, v40, v41
    v_sub_f32 v72, v72, v40
    v_sub_f32 v73, v73, v40
    v_sub_f32 v74, v74, v40
    v_sub_f32 v75, v75, v40
    v_sub_f32 v44, v44, v40
    v_exp_f32 v72, v72
    v_exp_f32 v73, v73
    v_exp_f32 v74, v74
    v_exp_f32 v75, v75
    v_exp_f32 v44, v44
    v_cvt_pk_bf16_f32 v36, v72, v73
    v_cvt_pk_bf16_f32 v38, v74, v75
    v_cvt_pk_bf16_f32 v37, v44, 0
    v_mov_b32 v39, 0
    s_nop 1
    v_permlane32_swap_b32 v37, v39
    v_mov_b64 v[28:29], 0
    v_mov_b64 v[30:31], 0
    v_mov_b64 v[32:33], 0
    v_mov_b64 v[34:35], 0
    v_mfma_f32_16x16x32_bf16 v[40:43], v[36:39], v[68:71], 0
    v_smfmac_f32_16x16x64_bf16 v[28:31], v[36:39], v[56:63], v4 abid:1
    v_smfmac_f32_16x16x64_bf16 v[32:35], v[36:39], v[62:69], v4 abid:1
    s_nop 5
    v_add_f32 v40, v40, v42
    v_add_f32 v41, v41, v43
    v_rcp_f32 v42, v40
    v_rcp_f32 v43, v41
    v_pk_add_f32 v[28:29], v[28:29], v[30:31]
    v_pk_add_f32 v[32:33], v[32:33], v[34:35]
    v_pk_mul_f32 v[28:29], v[28:29], v[42:43]
    v_pk_mul_f32 v[32:33], v[32:33], v[42:43]
    v_cvt_pk_bf16_f32 v30, v28, v32
    v_cvt_pk_bf16_f32 v31, v29, v33
    ds_write2_b32 v8, v30, v31 offset0:0 offset1:4
    s_waitcnt lgkmcnt(0)
    s_branch T3_sc
T3_ar:
    buffer_load_dwordx4 v[72:75], v1, s[8:11], s40 offen offset:0 sc1
    buffer_load_dwordx4 v[56:59], v1, s[8:11], s40 offen offset:1024 sc1
    s_waitcnt vmcnt(2)
    v_mfma_f32_16x16x32_bf16 v[32:35], v[28:31], v[68:71], 0
    v_bitop3_b32 v76, v68, v70, s36 bitop3:0x7e
    v_mfma_f32_16x16x32_bf16 v[32:35], v[28:31], v[64:67], v[32:35]
    v_bitop3_b32 v36, v64, v66, s36 bitop3:0x7e
    v_bitop3_b32 v76, v76, v36, 1 bitop3:0xa8
    v_cmp_ne_u32 vcc, 0, v76
    s_nop 3
    s_cbranch_vccz T3_ad
    buffer_load_dwordx4 v[68:71], v1, s[8:11], s40 offen offset:0 sc1
    buffer_load_dwordx4 v[64:67], v1, s[8:11], s40 offen offset:1024 sc1
T3_aq:
    s_add_u32 s13, s13, 1
    s_and_b32 s56, s13, 31
    s_cbranch_scc1 T3_aq_nw
    s_sub_u32 s35, s35, 1
    s_cmp_eq_u32 s35, 0
    s_cbranch_scc1 L_end
    buffer_wbl2 sc1
    s_waitcnt vmcnt(0)
    buffer_inv sc1
T3_aq_nw:
    s_waitcnt vmcnt(2)
    s_branch T3_ac
L_team_done:
    s_nop 7
    s_waitcnt vmcnt(0) lgkmcnt(0)
    s_barrier
    s_cmp_eq_u32 s96, 0
    s_cbranch_scc1 T_nh
    s_mov_b32 s36, 41
    s_branch R_h
T_nh:
    s_cmp_lg_u32 s96, 0
    s_cbranch_scc1 L_end
    s_mov_b32 s96, 1
    s_add_u32 s8, s8, 100663296
    s_addc_u32 s9, s9, 0
    s_mov_b32 s10, 167772160
    s_branch T_again
T_again:
    s_cmp_eq_u32 s32, 0
    s_cbranch_scc1 T0_layer
    s_cmp_eq_u32 s32, 1
    s_cbranch_scc1 T1_layer
    s_cmp_eq_u32 s32, 2
    s_cbranch_scc1 T2_layer
    s_branch T3_layer
L_end:
    s_waitcnt vmcnt(0)
L_exit:
    s_endpgm
.p2align 8
fin_kernel:
    s_cmp_ge_u32 s2, 256
    s_cbranch_scc1 F_exit
    s_load_dwordx2 s[4:5], s[0:1], 96
    s_load_dwordx4 s[24:27], s[0:1], 72
    v_lshrrev_b32 v8, 6, v0
    v_and_b32 v0, 63, v0
    s_and_b32 s33, s2, 7
    s_lshl_b32 s33, s33, 2
    s_bfe_u32 s34, s2, 0x20003
    s_add_u32 s33, s33, s34
    v_readfirstlane_b32 s32, v8
    s_lshr_b32 s12, s2, 5
    s_mov_b32 s95, 400000
    s_lshl_b32 s35, s32, 2
    s_lshr_b32 s14, 0x76664440, s35
    s_and_b32 s14, s14, 7
    s_lshr_b32 s34, 0x04326577, s35
    s_and_b32 s34, s34, 7
    s_lshl_b32 s13, s34, 3
    s_add_u32 s13, s13, s12
    v_lshlrev_b32 v1, 4, v0
    v_and_b32 v6, 31, v0
    v_lshlrev_b32 v5, 2, v6
    s_waitcnt lgkmcnt(0)
    s_add_u32 s4, s4, 100663296
    s_addc_u32 s5, s5, 0
    s_mov_b32 s8, s4
    s_mov_b32 s9, s5
    s_mov_b32 s10, 167772160
    s_mov_b32 s11, 0x00020000
    s_mov_b32 s16, s24
    s_mov_b32 s17, s25
    s_mov_b32 s18, 663552
    s_mov_b32 s19, 0x00020000
    s_mov_b32 s20, s26
    s_mov_b32 s21, s27
    s_mov_b32 s22, 2359296
    s_mov_b32 s23, 0x00020000
    v_mov_b64 v[20:21], 0
    v_mov_b64 v[22:23], 0
    v_mov_b64 v[24:25], 0
    v_mov_b64 v[26:27], 0
    v_mov_b64 v[28:29], 0
    v_mov_b64 v[30:31], 0
    s_lshl_b32 s34, s33, 6
    s_add_u32 s34, s34, s13
    s_lshl_b32 s35, s34, 10
    s_add_u32 s35, s35, 83886080
    s_lshl_b32 s36, s34, 7
    s_add_u32 s36, s36, 88080384
    s_mul_i32 s34, s34, 3072
    s_add_u32 s34, s34, 20971520
    buffer_load_dwordx4 v[8:11], v1, s[8:11], s35 offen
    buffer_load_dword v19, v5, s[8:11], s36 offen
    s_cmp_lt_u32 s32, 2
    s_cbranch_scc1 F_np
    buffer_load_dwordx4 v[20:23], v1, s[8:11], s34 offen offset:0
    buffer_load_dwordx4 v[24:27], v1, s[8:11], s34 offen offset:1024
    buffer_load_dwordx4 v[28:31], v1, s[8:11], s34 offen offset:2048
    s_cmp_lg_u32 s32, 6
    s_cbranch_scc1 F_np
    s_add_u32 s34, s34, 73728
    buffer_load_dwordx4 v[36:39], v1, s[8:11], s34 offen offset:0
    buffer_load_dwordx4 v[40:43], v1, s[8:11], s34 offen offset:1024
    buffer_load_dwordx4 v[44:47], v1, s[8:11], s34 offen offset:2048
F_np:
    s_lshl_b32 s37, s32, 10
    s_lshl_b32 s34, s33, 16
    s_add_u32 s34, s34, 85983232
    s_add_u32 s34, s34, s37
    s_lshl_b32 s36, s33, 13
    s_add_u32 s36, s36, 88342528
    s_add_u32 s36, s36, s37
    s_mul_i32 s39, s33, 77824
    s_add_u32 s40, s39, 89128960
    s_add_u32 s39, s40, s37
    s_add_u32 m0, s37, 65536
    s_add_u32 s41, s36, 0
    buffer_load_dwordx4 v1, s[8:11], s41 offen lds
    s_add_u32 m0, s37, 0
    s_add_u32 s41, s34, 0
    buffer_load_dwordx4 v1, s[8:11], s41 offen lds
    s_add_u32 m0, s37, 73728
    s_add_u32 s41, s39, 0
    buffer_load_dwordx4 v1, s[8:11], s41 offen lds
    s_add_u32 m0, s37, 32768
    s_add_u32 s41, s34, 32768
    buffer_load_dwordx4 v1, s[8:11], s41 offen lds
    s_add_u32 m0, s37, 112640
    s_add_u32 s41, s39, 38912
    buffer_load_dwordx4 v1, s[8:11], s41 offen lds
    s_add_u32 m0, s37, 49152
    s_add_u32 s41, s34, 49152
    buffer_load_dwordx4 v1, s[8:11], s41 offen lds
    s_add_u32 m0, s37, 132096
    s_add_u32 s41, s39, 58368
    buffer_load_dwordx4 v1, s[8:11], s41 offen lds
    s_add_u32 m0, s37, 57344
    s_add_u32 s41, s34, 57344
    buffer_load_dwordx4 v1, s[8:11], s41 offen lds
    s_add_u32 m0, s37, 141824
    s_add_u32 s41, s39, 68096
    buffer_load_dwordx4 v1, s[8:11], s41 offen lds
    s_mul_i32 s38, s32, 9728
    s_add_u32 s38, s38, 8192
    s_add_u32 s40, s40, s38
    s_add_u32 m0, s38, 73728
    s_add_u32 s41, s40, 0
    buffer_load_dwordx4 v1, s[8:11], s41 offen lds
    s_add_u32 m0, s38, 74752
    s_add_u32 s41, s40, 1024
    buffer_load_dwordx4 v1, s[8:11], s41 offen lds
    s_mov_b32 s43, s34
    s_mul_i32 s47, s33, 43
    s_lshr_b32 s47, s47, 7
    s_mul_i32 s46, s47, 3
    s_sub_u32 s46, s33, s46
    s_mul_i32 s46, s46, 6
    s_max_u32 s48, s32, 2
    s_add_u32 s46, s46, s48
    s_sub_u32 s46, s46, 2
    s_lshl_b32 s47, s47, 3
    s_add_u32 s47, s47, s12
    s_mul_i32 s47, s47, 36864
    s_mul_i32 s48, s46, 36864
    s_add_u32 s48, s48, 29360128
    s_cmp_lt_u32 s32, 2
    s_cselect_b32 s48, 0x40000000, s48
    s_cmp_ge_u32 s33, 24
    s_cselect_b32 s48, 0x40000000, s48
    v_lshlrev_b32 v2, 2, v0
    v_add_u32 v2, 65536, v2
    v_lshrrev_b32 v7, 5, v0
    v_mul_u32_u24 v7, 304, v7
    v_lshl_add_u32 v7, v6, 4, v7
    v_cmp_lt_u32 vcc, 18, v6
    v_mov_b32 v6, 0x40000000
    s_nop 0
    v_cndmask_b32 v7, v7, v6, vcc
    v_add_u32 v3, 73728, v7
    v_mov_b32 v4, 0xdddd
    s_mov_b32 s28, -1
    s_mov_b32 s29, 0
    s_lshl_b32 s42, s14, 13
    v_add_u32 v96, s42, v1
    s_lshl_b32 s42, s14, 10
    v_add_u32 v97, s42, v2
    s_mul_i32 s42, s14, 9728
    v_add_u32 v98, s42, v3
    v_mov_b32 v13, 0
    v_mov_b32 v15, 0
    v_mov_b32 v16, 0
    v_mov_b32 v18, 0
    s_waitcnt vmcnt(11)
    v_cndmask_b32 v12, 0, v19, s[28:29]
    v_cndmask_b32 v17, 0, v19, s[28:29]
    v_cndmask_b32 v19, v19, 0, s[28:29]
    v_mov_b32 v14, v19
    s_cmp_lg_u32 s32, 6
    s_cbranch_scc1 F_n2
    v_add_f32 v20, v20, v36
    v_add_f32 v21, v21, v37
    v_add_f32 v22, v22, v38
    v_add_f32 v23, v23, v39
    v_add_f32 v24, v24, v40
    v_add_f32 v25, v25, v41
    v_add_f32 v26, v26, v42
    v_add_f32 v27, v27, v43
    v_add_f32 v28, v28, v44
    v_add_f32 v29, v29, v45
    v_add_f32 v30, v30, v46
    v_add_f32 v31, v31, v47
F_n2:
    s_waitcnt vmcnt(0)
    s_barrier
    s_add_u32 m0, s37, 8192
    s_add_u32 s41, s43, 8192
    buffer_load_dwordx4 v1, s[8:11], s41 offen lds
    s_add_u32 m0, s37, 83456
    s_add_u32 s41, s39, 9728
    buffer_load_dwordx4 v1, s[8:11], s41 offen lds
    s_add_u32 m0, s37, 40960
    s_add_u32 s41, s43, 40960
    buffer_load_dwordx4 v1, s[8:11], s41 offen lds
    s_add_u32 m0, s37, 122368
    s_add_u32 s41, s39, 48640
    buffer_load_dwordx4 v1, s[8:11], s41 offen lds
    s_cmp_eq_u32 s32, 7
    s_cbranch_scc1 F_w7
    s_cmp_ge_u32 s32, 4
    s_cbranch_scc1 F_w4
    ds_read_b128 v[68:71], v96 offset:0
    ds_read2st64_b32 v[76:77], v97 offset0:0 offset1:1
    ds_read_b128 v[72:75], v96 offset:1024
    ds_read_b128 v[80:83], v98 offset:0
    ds_read_b128 v[84:87], v98 offset:608
    s_waitcnt lgkmcnt(4)
    v_mfma_f32_32x32x16_bf16 v[36:51], v[68:71], v[8:11], 0
    s_waitcnt lgkmcnt(3)
    v_mfma_f32_32x32x8_bf16 v[36:51], v[76:77], v[12:13], v[36:51]
    s_nop 11
    v_exp_f32 v36, v36
    v_exp_f32 v37, v37
    ds_read_b128 v[88:91], v98 offset:1216
    v_exp_f32 v38, v38
    v_exp_f32 v39, v39
    v_exp_f32 v40, v40
    v_exp_f32 v41, v41
    s_waitcnt lgkmcnt(3)
    v_mfma_f32_32x32x16_bf16 v[52:67], v[72:75], v[8:11], 0
    ds_read_b128 v[68:71], v96 offset:2048
    v_exp_f32 v42, v42
    v_exp_f32 v43, v43
    s_add_u32 m0, s37, 16384
    s_add_u32 s41, s43, 16384
    buffer_load_dwordx4 v1, s[8:11], s41 offen lds
    v_exp_f32 v44, v44
    v_exp_f32 v45, v45
    v_mfma_f32_32x32x8_bf16 v[52:67], v[76:77], v[14:15], v[52:67]
    v_exp_f32 v46, v46
    v_exp_f32 v47, v47
    v_exp_f32 v48, v48
    v_exp_f32 v49, v49
    s_waitcnt lgkmcnt(3)
    v_smfmac_f32_32x32x32_bf16 v[20:35], v[80:83], v[36:43], v4
    ds_read_b128 v[92:95], v98 offset:1824
    v_exp_f32 v50, v50
    v_exp_f32 v51, v51
    s_add_u32 m0, s37, 93184
    s_add_u32 s41, s39, 19456
    buffer_load_dwordx4 v1, s[8:11], s41 offen lds
    v_exp_f32 v52, v52
    v_exp_f32 v53, v53
    s_waitcnt lgkmcnt(3)
    v_smfmac_f32_32x32x32_bf16 v[20:35], v[84:87], v[44:51], v4
    ds_read_b128 v[80:83], v98 offset:2432
    v_exp_f32 v54, v54
    v_exp_f32 v55, v55
    v_exp_f32 v56, v56
    v_exp_f32 v57, v57
    s_waitcnt lgkmcnt(2)
    v_mfma_f32_32x32x16_bf16 v[36:51], v[68:71], v[8:11], 0
    ds_read_b128 v[72:75], v96 offset:3072
    v_exp_f32 v58, v58
    v_exp_f32 v59, v59
    s_add_u32 m0, s37, 24576
    s_add_u32 s41, s43, 24576
    buffer_load_dwordx4 v1, s[8:11], s41 offen lds
    v_exp_f32 v60, v60
    v_exp_f32 v61, v61
    v_mfma_f32_32x32x8_bf16 v[36:51], v[76:77], v[16:17], v[36:51]
    ds_read2st64_b32 v[78:79], v97 offset0:2 offset1:3
    v_exp_f32 v62, v62
    v_exp_f32 v63, v63
    v_exp_f32 v64, v64
    v_exp_f32 v65, v65
    v_smfmac_f32_32x32x32_bf16 v[20:35], v[88:91], v[52:59], v4
    ds_read_b128 v[84:87], v98 offset:3040
    v_exp_f32 v66, v66
    v_exp_f32 v67, v67
    s_add_u32 m0, s37, 102912
    s_add_u32 s41, s39, 29184
    buffer_load_dwordx4 v1, s[8:11], s41 offen lds
    v_exp_f32 v36, v36
    v_exp_f32 v37, v37
    s_waitcnt lgkmcnt(4)
    v_smfmac_f32_32x32x32_bf16 v[20:35], v[92:95], v[60:67], v4
    ds_read_b128 v[88:91], v98 offset:3648
    v_exp_f32 v38, v38
    v_exp_f32 v39, v39
    v_exp_f32 v40, v40
    v_exp_f32 v41, v41
    s_waitcnt lgkmcnt(3)
    v_mfma_f32_32x32x16_bf16 v[52:67], v[72:75], v[8:11], 0
    ds_read_b128 v[68:71], v96 offset:4096
    v_exp_f32 v42, v42
    v_exp_f32 v43, v43
    v_exp_f32 v44, v44
    v_exp_f32 v45, v45
    v_mfma_f32_32x32x8_bf16 v[52:67], v[76:77], v[18:19], v[52:67]
    v_exp_f32 v46, v46
    v_exp_f32 v47, v47
    v_exp_f32 v48, v48
    v_exp_f32 v49, v49
    v_smfmac_f32_32x32x32_bf16 v[20:35], v[80:83], v[36:43], v4
    ds_read_b128 v[92:95], v98 offset:4256
    v_exp_f32 v50, v50
    v_exp_f32 v51, v51
    v_exp_f32 v52, v52
    v_exp_f32 v53, v53
    s_waitcnt lgkmcnt(3)
    v_smfmac_f32_32x32x32_bf16 v[20:35], v[84:87], v[44:51], v4
    ds_read_b128 v[80:83], v98 offset:4864
    v_exp_f32 v54, v54
    v_exp_f32 v55, v55
    v_exp_f32 v56, v56
    v_exp_f32 v57, v57
    s_waitcnt lgkmcnt(2)
    v_mfma_f32_32x32x16_bf16 v[36:51], v[68:71], v[8:11], 0
    ds_read_b128 v[72:75], v96 offset:5120
    v_exp_f32 v58, v58
    v_exp_f32 v59, v59
    v_exp_f32 v60, v60
    v_exp_f32 v61, v61
    v_mfma_f32_32x32x8_bf16 v[36:51], v[78:79], v[12:13], v[36:51]
    v_exp_f32 v62, v62
    v_exp_f32 v63, v63
    v_exp_f32 v64, v64
    v_exp_f32 v65, v65
    v_smfmac_f32_32x32x32_bf16 v[20:35], v[88:91], v[52:59], v4
    ds_read_b128 v[84:87], v98 offset:5472
    v_exp_f32 v66, v66
    v_exp_f32 v67, v67
    v_exp_f32 v36, v36
    v_exp_f32 v37, v37
    s_waitcnt lgkmcnt(3)
    v_smfmac_f32_32x32x32_bf16 v[20:35], v[92:95], v[60:67], v4
    ds_read_b128 v[88:91], v98 offset:6080
    v_exp_f32 v38, v38
    v_exp_f32 v39, v39
    v_exp_f32 v40, v40
    v_exp_f32 v41, v41
    s_waitcnt lgkmcnt(2)
    v_mfma_f32_32x32x16_bf16 v[52:67], v[72:75], v[8:11], 0
    ds_read_b128 v[68:71], v96 offset:6144
    v_exp_f32 v42, v42
    v_exp_f32 v43, v43
    v_exp_f32 v44, v44
    v_exp_f32 v45, v45
    v_mfma_f32_32x32x8_bf16 v[52:67], v[78:79], v[14:15], v[52:67]
    v_exp_f32 v46, v46
    v_exp_f32 v47, v47
    v_exp_f32 v48, v48
    v_exp_f32 v49, v49
    v_smfmac_f32_32x32x32_bf16 v[20:35], v[80:83], v[36:43], v4
    ds_read_b128 v[92:95], v98 offset:6688
    v_exp_f32 v50, v50
    v_exp_f32 v51, v51
    v_exp_f32 v52, v52
    v_exp_f32 v53, v53
    s_waitcnt lgkmcnt(3)
    v_smfmac_f32_32x32x32_bf16 v[20:35], v[84:87], v[44:51], v4
    ds_read_b128 v[80:83], v98 offset:7296
    v_exp_f32 v54, v54
    v_exp_f32 v55, v55
    v_exp_f32 v56, v56
    v_exp_f32 v57, v57
    s_waitcnt lgkmcnt(2)
    v_mfma_f32_32x32x16_bf16 v[36:51], v[68:71], v[8:11], 0
    ds_read_b128 v[72:75], v96 offset:7168
    v_exp_f32 v58, v58
    v_exp_f32 v59, v59
    v_exp_f32 v60, v60
    v_exp_f32 v61, v61
    v_mfma_f32_32x32x8_bf16 v[36:51], v[78:79], v[16:17], v[36:51]
    ds_read2st64_b32 v[76:77], v97 offset0:4 offset1:5
    v_exp_f32 v62, v62
    v_exp_f32 v63, v63
    v_exp_f32 v64, v64
    v_exp_f32 v65, v65
    v_smfmac_f32_32x32x32_bf16 v[20:35], v[88:91], v[52:59], v4
    ds_read_b128 v[84:87], v98 offset:7904
    v_exp_f32 v66, v66
    v_exp_f32 v67, v67
    s_waitcnt vmcnt(0)
    s_barrier
    v_exp_f32 v36, v36
    v_exp_f32 v37, v37
    s_waitcnt lgkmcnt(4)
    v_smfmac_f32_32x32x32_bf16 v[20:35], v[92:95], v[60:67], v4
    ds_read_b128 v[88:91], v98 offset:8512
    v_exp_f32 v38, v38
    v_exp_f32 v39, v39
    v_exp_f32 v40, v40
    v_exp_f32 v41, v41
    s_waitcnt lgkmcnt(3)
    v_mfma_f32_32x32x16_bf16 v[52:67], v[72:75], v[8:11], 0
    ds_read_b128 v[68:71], v96 offset:8192
    v_exp_f32 v42, v42
    v_exp_f32 v43, v43
    buffer_load_dwordx4 a[0:3], v1, s[8:11], s48 offen offset:0
    v_exp_f32 v44, v44
    v_exp_f32 v45, v45
    v_mfma_f32_32x32x8_bf16 v[52:67], v[78:79], v[18:19], v[52:67]
    v_exp_f32 v46, v46
    v_exp_f32 v47, v47
    v_exp_f32 v48, v48
    v_exp_f32 v49, v49
    v_smfmac_f32_32x32x32_bf16 v[20:35], v[80:83], v[36:43], v4
    ds_read_b128 v[92:95], v98 offset:9120
    v_exp_f32 v50, v50
    v_exp_f32 v51, v51
    buffer_load_dwordx4 a[4:7], v1, s[8:11], s48 offen offset:1024
    v_exp_f32 v52, v52
    v_exp_f32 v53, v53
    s_waitcnt lgkmcnt(3)
    v_smfmac_f32_32x32x32_bf16 v[20:35], v[84:87], v[44:51], v4
    ds_read_b128 v[80:83], v98 offset:9728
    v_exp_f32 v54, v54
    v_exp_f32 v55, v55
    v_exp_f32 v56, v56
    v_exp_f32 v57, v57
    s_waitcnt lgkmcnt(2)
    v_mfma_f32_32x32x16_bf16 v[36:51], v[68:71], v[8:11], 0
    ds_read_b128 v[72:75], v96 offset:9216
    v_exp_f32 v58, v58
    v_exp_f32 v59, v59
    buffer_load_dwordx4 a[8:11], v1, s[8:11], s48 offen offset:2048
    v_exp_f32 v60, v60
    v_exp_f32 v61, v61
    v_mfma_f32_32x32x8_bf16 v[36:51], v[76:77], v[12:13], v[36:51]
    v_exp_f32 v62, v62
    v_exp_f32 v63, v63
    v_exp_f32 v64, v64
    v_exp_f32 v65, v65
    v_smfmac_f32_32x32x32_bf16 v[20:35], v[88:91], v[52:59], v4
    ds_read_b128 v[84:87], v98 offset:10336
    v_exp_f32 v66, v66
    v_exp_f32 v67, v67
    buffer_load_dwordx4 a[12:15], v1, s[8:11], s48 offen offset:3072
    s_add_u32 s48, s48, 4096
    v_exp_f32 v36, v36
    v_exp_f32 v37, v37
    s_waitcnt lgkmcnt(3)
    v_smfmac_f32_32x32x32_bf16 v[20:35], v[92:95], v[60:67], v4
    ds_read_b128 v[88:91], v98 offset:10944
    v_exp_f32 v38, v38
    v_exp_f32 v39, v39
    v_exp_f32 v40, v40
    v_exp_f32 v41, v41
    s_waitcnt lgkmcnt(2)
    v_mfma_f32_32x32x16_bf16 v[52:67], v[72:75], v[8:11], 0
    ds_read_b128 v[68:71], v96 offset:10240
    v_exp_f32 v42, v42
    v_exp_f32 v43, v43
    buffer_load_dwordx4 a[16:19], v1, s[8:11], s48 offen offset:0
    v_exp_f32 v44, v44
    v_exp_f32 v45, v45
    v_mfma_f32_32x32x8_bf16 v[52:67], v[76:77], v[14:15], v[52:67]
    v_exp_f32 v46, v46
    v_exp_f32 v47, v47
    v_exp_f32 v48, v48
    v_exp_f32 v49, v49
    v_smfmac_f32_32x32x32_bf16 v[20:35], v[80:83], v[36:43], v4
    ds_read_b128 v[92:95], v98 offset:11552
    v_exp_f32 v50, v50
    v_exp_f32 v51, v51
    buffer_load_dwordx4 a[20:23], v1, s[8:11], s48 offen offset:1024
    v_exp_f32 v52, v52
    v_exp_f32 v53, v53
    s_waitcnt lgkmcnt(3)
    v_smfmac_f32_32x32x32_bf16 v[20:35], v[84:87], v[44:51], v4
    ds_read_b128 v[80:83], v98 offset:12160
    v_exp_f32 v54, v54
    v_exp_f32 v55, v55
    v_exp_f32 v56, v56
    v_exp_f32 v57, v57
    s_waitcnt lgkmcnt(2)
    v_mfma_f32_32x32x16_bf16 v[36:51], v[68:71], v[8:11], 0
    ds_read_b128 v[72:75], v96 offset:11264
    v_exp_f32 v58, v58
    v_exp_f32 v59, v59
    buffer_load_dwordx4 a[24:27], v1, s[8:11], s48 offen offset:2048
    v_exp_f32 v60, v60
    v_exp_f32 v61, v61
    v_mfma_f32_32x32x8_bf16 v[36:51], v[76:77], v[16:17], v[36:51]
    ds_read2st64_b32 v[78:79], v97 offset0:6 offset1:7
    v_exp_f32 v62, v62
    v_exp_f32 v63, v63
    v_exp_f32 v64, v64
    v_exp_f32 v65, v65
    v_smfmac_f32_32x32x32_bf16 v[20:35], v[88:91], v[52:59], v4
    ds_read_b128 v[84:87], v98 offset:12768
    v_exp_f32 v66, v66
    v_exp_f32 v67, v67
    buffer_load_dwordx4 a[28:31], v1, s[8:11], s48 offen offset:3072
    s_add_u32 s48, s48, 4096
    v_exp_f32 v36, v36
    v_exp_f32 v37, v37
    s_waitcnt lgkmcnt(4)
    v_smfmac_f32_32x32x32_bf16 v[20:35], v[92:95], v[60:67], v4
    ds_read_b128 v[88:91], v98 offset:13376
    v_exp_f32 v38, v38
    v_exp_f32 v39, v39
    v_exp_f32 v40, v40
    v_exp_f32 v41, v41
    s_waitcnt lgkmcnt(3)
    v_mfma_f32_32x32x16_bf16 v[52:67], v[72:75], v[8:11], 0
    ds_read_b128 v[68:71], v96 offset:12288
    v_exp_f32 v42, v42
    v_exp_f32 v43, v43
    buffer_load_dwordx4 a[32:35], v1, s[8:11], s48 offen offset:0
    v_exp_f32 v44, v44
    v_exp_f32 v45, v45
    v_mfma_f32_32x32x8_bf16 v[52:67], v[76:77], v[18:19], v[52:67]
    v_exp_f32 v46, v46
    v_exp_f32 v47, v47
    v_exp_f32 v48, v48
    v_exp_f32 v49, v49
    v_smfmac_f32_32x32x32_bf16 v[20:35], v[80:83], v[36:43], v4
    ds_read_b128 v[92:95], v98 offset:13984
    v_exp_f32 v50, v50
    v_exp_f32 v51, v51
    buffer_load_dwordx4 a[36:39], v1, s[8:11], s48 offen offset:1024
    v_exp_f32 v52, v52
    v_exp_f32 v53, v53
    s_waitcnt lgkmcnt(3)
    v_smfmac_f32_32x32x32_bf16 v[20:35], v[84:87], v[44:51], v4
    ds_read_b128 v[80:83], v98 offset:14592
    v_exp_f32 v54, v54
    v_exp_f32 v55, v55
    v_exp_f32 v56, v56
    v_exp_f32 v57, v57
    s_waitcnt lgkmcnt(2)
    v_mfma_f32_32x32x16_bf16 v[36:51], v[68:71], v[8:11], 0
    ds_read_b128 v[72:75], v96 offset:13312
    v_exp_f32 v58, v58
    v_exp_f32 v59, v59
    buffer_load_dwordx4 a[40:43], v1, s[8:11], s48 offen offset:2048
    v_exp_f32 v60, v60
    v_exp_f32 v61, v61
    v_mfma_f32_32x32x8_bf16 v[36:51], v[78:79], v[12:13], v[36:51]
    v_exp_f32 v62, v62
    v_exp_f32 v63, v63
    v_exp_f32 v64, v64
    v_exp_f32 v65, v65
    v_smfmac_f32_32x32x32_bf16 v[20:35], v[88:91], v[52:59], v4
    ds_read_b128 v[84:87], v98 offset:15200
    v_exp_f32 v66, v66
    v_exp_f32 v67, v67
    buffer_load_dwordx4 a[44:47], v1, s[8:11], s48 offen offset:3072
    s_add_u32 s48, s48, 4096
    v_exp_f32 v36, v36
    v_exp_f32 v37, v37
    s_waitcnt lgkmcnt(3)
    v_smfmac_f32_32x32x32_bf16 v[20:35], v[92:95], v[60:67], v4
    ds_read_b128 v[88:91], v98 offset:15808
    v_exp_f32 v38, v38
    v_exp_f32 v39, v39
    v_exp_f32 v40, v40
    v_exp_f32 v41, v41
    s_waitcnt lgkmcnt(2)
    v_mfma_f32_32x32x16_bf16 v[52:67], v[72:75], v[8:11], 0
    ds_read_b128 v[68:71], v96 offset:14336
    v_exp_f32 v42, v42
    v_exp_f32 v43, v43
    buffer_load_dwordx4 a[48:51], v1, s[8:11], s48 offen offset:0
    v_exp_f32 v44, v44
    v_exp_f32 v45, v45
    v_mfma_f32_32x32x8_bf16 v[52:67], v[78:79], v[14:15], v[52:67]
    v_exp_f32 v46, v46
    v_exp_f32 v47, v47
    v_exp_f32 v48, v48
    v_exp_f32 v49, v49
    v_smfmac_f32_32x32x32_bf16 v[20:35], v[80:83], v[36:43], v4
    ds_read_b128 v[92:95], v98 offset:16416
    v_exp_f32 v50, v50
    v_exp_f32 v51, v51
    buffer_load_dwordx4 a[52:55], v1, s[8:11], s48 offen offset:1024
    v_exp_f32 v52, v52
    v_exp_f32 v53, v53
    s_waitcnt lgkmcnt(3)
    v_smfmac_f32_32x32x32_bf16 v[20:35], v[84:87], v[44:51], v4
    ds_read_b128 v[80:83], v98 offset:17024
    v_exp_f32 v54, v54
    v_exp_f32 v55, v55
    v_exp_f32 v56, v56
    v_exp_f32 v57, v57
    s_waitcnt lgkmcnt(2)
    v_mfma_f32_32x32x16_bf16 v[36:51], v[68:71], v[8:11], 0
    ds_read_b128 v[72:75], v96 offset:15360
    v_exp_f32 v58, v58
    v_exp_f32 v59, v59
    buffer_load_dwordx4 a[56:59], v1, s[8:11], s48 offen offset:2048
    v_exp_f32 v60, v60
    v_exp_f32 v61, v61
    v_mfma_f32_32x32x8_bf16 v[36:51], v[78:79], v[16:17], v[36:51]
    ds_read2st64_b32 v[76:77], v97 offset0:8 offset1:9
    v_exp_f32 v62, v62
    v_exp_f32 v63, v63
    v_exp_f32 v64, v64
    v_exp_f32 v65, v65
    v_smfmac_f32_32x32x32_bf16 v[20:35], v[88:91], v[52:59], v4
    ds_read_b128 v[84:87], v98 offset:17632
    v_exp_f32 v66, v66
    v_exp_f32 v67, v67
    buffer_load_dwordx4 a[60:63], v1, s[8:11], s48 offen offset:3072
    s_add_u32 s48, s48, 4096
    v_exp_f32 v36, v36
    v_exp_f32 v37, v37
    s_waitcnt lgkmcnt(4)
    v_smfmac_f32_32x32x32_bf16 v[20:35], v[92:95], v[60:67], v4
    ds_read_b128 v[88:91], v98 offset:18240
    v_exp_f32 v38, v38
    v_exp_f32 v39, v39
    v_exp_f32 v40, v40
    v_exp_f32 v41, v41
    s_waitcnt lgkmcnt(3)
    v_mfma_f32_32x32x16_bf16 v[52:67], v[72:75], v[8:11], 0
    ds_read_b128 v[68:71], v96 offset:16384
    v_exp_f32 v42, v42
    v_exp_f32 v43, v43
    buffer_load_dwordx4 a[64:67], v1, s[8:11], s48 offen offset:0
    v_exp_f32 v44, v44
    v_exp_f32 v45, v45
    v_mfma_f32_32x32x8_bf16 v[52:67], v[78:79], v[18:19], v[52:67]
    v_exp_f32 v46, v46
    v_exp_f32 v47, v47
    v_exp_f32 v48, v48
    v_exp_f32 v49, v49
    v_smfmac_f32_32x32x32_bf16 v[20:35], v[80:83], v[36:43], v4
    ds_read_b128 v[92:95], v98 offset:18848
    v_exp_f32 v50, v50
    v_exp_f32 v51, v51
    buffer_load_dwordx4 a[68:71], v1, s[8:11], s48 offen offset:1024
    v_exp_f32 v52, v52
    v_exp_f32 v53, v53
    s_waitcnt lgkmcnt(3)
    v_smfmac_f32_32x32x32_bf16 v[20:35], v[84:87], v[44:51], v4
    ds_read_b128 v[80:83], v98 offset:19456
    v_exp_f32 v54, v54
    v_exp_f32 v55, v55
    v_exp_f32 v56, v56
    v_exp_f32 v57, v57
    s_waitcnt lgkmcnt(2)
    v_mfma_f32_32x32x16_bf16 v[36:51], v[68:71], v[8:11], 0
    ds_read_b128 v[72:75], v96 offset:17408
    v_exp_f32 v58, v58
    v_exp_f32 v59, v59
    buffer_load_dwordx4 a[72:75], v1, s[8:11], s48 offen offset:2048
    v_exp_f32 v60, v60
    v_exp_f32 v61, v61
    v_mfma_f32_32x32x8_bf16 v[36:51], v[76:77], v[12:13], v[36:51]
    v_exp_f32 v62, v62
    v_exp_f32 v63, v63
    v_exp_f32 v64, v64
    v_exp_f32 v65, v65
    v_smfmac_f32_32x32x32_bf16 v[20:35], v[88:91], v[52:59], v4
    ds_read_b128 v[84:87], v98 offset:20064
    v_exp_f32 v66, v66
    v_exp_f32 v67, v67
    buffer_load_dwordx4 a[76:79], v1, s[8:11], s48 offen offset:3072
    s_add_u32 s48, s48, 4096
    v_exp_f32 v36, v36
    v_exp_f32 v37, v37
    s_waitcnt lgkmcnt(3)
    v_smfmac_f32_32x32x32_bf16 v[20:35], v[92:95], v[60:67], v4
    ds_read_b128 v[88:91], v98 offset:20672
    v_exp_f32 v38, v38
    v_exp_f32 v39, v39
    v_exp_f32 v40, v40
    v_exp_f32 v41, v41
    s_waitcnt lgkmcnt(2)
    v_mfma_f32_32x32x16_bf16 v[52:67], v[72:75], v[8:11], 0
    ds_read_b128 v[68:71], v96 offset:18432
    v_exp_f32 v42, v42
    v_exp_f32 v43, v43
    buffer_load_dwordx4 a[80:83], v1, s[8:11], s48 offen offset:0
    v_exp_f32 v44, v44
    v_exp_f32 v45, v45
    v_mfma_f32_32x32x8_bf16 v[52:67], v[76:77], v[14:15], v[52:67]
    v_exp_f32 v46, v46
    v_exp_f32 v47, v47
    v_exp_f32 v48, v48
    v_exp_f32 v49, v49
    v_smfmac_f32_32x32x32_bf16 v[20:35], v[80:83], v[36:43], v4
    ds_read_b128 v[92:95], v98 offset:21280
    v_exp_f32 v50, v50
    v_exp_f32 v51, v51
    buffer_load_dwordx4 a[84:87], v1, s[8:11], s48 offen offset:1024
    v_exp_f32 v52, v52
    v_exp_f32 v53, v53
    s_waitcnt lgkmcnt(3)
    v_smfmac_f32_32x32x32_bf16 v[20:35], v[84:87], v[44:51], v4
    ds_read_b128 v[80:83], v98 offset:21888
    v_exp_f32 v54, v54
    v_exp_f32 v55, v55
    v_exp_f32 v56, v56
    v_exp_f32 v57, v57
    s_waitcnt lgkmcnt(2)
    v_mfma_f32_32x32x16_bf16 v[36:51], v[68:71], v[8:11], 0
    ds_read_b128 v[72:75], v96 offset:19456
    v_exp_f32 v58, v58
    v_exp_f32 v59, v59
    buffer_load_dwordx4 a[88:91], v1, s[8:11], s48 offen offset:2048
    v_exp_f32 v60, v60
    v_exp_f32 v61, v61
    v_mfma_f32_32x32x8_bf16 v[36:51], v[76:77], v[16:17], v[36:51]
    ds_read2st64_b32 v[78:79], v97 offset0:10 offset1:11
    v_exp_f32 v62, v62
    v_exp_f32 v63, v63
    v_exp_f32 v64, v64
    v_exp_f32 v65, v65
    v_smfmac_f32_32x32x32_bf16 v[20:35], v[88:91], v[52:59], v4
    ds_read_b128 v[84:87], v98 offset:22496
    v_exp_f32 v66, v66
    v_exp_f32 v67, v67
    buffer_load_dwordx4 a[92:95], v1, s[8:11], s48 offen offset:3072
    s_add_u32 s48, s48, 4096
    v_exp_f32 v36, v36
    v_exp_f32 v37, v37
    s_waitcnt lgkmcnt(4)
    v_smfmac_f32_32x32x32_bf16 v[20:35], v[92:95], v[60:67], v4
    ds_read_b128 v[88:91], v98 offset:23104
    v_exp_f32 v38, v38
    v_exp_f32 v39, v39
    v_exp_f32 v40, v40
    v_exp_f32 v41, v41
    s_waitcnt lgkmcnt(3)
    v_mfma_f32_32x32x16_bf16 v[52:67], v[72:75], v[8:11], 0
    ds_read_b128 v[68:71], v96 offset:20480
    v_exp_f32 v42, v42
    v_exp_f32 v43, v43
    buffer_load_dwordx4 a[96:99], v1, s[8:11], s48 offen offset:0
    v_exp_f32 v44, v44
    v_exp_f32 v45, v45
    v_mfma_f32_32x32x8_bf16 v[52:67], v[76:77], v[18:19], v[52:67]
    v_exp_f32 v46, v46
    v_exp_f32 v47, v47
    v_exp_f32 v48, v48
    v_exp_f32 v49, v49
    v_smfmac_f32_32x32x32_bf16 v[20:35], v[80:83], v[36:43], v4
    ds_read_b128 v[92:95], v98 offset:23712
    v_exp_f32 v50, v50
    v_exp_f32 v51, v51
    buffer_load_dwordx4 a[100:103], v1, s[8:11], s48 offen offset:1024
    v_exp_f32 v52, v52
    v_exp_f32 v53, v53
    s_waitcnt lgkmcnt(3)
    v_smfmac_f32_32x32x32_bf16 v[20:35], v[84:87], v[44:51], v4
    ds_read_b128 v[80:83], v98 offset:24320
    v_exp_f32 v54, v54
    v_exp_f32 v55, v55
    v_exp_f32 v56, v56
    v_exp_f32 v57, v57
    s_waitcnt lgkmcnt(2)
    v_mfma_f32_32x32x16_bf16 v[36:51], v[68:71], v[8:11], 0
    ds_read_b128 v[72:75], v96 offset:21504
    v_exp_f32 v58, v58
    v_exp_f32 v59, v59
    buffer_load_dwordx4 a[104:107], v1, s[8:11], s48 offen offset:2048
    v_exp_f32 v60, v60
    v_exp_f32 v61, v61
    v_mfma_f32_32x32x8_bf16 v[36:51], v[78:79], v[12:13], v[36:51]
    v_exp_f32 v62, v62
    v_exp_f32 v63, v63
    v_exp_f32 v64, v64
    v_exp_f32 v65, v65
    v_smfmac_f32_32x32x32_bf16 v[20:35], v[88:91], v[52:59], v4
    ds_read_b128 v[84:87], v98 offset:24928
    v_exp_f32 v66, v66
    v_exp_f32 v67, v67
    buffer_load_dwordx4 a[108:111], v1, s[8:11], s48 offen offset:3072
    s_add_u32 s48, s48, 4096
    v_exp_f32 v36, v36
    v_exp_f32 v37, v37
    s_waitcnt lgkmcnt(3)
    v_smfmac_f32_32x32x32_bf16 v[20:35], v[92:95], v[60:67], v4
    ds_read_b128 v[88:91], v98 offset:25536
    v_exp_f32 v38, v38
    v_exp_f32 v39, v39
    v_exp_f32 v40, v40
    v_exp_f32 v41, v41
    s_waitcnt lgkmcnt(2)
    v_mfma_f32_32x32x16_bf16 v[52:67], v[72:75], v[8:11], 0
    ds_read_b128 v[68:71], v96 offset:22528
    v_exp_f32 v42, v42
    v_exp_f32 v43, v43
    buffer_load_dwordx4 a[112:115], v1, s[8:11], s48 offen offset:0
    v_exp_f32 v44, v44
    v_exp_f32 v45, v45
    v_mfma_f32_32x32x8_bf16 v[52:67], v[78:79], v[14:15], v[52:67]
    v_exp_f32 v46, v46
    v_exp_f32 v47, v47
    v_exp_f32 v48, v48
    v_exp_f32 v49, v49
    v_smfmac_f32_32x32x32_bf16 v[20:35], v[80:83], v[36:43], v4
    ds_read_b128 v[92:95], v98 offset:26144
    v_exp_f32 v50, v50
    v_exp_f32 v51, v51
    buffer_load_dwordx4 a[116:119], v1, s[8:11], s48 offen offset:1024
    v_exp_f32 v52, v52
    v_exp_f32 v53, v53
    s_waitcnt lgkmcnt(3)
    v_smfmac_f32_32x32x32_bf16 v[20:35], v[84:87], v[44:51], v4
    ds_read_b128 v[80:83], v98 offset:26752
    v_exp_f32 v54, v54
    v_exp_f32 v55, v55
    v_exp_f32 v56, v56
    v_exp_f32 v57, v57
    s_waitcnt lgkmcnt(2)
    v_mfma_f32_32x32x16_bf16 v[36:51], v[68:71], v[8:11], 0
    ds_read_b128 v[72:75], v96 offset:23552
    v_exp_f32 v58, v58
    v_exp_f32 v59, v59
    buffer_load_dwordx4 a[120:123], v1, s[8:11], s48 offen offset:2048
    v_exp_f32 v60, v60
    v_exp_f32 v61, v61
    v_mfma_f32_32x32x8_bf16 v[36:51], v[78:79], v[16:17], v[36:51]
    ds_read2st64_b32 v[76:77], v97 offset0:12 offset1:13
    v_exp_f32 v62, v62
    v_exp_f32 v63, v63
    v_exp_f32 v64, v64
    v_exp_f32 v65, v65
    v_smfmac_f32_32x32x32_bf16 v[20:35], v[88:91], v[52:59], v4
    ds_read_b128 v[84:87], v98 offset:27360
    v_exp_f32 v66, v66
    v_exp_f32 v67, v67
    buffer_load_dwordx4 a[124:127], v1, s[8:11], s48 offen offset:3072
    s_add_u32 s48, s48, 4096
    v_exp_f32 v36, v36
    v_exp_f32 v37, v37
    s_waitcnt lgkmcnt(4)
    v_smfmac_f32_32x32x32_bf16 v[20:35], v[92:95], v[60:67], v4
    ds_read_b128 v[88:91], v98 offset:27968
    v_exp_f32 v38, v38
    v_exp_f32 v39, v39
    v_exp_f32 v40, v40
    v_exp_f32 v41, v41
    s_waitcnt lgkmcnt(3)
    v_mfma_f32_32x32x16_bf16 v[52:67], v[72:75], v[8:11], 0
    ds_read_b128 v[68:71], v96 offset:24576
    v_exp_f32 v42, v42
    v_exp_f32 v43, v43
    buffer_load_dwordx4 a[128:131], v1, s[8:11], s48 offen offset:0
    v_exp_f32 v44, v44
    v_exp_f32 v45, v45
    v_mfma_f32_32x32x8_bf16 v[52:67], v[78:79], v[18:19], v[52:67]
    v_exp_f32 v46, v46
    v_exp_f32 v47, v47
    v_exp_f32 v48, v48
    v_exp_f32 v49, v49
    v_smfmac_f32_32x32x32_bf16 v[20:35], v[80:83], v[36:43], v4
    ds_read_b128 v[92:95], v98 offset:28576
    v_exp_f32 v50, v50
    v_exp_f32 v51, v51
    buffer_load_dwordx4 a[132:135], v1, s[8:11], s48 offen offset:1024
    v_exp_f32 v52, v52
    v_exp_f32 v53, v53
    s_waitcnt lgkmcnt(3)
    v_smfmac_f32_32x32x32_bf16 v[20:35], v[84:87], v[44:51], v4
    ds_read_b128 v[80:83], v98 offset:29184
    v_exp_f32 v54, v54
    v_exp_f32 v55, v55
    v_exp_f32 v56, v56
    v_exp_f32 v57, v57
    s_waitcnt lgkmcnt(2)
    v_mfma_f32_32x32x16_bf16 v[36:51], v[68:71], v[8:11], 0
    ds_read_b128 v[72:75], v96 offset:25600
    v_exp_f32 v58, v58
    v_exp_f32 v59, v59
    buffer_load_dwordx4 a[136:139], v1, s[8:11], s48 offen offset:2048
    v_exp_f32 v60, v60
    v_exp_f32 v61, v61
    v_mfma_f32_32x32x8_bf16 v[36:51], v[76:77], v[12:13], v[36:51]
    v_exp_f32 v62, v62
    v_exp_f32 v63, v63
    v_exp_f32 v64, v64
    v_exp_f32 v65, v65
    v_smfmac_f32_32x32x32_bf16 v[20:35], v[88:91], v[52:59], v4
    ds_read_b128 v[84:87], v98 offset:29792
    v_exp_f32 v66, v66
    v_exp_f32 v67, v67
    buffer_load_dwordx4 a[140:143], v1, s[8:11], s48 offen offset:3072
    s_add_u32 s48, s48, 4096
    v_exp_f32 v36, v36
    v_exp_f32 v37, v37
    s_waitcnt lgkmcnt(3)
    v_smfmac_f32_32x32x32_bf16 v[20:35], v[92:95], v[60:67], v4
    ds_read_b128 v[88:91], v98 offset:30400
    v_exp_f32 v38, v38
    v_exp_f32 v39, v39
    v_exp_f32 v40, v40
    v_exp_f32 v41, v41
    s_waitcnt lgkmcnt(2)
    v_mfma_f32_32x32x16_bf16 v[52:67], v[72:75], v[8:11], 0
    ds_read_b128 v[68:71], v96 offset:26624
    v_exp_f32 v42, v42
    v_exp_f32 v43, v43
    v_exp_f32 v44, v44
    v_exp_f32 v45, v45
    v_mfma_f32_32x32x8_bf16 v[52:67], v[76:77], v[14:15], v[52:67]
    v_exp_f32 v46, v46
    v_exp_f32 v47, v47
    v_exp_f32 v48, v48
    v_exp_f32 v49, v49
    v_smfmac_f32_32x32x32_bf16 v[20:35], v[80:83], v[36:43], v4
    ds_read_b128 v[92:95], v98 offset:31008
    v_exp_f32 v50, v50
    v_exp_f32 v51, v51
    v_exp_f32 v52, v52
    v_exp_f32 v53, v53
    s_waitcnt lgkmcnt(3)
    v_smfmac_f32_32x32x32_bf16 v[20:35], v[84:87], v[44:51], v4
    ds_read_b128 v[80:83], v98 offset:31616
    v_exp_f32 v54, v54
    v_exp_f32 v55, v55
    v_exp_f32 v56, v56
    v_exp_f32 v57, v57
    s_waitcnt lgkmcnt(2)
    v_mfma_f32_32x32x16_bf16 v[36:51], v[68:71], v[8:11], 0
    ds_read_b128 v[72:75], v96 offset:27648
    v_exp_f32 v58, v58
    v_exp_f32 v59, v59
    v_exp_f32 v60, v60
    v_exp_f32 v61, v61
    v_mfma_f32_32x32x8_bf16 v[36:51], v[76:77], v[16:17], v[36:51]
    ds_read2st64_b32 v[78:79], v97 offset0:14 offset1:15
    v_exp_f32 v62, v62
    v_exp_f32 v63, v63
    v_exp_f32 v64, v64
    v_exp_f32 v65, v65
    v_smfmac_f32_32x32x32_bf16 v[20:35], v[88:91], v[52:59], v4
    ds_read_b128 v[84:87], v98 offset:32224
    v_exp_f32 v66, v66
    v_exp_f32 v67, v67
    v_exp_f32 v36, v36
    v_exp_f32 v37, v37
    s_waitcnt lgkmcnt(4)
    v_smfmac_f32_32x32x32_bf16 v[20:35], v[92:95], v[60:67], v4
    ds_read_b128 v[88:91], v98 offset:32832
    v_exp_f32 v38, v38
    v_exp_f32 v39, v39
    v_exp_f32 v40, v40
    v_exp_f32 v41, v41
    s_waitcnt lgkmcnt(3)
    v_mfma_f32_32x32x16_bf16 v[52:67], v[72:75], v[8:11], 0
    ds_read_b128 v[68:71], v96 offset:28672
    v_exp_f32 v42, v42
    v_exp_f32 v43, v43
    v_exp_f32 v44, v44
    v_exp_f32 v45, v45
    v_mfma_f32_32x32x8_bf16 v[52:67], v[76:77], v[18:19], v[52:67]
    v_exp_f32 v46, v46
    v_exp_f32 v47, v47
    v_exp_f32 v48, v48
    v_exp_f32 v49, v49
    v_smfmac_f32_32x32x32_bf16 v[20:35], v[80:83], v[36:43], v4
    ds_read_b128 v[92:95], v98 offset:33440
    v_exp_f32 v50, v50
    v_exp_f32 v51, v51
    v_exp_f32 v52, v52
    v_exp_f32 v53, v53
    s_waitcnt lgkmcnt(3)
    v_smfmac_f32_32x32x32_bf16 v[20:35], v[84:87], v[44:51], v4
    ds_read_b128 v[80:83], v98 offset:34048
    v_exp_f32 v54, v54
    v_exp_f32 v55, v55
    v_exp_f32 v56, v56
    v_exp_f32 v57, v57
    s_waitcnt lgkmcnt(2)
    v_mfma_f32_32x32x16_bf16 v[36:51], v[68:71], v[8:11], 0
    ds_read_b128 v[72:75], v96 offset:29696
    v_exp_f32 v58, v58
    v_exp_f32 v59, v59
    v_exp_f32 v60, v60
    v_exp_f32 v61, v61
    v_mfma_f32_32x32x8_bf16 v[36:51], v[78:79], v[12:13], v[36:51]
    v_exp_f32 v62, v62
    v_exp_f32 v63, v63
    v_exp_f32 v64, v64
    v_exp_f32 v65, v65
    v_smfmac_f32_32x32x32_bf16 v[20:35], v[88:91], v[52:59], v4
    ds_read_b128 v[84:87], v98 offset:34656
    v_exp_f32 v66, v66
    v_exp_f32 v67, v67
    v_exp_f32 v36, v36
    v_exp_f32 v37, v37
    s_waitcnt lgkmcnt(3)
    v_smfmac_f32_32x32x32_bf16 v[20:35], v[92:95], v[60:67], v4
    ds_read_b128 v[88:91], v98 offset:35264
    v_exp_f32 v38, v38
    v_exp_f32 v39, v39
    v_exp_f32 v40, v40
    v_exp_f32 v41, v41
    s_waitcnt lgkmcnt(2)
    v_mfma_f32_32x32x16_bf16 v[52:67], v[72:75], v[8:11], 0
    ds_read_b128 v[68:71], v96 offset:30720
    v_exp_f32 v42, v42
    v_exp_f32 v43, v43
    v_exp_f32 v44, v44
    v_exp_f32 v45, v45
    v_mfma_f32_32x32x8_bf16 v[52:67], v[78:79], v[14:15], v[52:67]
    v_exp_f32 v46, v46
    v_exp_f32 v47, v47
    v_exp_f32 v48, v48
    v_exp_f32 v49, v49
    v_smfmac_f32_32x32x32_bf16 v[20:35], v[80:83], v[36:43], v4
    ds_read_b128 v[92:95], v98 offset:35872
    v_exp_f32 v50, v50
    v_exp_f32 v51, v51
    v_exp_f32 v52, v52
    v_exp_f32 v53, v53
    s_waitcnt lgkmcnt(3)
    v_smfmac_f32_32x32x32_bf16 v[20:35], v[84:87], v[44:51], v4
    ds_read_b128 v[80:83], v98 offset:36480
    v_exp_f32 v54, v54
    v_exp_f32 v55, v55
    v_exp_f32 v56, v56
    v_exp_f32 v57, v57
    s_waitcnt lgkmcnt(2)
    v_mfma_f32_32x32x16_bf16 v[36:51], v[68:71], v[8:11], 0
    ds_read_b128 v[72:75], v96 offset:31744
    v_exp_f32 v58, v58
    v_exp_f32 v59, v59
    v_exp_f32 v60, v60
    v_exp_f32 v61, v61
    v_mfma_f32_32x32x8_bf16 v[36:51], v[78:79], v[16:17], v[36:51]
    v_exp_f32 v62, v62
    v_exp_f32 v63, v63
    v_exp_f32 v64, v64
    v_exp_f32 v65, v65
    v_smfmac_f32_32x32x32_bf16 v[20:35], v[88:91], v[52:59], v4
    ds_read_b128 v[84:87], v98 offset:37088
    v_exp_f32 v66, v66
    v_exp_f32 v67, v67
    v_exp_f32 v36, v36
    v_exp_f32 v37, v37
    s_waitcnt lgkmcnt(3)
    v_smfmac_f32_32x32x32_bf16 v[20:35], v[92:95], v[60:67], v4
    ds_read_b128 v[88:91], v98 offset:37696
    v_exp_f32 v38, v38
    v_exp_f32 v39, v39
    v_exp_f32 v40, v40
    v_exp_f32 v41, v41
    s_waitcnt lgkmcnt(2)
    v_mfma_f32_32x32x16_bf16 v[52:67], v[72:75], v[8:11], 0
    v_exp_f32 v42, v42
    v_exp_f32 v43, v43
    v_exp_f32 v44, v44
    v_exp_f32 v45, v45
    v_mfma_f32_32x32x8_bf16 v[52:67], v[78:79], v[18:19], v[52:67]
    v_exp_f32 v46, v46
    v_exp_f32 v47, v47
    v_exp_f32 v48, v48
    v_exp_f32 v49, v49
    v_smfmac_f32_32x32x32_bf16 v[20:35], v[80:83], v[36:43], v4
    ds_read_b128 v[92:95], v98 offset:38304
    v_exp_f32 v50, v50
    v_exp_f32 v51, v51
    v_exp_f32 v52, v52
    v_exp_f32 v53, v53
    s_waitcnt lgkmcnt(2)
    v_smfmac_f32_32x32x32_bf16 v[20:35], v[84:87], v[44:51], v4
    v_exp_f32 v54, v54
    v_exp_f32 v55, v55
    v_exp_f32 v56, v56
    v_exp_f32 v57, v57
    v_exp_f32 v58, v58
    v_exp_f32 v59, v59
    v_exp_f32 v60, v60
    v_exp_f32 v61, v61
    v_exp_f32 v62, v62
    v_exp_f32 v63, v63
    v_exp_f32 v64, v64
    v_exp_f32 v65, v65
    s_waitcnt lgkmcnt(1)
    v_smfmac_f32_32x32x32_bf16 v[20:35], v[88:91], v[52:59], v4
    v_exp_f32 v66, v66
    v_exp_f32 v67, v67
    s_waitcnt lgkmcnt(0)
    s_nop 0
    v_smfmac_f32_32x32x32_bf16 v[20:35], v[92:95], v[60:67], v4
    s_nop 11
    v_add_u32 v6, 152064, v1
    s_cmp_eq_u32 s32, 1
    s_cbranch_scc0 F_even
    ds_write_b128 v6, v[20:23] offset:0
    ds_write_b128 v6, v[24:27] offset:1024
    ds_write_b128 v6, v[28:31] offset:2048
    s_waitcnt lgkmcnt(0)
    s_barrier
    s_branch F_bo
F_even:
    s_barrier
    s_cmp_eq_u32 s32, 0
    s_cbranch_scc0 F_e1
    ds_read_b128 v[36:39], v6 offset:0
    ds_read_b128 v[40:43], v6 offset:1024
    ds_read_b128 v[44:47], v6 offset:2048
    s_waitcnt lgkmcnt(0)
    v_add_f32 v20, v20, v36
    v_add_f32 v21, v21, v37
    v_add_f32 v22, v22, v38
    v_add_f32 v23, v23, v39
    v_add_f32 v24, v24, v40
    v_add_f32 v25, v25, v41
    v_add_f32 v26, v26, v42
    v_add_f32 v27, v27, v43
    v_add_f32 v28, v28, v44
    v_add_f32 v29, v29, v45
    v_add_f32 v30, v30, v46
    v_add_f32 v31, v31, v47
F_e1:
    s_call_b64 s[30:31], F_fin
    s_branch F_bo
F_w4:
    s_setprio 1
    ds_read_b128 v[68:71], v96 offset:0
    ds_read2st64_b32 v[76:77], v97 offset0:0 offset1:1
    ds_read_b128 v[72:75], v96 offset:1024
    ds_read_b128 v[80:83], v98 offset:0
    ds_read_b128 v[84:87], v98 offset:608
    s_waitcnt lgkmcnt(4)
    v_mfma_f32_32x32x16_bf16 v[36:51], v[68:71], v[8:11], 0
    s_waitcnt lgkmcnt(3)
    v_mfma_f32_32x32x8_bf16 v[36:51], v[76:77], v[12:13], v[36:51]
    s_nop 11
    v_exp_f32 v36, v36
    v_exp_f32 v37, v37
    ds_read_b128 v[88:91], v98 offset:1216
    v_exp_f32 v38, v38
    v_exp_f32 v39, v39
    v_exp_f32 v40, v40
    v_exp_f32 v41, v41
    s_waitcnt lgkmcnt(3)
    v_mfma_f32_32x32x16_bf16 v[52:67], v[72:75], v[8:11], 0
    ds_read_b128 v[68:71], v96 offset:2048
    v_exp_f32 v42, v42
    v_exp_f32 v43, v43
    s_add_u32 m0, s37, 16384
    s_add_u32 s41, s43, 16384
    buffer_load_dwordx4 v1, s[8:11], s41 offen lds
    v_exp_f32 v44, v44
    v_exp_f32 v45, v45
    v_mfma_f32_32x32x8_bf16 v[52:67], v[76:77], v[14:15], v[52:67]
    v_exp_f32 v46, v46
    v_exp_f32 v47, v47
    v_exp_f32 v48, v48
    v_exp_f32 v49, v49
    s_waitcnt lgkmcnt(3)
    v_smfmac_f32_32x32x32_bf16 v[20:35], v[80:83], v[36:43], v4
    ds_read_b128 v[92:95], v98 offset:1824
    v_exp_f32 v50, v50
    v_exp_f32 v51, v51
    s_add_u32 m0, s37, 93184
    s_add_u32 s41, s39, 19456
    buffer_load_dwordx4 v1, s[8:11], s41 offen lds
    v_exp_f32 v52, v52
    v_exp_f32 v53, v53
    s_waitcnt lgkmcnt(3)
    v_smfmac_f32_32x32x32_bf16 v[20:35], v[84:87], v[44:51], v4
    ds_read_b128 v[80:83], v98 offset:2432
    v_exp_f32 v54, v54
    v_exp_f32 v55, v55
    v_exp_f32 v56, v56
    v_exp_f32 v57, v57
    s_waitcnt lgkmcnt(2)
    v_mfma_f32_32x32x16_bf16 v[36:51], v[68:71], v[8:11], 0
    ds_read_b128 v[72:75], v96 offset:3072
    v_exp_f32 v58, v58
    v_exp_f32 v59, v59
    s_add_u32 m0, s37, 24576
    s_add_u32 s41, s43, 24576
    buffer_load_dwordx4 v1, s[8:11], s41 offen lds
    v_exp_f32 v60, v60
    v_exp_f32 v61, v61
    v_mfma_f32_32x32x8_bf16 v[36:51], v[76:77], v[16:17], v[36:51]
    ds_read2st64_b32 v[78:79], v97 offset0:2 offset1:3
    v_exp_f32 v62, v62
    v_exp_f32 v63, v63
    v_exp_f32 v64, v64
    v_exp_f32 v65, v65
    v_smfmac_f32_32x32x32_bf16 v[20:35], v[88:91], v[52:59], v4
    ds_read_b128 v[84:87], v98 offset:3040
    v_exp_f32 v66, v66
    v_exp_f32 v67, v67
    s_add_u32 m0, s37, 102912
    s_add_u32 s41, s39, 29184
    buffer_load_dwordx4 v1, s[8:11], s41 offen lds
    v_exp_f32 v36, v36
    v_exp_f32 v37, v37
    s_waitcnt lgkmcnt(4)
    v_smfmac_f32_32x32x32_bf16 v[20:35], v[92:95], v[60:67], v4
    ds_read_b128 v[88:91], v98 offset:3648
    v_exp_f32 v38, v38
    v_exp_f32 v39, v39
    v_exp_f32 v40, v40
    v_exp_f32 v41, v41
    s_waitcnt lgkmcnt(3)
    v_mfma_f32_32x32x16_bf16 v[52:67], v[72:75], v[8:11], 0
    ds_read_b128 v[68:71], v96 offset:4096
    v_exp_f32 v42, v42
    v_exp_f32 v43, v43
    v_exp_f32 v44, v44
    v_exp_f32 v45, v45
    v_mfma_f32_32x32x8_bf16 v[52:67], v[76:77], v[18:19], v[52:67]
    v_exp_f32 v46, v46
    v_exp_f32 v47, v47
    v_exp_f32 v48, v48
    v_exp_f32 v49, v49
    v_smfmac_f32_32x32x32_bf16 v[20:35], v[80:83], v[36:43], v4
    ds_read_b128 v[92:95], v98 offset:4256
    v_exp_f32 v50, v50
    v_exp_f32 v51, v51
    v_exp_f32 v52, v52
    v_exp_f32 v53, v53
    s_waitcnt lgkmcnt(3)
    v_smfmac_f32_32x32x32_bf16 v[20:35], v[84:87], v[44:51], v4
    ds_read_b128 v[80:83], v98 offset:4864
    v_exp_f32 v54, v54
    v_exp_f32 v55, v55
    v_exp_f32 v56, v56
    v_exp_f32 v57, v57
    s_waitcnt lgkmcnt(2)
    v_mfma_f32_32x32x16_bf16 v[36:51], v[68:71], v[8:11], 0
    ds_read_b128 v[72:75], v96 offset:5120
    v_exp_f32 v58, v58
    v_exp_f32 v59, v59
    v_exp_f32 v60, v60
    v_exp_f32 v61, v61
    v_mfma_f32_32x32x8_bf16 v[36:51], v[78:79], v[12:13], v[36:51]
    v_exp_f32 v62, v62
    v_exp_f32 v63, v63
    v_exp_f32 v64, v64
    v_exp_f32 v65, v65
    v_smfmac_f32_32x32x32_bf16 v[20:35], v[88:91], v[52:59], v4
    ds_read_b128 v[84:87], v98 offset:5472
    v_exp_f32 v66, v66
    v_exp_f32 v67, v67
    v_exp_f32 v36, v36
    v_exp_f32 v37, v37
    s_waitcnt lgkmcnt(3)
    v_smfmac_f32_32x32x32_bf16 v[20:35], v[92:95], v[60:67], v4
    ds_read_b128 v[88:91], v98 offset:6080
    v_exp_f32 v38, v38
    v_exp_f32 v39, v39
    v_exp_f32 v40, v40
    v_exp_f32 v41, v41
    s_waitcnt lgkmcnt(2)
    v_mfma_f32_32x32x16_bf16 v[52:67], v[72:75], v[8:11], 0
    ds_read_b128 v[68:71], v96 offset:6144
    v_exp_f32 v42, v42
    v_exp_f32 v43, v43
    v_exp_f32 v44, v44
    v_exp_f32 v45, v45
    v_mfma_f32_32x32x8_bf16 v[52:67], v[78:79], v[14:15], v[52:67]
    v_exp_f32 v46, v46
    v_exp_f32 v47, v47
    v_exp_f32 v48, v48
    v_exp_f32 v49, v49
    v_smfmac_f32_32x32x32_bf16 v[20:35], v[80:83], v[36:43], v4
    ds_read_b128 v[92:95], v98 offset:6688
    v_exp_f32 v50, v50
    v_exp_f32 v51, v51
    v_exp_f32 v52, v52
    v_exp_f32 v53, v53
    s_waitcnt lgkmcnt(3)
    v_smfmac_f32_32x32x32_bf16 v[20:35], v[84:87], v[44:51], v4
    ds_read_b128 v[80:83], v98 offset:7296
    v_exp_f32 v54, v54
    v_exp_f32 v55, v55
    v_exp_f32 v56, v56
    v_exp_f32 v57, v57
    s_waitcnt lgkmcnt(2)
    v_mfma_f32_32x32x16_bf16 v[36:51], v[68:71], v[8:11], 0
    ds_read_b128 v[72:75], v96 offset:7168
    v_exp_f32 v58, v58
    v_exp_f32 v59, v59
    v_exp_f32 v60, v60
    v_exp_f32 v61, v61
    v_mfma_f32_32x32x8_bf16 v[36:51], v[78:79], v[16:17], v[36:51]
    ds_read2st64_b32 v[76:77], v97 offset0:4 offset1:5
    v_exp_f32 v62, v62
    v_exp_f32 v63, v63
    v_exp_f32 v64, v64
    v_exp_f32 v65, v65
    v_smfmac_f32_32x32x32_bf16 v[20:35], v[88:91], v[52:59], v4
    ds_read_b128 v[84:87], v98 offset:7904
    v_exp_f32 v66, v66
    v_exp_f32 v67, v67
    s_waitcnt vmcnt(0)
    s_barrier
    v_exp_f32 v36, v36
    v_exp_f32 v37, v37
    s_waitcnt lgkmcnt(4)
    v_smfmac_f32_32x32x32_bf16 v[20:35], v[92:95], v[60:67], v4
    ds_read_b128 v[88:91], v98 offset:8512
    v_exp_f32 v38, v38
    v_exp_f32 v39, v39
    v_exp_f32 v40, v40
    v_exp_f32 v41, v41
    s_waitcnt lgkmcnt(3)
    v_mfma_f32_32x32x16_bf16 v[52:67], v[72:75], v[8:11], 0
    ds_read_b128 v[68:71], v96 offset:8192
    v_exp_f32 v42, v42
    v_exp_f32 v43, v43
    buffer_load_dwordx4 a[0:3], v1, s[8:11], s48 offen offset:0
    buffer_load_dwordx4 a[4:7], v1, s[8:11], s48 offen offset:1024
    v_exp_f32 v44, v44
    v_exp_f32 v45, v45
    v_mfma_f32_32x32x8_bf16 v[52:67], v[78:79], v[18:19], v[52:67]
    v_exp_f32 v46, v46
    v_exp_f32 v47, v47
    v_exp_f32 v48, v48
    v_exp_f32 v49, v49
    v_smfmac_f32_32x32x32_bf16 v[20:35], v[80:83], v[36:43], v4
    ds_read_b128 v[92:95], v98 offset:9120
    v_exp_f32 v50, v50
    v_exp_f32 v51, v51
    buffer_load_dwordx4 a[8:11], v1, s[8:11], s48 offen offset:2048
    buffer_load_dwordx4 a[12:15], v1, s[8:11], s48 offen offset:3072
    s_add_u32 s48, s48, 4096
    v_exp_f32 v52, v52
    v_exp_f32 v53, v53
    s_waitcnt lgkmcnt(3)
    v_smfmac_f32_32x32x32_bf16 v[20:35], v[84:87], v[44:51], v4
    ds_read_b128 v[80:83], v98 offset:9728
    v_exp_f32 v54, v54
    v_exp_f32 v55, v55
    v_exp_f32 v56, v56
    v_exp_f32 v57, v57
    s_waitcnt lgkmcnt(2)
    v_mfma_f32_32x32x16_bf16 v[36:51], v[68:71], v[8:11], 0
    ds_read_b128 v[72:75], v96 offset:9216
    v_exp_f32 v58, v58
    v_exp_f32 v59, v59
    buffer_load_dwordx4 a[16:19], v1, s[8:11], s48 offen offset:0
    buffer_load_dwordx4 a[20:23], v1, s[8:11], s48 offen offset:1024
    v_exp_f32 v60, v60
    v_exp_f32 v61, v61
    v_mfma_f32_32x32x8_bf16 v[36:51], v[76:77], v[12:13], v[36:51]
    v_exp_f32 v62, v62
    v_exp_f32 v63, v63
    v_exp_f32 v64, v64
    v_exp_f32 v65, v65
    v_smfmac_f32_32x32x32_bf16 v[20:35], v[88:91], v[52:59], v4
    ds_read_b128 v[84:87], v98 offset:10336
    v_exp_f32 v66, v66
    v_exp_f32 v67, v67
    buffer_load_dwordx4 a[24:27], v1, s[8:11], s48 offen offset:2048
    buffer_load_dwordx4 a[28:31], v1, s[8:11], s48 offen offset:3072
    s_add_u32 s48, s48, 4096
    v_exp_f32 v36, v36
    v_exp_f32 v37, v37
    s_waitcnt lgkmcnt(3)
    v_smfmac_f32_32x32x32_bf16 v[20:35], v[92:95], v[60:67], v4
    ds_read_b128 v[88:91], v98 offset:10944
    v_exp_f32 v38, v38
    v_exp_f32 v39, v39
    v_exp_f32 v40, v40
    v_exp_f32 v41, v41
    s_waitcnt lgkmcnt(2)
    v_mfma_f32_32x32x16_bf16 v[52:67], v[72:75], v[8:11], 0
    ds_read_b128 v[68:71], v96 offset:10240
    v_exp_f32 v42, v42
    v_exp_f32 v43, v43
    buffer_load_dwordx4 a[32:35], v1, s[8:11], s48 offen offset:0
    buffer_load_dwordx4 a[36:39], v1, s[8:11], s48 offen offset:1024
    v_exp_f32 v44, v44
    v_exp_f32 v45, v45
    v_mfma_f32_32x32x8_bf16 v[52:67], v[76:77], v[14:15], v[52:67]
    v_exp_f32 v46, v46
    v_exp_f32 v47, v47
    v_exp_f32 v48, v48
    v_exp_f32 v49, v49
    v_smfmac_f32_32x32x32_bf16 v[20:35], v[80:83], v[36:43], v4
    ds_read_b128 v[92:95], v98 offset:11552
    v_exp_f32 v50, v50
    v_exp_f32 v51, v51
    buffer_load_dwordx4 a[40:43], v1, s[8:11], s48 offen offset:2048
    buffer_load_dwordx4 a[44:47], v1, s[8:11], s48 offen offset:3072
    s_add_u32 s48, s48, 4096
    v_exp_f32 v52, v52
    v_exp_f32 v53, v53
    s_waitcnt lgkmcnt(3)
    v_smfmac_f32_32x32x32_bf16 v[20:35], v[84:87], v[44:51], v4
    ds_read_b128 v[80:83], v98 offset:12160
    v_exp_f32 v54, v54
    v_exp_f32 v55, v55
    v_exp_f32 v56, v56
    v_exp_f32 v57, v57
    s_waitcnt lgkmcnt(2)
    v_mfma_f32_32x32x16_bf16 v[36:51], v[68:71], v[8:11], 0
    ds_read_b128 v[72:75], v96 offset:11264
    v_exp_f32 v58, v58
    v_exp_f32 v59, v59
    buffer_load_dwordx4 a[48:51], v1, s[8:11], s48 offen offset:0
    buffer_load_dwordx4 a[52:55], v1, s[8:11], s48 offen offset:1024
    v_exp_f32 v60, v60
    v_exp_f32 v61, v61
    v_mfma_f32_32x32x8_bf16 v[36:51], v[76:77], v[16:17], v[36:51]
    ds_read2st64_b32 v[78:79], v97 offset0:6 offset1:7
    v_exp_f32 v62, v62
    v_exp_f32 v63, v63
    v_exp_f32 v64, v64
    v_exp_f32 v65, v65
    v_smfmac_f32_32x32x32_bf16 v[20:35], v[88:91], v[52:59], v4
    ds_read_b128 v[84:87], v98 offset:12768
    v_exp_f32 v66, v66
    v_exp_f32 v67, v67
    buffer_load_dwordx4 a[56:59], v1, s[8:11], s48 offen offset:2048
    buffer_load_dwordx4 a[60:63], v1, s[8:11], s48 offen offset:3072
    s_add_u32 s48, s48, 4096
    v_exp_f32 v36, v36
    v_exp_f32 v37, v37
    s_waitcnt lgkmcnt(4)
    v_smfmac_f32_32x32x32_bf16 v[20:35], v[92:95], v[60:67], v4
    ds_read_b128 v[88:91], v98 offset:13376
    v_exp_f32 v38, v38
    v_exp_f32 v39, v39
    v_exp_f32 v40, v40
    v_exp_f32 v41, v41
    s_waitcnt lgkmcnt(3)
    v_mfma_f32_32x32x16_bf16 v[52:67], v[72:75], v[8:11], 0
    ds_read_b128 v[68:71], v96 offset:12288
    v_exp_f32 v42, v42
    v_exp_f32 v43, v43
    buffer_load_dwordx4 a[64:67], v1, s[8:11], s48 offen offset:0
    buffer_load_dwordx4 a[68:71], v1, s[8:11], s48 offen offset:1024
    v_exp_f32 v44, v44
    v_exp_f32 v45, v45
    v_mfma_f32_32x32x8_bf16 v[52:67], v[76:77], v[18:19], v[52:67]
    v_exp_f32 v46, v46
    v_exp_f32 v47, v47
    v_exp_f32 v48, v48
    v_exp_f32 v49, v49
    v_smfmac_f32_32x32x32_bf16 v[20:35], v[80:83], v[36:43], v4
    ds_read_b128 v[92:95], v98 offset:13984
    v_exp_f32 v50, v50
    v_exp_f32 v51, v51
    buffer_load_dwordx4 a[72:75], v1, s[8:11], s48 offen offset:2048
    buffer_load_dwordx4 a[76:79], v1, s[8:11], s48 offen offset:3072
    s_add_u32 s48, s48, 4096
    v_exp_f32 v52, v52
    v_exp_f32 v53, v53
    s_waitcnt lgkmcnt(3)
    v_smfmac_f32_32x32x32_bf16 v[20:35], v[84:87], v[44:51], v4
    ds_read_b128 v[80:83], v98 offset:14592
    v_exp_f32 v54, v54
    v_exp_f32 v55, v55
    v_exp_f32 v56, v56
    v_exp_f32 v57, v57
    s_waitcnt lgkmcnt(2)
    v_mfma_f32_32x32x16_bf16 v[36:51], v[68:71], v[8:11], 0
    ds_read_b128 v[72:75], v96 offset:13312
    v_exp_f32 v58, v58
    v_exp_f32 v59, v59
    buffer_load_dwordx4 a[80:83], v1, s[8:11], s48 offen offset:0
    buffer_load_dwordx4 a[84:87], v1, s[8:11], s48 offen offset:1024
    v_exp_f32 v60, v60
    v_exp_f32 v61, v61
    v_mfma_f32_32x32x8_bf16 v[36:51], v[78:79], v[12:13], v[36:51]
    v_exp_f32 v62, v62
    v_exp_f32 v63, v63
    v_exp_f32 v64, v64
    v_exp_f32 v65, v65
    v_smfmac_f32_32x32x32_bf16 v[20:35], v[88:91], v[52:59], v4
    ds_read_b128 v[84:87], v98 offset:15200
    v_exp_f32 v66, v66
    v_exp_f32 v67, v67
    buffer_load_dwordx4 a[88:91], v1, s[8:11], s48 offen offset:2048
    buffer_load_dwordx4 a[92:95], v1, s[8:11], s48 offen offset:3072
    s_add_u32 s48, s48, 4096
    v_exp_f32 v36, v36
    v_exp_f32 v37, v37
    s_waitcnt lgkmcnt(3)
    v_smfmac_f32_32x32x32_bf16 v[20:35], v[92:95], v[60:67], v4
    ds_read_b128 v[88:91], v98 offset:15808
    v_exp_f32 v38, v38
    v_exp_f32 v39, v39
    v_exp_f32 v40, v40
    v_exp_f32 v41, v41
    s_waitcnt lgkmcnt(2)
    v_mfma_f32_32x32x16_bf16 v[52:67], v[72:75], v[8:11], 0
    ds_read_b128 v[68:71], v96 offset:14336
    v_exp_f32 v42, v42
    v_exp_f32 v43, v43
    buffer_load_dwordx4 a[96:99], v1, s[8:11], s48 offen offset:0
    buffer_load_dwordx4 a[100:103], v1, s[8:11], s48 offen offset:1024
    v_exp_f32 v44, v44
    v_exp_f32 v45, v45
    v_mfma_f32_32x32x8_bf16 v[52:67], v[78:79], v[14:15], v[52:67]
    v_exp_f32 v46, v46
    v_exp_f32 v47, v47
    v_exp_f32 v48, v48
    v_exp_f32 v49, v49
    v_smfmac_f32_32x32x32_bf16 v[20:35], v[80:83], v[36:43], v4
    ds_read_b128 v[92:95], v98 offset:16416
    v_exp_f32 v50, v50
    v_exp_f32 v51, v51
    buffer_load_dwordx4 a[104:107], v1, s[8:11], s48 offen offset:2048
    buffer_load_dwordx4 a[108:111], v1, s[8:11], s48 offen offset:3072
    s_add_u32 s48, s48, 4096
    v_exp_f32 v52, v52
    v_exp_f32 v53, v53
    s_waitcnt lgkmcnt(3)
    v_smfmac_f32_32x32x32_bf16 v[20:35], v[84:87], v[44:51], v4
    ds_read_b128 v[80:83], v98 offset:17024
    v_exp_f32 v54, v54
    v_exp_f32 v55, v55
    v_exp_f32 v56, v56
    v_exp_f32 v57, v57
    s_waitcnt lgkmcnt(2)
    v_mfma_f32_32x32x16_bf16 v[36:51], v[68:71], v[8:11], 0
    ds_read_b128 v[72:75], v96 offset:15360
    v_exp_f32 v58, v58
    v_exp_f32 v59, v59
    buffer_load_dwordx4 a[112:115], v1, s[8:11], s48 offen offset:0
    buffer_load_dwordx4 a[116:119], v1, s[8:11], s48 offen offset:1024
    v_exp_f32 v60, v60
    v_exp_f32 v61, v61
    v_mfma_f32_32x32x8_bf16 v[36:51], v[78:79], v[16:17], v[36:51]
    v_exp_f32 v62, v62
    v_exp_f32 v63, v63
    v_exp_f32 v64, v64
    v_exp_f32 v65, v65
    v_smfmac_f32_32x32x32_bf16 v[20:35], v[88:91], v[52:59], v4
    ds_read_b128 v[84:87], v98 offset:17632
    v_exp_f32 v66, v66
    v_exp_f32 v67, v67
    buffer_load_dwordx4 a[120:123], v1, s[8:11], s48 offen offset:2048
    buffer_load_dwordx4 a[124:127], v1, s[8:11], s48 offen offset:3072
    s_add_u32 s48, s48, 4096
    v_exp_f32 v36, v36
    v_exp_f32 v37, v37
    s_waitcnt lgkmcnt(3)
    v_smfmac_f32_32x32x32_bf16 v[20:35], v[92:95], v[60:67], v4
    ds_read_b128 v[88:91], v98 offset:18240
    v_exp_f32 v38, v38
    v_exp_f32 v39, v39
    v_exp_f32 v40, v40
    v_exp_f32 v41, v41
    s_waitcnt lgkmcnt(2)
    v_mfma_f32_32x32x16_bf16 v[52:67], v[72:75], v[8:11], 0
    v_exp_f32 v42, v42
    v_exp_f32 v43, v43
    buffer_load_dwordx4 a[128:131], v1, s[8:11], s48 offen offset:0
    buffer_load_dwordx4 a[132:135], v1, s[8:11], s48 offen offset:1024
    v_exp_f32 v44, v44
    v_exp_f32 v45, v45
    v_mfma_f32_32x32x8_bf16 v[52:67], v[78:79], v[18:19], v[52:67]
    v_exp_f32 v46, v46
    v_exp_f32 v47, v47
    v_exp_f32 v48, v48
    v_exp_f32 v49, v49
    v_smfmac_f32_32x32x32_bf16 v[20:35], v[80:83], v[36:43], v4
    ds_read_b128 v[92:95], v98 offset:18848
    v_exp_f32 v50, v50
    v_exp_f32 v51, v51
    buffer_load_dwordx4 a[136:139], v1, s[8:11], s48 offen offset:2048
    buffer_load_dwordx4 a[140:143], v1, s[8:11], s48 offen offset:3072
    s_add_u32 s48, s48, 4096
    v_exp_f32 v52, v52
    v_exp_f32 v53, v53
    s_waitcnt lgkmcnt(2)
    v_smfmac_f32_32x32x32_bf16 v[20:35], v[84:87], v[44:51], v4
    v_exp_f32 v54, v54
    v_exp_f32 v55, v55
    v_exp_f32 v56, v56
    v_exp_f32 v57, v57
    v_exp_f32 v58, v58
    v_exp_f32 v59, v59
    v_exp_f32 v60, v60
    v_exp_f32 v61, v61
    v_exp_f32 v62, v62
    v_exp_f32 v63, v63
    v_exp_f32 v64, v64
    v_exp_f32 v65, v65
    s_waitcnt lgkmcnt(1)
    v_smfmac_f32_32x32x32_bf16 v[20:35], v[88:91], v[52:59], v4
    v_exp_f32 v66, v66
    v_exp_f32 v67, v67
    s_waitcnt lgkmcnt(0)
    s_nop 0
    v_smfmac_f32_32x32x32_bf16 v[20:35], v[92:95], v[60:67], v4
    s_nop 11
F_e2:
    s_call_b64 s[30:31], F_fin
    s_barrier
    s_branch F_bo
F_w7:
    s_setprio 1
    ds_read_b128 v[68:71], v96 offset:0
    ds_read2st64_b32 v[76:77], v97 offset0:0 offset1:1
    ds_read_b128 v[72:75], v96 offset:1024
    ds_read_b128 v[80:83], v98 offset:0
    ds_read_b128 v[84:87], v98 offset:608
    s_waitcnt lgkmcnt(4)
    v_mfma_f32_32x32x16_bf16 v[36:51], v[68:71], v[8:11], 0
    s_waitcnt lgkmcnt(3)
    v_mfma_f32_32x32x8_bf16 v[36:51], v[76:77], v[12:13], v[36:51]
    s_nop 11
    v_exp_f32 v36, v36
    v_exp_f32 v37, v37
    ds_read_b128 v[88:91], v98 offset:1216
    v_exp_f32 v38, v38
    v_exp_f32 v39, v39
    v_exp_f32 v40, v40
    v_exp_f32 v41, v41
    s_waitcnt lgkmcnt(3)
    v_mfma_f32_32x32x16_bf16 v[52:67], v[72:75], v[8:11], 0
    ds_read_b128 v[68:71], v96 offset:2048
    v_exp_f32 v42, v42
    v_exp_f32 v43, v43
    s_add_u32 m0, s37, 16384
    s_add_u32 s41, s43, 16384
    buffer_load_dwordx4 v1, s[8:11], s41 offen lds
    v_exp_f32 v44, v44
    v_exp_f32 v45, v45
    v_mfma_f32_32x32x8_bf16 v[52:67], v[76:77], v[14:15], v[52:67]
    v_exp_f32 v46, v46
    v_exp_f32 v47, v47
    v_exp_f32 v48, v48
    v_exp_f32 v49, v49
    s_waitcnt lgkmcnt(3)
    v_smfmac_f32_32x32x32_bf16 v[20:35], v[80:83], v[36:43], v4
    ds_read_b128 v[92:95], v98 offset:1824
    v_exp_f32 v50, v50
    v_exp_f32 v51, v51
    s_add_u32 m0, s37, 93184
    s_add_u32 s41, s39, 19456
    buffer_load_dwordx4 v1, s[8:11], s41 offen lds
    v_exp_f32 v52, v52
    v_exp_f32 v53, v53
    s_waitcnt lgkmcnt(3)
    v_smfmac_f32_32x32x32_bf16 v[20:35], v[84:87], v[44:51], v4
    ds_read_b128 v[80:83], v98 offset:2432
    v_exp_f32 v54, v54
    v_exp_f32 v55, v55
    v_exp_f32 v56, v56
    v_exp_f32 v57, v57
    s_waitcnt lgkmcnt(2)
    v_mfma_f32_32x32x16_bf16 v[36:51], v[68:71], v[8:11], 0
    ds_read_b128 v[72:75], v96 offset:3072
    v_exp_f32 v58, v58
    v_exp_f32 v59, v59
    s_add_u32 m0, s37, 24576
    s_add_u32 s41, s43, 24576
    buffer_load_dwordx4 v1, s[8:11], s41 offen lds
    v_exp_f32 v60, v60
    v_exp_f32 v61, v61
    v_mfma_f32_32x32x8_bf16 v[36:51], v[76:77], v[16:17], v[36:51]
    ds_read2st64_b32 v[78:79], v97 offset0:2 offset1:3
    v_exp_f32 v62, v62
    v_exp_f32 v63, v63
    v_exp_f32 v64, v64
    v_exp_f32 v65, v65
    v_smfmac_f32_32x32x32_bf16 v[20:35], v[88:91], v[52:59], v4
    ds_read_b128 v[84:87], v98 offset:3040
    v_exp_f32 v66, v66
    v_exp_f32 v67, v67
    s_add_u32 m0, s37, 102912
    s_add_u32 s41, s39, 29184
    buffer_load_dwordx4 v1, s[8:11], s41 offen lds
    v_exp_f32 v36, v36
    v_exp_f32 v37, v37
    s_waitcnt lgkmcnt(4)
    v_smfmac_f32_32x32x32_bf16 v[20:35], v[92:95], v[60:67], v4
    ds_read_b128 v[88:91], v98 offset:3648
    v_exp_f32 v38, v38
    v_exp_f32 v39, v39
    v_exp_f32 v40, v40
    v_exp_f32 v41, v41
    s_waitcnt lgkmcnt(3)
    v_mfma_f32_32x32x16_bf16 v[52:67], v[72:75], v[8:11], 0
    ds_read_b128 v[68:71], v96 offset:4096
    v_exp_f32 v42, v42
    v_exp_f32 v43, v43
    s_lshl_b32 s34, s33, 6
    s_add_u32 s34, s34, s13
    s_add_u32 s34, s34, 8
    s_lshl_b32 s35, s34, 10
    s_add_u32 s35, s35, 83886080
    s_lshl_b32 s36, s34, 7
    s_add_u32 s36, s36, 88080384
    s_mul_i32 s34, s34, 3072
    s_add_u32 s34, s34, 20971520
    buffer_load_dwordx4 a[124:127], v1, s[8:11], s35 offen
    buffer_load_dword a128, v5, s[8:11], s36 offen
    buffer_load_dwordx4 a[132:135], v1, s[8:11], s34 offen offset:0
    buffer_load_dwordx4 a[136:139], v1, s[8:11], s34 offen offset:1024
    buffer_load_dwordx4 a[140:143], v1, s[8:11], s34 offen offset:2048
    v_exp_f32 v44, v44
    v_exp_f32 v45, v45
    v_mfma_f32_32x32x8_bf16 v[52:67], v[76:77], v[18:19], v[52:67]
    v_exp_f32 v46, v46
    v_exp_f32 v47, v47
    v_exp_f32 v48, v48
    v_exp_f32 v49, v49
    v_smfmac_f32_32x32x32_bf16 v[20:35], v[80:83], v[36:43], v4
    ds_read_b128 v[92:95], v98 offset:4256
    v_exp_f32 v50, v50
    v_exp_f32 v51, v51
    v_exp_f32 v52, v52
    v_exp_f32 v53, v53
    s_waitcnt lgkmcnt(3)
    v_smfmac_f32_32x32x32_bf16 v[20:35], v[84:87], v[44:51], v4
    ds_read_b128 v[80:83], v98 offset:4864
    v_exp_f32 v54, v54
    v_exp_f32 v55, v55
    v_exp_f32 v56, v56
    v_exp_f32 v57, v57
    s_waitcnt lgkmcnt(2)
    v_mfma_f32_32x32x16_bf16 v[36:51], v[68:71], v[8:11], 0
    ds_read_b128 v[72:75], v96 offset:5120
    v_exp_f32 v58, v58
    v_exp_f32 v59, v59
    v_exp_f32 v60, v60
    v_exp_f32 v61, v61
    v_mfma_f32_32x32x8_bf16 v[36:51], v[78:79], v[12:13], v[36:51]
    v_exp_f32 v62, v62
    v_exp_f32 v63, v63
    v_exp_f32 v64, v64
    v_exp_f32 v65, v65
    v_smfmac_f32_32x32x32_bf16 v[20:35], v[88:91], v[52:59], v4
    ds_read_b128 v[84:87], v98 offset:5472
    v_exp_f32 v66, v66
    v_exp_f32 v67, v67
    v_exp_f32 v36, v36
    v_exp_f32 v37, v37
    s_waitcnt lgkmcnt(3)
    v_smfmac_f32_32x32x32_bf16 v[20:35], v[92:95], v[60:67], v4
    ds_read_b128 v[88:91], v98 offset:6080
    v_exp_f32 v38, v38
    v_exp_f32 v39, v39
    v_exp_f32 v40, v40
    v_exp_f32 v41, v41
    s_waitcnt lgkmcnt(2)
    v_mfma_f32_32x32x16_bf16 v[52:67], v[72:75], v[8:11], 0
    ds_read_b128 v[68:71], v96 offset:6144
    v_exp_f32 v42, v42
    v_exp_f32 v43, v43
    v_exp_f32 v44, v44
    v_exp_f32 v45, v45
    v_mfma_f32_32x32x8_bf16 v[52:67], v[78:79], v[14:15], v[52:67]
    v_exp_f32 v46, v46
    v_exp_f32 v47, v47
    v_exp_f32 v48, v48
    v_exp_f32 v49, v49
    v_smfmac_f32_32x32x32_bf16 v[20:35], v[80:83], v[36:43], v4
    ds_read_b128 v[92:95], v98 offset:6688
    v_exp_f32 v50, v50
    v_exp_f32 v51, v51
    v_exp_f32 v52, v52
    v_exp_f32 v53, v53
    s_waitcnt lgkmcnt(3)
    v_smfmac_f32_32x32x32_bf16 v[20:35], v[84:87], v[44:51], v4
    ds_read_b128 v[80:83], v98 offset:7296
    v_exp_f32 v54, v54
    v_exp_f32 v55, v55
    v_exp_f32 v56, v56
    v_exp_f32 v57, v57
    s_waitcnt lgkmcnt(2)
    v_mfma_f32_32x32x16_bf16 v[36:51], v[68:71], v[8:11], 0
    ds_read_b128 v[72:75], v96 offset:7168
    v_exp_f32 v58, v58
    v_exp_f32 v59, v59
    v_exp_f32 v60, v60
    v_exp_f32 v61, v61
    v_mfma_f32_32x32x8_bf16 v[36:51], v[78:79], v[16:17], v[36:51]
    v_exp_f32 v62, v62
    v_exp_f32 v63, v63
    v_exp_f32 v64, v64
    v_exp_f32 v65, v65
    v_smfmac_f32_32x32x32_bf16 v[20:35], v[88:91], v[52:59], v4
    ds_read_b128 v[84:87], v98 offset:7904
    v_exp_f32 v66, v66
    v_exp_f32 v67, v67
    s_waitcnt vmcnt(0)
    s_barrier
    v_exp_f32 v36, v36
    v_exp_f32 v37, v37
    s_waitcnt lgkmcnt(3)
    v_smfmac_f32_32x32x32_bf16 v[20:35], v[92:95], v[60:67], v4
    ds_read_b128 v[88:91], v98 offset:8512
    v_exp_f32 v38, v38
    v_exp_f32 v39, v39
    v_exp_f32 v40, v40
    v_exp_f32 v41, v41
    s_waitcnt lgkmcnt(2)
    v_mfma_f32_32x32x16_bf16 v[52:67], v[72:75], v[8:11], 0
    v_exp_f32 v42, v42
    v_exp_f32 v43, v43
    buffer_load_dwordx4 a[0:3], v1, s[8:11], s48 offen offset:0
    buffer_load_dwordx4 a[4:7], v1, s[8:11], s48 offen offset:1024
    v_exp_f32 v44, v44
    v_exp_f32 v45, v45
    v_mfma_f32_32x32x8_bf16 v[52:67], v[78:79], v[18:19], v[52:67]
    v_exp_f32 v46, v46
    v_exp_f32 v47, v47
    v_exp_f32 v48, v48
    v_exp_f32 v49, v49
    v_smfmac_f32_32x32x32_bf16 v[20:35], v[80:83], v[36:43], v4
    ds_read_b128 v[92:95], v98 offset:9120
    v_exp_f32 v50, v50
    v_exp_f32 v51, v51
    buffer_load_dwordx4 a[8:11], v1, s[8:11], s48 offen offset:2048
    buffer_load_dwordx4 a[12:15], v1, s[8:11], s48 offen offset:3072
    s_add_u32 s48, s48, 4096
    v_exp_f32 v52, v52
    v_exp_f32 v53, v53
    s_waitcnt lgkmcnt(2)
    v_smfmac_f32_32x32x32_bf16 v[20:35], v[84:87], v[44:51], v4
    v_exp_f32 v54, v54
    v_exp_f32 v55, v55
    v_exp_f32 v56, v56
    v_exp_f32 v57, v57
    v_exp_f32 v58, v58
    v_exp_f32 v59, v59
    buffer_load_dwordx4 a[16:19], v1, s[8:11], s48 offen offset:0
    buffer_load_dwordx4 a[20:23], v1, s[8:11], s48 offen offset:1024
    v_exp_f32 v60, v60
    v_exp_f32 v61, v61
    v_exp_f32 v62, v62
    v_exp_f32 v63, v63
    v_exp_f32 v64, v64
    v_exp_f32 v65, v65
    s_waitcnt lgkmcnt(1)
    v_smfmac_f32_32x32x32_bf16 v[20:35], v[88:91], v[52:59], v4
    v_exp_f32 v66, v66
    v_exp_f32 v67, v67
    buffer_load_dwordx4 a[24:27], v1, s[8:11], s48 offen offset:2048
    buffer_load_dwordx4 a[28:31], v1, s[8:11], s48 offen offset:3072
    s_add_u32 s48, s48, 4096
    s_waitcnt lgkmcnt(0)
    v_smfmac_f32_32x32x32_bf16 v[20:35], v[92:95], v[60:67], v4
    s_nop 11
    s_call_b64 s[30:31], F_fin
    v_accvgpr_read_b32 v8, a124
    v_accvgpr_read_b32 v9, a125
    v_accvgpr_read_b32 v10, a126
    v_accvgpr_read_b32 v11, a127
    v_accvgpr_read_b32 v19, a128
    v_accvgpr_read_b32 v20, a132
    v_accvgpr_read_b32 v21, a133
    v_accvgpr_read_b32 v22, a134
    v_accvgpr_read_b32 v23, a135
    v_accvgpr_read_b32 v24, a136
    v_accvgpr_read_b32 v25, a137
    v_accvgpr_read_b32 v26, a138
    v_accvgpr_read_b32 v27, a139
    v_accvgpr_read_b32 v28, a140
    v_accvgpr_read_b32 v29, a141
    v_accvgpr_read_b32 v30, a142
    v_accvgpr_read_b32 v31, a143
    v_cndmask_b32 v12, 0, v19, s[28:29]
    v_cndmask_b32 v17, 0, v19, s[28:29]
    v_cndmask_b32 v19, v19, 0, s[28:29]
    v_mov_b32 v14, v19
    s_lshl_b32 s42, s14, 13
    v_add_u32 v96, s42, v1
    s_lshl_b32 s42, s14, 10
    v_add_u32 v97, s42, v2
    s_mul_i32 s42, s14, 9728
    v_add_u32 v98, s42, v3
    s_add_u32 s13, s13, 8
    ds_read_b128 v[68:71], v96 offset:0
    ds_read2st64_b32 v[76:77], v97 offset0:0 offset1:1
    ds_read_b128 v[72:75], v96 offset:1024
    ds_read_b128 v[80:83], v98 offset:0
    ds_read_b128 v[84:87], v98 offset:608
    s_waitcnt lgkmcnt(4)
    v_mfma_f32_32x32x16_bf16 v[36:51], v[68:71], v[8:11], 0
    s_waitcnt lgkmcnt(3)
    v_mfma_f32_32x32x8_bf16 v[36:51], v[76:77], v[12:13], v[36:51]
    s_nop 11
    v_exp_f32 v36, v36
    v_exp_f32 v37, v37
    ds_read_b128 v[88:91], v98 offset:1216
    v_exp_f32 v38, v38
    v_exp_f32 v39, v39
    v_exp_f32 v40, v40
    v_exp_f32 v41, v41
    s_waitcnt lgkmcnt(3)
    v_mfma_f32_32x32x16_bf16 v[52:67], v[72:75], v[8:11], 0
    ds_read_b128 v[68:71], v96 offset:2048
    v_exp_f32 v42, v42
    v_exp_f32 v43, v43
    buffer_load_dwordx4 a[32:35], v1, s[8:11], s48 offen offset:0
    buffer_load_dwordx4 a[36:39], v1, s[8:11], s48 offen offset:1024
    v_exp_f32 v44, v44
    v_exp_f32 v45, v45
    v_mfma_f32_32x32x8_bf16 v[52:67], v[76:77], v[14:15], v[52:67]
    v_exp_f32 v46, v46
    v_exp_f32 v47, v47
    v_exp_f32 v48, v48
    v_exp_f32 v49, v49
    s_waitcnt lgkmcnt(3)
    v_smfmac_f32_32x32x32_bf16 v[20:35], v[80:83], v[36:43], v4
    ds_read_b128 v[92:95], v98 offset:1824
    v_exp_f32 v50, v50
    v_exp_f32 v51, v51
    buffer_load_dwordx4 a[40:43], v1, s[8:11], s48 offen offset:2048
    buffer_load_dwordx4 a[44:47], v1, s[8:11], s48 offen offset:3072
    s_add_u32 s48, s48, 4096
    v_exp_f32 v52, v52
    v_exp_f32 v53, v53
    s_waitcnt lgkmcnt(3)
    v_smfmac_f32_32x32x32_bf16 v[20:35], v[84:87], v[44:51], v4
    ds_read_b128 v[80:83], v98 offset:2432
    v_exp_f32 v54, v54
    v_exp_f32 v55, v55
    v_exp_f32 v56, v56
    v_exp_f32 v57, v57
    s_waitcnt lgkmcnt(2)
    v_mfma_f32_32x32x16_bf16 v[36:51], v[68:71], v[8:11], 0
    ds_read_b128 v[72:75], v96 offset:3072
    v_exp_f32 v58, v58
    v_exp_f32 v59, v59
    buffer_load_dwordx4 a[48:51], v1, s[8:11], s48 offen offset:0
    buffer_load_dwordx4 a[52:55], v1, s[8:11], s48 offen offset:1024
    v_exp_f32 v60, v60
    v_exp_f32 v61, v61
    v_mfma_f32_32x32x8_bf16 v[36:51], v[76:77], v[16:17], v[36:51]
    ds_read2st64_b32 v[78:79], v97 offset0:2 offset1:3
    v_exp_f32 v62, v62
    v_exp_f32 v63, v63
    v_exp_f32 v64, v64
    v_exp_f32 v65, v65
    v_smfmac_f32_32x32x32_bf16 v[20:35], v[88:91], v[52:59], v4
    ds_read_b128 v[84:87], v98 offset:3040
    v_exp_f32 v66, v66
    v_exp_f32 v67, v67
    buffer_load_dwordx4 a[56:59], v1, s[8:11], s48 offen offset:2048
    buffer_load_dwordx4 a[60:63], v1, s[8:11], s48 offen offset:3072
    s_add_u32 s48, s48, 4096
    v_exp_f32 v36, v36
    v_exp_f32 v37, v37
    s_waitcnt lgkmcnt(4)
    v_smfmac_f32_32x32x32_bf16 v[20:35], v[92:95], v[60:67], v4
    ds_read_b128 v[88:91], v98 offset:3648
    v_exp_f32 v38, v38
    v_exp_f32 v39, v39
    v_exp_f32 v40, v40
    v_exp_f32 v41, v41
    s_waitcnt lgkmcnt(3)
    v_mfma_f32_32x32x16_bf16 v[52:67], v[72:75], v[8:11], 0
    ds_read_b128 v[68:71], v96 offset:4096
    v_exp_f32 v42, v42
    v_exp_f32 v43, v43
    buffer_load_dwordx4 a[64:67], v1, s[8:11], s48 offen offset:0
    buffer_load_dwordx4 a[68:71], v1, s[8:11], s48 offen offset:1024
    v_exp_f32 v44, v44
    v_exp_f32 v45, v45
    v_mfma_f32_32x32x8_bf16 v[52:67], v[76:77], v[18:19], v[52:67]
    v_exp_f32 v46, v46
    v_exp_f32 v47, v47
    v_exp_f32 v48, v48
    v_exp_f32 v49, v49
    v_smfmac_f32_32x32x32_bf16 v[20:35], v[80:83], v[36:43], v4
    ds_read_b128 v[92:95], v98 offset:4256
    v_exp_f32 v50, v50
    v_exp_f32 v51, v51
    buffer_load_dwordx4 a[72:75], v1, s[8:11], s48 offen offset:2048
    buffer_load_dwordx4 a[76:79], v1, s[8:11], s48 offen offset:3072
    s_add_u32 s48, s48, 4096
    v_exp_f32 v52, v52
    v_exp_f32 v53, v53
    s_waitcnt lgkmcnt(3)
    v_smfmac_f32_32x32x32_bf16 v[20:35], v[84:87], v[44:51], v4
    ds_read_b128 v[80:83], v98 offset:4864
    v_exp_f32 v54, v54
    v_exp_f32 v55, v55
    v_exp_f32 v56, v56
    v_exp_f32 v57, v57
    s_waitcnt lgkmcnt(2)
    v_mfma_f32_32x32x16_bf16 v[36:51], v[68:71], v[8:11], 0
    ds_read_b128 v[72:75], v96 offset:5120
    v_exp_f32 v58, v58
    v_exp_f32 v59, v59
    buffer_load_dwordx4 a[80:83], v1, s[8:11], s48 offen offset:0
    buffer_load_dwordx4 a[84:87], v1, s[8:11], s48 offen offset:1024
    v_exp_f32 v60, v60
    v_exp_f32 v61, v61
    v_mfma_f32_32x32x8_bf16 v[36:51], v[78:79], v[12:13], v[36:51]
    v_exp_f32 v62, v62
    v_exp_f32 v63, v63
    v_exp_f32 v64, v64
    v_exp_f32 v65, v65
    v_smfmac_f32_32x32x32_bf16 v[20:35], v[88:91], v[52:59], v4
    ds_read_b128 v[84:87], v98 offset:5472
    v_exp_f32 v66, v66
    v_exp_f32 v67, v67
    buffer_load_dwordx4 a[88:91], v1, s[8:11], s48 offen offset:2048
    buffer_load_dwordx4 a[92:95], v1, s[8:11], s48 offen offset:3072
    s_add_u32 s48, s48, 4096
    v_exp_f32 v36, v36
    v_exp_f32 v37, v37
    s_waitcnt lgkmcnt(3)
    v_smfmac_f32_32x32x32_bf16 v[20:35], v[92:95], v[60:67], v4
    ds_read_b128 v[88:91], v98 offset:6080
    v_exp_f32 v38, v38
    v_exp_f32 v39, v39
    v_exp_f32 v40, v40
    v_exp_f32 v41, v41
    s_waitcnt lgkmcnt(2)
    v_mfma_f32_32x32x16_bf16 v[52:67], v[72:75], v[8:11], 0
    ds_read_b128 v[68:71], v96 offset:6144
    v_exp_f32 v42, v42
    v_exp_f32 v43, v43
    buffer_load_dwordx4 a[96:99], v1, s[8:11], s48 offen offset:0
    buffer_load_dwordx4 a[100:103], v1, s[8:11], s48 offen offset:1024
    v_exp_f32 v44, v44
    v_exp_f32 v45, v45
    v_mfma_f32_32x32x8_bf16 v[52:67], v[78:79], v[14:15], v[52:67]
    v_exp_f32 v46, v46
    v_exp_f32 v47, v47
    v_exp_f32 v48, v48
    v_exp_f32 v49, v49
    v_smfmac_f32_32x32x32_bf16 v[20:35], v[80:83], v[36:43], v4
    ds_read_b128 v[92:95], v98 offset:6688
    v_exp_f32 v50, v50
    v_exp_f32 v51, v51
    buffer_load_dwordx4 a[104:107], v1, s[8:11], s48 offen offset:2048
    buffer_load_dwordx4 a[108:111], v1, s[8:11], s48 offen offset:3072
    s_add_u32 s48, s48, 4096
    v_exp_f32 v52, v52
    v_exp_f32 v53, v53
    s_waitcnt lgkmcnt(3)
    v_smfmac_f32_32x32x32_bf16 v[20:35], v[84:87], v[44:51], v4
    ds_read_b128 v[80:83], v98 offset:7296
    v_exp_f32 v54, v54
    v_exp_f32 v55, v55
    v_exp_f32 v56, v56
    v_exp_f32 v57, v57
    s_waitcnt lgkmcnt(2)
    v_mfma_f32_32x32x16_bf16 v[36:51], v[68:71], v[8:11], 0
    ds_read_b128 v[72:75], v96 offset:7168
    v_exp_f32 v58, v58
    v_exp_f32 v59, v59
    buffer_load_dwordx4 a[112:115], v1, s[8:11], s48 offen offset:0
    buffer_load_dwordx4 a[116:119], v1, s[8:11], s48 offen offset:1024
    v_exp_f32 v60, v60
    v_exp_f32 v61, v61
    v_mfma_f32_32x32x8_bf16 v[36:51], v[78:79], v[16:17], v[36:51]
    v_exp_f32 v62, v62
    v_exp_f32 v63, v63
    v_exp_f32 v64, v64
    v_exp_f32 v65, v65
    v_smfmac_f32_32x32x32_bf16 v[20:35], v[88:91], v[52:59], v4
    ds_read_b128 v[84:87], v98 offset:7904
    v_exp_f32 v66, v66
    v_exp_f32 v67, v67
    buffer_load_dwordx4 a[120:123], v1, s[8:11], s48 offen offset:2048
    buffer_load_dwordx4 a[124:127], v1, s[8:11], s48 offen offset:3072
    s_add_u32 s48, s48, 4096
    v_exp_f32 v36, v36
    v_exp_f32 v37, v37
    s_waitcnt lgkmcnt(3)
    v_smfmac_f32_32x32x32_bf16 v[20:35], v[92:95], v[60:67], v4
    ds_read_b128 v[88:91], v98 offset:8512
    v_exp_f32 v38, v38
    v_exp_f32 v39, v39
    v_exp_f32 v40, v40
    v_exp_f32 v41, v41
    s_waitcnt lgkmcnt(2)
    v_mfma_f32_32x32x16_bf16 v[52:67], v[72:75], v[8:11], 0
    v_exp_f32 v42, v42
    v_exp_f32 v43, v43
    buffer_load_dwordx4 a[128:131], v1, s[8:11], s48 offen offset:0
    buffer_load_dwordx4 a[132:135], v1, s[8:11], s48 offen offset:1024
    v_exp_f32 v44, v44
    v_exp_f32 v45, v45
    v_mfma_f32_32x32x8_bf16 v[52:67], v[78:79], v[18:19], v[52:67]
    v_exp_f32 v46, v46
    v_exp_f32 v47, v47
    v_exp_f32 v48, v48
    v_exp_f32 v49, v49
    v_smfmac_f32_32x32x32_bf16 v[20:35], v[80:83], v[36:43], v4
    ds_read_b128 v[92:95], v98 offset:9120
    v_exp_f32 v50, v50
    v_exp_f32 v51, v51
    buffer_load_dwordx4 a[136:139], v1, s[8:11], s48 offen offset:2048
    buffer_load_dwordx4 a[140:143], v1, s[8:11], s48 offen offset:3072
    s_add_u32 s48, s48, 4096
    v_exp_f32 v52, v52
    v_exp_f32 v53, v53
    s_waitcnt lgkmcnt(2)
    v_smfmac_f32_32x32x32_bf16 v[20:35], v[84:87], v[44:51], v4
    v_exp_f32 v54, v54
    v_exp_f32 v55, v55
    v_exp_f32 v56, v56
    v_exp_f32 v57, v57
    v_exp_f32 v58, v58
    v_exp_f32 v59, v59
    v_exp_f32 v60, v60
    v_exp_f32 v61, v61
    v_exp_f32 v62, v62
    v_exp_f32 v63, v63
    v_exp_f32 v64, v64
    v_exp_f32 v65, v65
    s_waitcnt lgkmcnt(1)
    v_smfmac_f32_32x32x32_bf16 v[20:35], v[88:91], v[52:59], v4
    v_exp_f32 v66, v66
    v_exp_f32 v67, v67
    s_waitcnt lgkmcnt(0)
    s_nop 0
    v_smfmac_f32_32x32x32_bf16 v[20:35], v[92:95], v[60:67], v4
    s_nop 11
    s_branch F_e2
F_bo:
    s_lshl_b32 s43, s12, 7
    s_add_u32 s43, s43, 3201024
    s_lshl_b32 s40, s46, 11
    s_add_u32 s40, s40, s47
    s_add_u32 s40, s40, 8388608
    s_waitcnt vmcnt(0)
    s_barrier
    s_cmp_lg_u32 s32, 1
    s_cbranch_scc1 F_s1
    v_mov_b32 v12, 1
    s_mov_b64 exec, 1
    buffer_atomic_add v12, off, s[8:11], s43
    s_mov_b64 exec, -1
F_s1:
    s_cmp_ge_u32 s33, 24
    s_cbranch_scc1 F_exit
    s_cmp_lt_u32 s32, 2
    s_cbranch_scc1 F_b2
    buffer_load_dwordx4 v[32:35], v1, s[8:11], s40 offen offset:0
    buffer_load_dwordx4 v[36:39], v1, s[8:11], s40 offen offset:1024
    s_lshl_b32 s34, s46, 6
    v_and_b32 v7, 31, v0
    v_mul_u32_u24 v7, 1152, v7
    v_lshrrev_b32 v6, 5, v0
    v_lshl_add_u32 v7, v6, 4, v7
    v_add_u32 v11, s34, v7
    s_waitcnt vmcnt(0)
    v_lshlrev_b32 v16, 16, v32
    v_and_b32 v17, 0xffff0000, v32
    v_lshlrev_b32 v18, 16, v33
    v_and_b32 v19, 0xffff0000, v33
    v_lshlrev_b32 v20, 16, v34
    v_and_b32 v21, 0xffff0000, v34
    v_lshlrev_b32 v22, 16, v35
    v_and_b32 v23, 0xffff0000, v35
    v_lshlrev_b32 v24, 16, v36
    v_and_b32 v25, 0xffff0000, v36
    v_lshlrev_b32 v26, 16, v37
    v_and_b32 v27, 0xffff0000, v37
    v_lshlrev_b32 v28, 16, v38
    v_and_b32 v29, 0xffff0000, v38
    v_lshlrev_b32 v30, 16, v39
    v_and_b32 v31, 0xffff0000, v39
    s_branch F_fl_ok
F_b2:
    s_cmp_lg_u32 s32, 1
    s_cbranch_scc1 F_fl_ok
F_fl:
    buffer_load_dword v12, off, s[8:11], s43 sc1
    s_sub_u32 s95, s95, 1
    s_cmp_eq_u32 s95, 0
    s_cbranch_scc1 F_exit
    s_waitcnt vmcnt(0)
    v_cmp_gt_u32 vcc, 32, v12
    s_cbranch_vccz F_fl_ok
    s_sleep 0
    s_branch F_fl
F_fl_ok:
    s_barrier
    s_lshl_b32 s34, s32, 10
    s_add_u32 s35, s47, s34
    s_add_u32 s35, s35, 92274688
    s_add_u32 m0, s34, 0
    s_add_u32 s37, s35, 0
    buffer_load_dwordx4 v1, s[8:11], s37 offen sc1 lds
    s_add_u32 m0, s34, 8192
    s_add_u32 s37, s35, 8192
    buffer_load_dwordx4 v1, s[8:11], s37 offen sc1 lds
    s_add_u32 m0, s34, 16384
    s_add_u32 s37, s35, 16384
    buffer_load_dwordx4 v1, s[8:11], s37 offen sc1 lds
    s_add_u32 m0, s34, 24576
    s_add_u32 s37, s35, 24576
    buffer_load_dwordx4 v1, s[8:11], s37 offen sc1 lds
    s_cmp_ge_u32 s32, 4
    s_cbranch_scc1 F_b4
    s_add_u32 m0, s34, 32768
    s_add_u32 s37, s35, 32768
    buffer_load_dwordx4 v1, s[8:11], s37 offen sc1 lds
F_b4:
    s_waitcnt vmcnt(0)
    s_barrier
    s_cmp_lt_u32 s32, 2
    s_cbranch_scc1 F_exit
    ds_read_b128 v[40:43], v1 offset:0
    ds_read_b128 v[44:47], v1 offset:1024
    ds_read_b128 v[48:51], v1 offset:2048
    s_waitcnt lgkmcnt(2)
    v_mfma_f32_32x32x16_bf16 v[16:31], a[0:3], v[40:43], v[16:31]
    ds_read_b128 v[52:55], v1 offset:3072
    s_waitcnt lgkmcnt(2)
    v_mfma_f32_32x32x16_bf16 v[16:31], a[4:7], v[44:47], v[16:31]
    ds_read_b128 v[40:43], v1 offset:4096
    s_waitcnt lgkmcnt(2)
    v_mfma_f32_32x32x16_bf16 v[16:31], a[8:11], v[48:51], v[16:31]
    ds_read_b128 v[44:47], v1 offset:5120
    s_waitcnt lgkmcnt(2)
    v_mfma_f32_32x32x16_bf16 v[16:31], a[12:15], v[52:55], v[16:31]
    ds_read_b128 v[48:51], v1 offset:6144
    s_waitcnt lgkmcnt(2)
    v_mfma_f32_32x32x16_bf16 v[16:31], a[16:19], v[40:43], v[16:31]
    ds_read_b128 v[52:55], v1 offset:7168
    s_waitcnt lgkmcnt(2)
    v_mfma_f32_32x32x16_bf16 v[16:31], a[20:23], v[44:47], v[16:31]
    ds_read_b128 v[40:43], v1 offset:8192
    s_waitcnt lgkmcnt(2)
    v_mfma_f32_32x32x16_bf16 v[16:31], a[24:27], v[48:51], v[16:31]
    ds_read_b128 v[44:47], v1 offset:9216
    s_waitcnt lgkmcnt(2)
    v_mfma_f32_32x32x16_bf16 v[16:31], a[28:31], v[52:55], v[16:31]
    ds_read_b128 v[48:51], v1 offset:10240
    s_waitcnt lgkmcnt(2)
    v_mfma_f32_32x32x16_bf16 v[16:31], a[32:35], v[40:43], v[16:31]
    ds_read_b128 v[52:55], v1 offset:11264
    s_waitcnt lgkmcnt(2)
    v_mfma_f32_32x32x16_bf16 v[16:31], a[36:39], v[44:47], v[16:31]
    ds_read_b128 v[40:43], v1 offset:12288
    s_waitcnt lgkmcnt(2)
    v_mfma_f32_32x32x16_bf16 v[16:31], a[40:43], v[48:51], v[16:31]
    ds_read_b128 v[44:47], v1 offset:13312
    s_waitcnt lgkmcnt(2)
    v_mfma_f32_32x32x16_bf16 v[16:31], a[44:47], v[52:55], v[16:31]
    ds_read_b128 v[48:51], v1 offset:14336
    s_waitcnt lgkmcnt(2)
    v_mfma_f32_32x32x16_bf16 v[16:31], a[48:51], v[40:43], v[16:31]
    ds_read_b128 v[52:55], v1 offset:15360
    s_waitcnt lgkmcnt(2)
    v_mfma_f32_32x32x16_bf16 v[16:31], a[52:55], v[44:47], v[16:31]
    ds_read_b128 v[40:43], v1 offset:16384
    s_waitcnt lgkmcnt(2)
    v_mfma_f32_32x32x16_bf16 v[16:31], a[56:59], v[48:51], v[16:31]
    ds_read_b128 v[44:47], v1 offset:17408
    s_waitcnt lgkmcnt(2)
    v_mfma_f32_32x32x16_bf16 v[16:31], a[60:63], v[52:55], v[16:31]
    ds_read_b128 v[48:51], v1 offset:18432
    s_waitcnt lgkmcnt(2)
    v_mfma_f32_32x32x16_bf16 v[16:31], a[64:67], v[40:43], v[16:31]
    ds_read_b128 v[52:55], v1 offset:19456
    s_waitcnt lgkmcnt(2)
    v_mfma_f32_32x32x16_bf16 v[16:31], a[68:71], v[44:47], v[16:31]
    ds_read_b128 v[40:43], v1 offset:20480
    s_waitcnt lgkmcnt(2)
    v_mfma_f32_32x32x16_bf16 v[16:31], a[72:75], v[48:51], v[16:31]
    ds_read_b128 v[44:47], v1 offset:21504
    s_waitcnt lgkmcnt(2)
    v_mfma_f32_32x32x16_bf16 v[16:31], a[76:79], v[52:55], v[16:31]
    ds_read_b128 v[48:51], v1 offset:22528
    s_waitcnt lgkmcnt(2)
    v_mfma_f32_32x32x16_bf16 v[16:31], a[80:83], v[40:43], v[16:31]
    ds_read_b128 v[52:55], v1 offset:23552
    s_waitcnt lgkmcnt(2)
    v_mfma_f32_32x32x16_bf16 v[16:31], a[84:87], v[44:47], v[16:31]
    ds_read_b128 v[40:43], v1 offset:24576
    s_waitcnt lgkmcnt(2)
    v_mfma_f32_32x32x16_bf16 v[16:31], a[88:91], v[48:51], v[16:31]
    ds_read_b128 v[44:47], v1 offset:25600
    s_waitcnt lgkmcnt(2)
    v_mfma_f32_32x32x16_bf16 v[16:31], a[92:95], v[52:55], v[16:31]
    ds_read_b128 v[48:51], v1 offset:26624
    s_waitcnt lgkmcnt(2)
    v_mfma_f32_32x32x16_bf16 v[16:31], a[96:99], v[40:43], v[16:31]
    ds_read_b128 v[52:55], v1 offset:27648
    s_waitcnt lgkmcnt(2)
    v_mfma_f32_32x32x16_bf16 v[16:31], a[100:103], v[44:47], v[16:31]
    ds_read_b128 v[40:43], v1 offset:28672
    s_waitcnt lgkmcnt(2)
    v_mfma_f32_32x32x16_bf16 v[16:31], a[104:107], v[48:51], v[16:31]
    ds_read_b128 v[44:47], v1 offset:29696
    s_waitcnt lgkmcnt(2)
    v_mfma_f32_32x32x16_bf16 v[16:31], a[108:111], v[52:55], v[16:31]
    ds_read_b128 v[48:51], v1 offset:30720
    s_waitcnt lgkmcnt(2)
    v_mfma_f32_32x32x16_bf16 v[16:31], a[112:115], v[40:43], v[16:31]
    ds_read_b128 v[52:55], v1 offset:31744
    s_waitcnt lgkmcnt(2)
    v_mfma_f32_32x32x16_bf16 v[16:31], a[116:119], v[44:47], v[16:31]
    ds_read_b128 v[40:43], v1 offset:32768
    s_waitcnt lgkmcnt(2)
    v_mfma_f32_32x32x16_bf16 v[16:31], a[120:123], v[48:51], v[16:31]
    ds_read_b128 v[44:47], v1 offset:33792
    s_waitcnt lgkmcnt(2)
    v_mfma_f32_32x32x16_bf16 v[16:31], a[124:127], v[52:55], v[16:31]
    ds_read_b128 v[48:51], v1 offset:34816
    s_waitcnt lgkmcnt(2)
    v_mfma_f32_32x32x16_bf16 v[16:31], a[128:131], v[40:43], v[16:31]
    ds_read_b128 v[52:55], v1 offset:35840
    s_waitcnt lgkmcnt(2)
    v_mfma_f32_32x32x16_bf16 v[16:31], a[132:135], v[44:47], v[16:31]
    s_waitcnt lgkmcnt(1)
    v_mfma_f32_32x32x16_bf16 v[16:31], a[136:139], v[48:51], v[16:31]
    s_waitcnt lgkmcnt(0)
    v_mfma_f32_32x32x16_bf16 v[16:31], a[140:143], v[52:55], v[16:31]
    s_nop 11
    v_cvt_pk_bf16_f32 v32, v16, v17
    v_cvt_pk_bf16_f32 v33, v18, v19
    v_cvt_pk_bf16_f32 v34, v20, v21
    v_cvt_pk_bf16_f32 v35, v22, v23
    v_cvt_pk_bf16_f32 v36, v24, v25
    v_cvt_pk_bf16_f32 v37, v26, v27
    v_cvt_pk_bf16_f32 v38, v28, v29
    v_cvt_pk_bf16_f32 v39, v30, v31
    buffer_store_dwordx4 v[32:35], v11, s[20:23], s47 offen
    buffer_store_dwordx4 v[36:39], v11, s[20:23], s47 offen offset:32
F_exit:
    s_endpgm
F_fin:
    v_mov_b32 v6, v30
    v_mov_b32 v7, v30
    s_nop 1
    v_permlane32_swap_b32 v6, v7
    v_rcp_f32 v7, v6
    s_nop 0
    v_max_f32 v36, v6, v7
    v_cmp_nge_f32 vcc, 0x5d800000, v36
    s_cbranch_vccnz F_slow
F_out:
    v_mul_f32 v20, v20, v7
    v_mul_f32 v21, v21, v7
    v_mul_f32 v22, v22, v7
    v_mul_f32 v23, v23, v7
    v_mul_f32 v24, v24, v7
    v_mul_f32 v25, v25, v7
    v_mul_f32 v26, v26, v7
    v_mul_f32 v27, v27, v7
    v_mul_f32 v28, v28, v7
    v_mul_f32 v29, v29, v7
    v_cvt_pk_bf16_f32 v100, v20, v21
    v_cvt_pk_bf16_f32 v101, v22, v23
    v_cvt_pk_bf16_f32 v102, v24, v25
    v_cvt_pk_bf16_f32 v103, v26, v27
    v_cvt_pk_bf16_f32 v104, v28, v29
    s_mul_i32 s34, s13, 36864
    s_add_u32 s34, s34, 92274688
    s_lshl_b32 s35, s33, 10
    s_add_u32 s35, s35, s34
    buffer_store_dwordx4 v[100:103], v1, s[8:11], s35 offen sc1
    s_lshr_b32 s35, s33, 2
    s_lshl_b32 s35, s35, 9
    s_and_b32 s36, s33, 3
    s_lshl_b32 s36, s36, 2
    s_add_u32 s35, s35, s36
    s_add_u32 s35, s35, s34
    s_add_u32 s35, s35, 32768
    s_mov_b32 exec_hi, 0
    buffer_store_dword v104, v1, s[8:11], s35 offen sc1
    s_mov_b32 exec_hi, -1
    s_setpc_b64 s[30:31]
F_slow:
    s_nop 15
    v_mov_b32 v6, 0xff800000
    v_mov_b32 v96, v1
    v_mov_b32 v97, v2
    v_mov_b32 v98, v3
    s_mov_b32 s42, 16
F_p1:
    ds_read2st64_b32 v[76:77], v97 offset0:0 offset1:1
    ds_read_b128 v[68:71], v96 offset:0
    s_waitcnt lgkmcnt(0)
    v_mfma_f32_32x32x16_bf16 v[36:51], v[68:71], v[8:11], 0
    v_mfma_f32_32x32x8_bf16 v[36:51], v[76:77], v[12:13], v[36:51]
    s_nop 11
    v_max3_f32 v6, v6, v36, v37
    v_max3_f32 v6, v6, v38, v39
    v_max3_f32 v6, v6, v40, v41
    v_max3_f32 v6, v6, v42, v43
    v_max3_f32 v6, v6, v44, v45
    v_max3_f32 v6, v6, v46, v47
    v_max3_f32 v6, v6, v48, v49
    v_max3_f32 v6, v6, v50, v51
    ds_read_b128 v[72:75], v96 offset:1024
    s_waitcnt lgkmcnt(0)
    v_mfma_f32_32x32x16_bf16 v[36:51], v[72:75], v[8:11], 0
    v_mfma_f32_32x32x8_bf16 v[36:51], v[76:77], v[14:15], v[36:51]
    s_nop 11
    v_max3_f32 v6, v6, v36, v37
    v_max3_f32 v6, v6, v38, v39
    v_max3_f32 v6, v6, v40, v41
    v_max3_f32 v6, v6, v42, v43
    v_max3_f32 v6, v6, v44, v45
    v_max3_f32 v6, v6, v46, v47
    v_max3_f32 v6, v6, v48, v49
    v_max3_f32 v6, v6, v50, v51
    ds_read_b128 v[68:71], v96 offset:2048
    s_waitcnt lgkmcnt(0)
    v_mfma_f32_32x32x16_bf16 v[36:51], v[68:71], v[8:11], 0
    v_mfma_f32_32x32x8_bf16 v[36:51], v[76:77], v[16:17], v[36:51]
    s_nop 11
    v_max3_f32 v6, v6, v36, v37
    v_max3_f32 v6, v6, v38, v39
    v_max3_f32 v6, v6, v40, v41
    v_max3_f32 v6, v6, v42, v43
    v_max3_f32 v6, v6, v44, v45
    v_max3_f32 v6, v6, v46, v47
    v_max3_f32 v6, v6, v48, v49
    v_max3_f32 v6, v6, v50, v51
    ds_read_b128 v[72:75], v96 offset:3072
    s_waitcnt lgkmcnt(0)
    v_mfma_f32_32x32x16_bf16 v[36:51], v[72:75], v[8:11], 0
    v_mfma_f32_32x32x8_bf16 v[36:51], v[76:77], v[18:19], v[36:51]
    s_nop 11
    v_max3_f32 v6, v6, v36, v37
    v_max3_f32 v6, v6, v38, v39
    v_max3_f32 v6, v6, v40, v41
    v_max3_f32 v6, v6, v42, v43
    v_max3_f32 v6, v6, v44, v45
    v_max3_f32 v6, v6, v46, v47
    v_max3_f32 v6, v6, v48, v49
    v_max3_f32 v6, v6, v50, v51
    v_add_u32 v96, 4096, v96
    v_add_u32 v97, 512, v97
    v_add_u32 v98, 4864, v98
    s_sub_u32 s42, s42, 1
    s_cmp_lg_u32 s42, 0
    s_cbranch_scc1 F_p1
    s_nop 15
    v_mov_b32 v7, v6
    s_nop 1
    v_permlane32_swap_b32 v6, v7
    v_max_f32 v6, v6, v7
    v_sub_f32 v52, 0, v6
    v_sub_f32 v53, 0, v6
    v_sub_f32 v54, 0, v6
    v_sub_f32 v55, 0, v6
    v_sub_f32 v56, 0, v6
    v_sub_f32 v57, 0, v6
    v_sub_f32 v58, 0, v6
    v_sub_f32 v59, 0, v6
    v_sub_f32 v60, 0, v6
    v_sub_f32 v61, 0, v6
    v_sub_f32 v62, 0, v6
    v_sub_f32 v63, 0, v6
    v_sub_f32 v64, 0, v6
    v_sub_f32 v65, 0, v6
    v_sub_f32 v66, 0, v6
    v_sub_f32 v67, 0, v6
    v_mov_b32 v20, 0
    v_mov_b32 v21, 0
    v_mov_b32 v22, 0
    v_mov_b32 v23, 0
    v_mov_b32 v24, 0
    v_mov_b32 v25, 0
    v_mov_b32 v26, 0
    v_mov_b32 v27, 0
    v_mov_b32 v28, 0
    v_mov_b32 v29, 0
    v_mov_b32 v30, 0
    v_mov_b32 v31, 0
    v_mov_b32 v32, 0
    v_mov_b32 v33, 0
    v_mov_b32 v34, 0
    v_mov_b32 v35, 0
    v_mov_b32 v96, v1
    v_mov_b32 v97, v2
    v_mov_b32 v98, v3
    s_mov_b32 s42, 16
F_p2:
    ds_read2st64_b32 v[76:77], v97 offset0:0 offset1:1
    ds_read_b128 v[68:71], v96 offset:0
    ds_read_b128 v[80:83], v98 offset:0
    ds_read_b128 v[84:87], v98 offset:608
    s_waitcnt lgkmcnt(0)
    v_mfma_f32_32x32x16_bf16 v[36:51], v[68:71], v[8:11], v[52:67]
    v_mfma_f32_32x32x8_bf16 v[36:51], v[76:77], v[12:13], v[36:51]
    s_nop 11
    v_exp_f32 v36, v36
    v_exp_f32 v37, v37
    v_exp_f32 v38, v38
    v_exp_f32 v39, v39
    v_exp_f32 v40, v40
    v_exp_f32 v41, v41
    v_exp_f32 v42, v42
    v_exp_f32 v43, v43
    v_exp_f32 v44, v44
    v_exp_f32 v45, v45
    v_exp_f32 v46, v46
    v_exp_f32 v47, v47
    v_exp_f32 v48, v48
    v_exp_f32 v49, v49
    v_exp_f32 v50, v50
    v_exp_f32 v51, v51
    v_smfmac_f32_32x32x32_bf16 v[20:35], v[80:83], v[36:43], v4
    s_nop 0
    v_smfmac_f32_32x32x32_bf16 v[20:35], v[84:87], v[44:51], v4
    ds_read_b128 v[72:75], v96 offset:1024
    ds_read_b128 v[88:91], v98 offset:1216
    ds_read_b128 v[92:95], v98 offset:1824
    s_waitcnt lgkmcnt(0)
    v_mfma_f32_32x32x16_bf16 v[36:51], v[72:75], v[8:11], v[52:67]
    v_mfma_f32_32x32x8_bf16 v[36:51], v[76:77], v[14:15], v[36:51]
    s_nop 11
    v_exp_f32 v36, v36
    v_exp_f32 v37, v37
    v_exp_f32 v38, v38
    v_exp_f32 v39, v39
    v_exp_f32 v40, v40
    v_exp_f32 v41, v41
    v_exp_f32 v42, v42
    v_exp_f32 v43, v43
    v_exp_f32 v44, v44
    v_exp_f32 v45, v45
    v_exp_f32 v46, v46
    v_exp_f32 v47, v47
    v_exp_f32 v48, v48
    v_exp_f32 v49, v49
    v_exp_f32 v50, v50
    v_exp_f32 v51, v51
    v_smfmac_f32_32x32x32_bf16 v[20:35], v[88:91], v[36:43], v4
    s_nop 0
    v_smfmac_f32_32x32x32_bf16 v[20:35], v[92:95], v[44:51], v4
    ds_read_b128 v[68:71], v96 offset:2048
    ds_read_b128 v[80:83], v98 offset:2432
    ds_read_b128 v[84:87], v98 offset:3040
    s_waitcnt lgkmcnt(0)
    v_mfma_f32_32x32x16_bf16 v[36:51], v[68:71], v[8:11], v[52:67]
    v_mfma_f32_32x32x8_bf16 v[36:51], v[76:77], v[16:17], v[36:51]
    s_nop 11
    v_exp_f32 v36, v36
    v_exp_f32 v37, v37
    v_exp_f32 v38, v38
    v_exp_f32 v39, v39
    v_exp_f32 v40, v40
    v_exp_f32 v41, v41
    v_exp_f32 v42, v42
    v_exp_f32 v43, v43
    v_exp_f32 v44, v44
    v_exp_f32 v45, v45
    v_exp_f32 v46, v46
    v_exp_f32 v47, v47
    v_exp_f32 v48, v48
    v_exp_f32 v49, v49
    v_exp_f32 v50, v50
    v_exp_f32 v51, v51
    v_smfmac_f32_32x32x32_bf16 v[20:35], v[80:83], v[36:43], v4
    s_nop 0
    v_smfmac_f32_32x32x32_bf16 v[20:35], v[84:87], v[44:51], v4
    ds_read_b128 v[72:75], v96 offset:3072
    ds_read_b128 v[88:91], v98 offset:3648
    ds_read_b128 v[92:95], v98 offset:4256
    s_waitcnt lgkmcnt(0)
    v_mfma_f32_32x32x16_bf16 v[36:51], v[72:75], v[8:11], v[52:67]
    v_mfma_f32_32x32x8_bf16 v[36:51], v[76:77], v[18:19], v[36:51]
    s_nop 11
    v_exp_f32 v36, v36
    v_exp_f32 v37, v37
    v_exp_f32 v38, v38
    v_exp_f32 v39, v39
    v_exp_f32 v40, v40
    v_exp_f32 v41, v41
    v_exp_f32 v42, v42
    v_exp_f32 v43, v43
    v_exp_f32 v44, v44
    v_exp_f32 v45, v45
    v_exp_f32 v46, v46
    v_exp_f32 v47, v47
    v_exp_f32 v48, v48
    v_exp_f32 v49, v49
    v_exp_f32 v50, v50
    v_exp_f32 v51, v51
    v_smfmac_f32_32x32x32_bf16 v[20:35], v[88:91], v[36:43], v4
    s_nop 0
    v_smfmac_f32_32x32x32_bf16 v[20:35], v[92:95], v[44:51], v4
    v_add_u32 v96, 4096, v96
    v_add_u32 v97, 512, v97
    v_add_u32 v98, 4864, v98
    s_sub_u32 s42, s42, 1
    s_cmp_lg_u32 s42, 0
    s_cbranch_scc1 F_p2
    s_nop 15
    v_mov_b32 v6, v30
    v_mov_b32 v7, v30
    s_nop 1
    v_permlane32_swap_b32 v6, v7
    v_rcp_f32 v7, v6
    s_nop 1
    s_branch F_out
.section .rodata,"a"
.p2align 6
.amdhsa_kernel main_kernel
  .amdhsa_next_free_vgpr 512
  .amdhsa_next_free_sgpr 102
  .amdhsa_accum_offset 256
  .amdhsa_group_segment_fixed_size 0
  .amdhsa_kernarg_size 104
  .amdhsa_user_sgpr_count 2
  .amdhsa_user_sgpr_kernarg_segment_ptr 1
  .amdhsa_system_sgpr_workgroup_id_x 1
.end_amdhsa_kernel
.p2align 6
.amdhsa_kernel fin_kernel
  .amdhsa_next_free_vgpr 256
  .amdhsa_next_free_sgpr 102
  .amdhsa_accum_offset 112
  .amdhsa_group_segment_fixed_size 0
  .amdhsa_kernarg_size 104
  .amdhsa_user_sgpr_count 2
  .amdhsa_user_sgpr_kernarg_segment_ptr 1
  .amdhsa_system_sgpr_workgroup_id_x 1
.end_amdhsa_kernel
```
